```python
import torch

def _softmax(x, axis=-1):
    return torch.softmax(x, dim=axis)
def _gelu(x):
    return torch.nn.functional.gelu(x, approximate="tanh")
def _silu(x):
    return torch.nn.functional.silu(x)
def _sigmoid(x):
    return torch.sigmoid(x)
def _layernorm(x, axis=-1, eps=1e-5):
    m = x.mean(dim=axis, keepdim=True)
    v = x.var(dim=axis, keepdim=True, unbiased=False)
    return (x - m) / torch.sqrt(v + eps)
def _scatter_add(tgt, idx, src, axis=0):
    return tgt.clone().index_add_(axis, idx, src)
def _segment_sum(src, seg, n):
    out = torch.zeros((n,) + src.shape[1:], dtype=src.dtype)
    return out.index_add_(0, seg, src)
def _pad(x, pw):
    flat = tuple(v for pair in reversed(pw) for v in pair)
    return torch.nn.functional.pad(x, flat)

kernel_name = 'concat_heads__grouped_kv_mqa__spectral_gfnet__prompt'

def setup_inputs():

    _w = (lambda a: (lambda t: t.to(torch.bfloat16) if t.is_floating_point() else t)(torch.as_tensor(a)))
    def _A_setup():
        B, S, D, H = 1, 2048, 640, 32
        Dh = D // H
        return {
            "x": _w((lambda *s: torch.randn(*s, dtype=torch.bfloat16) * 0.05)(B, S, D)),
            "wq": _w((lambda *s: torch.randn(*s, dtype=torch.bfloat16) * 0.8)(D, H * Dh)),
            "wk": _w((lambda *s: torch.randn(*s, dtype=torch.bfloat16) * 0.8)(D, Dh)),
            "wv": _w((lambda *s: torch.randn(*s, dtype=torch.bfloat16) * 0.05)(D, Dh)),
            "wo": _w((lambda *s: torch.randn(*s, dtype=torch.bfloat16) * 0.05)(H * Dh, D)),
        }
    _A_in = _A_setup()

    def _B_setup():
        B, S, D = 1, 2048, 640
        Df = D // 2 + 1
        return {
            "x": _w((lambda *s: torch.randn(*s, dtype=torch.bfloat16) * 0.05)(B, S, D)),
            "w_r": _w((lambda *s: torch.randn(*s, dtype=torch.bfloat16) * 1.6)(S, Df) * 0.02),
            "w_i": _w((lambda *s: torch.randn(*s, dtype=torch.bfloat16) * 1.6)(S, Df) * 0.02),
        }
    _B_in = _B_setup()

    return {
        "A_x": _A_in["x"],
        "A_wq": _A_in["wq"],
        "A_wk": _A_in["wk"],
        "A_wv": _A_in["wv"],
        "A_wo": _A_in["wo"],
        "B_x": _B_in["x"],
        "B_w_r": _B_in["w_r"],
        "B_w_i": _B_in["w_i"],
    }

def reference(A_x, A_wq, A_wk, A_wv, A_wo, B_x, B_w_r, B_w_i):
    def _A_ref(x, wq, wk, wv, wo):
        B, S, D = x.shape
        H = 32
        Dh = D // H
        q = (lambda x, *d: x.permute(*d))((x @ wq).reshape(B, S, H, Dh), 0, 2, 1, 3)
        k = x @ wk
        v = x @ wv
        scores = torch.einsum("bhqd,bkd->bhqk", q, k) * (Dh ** -0.5)
        p = _softmax(scores, axis=-1)
        o = torch.einsum("bhqk,bkd->bhqd", p, v)
        return (lambda x, *d: x.permute(*d))(o, 0, 2, 1, 3).reshape(B, S, H * Dh) @ wo

    def _B_ref(x, w_r, w_i):
        B, S, D = x.shape
        X = (lambda x, axes=(-2,-1): torch.fft.rfft2(x.float(), dim=axes))(x, axes=(-2, -1))
        W = w_r + 1j * w_i
        X = X * W
        y = (lambda x, s, axes=(-2,-1): torch.fft.irfft2(x, s=s, dim=axes).to(torch.bfloat16))(X, (S, D), axes=(-2, -1))
        return y

    a = _A_ref(A_x, A_wq, A_wk, A_wv, A_wo)
    b = _B_ref(B_x, B_w_r, B_w_i)
    return torch.concatenate([a, b], axis=-1)
```

```asm
; @launch grid=(256,1,1) block=(576,1,1) lds=163840
.amdgcn_target "amdgcn-amd-amdhsa--gfx950"
.text
.globl concat_heads__grouped_kv_mqa__spectral_gfnet__prompt_kernel
.p2align 8
.type concat_heads__grouped_kv_mqa__spectral_gfnet__prompt_kernel,@function
concat_heads__grouped_kv_mqa__spectral_gfnet__prompt_kernel:
    s_cmp_ge_u32 s2, 256
    s_cbranch_scc1 L_exit
    s_load_dwordx16 s[16:31], s[0:1], 0
    s_load_dwordx4 s[32:35], s[0:1], 64
    s_load_dwordx2 s[36:37], s[0:1], 80
    v_lshrrev_b32 v1, 6, v0
    v_and_b32 v0, 63, v0
    v_readfirstlane_b32 s3, v1
    s_and_b32 s4, s2, 7
    s_lshr_b32 s5, s2, 3
    s_lshr_b32 s8, s5, 3
    s_lshl2_add_u32 s6, s4, s8
    s_and_b32 s7, s5, 7
    s_lshr_b32 s9, s7, 1
    v_mov_b32 v1, 163328
    v_mov_b32 v2, 1
    s_mov_b32 s76, 0x40000
    s_cmp_ge_u32 s3, 8
    s_cbranch_scc1 L_loader
    s_cmp_lt_u32 s3, 4
    s_cbranch_scc1 L_att
    s_setprio 3
    s_sub_u32 s10, s3, 4
    v_lshlrev_b32 v4, 4, v0
    v_lshrrev_b32 v5, 4, v0
    v_and_b32 v6, 15, v0
    s_and_b32 s56, s7, 1
    s_lshl2_add_u32 s12, s9, s10
    s_lshl_b32 s13, s12, 2
    v_add_u32 v7, s13, v5
    v_and_b32 v8, 15, v7
    v_xor_b32 v9, v8, v6
    v_mul_u32_u24 v7, 1280, v7
    v_lshlrev_b32 v9, 4, v9
    s_mul_i32 s13, s6, 81920
    v_add3_u32 v9, v7, v9, s13
    s_lshl_b32 s12, s12, 10
    s_lshl_b32 s13, s10, 10
    s_add_u32 m0, s13, 137728
    s_mov_b32 s14, s8
    s_mov_b32 s50, 25600
    s_mov_b32 s51, 0x20000
    s_mov_b32 s46, 2621440
    s_mov_b32 s47, 0x20000
    s_cmp_eq_u32 s56, 0
    s_waitcnt lgkmcnt(0)
    s_cselect_b32 s48, s20, s22
    s_cselect_b32 s49, s21, s23
    s_mov_b32 s44, s16
    s_mov_b32 s45, s17
    buffer_load_dwordx4 v4, s[48:51], s13 offen lds
    s_add_u32 m0, m0, 4096
    s_add_u32 s13, s13, 4096
    buffer_load_dwordx4 v4, s[48:51], s13 offen lds
    s_add_u32 m0, m0, 4096
    s_add_u32 s13, s13, 4096
    buffer_load_dwordx4 v4, s[48:51], s13 offen lds
    s_add_u32 m0, m0, 4096
    s_add_u32 s13, s13, 4096
    buffer_load_dwordx4 v4, s[48:51], s13 offen lds
    s_add_u32 m0, m0, 4096
    s_add_u32 s13, s13, 4096
    buffer_load_dwordx4 v4, s[48:51], s13 offen lds
    s_add_u32 m0, m0, 4096
    s_add_u32 s13, s13, 4096
    buffer_load_dwordx4 v4, s[48:51], s13 offen lds
    s_add_u32 m0, m0, 4096
    s_add_u32 s13, s13, 4096
    s_cmp_lg_u32 s10, 0
    s_cbranch_scc1 L_h_nw
    buffer_load_dwordx4 v4, s[48:51], s13 offen lds
L_h_nw:
    s_add_u32 m0, s12, 0
    s_lshl_b32 s15, s14, 8
    buffer_load_dwordx4 v9, s[44:47], s15 offen lds
    s_add_u32 s14, s14, 1
    s_cmp_eq_u32 s14, 5
    s_cselect_b32 s14, 0, s14
    s_add_u32 m0, s12, 16384
    s_lshl_b32 s15, s14, 8
    buffer_load_dwordx4 v9, s[44:47], s15 offen lds
    s_add_u32 s14, s14, 1
    s_cmp_eq_u32 s14, 5
    s_cselect_b32 s14, 0, s14
    s_add_u32 m0, s12, 32768
    s_lshl_b32 s15, s14, 8
    buffer_load_dwordx4 v9, s[44:47], s15 offen lds
    s_add_u32 s14, s14, 1
    s_cmp_eq_u32 s14, 5
    s_cselect_b32 s14, 0, s14
    s_add_u32 m0, s12, 49152
    s_lshl_b32 s15, s14, 8
    buffer_load_dwordx4 v9, s[44:47], s15 offen lds
    s_add_u32 s14, s14, 1
    s_cmp_eq_u32 s14, 5
    s_cselect_b32 s14, 0, s14
    s_add_u32 m0, s12, 65536
    s_lshl_b32 s15, s14, 8
    buffer_load_dwordx4 v9, s[44:47], s15 offen lds
    s_barrier
    s_load_dwordx2 s[38:39], s[36:37], 0
    s_mov_b32 s40, s36
    s_mov_b32 s41, s37
    s_mov_b32 s42, 0xa00000
    s_mov_b32 s43, 0x20000
    s_cmp_ge_u32 s10, 2
    s_cbranch_scc1 L_iss
    s_lshl_b32 s12, s9, 12
    v_lshlrev_b32 v12, 8, v6
    v_add_u32 v12, s12, v12
    v_or_b32 v13, 0, v5
    v_xor_b32 v13, v13, v6
    v_lshl_add_u32 v8, v13, 4, v12
    v_add_u32 v26, 65536, v8
    v_or_b32 v13, 4, v5
    v_xor_b32 v13, v13, v6
    v_lshl_add_u32 v9, v13, 4, v12
    v_add_u32 v27, 65536, v9
    v_or_b32 v13, 8, v5
    v_xor_b32 v13, v13, v6
    v_lshl_add_u32 v10, v13, 4, v12
    v_add_u32 v28, 65536, v10
    v_or_b32 v13, 12, v5
    v_xor_b32 v13, v13, v6
    v_lshl_add_u32 v11, v13, 4, v12
    v_add_u32 v29, 65536, v11
    v_bfe_u32 v12, v0, 2, 2
    v_lshl_add_u32 v12, v5, 3, v12
    v_mul_u32_u24 v12, 40, v12
    v_and_b32 v13, 3, v0
    v_lshlrev_b32 v13, 3, v13
    s_cmp_eq_u32 s10, 0
    s_cselect_b32 s12, -1, 0
    s_cselect_b32 s13, 0, 32
    s_add_u32 s13, s13, 137728
    v_and_b32 v13, s12, v13
    v_add3_u32 v13, v12, v13, s13
    s_mov_b32 s14, s8
    s_mul_i32 s15, s14, 5120
    v_add_u32 v20, s15, v13
    s_add_u32 s14, s14, 1
    s_cmp_eq_u32 s14, 5
    s_cselect_b32 s14, 0, s14
    s_mul_i32 s15, s14, 5120
    v_add_u32 v21, s15, v13
    s_add_u32 s14, s14, 1
    s_cmp_eq_u32 s14, 5
    s_cselect_b32 s14, 0, s14
    s_mul_i32 s15, s14, 5120
    v_add_u32 v22, s15, v13
    s_add_u32 s14, s14, 1
    s_cmp_eq_u32 s14, 5
    s_cselect_b32 s14, 0, s14
    s_mul_i32 s15, s14, 5120
    v_add_u32 v23, s15, v13
    s_add_u32 s14, s14, 1
    s_cmp_eq_u32 s14, 5
    s_cselect_b32 s14, 0, s14
    s_mul_i32 s15, s14, 5120
    v_add_u32 v24, s15, v13
    v_mov_b32 v80, 0
    v_mov_b32 v81, 0
    v_mov_b32 v82, 0
    v_mov_b32 v83, 0
    s_lshl_b32 s12, s6, 1
    s_lshr_b32 s13, s7, 2
    s_add_u32 s12, s12, s13
    s_mul_i32 s12, s12, 2688
    s_add_u32 s12, s12, 131072
    s_and_b32 s13, s9, 1
    v_lshrrev_b32 v14, 1, v5
    v_and_b32 v15, 1, v5
    s_mov_b64 s[68:69], 0
    v_mov_b32 v17, 0
    v_mov_b32 v18, 0
    s_cmp_lg_u32 s56, 0
    s_cbranch_scc1 L_h_va
    s_lshl_b32 s13, s13, 4
    v_add_u32 v16, s13, v6
    v_lshlrev_b32 v19, 4, v16
    v_lshl_add_u32 v19, v14, 9, v19
    v_lshl_add_u32 v19, v15, 3, v19
    v_lshlrev_b32 v16, 3, v16
    v_add_u32 v16, 1024, v16
    s_cmp_eq_u32 s10, 0
    s_cselect_b64 vcc, -1, 0
    s_cselect_b64 s[62:63], -1, 0xffff
    v_cndmask_b32 v16, v16, v19, vcc
    s_branch L_h_ad
L_h_va:
    s_mul_i32 s15, s13, 640
    s_add_u32 s15, s15, 1280
    v_lshlrev_b32 v16, 4, v6
    v_lshl_add_u32 v16, v15, 3, v16
    v_add_u32 v16, s15, v16
    v_lshl_add_u32 v19, v14, 8, v16
    v_lshl_add_u32 v16, v14, 6, v16
    v_add_u32 v16, 512, v16
    s_mov_b32 s62, 0x00ff00ff
    s_cmp_eq_u32 s13, 0
    s_cselect_b32 s62, s62, 0x000f000f
    s_cmp_eq_u32 s10, 0
    s_cselect_b64 vcc, -1, 0
    s_cselect_b32 s62, -1, s62
    s_mov_b32 s63, s62
    v_cndmask_b32 v16, v16, v19, vcc
    s_cbranch_scc1 L_h_ad
    v_subrev_u32 v14, 4, v6
    v_lshl_add_u32 v14, v14, 2, v5
    v_lshlrev_b32 v15, 3, v14
    v_add_u32 v15, 2560, v15
    v_cmp_lt_u32 s[68:69], 3, v6
    v_mov_b32 v19, 0x3f803f80
    v_mov_b32 v12, 0x3f80
    v_cmp_eq_u32 vcc, 0, v14
    v_lshrrev_b32 v14, 1, v14
    v_cndmask_b32 v16, v16, v15, s[68:69]
    v_cndmask_b32 v17, v17, v19, vcc
    v_cndmask_b32 v18, v18, v12, vcc
    v_cmp_eq_u32 vcc, 1, v14
    s_nop 1
    v_cndmask_b32 v17, v17, v19, vcc
    v_cndmask_b32 v18, v18, v19, vcc
L_h_ad:
    s_waitcnt lgkmcnt(0)
    s_mul_i32 s38, s38, 0x9E3779B1
    s_add_u32 s38, s38, 0x7F4A7C15
    s_mul_i32 s39, s39, 0x2C9277B5
    s_add_u32 s39, s39, 0x5851F42D
    s_waitcnt vmcnt(0)
    s_mov_b64 exec, 1
    ds_add_u32 v1, v2 offset:0
    s_mov_b64 exec, -1
L_w_1:
    ds_read_b32 v3, v1 offset:0
    s_waitcnt lgkmcnt(0)
    v_readfirstlane_b32 s60, v3
    s_nop 0
    s_cmp_ge_u32 s60, 4
    s_cbranch_scc1 L_wd_2
    s_cmp_eq_u32 s76, 0
    s_cbranch_scc1 L_wd_2
    s_sub_u32 s76, s76, 1
    s_sleep 0
    s_branch L_w_1
L_wd_2:
    s_cmp_lg_u32 s56, 0
    s_cbranch_scc1 L_h_vtype
    ds_read_b128 v[32:35], v8 offset:0
    ds_read_b64_tr_b16 v[36:37], v20 offset:0
    ds_read_b64_tr_b16 v[38:39], v20 offset:160
    ds_read_b128 v[40:43], v9 offset:0
    ds_read_b64_tr_b16 v[44:45], v20 offset:1280
    ds_read_b64_tr_b16 v[46:47], v20 offset:1440
    ds_read_b128 v[48:51], v10 offset:0
    ds_read_b64_tr_b16 v[52:53], v20 offset:2560
    ds_read_b64_tr_b16 v[54:55], v20 offset:2720
    ds_read_b128 v[56:59], v11 offset:0
    ds_read_b64_tr_b16 v[60:61], v20 offset:3840
    ds_read_b64_tr_b16 v[62:63], v20 offset:4000
    ds_read_b128 v[64:67], v8 offset:16384
    ds_read_b64_tr_b16 v[68:69], v21 offset:0
    ds_read_b64_tr_b16 v[70:71], v21 offset:160
    s_waitcnt lgkmcnt(12)
    v_mfma_f32_16x16x32_bf16 v[80:83], v[36:39], v[32:35], v[80:83]
    ds_read_b128 v[32:35], v9 offset:16384
    ds_read_b64_tr_b16 v[36:37], v21 offset:1280
    ds_read_b64_tr_b16 v[38:39], v21 offset:1440
    s_waitcnt lgkmcnt(12)
    v_mfma_f32_16x16x32_bf16 v[80:83], v[44:47], v[40:43], v[80:83]
    ds_read_b128 v[40:43], v10 offset:16384
    ds_read_b64_tr_b16 v[44:45], v21 offset:2560
    ds_read_b64_tr_b16 v[46:47], v21 offset:2720
    s_waitcnt lgkmcnt(12)
    v_mfma_f32_16x16x32_bf16 v[80:83], v[52:55], v[48:51], v[80:83]
    ds_read_b128 v[48:51], v11 offset:16384
    ds_read_b64_tr_b16 v[52:53], v21 offset:3840
    ds_read_b64_tr_b16 v[54:55], v21 offset:4000
    s_waitcnt lgkmcnt(12)
    v_mfma_f32_16x16x32_bf16 v[80:83], v[60:63], v[56:59], v[80:83]
    ds_read_b128 v[56:59], v8 offset:32768
    ds_read_b64_tr_b16 v[60:61], v22 offset:0
    ds_read_b64_tr_b16 v[62:63], v22 offset:160
    s_waitcnt lgkmcnt(12)
    v_mfma_f32_16x16x32_bf16 v[80:83], v[68:71], v[64:67], v[80:83]
    ds_read_b128 v[64:67], v9 offset:32768
    ds_read_b64_tr_b16 v[68:69], v22 offset:1280
    ds_read_b64_tr_b16 v[70:71], v22 offset:1440
    s_waitcnt lgkmcnt(12)
    v_mfma_f32_16x16x32_bf16 v[80:83], v[36:39], v[32:35], v[80:83]
    ds_read_b128 v[32:35], v10 offset:32768
    ds_read_b64_tr_b16 v[36:37], v22 offset:2560
    ds_read_b64_tr_b16 v[38:39], v22 offset:2720
    s_waitcnt lgkmcnt(12)
    v_mfma_f32_16x16x32_bf16 v[80:83], v[44:47], v[40:43], v[80:83]
    ds_read_b128 v[40:43], v11 offset:32768
    ds_read_b64_tr_b16 v[44:45], v22 offset:3840
    ds_read_b64_tr_b16 v[46:47], v22 offset:4000
    s_waitcnt lgkmcnt(12)
    v_mfma_f32_16x16x32_bf16 v[80:83], v[52:55], v[48:51], v[80:83]
    ds_read_b128 v[48:51], v8 offset:49152
    ds_read_b64_tr_b16 v[52:53], v23 offset:0
    ds_read_b64_tr_b16 v[54:55], v23 offset:160
    s_waitcnt lgkmcnt(12)
    v_mfma_f32_16x16x32_bf16 v[80:83], v[60:63], v[56:59], v[80:83]
    ds_read_b128 v[56:59], v9 offset:49152
    ds_read_b64_tr_b16 v[60:61], v23 offset:1280
    ds_read_b64_tr_b16 v[62:63], v23 offset:1440
    s_waitcnt lgkmcnt(12)
    v_mfma_f32_16x16x32_bf16 v[80:83], v[68:71], v[64:67], v[80:83]
    ds_read_b128 v[64:67], v10 offset:49152
    ds_read_b64_tr_b16 v[68:69], v23 offset:2560
    ds_read_b64_tr_b16 v[70:71], v23 offset:2720
    s_waitcnt lgkmcnt(12)
    v_mfma_f32_16x16x32_bf16 v[80:83], v[36:39], v[32:35], v[80:83]
    ds_read_b128 v[32:35], v11 offset:49152
    ds_read_b64_tr_b16 v[36:37], v23 offset:3840
    ds_read_b64_tr_b16 v[38:39], v23 offset:4000
    s_waitcnt lgkmcnt(12)
    v_mfma_f32_16x16x32_bf16 v[80:83], v[44:47], v[40:43], v[80:83]
    ds_read_b128 v[40:43], v26 offset:0
    ds_read_b64_tr_b16 v[44:45], v24 offset:0
    ds_read_b64_tr_b16 v[46:47], v24 offset:160
    s_waitcnt lgkmcnt(12)
    v_mfma_f32_16x16x32_bf16 v[80:83], v[52:55], v[48:51], v[80:83]
    ds_read_b128 v[48:51], v27 offset:0
    ds_read_b64_tr_b16 v[52:53], v24 offset:1280
    ds_read_b64_tr_b16 v[54:55], v24 offset:1440
    s_waitcnt lgkmcnt(12)
    v_mfma_f32_16x16x32_bf16 v[80:83], v[60:63], v[56:59], v[80:83]
    ds_read_b128 v[56:59], v28 offset:0
    ds_read_b64_tr_b16 v[60:61], v24 offset:2560
    ds_read_b64_tr_b16 v[62:63], v24 offset:2720
    s_waitcnt lgkmcnt(12)
    v_mfma_f32_16x16x32_bf16 v[80:83], v[68:71], v[64:67], v[80:83]
    ds_read_b128 v[64:67], v29 offset:0
    ds_read_b64_tr_b16 v[68:69], v24 offset:3840
    ds_read_b64_tr_b16 v[70:71], v24 offset:4000
    s_waitcnt lgkmcnt(12)
    v_mfma_f32_16x16x32_bf16 v[80:83], v[36:39], v[32:35], v[80:83]
    s_mov_b64 exec, 1
    ds_add_u32 v1, v2 offset:4
    s_mov_b64 exec, -1
    s_waitcnt lgkmcnt(10)
    v_mfma_f32_16x16x32_bf16 v[80:83], v[44:47], v[40:43], v[80:83]
    s_waitcnt lgkmcnt(7)
    v_mfma_f32_16x16x32_bf16 v[80:83], v[52:55], v[48:51], v[80:83]
    s_waitcnt lgkmcnt(4)
    v_mfma_f32_16x16x32_bf16 v[80:83], v[60:63], v[56:59], v[80:83]
    s_waitcnt lgkmcnt(1)
    v_mfma_f32_16x16x32_bf16 v[80:83], v[68:71], v[64:67], v[80:83]
    s_nop 7
    v_mul_f32 v80, 0x3ea52b5c, v80
    v_mul_f32 v81, 0x3ea52b5c, v81
    v_mul_f32 v82, 0x3ea52b5c, v82
    v_mul_f32 v83, 0x3ea52b5c, v83
    v_cvt_pk_bf16_f32 v14, v80, v81
    v_cvt_pk_bf16_f32 v15, v82, v83
    s_branch L_h_kvst
L_h_vtype:
    ds_read_b128 v[32:35], v8 offset:0
    ds_read_b64_tr_b16 v[36:37], v20 offset:0
    ds_read_b64_tr_b16 v[38:39], v20 offset:160
    ds_read_b128 v[40:43], v9 offset:0
    ds_read_b64_tr_b16 v[44:45], v20 offset:1280
    ds_read_b64_tr_b16 v[46:47], v20 offset:1440
    ds_read_b128 v[48:51], v10 offset:0
    ds_read_b64_tr_b16 v[52:53], v20 offset:2560
    ds_read_b64_tr_b16 v[54:55], v20 offset:2720
    ds_read_b128 v[56:59], v11 offset:0
    ds_read_b64_tr_b16 v[60:61], v20 offset:3840
    ds_read_b64_tr_b16 v[62:63], v20 offset:4000
    ds_read_b128 v[64:67], v8 offset:16384
    ds_read_b64_tr_b16 v[68:69], v21 offset:0
    ds_read_b64_tr_b16 v[70:71], v21 offset:160
    s_waitcnt lgkmcnt(12)
    v_mfma_f32_16x16x32_bf16 v[80:83], v[32:35], v[36:39], v[80:83]
    ds_read_b128 v[32:35], v9 offset:16384
    ds_read_b64_tr_b16 v[36:37], v21 offset:1280
    ds_read_b64_tr_b16 v[38:39], v21 offset:1440
    s_waitcnt lgkmcnt(12)
    v_mfma_f32_16x16x32_bf16 v[80:83], v[40:43], v[44:47], v[80:83]
    ds_read_b128 v[40:43], v10 offset:16384
    ds_read_b64_tr_b16 v[44:45], v21 offset:2560
    ds_read_b64_tr_b16 v[46:47], v21 offset:2720
    s_waitcnt lgkmcnt(12)
    v_mfma_f32_16x16x32_bf16 v[80:83], v[48:51], v[52:55], v[80:83]
    ds_read_b128 v[48:51], v11 offset:16384
    ds_read_b64_tr_b16 v[52:53], v21 offset:3840
    ds_read_b64_tr_b16 v[54:55], v21 offset:4000
    s_waitcnt lgkmcnt(12)
    v_mfma_f32_16x16x32_bf16 v[80:83], v[56:59], v[60:63], v[80:83]
    ds_read_b128 v[56:59], v8 offset:32768
    ds_read_b64_tr_b16 v[60:61], v22 offset:0
    ds_read_b64_tr_b16 v[62:63], v22 offset:160
    s_waitcnt lgkmcnt(12)
    v_mfma_f32_16x16x32_bf16 v[80:83], v[64:67], v[68:71], v[80:83]
    ds_read_b128 v[64:67], v9 offset:32768
    ds_read_b64_tr_b16 v[68:69], v22 offset:1280
    ds_read_b64_tr_b16 v[70:71], v22 offset:1440
    s_waitcnt lgkmcnt(12)
    v_mfma_f32_16x16x32_bf16 v[80:83], v[32:35], v[36:39], v[80:83]
    ds_read_b128 v[32:35], v10 offset:32768
    ds_read_b64_tr_b16 v[36:37], v22 offset:2560
    ds_read_b64_tr_b16 v[38:39], v22 offset:2720
    s_waitcnt lgkmcnt(12)
    v_mfma_f32_16x16x32_bf16 v[80:83], v[40:43], v[44:47], v[80:83]
    ds_read_b128 v[40:43], v11 offset:32768
    ds_read_b64_tr_b16 v[44:45], v22 offset:3840
    ds_read_b64_tr_b16 v[46:47], v22 offset:4000
    s_waitcnt lgkmcnt(12)
    v_mfma_f32_16x16x32_bf16 v[80:83], v[48:51], v[52:55], v[80:83]
    ds_read_b128 v[48:51], v8 offset:49152
    ds_read_b64_tr_b16 v[52:53], v23 offset:0
    ds_read_b64_tr_b16 v[54:55], v23 offset:160
    s_waitcnt lgkmcnt(12)
    v_mfma_f32_16x16x32_bf16 v[80:83], v[56:59], v[60:63], v[80:83]
    ds_read_b128 v[56:59], v9 offset:49152
    ds_read_b64_tr_b16 v[60:61], v23 offset:1280
    ds_read_b64_tr_b16 v[62:63], v23 offset:1440
    s_waitcnt lgkmcnt(12)
    v_mfma_f32_16x16x32_bf16 v[80:83], v[64:67], v[68:71], v[80:83]
    ds_read_b128 v[64:67], v10 offset:49152
    ds_read_b64_tr_b16 v[68:69], v23 offset:2560
    ds_read_b64_tr_b16 v[70:71], v23 offset:2720
    s_waitcnt lgkmcnt(12)
    v_mfma_f32_16x16x32_bf16 v[80:83], v[32:35], v[36:39], v[80:83]
    ds_read_b128 v[32:35], v11 offset:49152
    ds_read_b64_tr_b16 v[36:37], v23 offset:3840
    ds_read_b64_tr_b16 v[38:39], v23 offset:4000
    s_waitcnt lgkmcnt(12)
    v_mfma_f32_16x16x32_bf16 v[80:83], v[40:43], v[44:47], v[80:83]
    ds_read_b128 v[40:43], v26 offset:0
    ds_read_b64_tr_b16 v[44:45], v24 offset:0
    ds_read_b64_tr_b16 v[46:47], v24 offset:160
    s_waitcnt lgkmcnt(12)
    v_mfma_f32_16x16x32_bf16 v[80:83], v[48:51], v[52:55], v[80:83]
    ds_read_b128 v[48:51], v27 offset:0
    ds_read_b64_tr_b16 v[52:53], v24 offset:1280
    ds_read_b64_tr_b16 v[54:55], v24 offset:1440
    s_waitcnt lgkmcnt(12)
    v_mfma_f32_16x16x32_bf16 v[80:83], v[56:59], v[60:63], v[80:83]
    ds_read_b128 v[56:59], v28 offset:0
    ds_read_b64_tr_b16 v[60:61], v24 offset:2560
    ds_read_b64_tr_b16 v[62:63], v24 offset:2720
    s_waitcnt lgkmcnt(12)
    v_mfma_f32_16x16x32_bf16 v[80:83], v[64:67], v[68:71], v[80:83]
    ds_read_b128 v[64:67], v29 offset:0
    ds_read_b64_tr_b16 v[68:69], v24 offset:3840
    ds_read_b64_tr_b16 v[70:71], v24 offset:4000
    s_waitcnt lgkmcnt(12)
    v_mfma_f32_16x16x32_bf16 v[80:83], v[32:35], v[36:39], v[80:83]
    s_mov_b64 exec, 1
    ds_add_u32 v1, v2 offset:4
    s_mov_b64 exec, -1
    s_waitcnt lgkmcnt(10)
    v_mfma_f32_16x16x32_bf16 v[80:83], v[40:43], v[44:47], v[80:83]
    s_waitcnt lgkmcnt(7)
    v_mfma_f32_16x16x32_bf16 v[80:83], v[48:51], v[52:55], v[80:83]
    s_waitcnt lgkmcnt(4)
    v_mfma_f32_16x16x32_bf16 v[80:83], v[56:59], v[60:63], v[80:83]
    s_waitcnt lgkmcnt(1)
    v_mfma_f32_16x16x32_bf16 v[80:83], v[64:67], v[68:71], v[80:83]
    s_nop 7
    v_cvt_pk_bf16_f32 v14, v80, v81
    v_cvt_pk_bf16_f32 v15, v82, v83
    v_cndmask_b32 v14, v14, v17, s[68:69]
    v_cndmask_b32 v15, v15, v18, s[68:69]
L_h_kvst:
    s_mov_b64 exec, s[62:63]
    buffer_store_dwordx2 v[14:15], v16, s[40:43], s12 offen sc1
    s_mov_b64 exec, -1
    s_lshl_b32 s12, s6, 3
    s_add_u32 s12, s12, s7
    s_lshl_b32 s12, s12, 6
    s_add_u32 s12, s12, 4096
    s_waitcnt vmcnt(0)
    s_cmp_eq_u32 s10, 0
    s_cbranch_scc1 L_h_kvf
    s_mov_b64 exec, 1
    ds_add_u32 v1, v2 offset:52
    s_mov_b64 exec, -1
    s_branch L_h_kvd
L_h_kvf:
L_w_3:
    ds_read_b32 v3, v1 offset:52
    s_waitcnt lgkmcnt(0)
    v_readfirstlane_b32 s60, v3
    s_nop 0
    s_cmp_ge_u32 s60, 1
    s_cbranch_scc1 L_wd_4
    s_cmp_eq_u32 s76, 0
    s_cbranch_scc1 L_wd_4
    s_sub_u32 s76, s76, 1
    s_sleep 0
    s_branch L_w_3
L_wd_4:
    v_mov_b32 v16, s38
    v_mov_b32 v17, s39
    v_mov_b32 v18, 0
    s_mov_b64 exec, 1
    buffer_store_dwordx2 v[16:17], v18, s[40:43], s12 offen sc1
    s_mov_b64 exec, -1
L_h_kvd:
    s_setprio 1
    s_lshl_b32 s14, s10, 3
    v_lshrrev_b32 v24, 4, v0
    v_and_b32 v25, 15, v0
    v_add_u32 v24, s14, v24
    s_mul_i32 s13, s6, 81920
    v_add_u32 v26, 0, v24
    v_xor_b32 v27, v26, v25
    v_mul_u32_u24 v26, 1280, v26
    v_lshlrev_b32 v27, 4, v27
    v_add3_u32 v32, v26, v27, s13
    v_add_u32 v26, 4, v24
    v_xor_b32 v27, v26, v25
    v_mul_u32_u24 v26, 1280, v26
    v_lshlrev_b32 v27, 4, v27
    v_add3_u32 v33, v26, v27, s13
    v_subrev_u32 v33, 1024, v33
    s_mul_i32 s12, s7, 160
    s_and_b32 s12, s12, 0xffffffc0
    v_add_u32 v26, 0, v0
    v_mul_u32_u24 v27, 43691, v26
    v_lshrrev_b32 v27, 19, v27
    v_mul_u32_u24 v28, 12, v27
    v_sub_u32 v28, v26, v28
    v_mul_u32_u24 v27, 1280, v27
    v_lshlrev_b32 v28, 4, v28
    v_add3_u32 v36, v27, v28, s12
    v_add_u32 v26, 64, v0
    v_mul_u32_u24 v27, 43691, v26
    v_lshrrev_b32 v27, 19, v27
    v_mul_u32_u24 v28, 12, v27
    v_sub_u32 v28, v26, v28
    v_mul_u32_u24 v27, 1280, v27
    v_lshlrev_b32 v28, 4, v28
    v_add3_u32 v37, v27, v28, s12
    v_subrev_u32 v37, 1024, v37
    v_add_u32 v26, 128, v0
    v_mul_u32_u24 v27, 43691, v26
    v_lshrrev_b32 v27, 19, v27
    v_mul_u32_u24 v28, 12, v27
    v_sub_u32 v28, v26, v28
    v_mul_u32_u24 v27, 1280, v27
    v_lshlrev_b32 v28, 4, v28
    v_add3_u32 v38, v27, v28, s12
    v_subrev_u32 v38, 2048, v38
    s_mov_b32 s44, s16
    s_mov_b32 s45, s17
    s_mov_b32 s46, 0x280000
    s_mov_b32 s47, 0x20000
    s_mov_b32 s48, s18
    s_mov_b32 s49, s19
    s_mov_b32 s50, 0xc8000
    s_mov_b32 s51, 0x20000
    s_lshl_b32 s14, s10, 11
    s_mul_i32 s57, s10, 12288
    s_mul_i32 s58, s10, 81920
    s_add_u32 s12, s8, 4
    s_cmp_ge_u32 s12, 5
    s_cselect_b32 s13, 5, 0
    s_sub_u32 s12, s12, s13
    s_lshl_b32 s15, s12, 8
    s_cmp_eq_u32 s9, 0
    s_cbranch_scc1 L_us_5
    s_add_u32 m0, s14, 65536
    s_add_u32 s13, s15, 0
    buffer_load_dwordx4 v32, s[44:47], s13 offen offset:0 lds
    buffer_load_dwordx4 v33, s[44:47], s13 offen offset:1024 lds
L_us_5:
    s_cmp_eq_u32 s9, 1
    s_cbranch_scc1 L_us_6
    s_add_u32 m0, s14, 69632
    s_add_u32 s13, s15, 20480
    buffer_load_dwordx4 v32, s[44:47], s13 offen offset:0 lds
    buffer_load_dwordx4 v33, s[44:47], s13 offen offset:1024 lds
L_us_6:
    s_cmp_eq_u32 s9, 2
    s_cbranch_scc1 L_us_7
    s_add_u32 m0, s14, 73728
    s_add_u32 s13, s15, 40960
    buffer_load_dwordx4 v32, s[44:47], s13 offen offset:0 lds
    buffer_load_dwordx4 v33, s[44:47], s13 offen offset:1024 lds
L_us_7:
    s_cmp_eq_u32 s9, 3
    s_cbranch_scc1 L_us_8
    s_add_u32 m0, s14, 77824
    s_add_u32 s13, s15, 61440
    buffer_load_dwordx4 v32, s[44:47], s13 offen offset:0 lds
    buffer_load_dwordx4 v33, s[44:47], s13 offen offset:1024 lds
L_us_8:
L_w_9:
    ds_read_b128 v[20:23], v1 offset:64
    s_waitcnt lgkmcnt(0)
    v_min3_u32 v20, v20, v21, v22
    v_min_u32 v20, v20, v23
    s_nop 0
    v_readfirstlane_b32 s60, v20
    s_nop 0
    s_cmp_ge_u32 s60, 2
    s_cbranch_scc1 L_wd_10
    s_cmp_eq_u32 s76, 0
    s_cbranch_scc1 L_wd_10
    s_sub_u32 s76, s76, 1
    s_sleep 0
    s_branch L_w_9
L_wd_10:
    s_mul_i32 s13, s12, 163840
    s_add_u32 m0, s57, 106496
    s_add_u32 s13, s13, s58
    buffer_load_dwordx4 v36, s[48:51], s13 offen offset:0 lds
    buffer_load_dwordx4 v37, s[48:51], s13 offen offset:1024 lds
    buffer_load_dwordx4 v38, s[48:51], s13 offen offset:2048 lds
    s_add_u32 m0, m0, 3072
    s_add_u32 s13, s13, 20480
    buffer_load_dwordx4 v36, s[48:51], s13 offen offset:0 lds
    buffer_load_dwordx4 v37, s[48:51], s13 offen offset:1024 lds
    buffer_load_dwordx4 v38, s[48:51], s13 offen offset:2048 lds
    s_add_u32 m0, m0, 3072
    s_add_u32 s13, s13, 20480
    buffer_load_dwordx4 v36, s[48:51], s13 offen offset:0 lds
    buffer_load_dwordx4 v37, s[48:51], s13 offen offset:1024 lds
    buffer_load_dwordx4 v38, s[48:51], s13 offen offset:2048 lds
    s_add_u32 m0, m0, 3072
    s_add_u32 s13, s13, 20480
    buffer_load_dwordx4 v36, s[48:51], s13 offen offset:0 lds
    buffer_load_dwordx4 v37, s[48:51], s13 offen offset:1024 lds
    buffer_load_dwordx4 v38, s[48:51], s13 offen offset:2048 lds
    s_waitcnt vmcnt(0)
    s_mov_b64 exec, 1
    ds_add_u32 v1, v2 offset:48
    s_mov_b64 exec, -1
    s_branch L_h_b1
L_iss:
    s_setprio 1
    s_and_b32 s56, s3, 1
    s_lshl_b32 s14, s56, 3
    v_lshrrev_b32 v24, 4, v0
    v_and_b32 v25, 15, v0
    v_add_u32 v24, s14, v24
    s_mul_i32 s13, s6, 81920
    v_add_u32 v26, 0, v24
    v_xor_b32 v27, v26, v25
    v_mul_u32_u24 v26, 1280, v26
    v_lshlrev_b32 v27, 4, v27
    v_add3_u32 v32, v26, v27, s13
    v_add_u32 v26, 4, v24
    v_xor_b32 v27, v26, v25
    v_mul_u32_u24 v26, 1280, v26
    v_lshlrev_b32 v27, 4, v27
    v_add3_u32 v33, v26, v27, s13
    v_subrev_u32 v33, 1024, v33
    s_mul_i32 s12, s7, 160
    s_and_b32 s12, s12, 0xffffffc0
    v_add_u32 v26, 0, v0
    v_mul_u32_u24 v27, 43691, v26
    v_lshrrev_b32 v27, 19, v27
    v_mul_u32_u24 v28, 12, v27
    v_sub_u32 v28, v26, v28
    v_mul_u32_u24 v27, 1280, v27
    v_lshlrev_b32 v28, 4, v28
    v_add3_u32 v36, v27, v28, s12
    v_add_u32 v26, 64, v0
    v_mul_u32_u24 v27, 43691, v26
    v_lshrrev_b32 v27, 19, v27
    v_mul_u32_u24 v28, 12, v27
    v_sub_u32 v28, v26, v28
    v_mul_u32_u24 v27, 1280, v27
    v_lshlrev_b32 v28, 4, v28
    v_add3_u32 v37, v27, v28, s12
    v_subrev_u32 v37, 1024, v37
    v_add_u32 v26, 128, v0
    v_mul_u32_u24 v27, 43691, v26
    v_lshrrev_b32 v27, 19, v27
    v_mul_u32_u24 v28, 12, v27
    v_sub_u32 v28, v26, v28
    v_mul_u32_u24 v27, 1280, v27
    v_lshlrev_b32 v28, 4, v28
    v_add3_u32 v38, v27, v28, s12
    v_subrev_u32 v38, 2048, v38
    s_mov_b32 s44, s16
    s_mov_b32 s45, s17
    s_mov_b32 s46, 0x280000
    s_mov_b32 s47, 0x20000
    s_mov_b32 s48, s18
    s_mov_b32 s49, s19
    s_mov_b32 s50, 0xc8000
    s_mov_b32 s51, 0x20000
    s_lshl_b32 s14, s56, 11
    s_mul_i32 s57, s56, 12288
    s_mul_i32 s58, s56, 81920
    s_waitcnt vmcnt(0)
    s_mov_b64 exec, 1
    ds_add_u32 v1, v2 offset:0
    s_mov_b64 exec, -1
L_w_11:
    ds_read_b32 v3, v1 offset:28
    s_waitcnt lgkmcnt(0)
    v_readfirstlane_b32 s60, v3
    s_nop 0
    s_cmp_ge_u32 s60, 4
    s_cbranch_scc1 L_wd_12
    s_cmp_eq_u32 s76, 0
    s_cbranch_scc1 L_wd_12
    s_sub_u32 s76, s76, 1
    s_sleep 0
    s_branch L_w_11
L_wd_12:
    s_add_u32 s12, s8, 1
    s_cmp_ge_u32 s12, 5
    s_cselect_b32 s13, 5, 0
    s_sub_u32 s12, s12, s13
    s_lshl_b32 s15, s12, 8
    s_cmp_eq_u32 s9, 0
    s_cbranch_scc1 L_us_13
    s_add_u32 m0, s14, 16384
    s_add_u32 s13, s15, 0
    buffer_load_dwordx4 v32, s[44:47], s13 offen offset:0 lds
    buffer_load_dwordx4 v33, s[44:47], s13 offen offset:1024 lds
L_us_13:
    s_cmp_eq_u32 s9, 1
    s_cbranch_scc1 L_us_14
    s_add_u32 m0, s14, 20480
    s_add_u32 s13, s15, 20480
    buffer_load_dwordx4 v32, s[44:47], s13 offen offset:0 lds
    buffer_load_dwordx4 v33, s[44:47], s13 offen offset:1024 lds
L_us_14:
    s_cmp_eq_u32 s9, 2
    s_cbranch_scc1 L_us_15
    s_add_u32 m0, s14, 24576
    s_add_u32 s13, s15, 40960
    buffer_load_dwordx4 v32, s[44:47], s13 offen offset:0 lds
    buffer_load_dwordx4 v33, s[44:47], s13 offen offset:1024 lds
L_us_15:
    s_cmp_eq_u32 s9, 3
    s_cbranch_scc1 L_us_16
    s_add_u32 m0, s14, 28672
    s_add_u32 s13, s15, 61440
    buffer_load_dwordx4 v32, s[44:47], s13 offen offset:0 lds
    buffer_load_dwordx4 v33, s[44:47], s13 offen offset:1024 lds
L_us_16:
    s_mul_i32 s13, s12, 163840
    s_add_u32 m0, s57, 106496
    s_add_u32 s13, s13, s58
    buffer_load_dwordx4 v36, s[48:51], s13 offen offset:0 lds
    buffer_load_dwordx4 v37, s[48:51], s13 offen offset:1024 lds
    buffer_load_dwordx4 v38, s[48:51], s13 offen offset:2048 lds
    s_add_u32 m0, m0, 3072
    s_add_u32 s13, s13, 20480
    buffer_load_dwordx4 v36, s[48:51], s13 offen offset:0 lds
    buffer_load_dwordx4 v37, s[48:51], s13 offen offset:1024 lds
    buffer_load_dwordx4 v38, s[48:51], s13 offen offset:2048 lds
    s_add_u32 m0, m0, 3072
    s_add_u32 s13, s13, 20480
    buffer_load_dwordx4 v36, s[48:51], s13 offen offset:0 lds
    buffer_load_dwordx4 v37, s[48:51], s13 offen offset:1024 lds
    buffer_load_dwordx4 v38, s[48:51], s13 offen offset:2048 lds
    s_add_u32 m0, m0, 3072
    s_add_u32 s13, s13, 20480
    buffer_load_dwordx4 v36, s[48:51], s13 offen offset:0 lds
    buffer_load_dwordx4 v37, s[48:51], s13 offen offset:1024 lds
    buffer_load_dwordx4 v38, s[48:51], s13 offen offset:2048 lds
    s_mov_b64 exec, 1
    ds_add_u32 v1, v2 offset:28
    s_mov_b64 exec, -1
    s_waitcnt vmcnt(0)
    s_mov_b64 exec, 1
    ds_add_u32 v1, v2 offset:36
    s_mov_b64 exec, -1
    s_add_u32 s12, s8, 3
    s_cmp_ge_u32 s12, 5
    s_cselect_b32 s13, 5, 0
    s_sub_u32 s12, s12, s13
    s_lshl_b32 s15, s12, 8
    s_cmp_eq_u32 s9, 0
    s_cbranch_scc1 L_us_17
    s_add_u32 m0, s14, 49152
    s_add_u32 s13, s15, 0
    buffer_load_dwordx4 v32, s[44:47], s13 offen offset:0 lds
    buffer_load_dwordx4 v33, s[44:47], s13 offen offset:1024 lds
L_us_17:
    s_cmp_eq_u32 s9, 1
    s_cbranch_scc1 L_us_18
    s_add_u32 m0, s14, 53248
    s_add_u32 s13, s15, 20480
    buffer_load_dwordx4 v32, s[44:47], s13 offen offset:0 lds
    buffer_load_dwordx4 v33, s[44:47], s13 offen offset:1024 lds
L_us_18:
    s_cmp_eq_u32 s9, 2
    s_cbranch_scc1 L_us_19
    s_add_u32 m0, s14, 57344
    s_add_u32 s13, s15, 40960
    buffer_load_dwordx4 v32, s[44:47], s13 offen offset:0 lds
    buffer_load_dwordx4 v33, s[44:47], s13 offen offset:1024 lds
L_us_19:
    s_cmp_eq_u32 s9, 3
    s_cbranch_scc1 L_us_20
    s_add_u32 m0, s14, 61440
    s_add_u32 s13, s15, 61440
    buffer_load_dwordx4 v32, s[44:47], s13 offen offset:0 lds
    buffer_load_dwordx4 v33, s[44:47], s13 offen offset:1024 lds
L_us_20:
L_w_21:
    ds_read_b128 v[20:23], v1 offset:64
    s_waitcnt lgkmcnt(0)
    v_min3_u32 v20, v20, v21, v22
    v_min_u32 v20, v20, v23
    s_nop 0
    v_readfirstlane_b32 s60, v20
    s_nop 0
    s_cmp_ge_u32 s60, 1
    s_cbranch_scc1 L_wd_22
    s_cmp_eq_u32 s76, 0
    s_cbranch_scc1 L_wd_22
    s_sub_u32 s76, s76, 1
    s_sleep 0
    s_branch L_w_21
L_wd_22:
    s_mul_i32 s13, s12, 163840
    s_add_u32 m0, s57, 81920
    s_add_u32 s13, s13, s58
    buffer_load_dwordx4 v36, s[48:51], s13 offen offset:0 lds
    buffer_load_dwordx4 v37, s[48:51], s13 offen offset:1024 lds
    buffer_load_dwordx4 v38, s[48:51], s13 offen offset:2048 lds
    s_add_u32 m0, m0, 3072
    s_add_u32 s13, s13, 20480
    buffer_load_dwordx4 v36, s[48:51], s13 offen offset:0 lds
    buffer_load_dwordx4 v37, s[48:51], s13 offen offset:1024 lds
    buffer_load_dwordx4 v38, s[48:51], s13 offen offset:2048 lds
    s_add_u32 m0, m0, 3072
    s_add_u32 s13, s13, 20480
    buffer_load_dwordx4 v36, s[48:51], s13 offen offset:0 lds
    buffer_load_dwordx4 v37, s[48:51], s13 offen offset:1024 lds
    buffer_load_dwordx4 v38, s[48:51], s13 offen offset:2048 lds
    s_add_u32 m0, m0, 3072
    s_add_u32 s13, s13, 20480
    buffer_load_dwordx4 v36, s[48:51], s13 offen offset:0 lds
    buffer_load_dwordx4 v37, s[48:51], s13 offen offset:1024 lds
    buffer_load_dwordx4 v38, s[48:51], s13 offen offset:2048 lds
    s_waitcnt vmcnt(0)
    s_mov_b64 exec, 1
    ds_add_u32 v1, v2 offset:44
    s_mov_b64 exec, -1
    s_waitcnt lgkmcnt(0)
    s_mul_i32 s38, s38, 0x9E3779B1
    s_add_u32 s38, s38, 0x7F4A7C15
    s_mul_i32 s39, s39, 0x2C9277B5
    s_add_u32 s39, s39, 0x5851F42D
    s_branch L_h_b1
L_att:
    s_and_b32 s10, s3, 1
    s_lshr_b32 s11, s3, 1
    s_lshl_b32 s12, s3, 2
    v_add_u32 v145, s12, v1
    v_lshrrev_b32 v4, 4, v0
    v_and_b32 v5, 15, v0
    v_add_u32 v4, s12, v4
    v_xor_b32 v5, v4, v5
    v_mul_u32_u24 v4, 1280, v4
    v_lshlrev_b32 v5, 4, v5
    s_mul_i32 s13, s6, 81920
    v_add3_u32 v148, v4, v5, s13
    s_mul_i32 s12, s7, 160
    s_and_b32 s12, s12, 0xffffffc0
    v_add_u32 v4, 0, v0
    v_mul_u32_u24 v5, 43691, v4
    v_lshrrev_b32 v5, 19, v5
    v_mul_u32_u24 v6, 12, v5
    v_sub_u32 v6, v4, v6
    v_mul_u32_u24 v5, 1280, v5
    v_lshlrev_b32 v6, 4, v6
    v_add3_u32 v149, v5, v6, s12
    v_add_u32 v4, 64, v0
    v_mul_u32_u24 v5, 43691, v4
    v_lshrrev_b32 v5, 19, v5
    v_mul_u32_u24 v6, 12, v5
    v_sub_u32 v6, v4, v6
    v_mul_u32_u24 v5, 1280, v5
    v_lshlrev_b32 v6, 4, v6
    v_add3_u32 v150, v5, v6, s12
    v_subrev_u32 v150, 1024, v150
    v_add_u32 v4, 128, v0
    v_mul_u32_u24 v5, 43691, v4
    v_lshrrev_b32 v5, 19, v5
    v_mul_u32_u24 v6, 12, v5
    v_sub_u32 v6, v4, v6
    v_mul_u32_u24 v5, 1280, v5
    v_lshlrev_b32 v6, 4, v6
    v_add3_u32 v151, v5, v6, s12
    v_subrev_u32 v151, 2048, v151
    s_waitcnt lgkmcnt(0)
    s_mov_b32 s44, s16
    s_mov_b32 s45, s17
    s_mov_b32 s46, 0x280000
    s_mov_b32 s47, 0x20000
    s_mov_b32 s48, s18
    s_mov_b32 s49, s19
    s_mov_b32 s50, 0xc8000
    s_mov_b32 s51, 0x20000
    s_mov_b32 s40, s36
    s_mov_b32 s41, s37
    s_mov_b32 s42, 0xa00000
    s_mov_b32 s43, 0x20000
    s_load_dwordx2 s[38:39], s[36:37], 0
    s_mov_b32 s12, s8
    s_lshl_b32 s56, s3, 10
    s_mul_i32 s57, s3, 6144
    s_mul_i32 s58, s3, 40960
    s_barrier
    s_lshl_b32 s13, s12, 8
    s_cmp_eq_u32 s9, 0
    s_cbranch_scc1 L_sk_23
    s_add_u32 m0, s56, 0
    s_add_u32 s14, s13, 0
    buffer_load_dwordx4 v148, s[44:47], s14 offen lds
L_sk_23:
    s_cmp_eq_u32 s9, 1
    s_cbranch_scc1 L_sk_24
    s_add_u32 m0, s56, 4096
    s_add_u32 s14, s13, 20480
    buffer_load_dwordx4 v148, s[44:47], s14 offen lds
L_sk_24:
    s_cmp_eq_u32 s9, 2
    s_cbranch_scc1 L_sk_25
    s_add_u32 m0, s56, 8192
    s_add_u32 s14, s13, 40960
    buffer_load_dwordx4 v148, s[44:47], s14 offen lds
L_sk_25:
    s_cmp_eq_u32 s9, 3
    s_cbranch_scc1 L_sk_26
    s_add_u32 m0, s56, 12288
    s_add_u32 s14, s13, 61440
    buffer_load_dwordx4 v148, s[44:47], s14 offen lds
L_sk_26:
    s_mul_i32 s13, s12, 163840
    s_add_u32 s13, s13, s58
    s_add_u32 s14, s13, 20480
    s_add_u32 m0, s57, 81920
    s_nop 0
    buffer_load_dwordx4 v149, s[48:51], s13 offen offset:0 lds
    buffer_load_dwordx4 v150, s[48:51], s13 offen offset:1024 lds
    buffer_load_dwordx4 v151, s[48:51], s13 offen offset:2048 lds
    s_add_u32 m0, m0, 3072
    s_nop 0
    buffer_load_dwordx4 v149, s[48:51], s14 offen offset:0 lds
    buffer_load_dwordx4 v150, s[48:51], s14 offen offset:1024 lds
    buffer_load_dwordx4 v151, s[48:51], s14 offen offset:2048 lds
    s_mov_b64 exec, 1
    ds_add_u32 v1, v2 offset:28
    s_mov_b64 exec, -1
    v_lshrrev_b32 v96, 4, v0
    v_and_b32 v97, 15, v0
    v_lshrrev_b32 v99, 1, v96
    v_and_b32 v100, 1, v96
    v_lshlrev_b32 v98, 4, v97
    v_lshl_add_u32 v98, v100, 9, v98
    v_lshl_add_u32 v164, v99, 10, v98
    v_mul_u32_u24 v101, 5120, v99
    v_add_u32 v165, v101, v98
    s_lshl_b32 s12, s6, 1
    s_lshr_b32 s13, s3, 1
    s_add_u32 s12, s12, s13
    s_mul_i32 s12, s12, 40960
    s_and_b32 s13, s3, 1
    s_lshl_b32 s13, s13, 8
    s_add_u32 s12, s12, s13
    s_add_u32 s77, s12, 524288
    v_mul_u32_u24 v166, 2560, v97
    v_lshl_add_u32 v166, v96, 3, v166
    v_bfe_u32 v97, v0, 2, 2
    v_and_b32 v98, 3, v0
    v_mul_u32_u24 v101, 20, v99
    v_lshl_add_u32 v101, v100, 2, v101
    v_add_u32 v101, v101, v97
    v_mul_u32_u24 v101, 160, v101
    v_mul_u32_u24 v102, 80, v99
    v_mul_u32_u24 v103, 40, v100
    v_add3_u32 v102, v102, v103, v97
    v_mul_u32_u24 v102, 160, v102
    s_mov_b32 s12, 32768
    v_lshlrev_b32 v98, 3, v98
    v_add3_u32 v152, v101, v98, s12
    s_add_u32 s12, s12, 2560
    v_add3_u32 v153, v102, v98, s12
    s_lshl_b32 s12, s6, 2
    s_add_u32 s12, s12, s3
    s_mul_i32 s12, s12, 40960
    s_mul_i32 s13, s7, 160
    s_add_u32 s78, s12, s13
    s_lshl_b32 s58, s6, 1
    s_add_u32 s58, s58, s10
    s_lshl_b32 s58, s58, 3
    s_add_u32 s58, s58, s7
    s_mul_i32 s58, s58, 5120
    s_add_u32 s58, s58, 524288
    s_lshl_b32 s73, s11, 11
    s_add_u32 s73, s73, s58
    s_lshl_b32 s74, s11, 9
    s_add_u32 s74, s74, s58
    s_add_u32 s74, s74, 4096
    v_lshlrev_b32 v149, 4, v0
    s_mov_b32 s68, 0x21800000
    s_mov_b32 s69, 0x5d800000
    s_lshl3_add_u32 s79, s6, s7
    s_lshl_b32 s79, s79, 6
    s_add_u32 s79, s79, 98304
    s_waitcnt lgkmcnt(0)
    s_mul_i32 s38, s38, 0x9E3779B1
    s_add_u32 s38, s38, 0x7F4A7C15
    s_mul_i32 s39, s39, 0x2C9277B5
    s_add_u32 s39, s39, 0x5851F42D
    v_lshlrev_b32 v140, 4, v0
    v_add_u32 v140, 0, v140
    v_and_b32 v96, 31, v0
    v_lshrrev_b32 v97, 5, v0
    v_lshlrev_b32 v98, 3, v96
    v_add_u32 v98, 1024, v98
    v_mov_b32 v99, 2560
    v_cmp_lt_u32 s[66:67], 31, v0
    v_lshlrev_b32 v100, 4, v96
    v_lshl_add_u32 v101, v97, 8, v100
    v_mov_b32 v141, v98
    v_lshl_add_u32 v102, v97, 6, v100
    v_add_u32 v102, 256, v102
    v_cmp_lt_u32 vcc, 15, v96
    v_and_b32 v103, 27, v96
    s_nop 0
    v_cndmask_b32 v101, v101, v102, vcc
    v_add_u32 v101, 1280, v101
    v_add_u32 v102, 640, v101
    v_cmp_eq_u32 vcc, 24, v103
    v_mov_b32 v104, 2592
    v_mov_b32 v105, 2576
    v_cndmask_b32 v104, v104, v105, vcc
    v_cmp_lt_u32 vcc, 19, v96
    s_nop 1
    v_cndmask_b32 v142, v101, v104, vcc
    v_cndmask_b32 v143, v102, v104, vcc
    v_mov_b32 v16, 0
    v_mov_b32 v17, 0
    v_mov_b32 v18, 0
    v_mov_b32 v19, 0
    v_mov_b32 v20, 0
    v_mov_b32 v21, 0
    v_mov_b32 v22, 0
    v_mov_b32 v23, 0
    v_mov_b32 v24, 0
    v_mov_b32 v25, 0
    v_mov_b32 v26, 0
    v_mov_b32 v27, 0
    v_mov_b32 v28, 0
    v_mov_b32 v29, 0
    v_mov_b32 v30, 0
    v_mov_b32 v31, 0
    v_mov_b32 v32, 0
    v_mov_b32 v33, 0
    v_mov_b32 v34, 0
    v_mov_b32 v35, 0
    v_mov_b32 v36, 0
    v_mov_b32 v37, 0
    v_mov_b32 v38, 0
    v_mov_b32 v39, 0
    v_mov_b32 v40, 0
    v_mov_b32 v41, 0
    v_mov_b32 v42, 0
    v_mov_b32 v43, 0
    v_mov_b32 v44, 0
    v_mov_b32 v45, 0
    v_mov_b32 v46, 0
    v_mov_b32 v47, 0
    v_and_b32 v4, 31, v0
    v_lshrrev_b32 v5, 5, v0
    v_and_b32 v6, 15, v0
    s_lshl_b32 s14, s10, 13
    v_lshlrev_b32 v4, 8, v4
    v_add_u32 v4, s14, v4
    v_or_b32 v7, 0, v5
    v_xor_b32 v7, v7, v6
    v_lshl_add_u32 v154, v7, 4, v4
    v_or_b32 v7, 2, v5
    v_xor_b32 v7, v7, v6
    v_lshl_add_u32 v155, v7, 4, v4
    v_or_b32 v7, 4, v5
    v_xor_b32 v7, v7, v6
    v_lshl_add_u32 v156, v7, 4, v4
    v_or_b32 v7, 6, v5
    v_xor_b32 v7, v7, v6
    v_lshl_add_u32 v157, v7, 4, v4
    v_or_b32 v7, 8, v5
    v_xor_b32 v7, v7, v6
    v_lshl_add_u32 v158, v7, 4, v4
    v_or_b32 v7, 10, v5
    v_xor_b32 v7, v7, v6
    v_lshl_add_u32 v159, v7, 4, v4
    v_or_b32 v7, 12, v5
    v_xor_b32 v7, v7, v6
    v_lshl_add_u32 v160, v7, 4, v4
    v_or_b32 v7, 14, v5
    v_xor_b32 v7, v7, v6
    v_lshl_add_u32 v161, v7, 4, v4
    v_lshlrev_b32 v4, 8, v6
    v_add_u32 v4, s14, v4
    v_lshrrev_b32 v8, 4, v0
    v_or_b32 v7, 0, v8
    v_xor_b32 v7, v7, v6
    v_lshl_add_u32 v132, v7, 4, v4
    v_or_b32 v7, 4, v8
    v_xor_b32 v7, v7, v6
    v_lshl_add_u32 v133, v7, 4, v4
    v_or_b32 v7, 8, v8
    v_xor_b32 v7, v7, v6
    v_lshl_add_u32 v134, v7, 4, v4
    v_or_b32 v7, 12, v8
    v_xor_b32 v7, v7, v6
    v_lshl_add_u32 v135, v7, 4, v4
    v_bfe_u32 v4, v0, 4, 1
    v_mul_u32_u24 v4, 40, v4
    v_and_b32 v9, 3, v0
    v_lshlrev_b32 v7, 3, v9
    s_mov_b32 s15, 0x18081000
    v_bfe_u32 v7, s15, v7, 8
    v_add_u32 v7, v7, v4
    v_lshrrev_b32 v9, 1, v9
    v_mul_u32_u24 v9, 40, v9
    v_bfe_u32 v4, v0, 2, 2
    v_lshl_add_u32 v5, v5, 3, v4
    v_mul_u32_u24 v5, 192, v5
    v_lshl_add_u32 v8, v8, 3, v4
    v_mul_u32_u24 v8, 192, v8
    s_and_b32 s14, s7, 1
    s_lshl_b32 s14, s14, 5
    s_mul_i32 s15, s11, 80
    s_add_u32 s14, s14, s15
    s_add_u32 s14, s14, 81920
    v_add3_u32 v162, v5, v7, s14
    s_add_u32 s14, s14, 32
    v_add3_u32 v163, v8, v9, s14
    v_bfe_u32 v4, v0, 4, 1
    v_cmp_eq_u32 s[90:91], 1, v4
    v_mov_b32 v108, 0
    v_mov_b32 v109, 0
    v_mov_b32 v110, 0
    v_mov_b32 v111, 0
    v_mov_b32 v112, 0
    v_mov_b32 v113, 0
    v_mov_b32 v114, 0
    v_mov_b32 v115, 0
    v_mov_b32 v116, 0
    v_mov_b32 v117, 0
    v_mov_b32 v118, 0
    v_mov_b32 v119, 0
    v_mov_b32 v120, 0
    v_mov_b32 v121, 0
    v_mov_b32 v122, 0
    v_mov_b32 v123, 0
    v_mov_b32 v124, 0
    v_mov_b32 v125, 0
    v_mov_b32 v126, 0
    v_mov_b32 v127, 0
    v_mov_b32 v128, 0
    v_mov_b32 v129, 0
    v_mov_b32 v130, 0
    v_mov_b32 v131, 0
    s_mov_b32 s80, 24576
    s_mov_b32 s81, 31232
    s_mov_b32 s82, 4294911488
    s_mov_b32 s83, 24576
    s_mov_b32 s84, 0
    s_mov_b32 s12, 0
    v_mov_b32 v148, 163332
    s_mov_b32 s61, 2
    s_waitcnt vmcnt(0)
    s_mov_b64 exec, 1
    ds_add_u32 v1, v2 offset:32
    s_mov_b64 exec, -1
L_w_27:
    ds_read_b32 v3, v1 offset:0
    s_waitcnt lgkmcnt(0)
    v_readfirstlane_b32 s60, v3
    s_nop 0
    s_cmp_ge_u32 s60, 4
    s_cbranch_scc1 L_wd_28
    s_cmp_eq_u32 s76, 0
    s_cbranch_scc1 L_wd_28
    s_sub_u32 s76, s76, 1
    s_sleep 0
    s_branch L_w_27
L_wd_28:
L_w_29:
    ds_read_b32 v3, v1 offset:32
    s_waitcnt lgkmcnt(0)
    v_readfirstlane_b32 s60, v3
    s_nop 0
    s_cmp_ge_u32 s60, 4
    s_cbranch_scc1 L_wd_30
    s_cmp_eq_u32 s76, 0
    s_cbranch_scc1 L_wd_30
    s_sub_u32 s76, s76, 1
    s_sleep 0
    s_branch L_w_29
L_wd_30:
    ds_read_b128 v[48:51], v154
    ds_read_b64_tr_b16 v[52:53], v162 offset:0
    ds_read_b64_tr_b16 v[54:55], v162 offset:768
    v_add_u32 v154, 16384, v154
    ds_read_b128 v[56:59], v155
    ds_read_b64_tr_b16 v[60:61], v162 offset:3072
    ds_read_b64_tr_b16 v[62:63], v162 offset:3840
    v_add_u32 v155, 16384, v155
    ds_read_b128 v[64:67], v132 offset:0
    ds_read_b128 v[68:71], v132 offset:4096
    ds_read_b64_tr_b16 v[72:73], v163 offset:0
    ds_read_b64_tr_b16 v[74:75], v163 offset:768
    v_add_u32 v132, 16384, v132
L_qloop:
    s_waitcnt lgkmcnt(7)
    v_mfma_f32_32x32x16_bf16 v[108:123], v[52:55], v[48:51], v[108:123]
    ds_read_b128 v[76:79], v156
    ds_read_b64_tr_b16 v[80:81], v162 offset:6144
    ds_read_b64_tr_b16 v[82:83], v162 offset:6912
    v_add_u32 v156, 16384, v156
    s_waitcnt lgkmcnt(7)
    v_mfma_f32_32x32x16_bf16 v[108:123], v[60:63], v[56:59], v[108:123]
    ds_read_b128 v[84:87], v157
    ds_read_b64_tr_b16 v[88:89], v162 offset:9216
    ds_read_b64_tr_b16 v[90:91], v162 offset:9984
    v_add_u32 v157, 16384, v157
    s_waitcnt lgkmcnt(6)
    v_mfma_f32_16x16x32_bf16 v[124:127], v[72:75], v[64:67], v[124:127]
    v_mfma_f32_16x16x32_bf16 v[128:131], v[72:75], v[68:71], v[128:131]
    ds_read_b128 v[92:95], v133 offset:0
    ds_read_b128 v[96:99], v133 offset:4096
    ds_read_b64_tr_b16 v[100:101], v163 offset:6144
    ds_read_b64_tr_b16 v[102:103], v163 offset:6912
    v_add_u32 v133, 16384, v133
    s_waitcnt lgkmcnt(7)
    v_mfma_f32_32x32x16_bf16 v[108:123], v[80:83], v[76:79], v[108:123]
    ds_read_b128 v[48:51], v158
    ds_read_b64_tr_b16 v[52:53], v162 offset:12288
    ds_read_b64_tr_b16 v[54:55], v162 offset:13056
    v_add_u32 v158, 16384, v158
    s_waitcnt lgkmcnt(7)
    v_mfma_f32_32x32x16_bf16 v[108:123], v[88:91], v[84:87], v[108:123]
    ds_read_b128 v[56:59], v159
    ds_read_b64_tr_b16 v[60:61], v162 offset:15360
    ds_read_b64_tr_b16 v[62:63], v162 offset:16128
    v_add_u32 v159, 16384, v159
    s_waitcnt lgkmcnt(6)
    v_mfma_f32_16x16x32_bf16 v[124:127], v[100:103], v[92:95], v[124:127]
    v_mfma_f32_16x16x32_bf16 v[128:131], v[100:103], v[96:99], v[128:131]
    ds_read_b128 v[64:67], v134 offset:0
    ds_read_b128 v[68:71], v134 offset:4096
    ds_read_b64_tr_b16 v[72:73], v163 offset:12288
    ds_read_b64_tr_b16 v[74:75], v163 offset:13056
    v_add_u32 v134, 16384, v134
    ds_read_b32 v3, v148 offset:32
    s_waitcnt lgkmcnt(7)
    v_mfma_f32_32x32x16_bf16 v[108:123], v[52:55], v[48:51], v[108:123]
    ds_read_b128 v[76:79], v160
    ds_read_b64_tr_b16 v[80:81], v162 offset:18432
    ds_read_b64_tr_b16 v[82:83], v162 offset:19200
    v_add_u32 v160, 16384, v160
    s_waitcnt lgkmcnt(7)
    v_mfma_f32_32x32x16_bf16 v[108:123], v[60:63], v[56:59], v[108:123]
    ds_read_b128 v[84:87], v161
    ds_read_b64_tr_b16 v[88:89], v162 offset:21504
    ds_read_b64_tr_b16 v[90:91], v162 offset:22272
    v_add_u32 v161, 16384, v161
    s_waitcnt lgkmcnt(6)
    v_mfma_f32_16x16x32_bf16 v[124:127], v[72:75], v[64:67], v[124:127]
    v_mfma_f32_16x16x32_bf16 v[128:131], v[72:75], v[68:71], v[128:131]
    ds_read_b128 v[92:95], v135 offset:0
    ds_read_b128 v[96:99], v135 offset:4096
    ds_read_b64_tr_b16 v[100:101], v163 offset:18432
    ds_read_b64_tr_b16 v[102:103], v163 offset:19200
    v_add_u32 v135, 16384, v135
    s_mov_b32 m0, s12
    s_waitcnt lgkmcnt(7)
    v_readfirstlane_b32 s60, v3
    s_movrels_b32 s14, s80
    s_mov_b64 exec, 1
    ds_add_u32 v145, v2 offset:64
    s_mov_b64 exec, -1
    v_add_u32 v162, s14, v162
    v_add_u32 v163, s14, v163
    s_cmp_lt_u32 s60, s61
    s_cbranch_scc1 L_qwait
L_qgo:
    v_mfma_f32_32x32x16_bf16 v[108:123], v[80:83], v[76:79], v[108:123]
    ds_read_b128 v[48:51], v154
    ds_read_b64_tr_b16 v[52:53], v162 offset:0
    ds_read_b64_tr_b16 v[54:55], v162 offset:768
    v_add_u32 v154, 16384, v154
    s_waitcnt lgkmcnt(7)
    v_mfma_f32_32x32x16_bf16 v[108:123], v[88:91], v[84:87], v[108:123]
    ds_read_b128 v[56:59], v155
    ds_read_b64_tr_b16 v[60:61], v162 offset:3072
    ds_read_b64_tr_b16 v[62:63], v162 offset:3840
    v_add_u32 v155, 16384, v155
    s_waitcnt lgkmcnt(6)
    v_mfma_f32_16x16x32_bf16 v[124:127], v[100:103], v[92:95], v[124:127]
    v_mfma_f32_16x16x32_bf16 v[128:131], v[100:103], v[96:99], v[128:131]
    ds_read_b128 v[64:67], v132 offset:0
    ds_read_b128 v[68:71], v132 offset:4096
    ds_read_b64_tr_b16 v[72:73], v163 offset:0
    ds_read_b64_tr_b16 v[74:75], v163 offset:768
    v_add_u32 v132, 16384, v132
    v_add_u32 v148, 4, v148
    s_add_u32 s12, s12, 1
    s_cmp_eq_u32 s12, 4
    s_cselect_b32 s61, 0, s61
    s_cmp_lt_u32 s12, 5
    s_cbranch_scc1 L_qloop
    s_waitcnt lgkmcnt(0)
    v_mov_b32 v154, v140
    v_mov_b32 v155, v141
    v_mov_b32 v156, v142
    v_mov_b32 v157, v143
    v_mov_b32 v158, 0xdddd
    v_mov_b32 v159, v145
    s_mov_b32 s80, 141824
    s_mov_b32 s81, 4294858240
    s_mov_b32 s82, 21504
    s_mov_b32 s83, 21504
    s_mov_b32 s84, 21504
    s_mov_b32 s85, 4294870016
    s_mov_b32 s86, 141824
    s_mov_b32 s87, 4294825472
    s_mov_b32 s88, 141824
    s_mov_b32 s12, 0
    s_mov_b32 s57, 0
    v_cndmask_b32 v124, v124, v128, s[90:91]
    v_cndmask_b32 v125, v125, v129, s[90:91]
    v_cndmask_b32 v126, v126, v130, s[90:91]
    v_cndmask_b32 v127, v127, v131, s[90:91]
    v_cvt_pk_bf16_f32 v8, v124, v125
    v_cvt_pk_bf16_f32 v9, v126, v127
    v_cvt_pk_bf16_f32 v4, v108, v109
    v_cvt_pk_bf16_f32 v5, v110, v111
    v_cvt_pk_bf16_f32 v6, v112, v113
    v_cvt_pk_bf16_f32 v7, v114, v115
    v_cvt_pk_bf16_f32 v10, v116, v117
    v_cvt_pk_bf16_f32 v11, v118, v119
    v_cvt_pk_bf16_f32 v12, v120, v121
    v_cvt_pk_bf16_f32 v13, v122, v123
L_pass0:
L_w_31:
    ds_read_b32 v3, v1 offset:12
    s_waitcnt lgkmcnt(0)
    v_readfirstlane_b32 s60, v3
    s_nop 0
    s_cmp_ge_u32 s60, 2
    s_cbranch_scc1 L_wd_32
    s_cmp_eq_u32 s76, 0
    s_cbranch_scc1 L_wd_32
    s_sub_u32 s76, s76, 1
    s_sleep 0
    s_branch L_w_31
L_wd_32:
    ds_read_b64 v[120:121], v155
    ds_read_b128 v[112:115], v154
    ds_read_b64 v[122:123], v155 offset:2688
    ds_read_b128 v[116:119], v154 offset:2688
    ds_read_b128 v[124:127], v156
    ds_read_b128 v[128:131], v157
    s_waitcnt lgkmcnt(5)
    v_mfma_f32_32x32x4_2b_bf16 v[48:79], v[120:121], v[8:9], 0
    v_mov_b32 v140, 0
    v_mov_b32 v141, 0
    v_mov_b32 v142, 0
    v_mov_b32 v143, 0
    v_mov_b32 v144, 0
    v_mov_b32 v145, 0
    v_mov_b32 v146, 0
    v_mov_b32 v147, 0
    v_mov_b32 v136, 0
    v_mov_b32 v137, 0
    v_mov_b32 v138, 0
    v_mov_b32 v139, 0
    s_mov_b32 s13, 0
    s_mov_b32 s15, 141824
    s_mov_b32 s14, 4
    s_waitcnt lgkmcnt(4)
    s_nop 1
    v_mfma_f32_32x32x16_bf16 v[48:63], v[112:115], v[4:7], v[48:63]
    v_mfma_f32_32x32x16_bf16 v[64:79], v[112:115], v[10:13], v[64:79]
    s_nop 7
.p2align 3
L_epoch:
    s_waitcnt lgkmcnt(0)
    v_mfma_f32_32x32x4_2b_bf16 v[80:111], v[122:123], v[8:9], 0
    ds_read_b64 v[120:121], v155 offset:5376
    v_exp_f32 v48, v48
    v_exp_f32 v49, v49
    v_exp_f32 v50, v50
    v_exp_f32 v51, v51
    v_exp_f32 v52, v52
    v_exp_f32 v53, v53
    v_exp_f32 v54, v54
    v_exp_f32 v55, v55
    v_smfmac_f32_32x32x32_bf16 v[32:47], v[136:139], v[140:147], v158
    ds_read_b128 v[112:115], v154 offset:5376
    v_exp_f32 v56, v56
    v_exp_f32 v57, v57
    v_exp_f32 v58, v58
    v_exp_f32 v59, v59
    v_smfmac_f32_32x32x32_bf16 v[16:31], v[124:127], v[48:55], v158
    ds_read_b128 v[132:135], v156 offset:2688
    v_exp_f32 v60, v60
    v_exp_f32 v61, v61
    v_exp_f32 v62, v62
    v_exp_f32 v63, v63
    v_mfma_f32_32x32x16_bf16 v[80:95], v[116:119], v[4:7], v[80:95]
    ds_read_b128 v[136:139], v157 offset:2688
    v_exp_f32 v64, v64
    v_exp_f32 v65, v65
    v_exp_f32 v66, v66
    v_exp_f32 v67, v67
    v_mfma_f32_32x32x16_bf16 v[96:111], v[116:119], v[10:13], v[96:111]
    v_exp_f32 v68, v68
    v_exp_f32 v69, v69
    v_exp_f32 v70, v70
    v_exp_f32 v71, v71
    v_smfmac_f32_32x32x32_bf16 v[16:31], v[128:131], v[56:63], v158
    v_exp_f32 v140, v72
    v_exp_f32 v141, v73
    v_exp_f32 v142, v74
    v_exp_f32 v143, v75
    v_smfmac_f32_32x32x32_bf16 v[32:47], v[124:127], v[64:71], v158
    v_exp_f32 v144, v76
    v_exp_f32 v145, v77
    v_exp_f32 v146, v78
    v_exp_f32 v147, v79
    s_waitcnt lgkmcnt(0)
    v_mfma_f32_32x32x4_2b_bf16 v[48:79], v[120:121], v[8:9], 0
    ds_read_b64 v[122:123], v155 offset:8064
    v_exp_f32 v80, v80
    v_exp_f32 v81, v81
    v_exp_f32 v82, v82
    v_exp_f32 v83, v83
    v_exp_f32 v84, v84
    v_exp_f32 v85, v85
    v_exp_f32 v86, v86
    v_exp_f32 v87, v87
    v_smfmac_f32_32x32x32_bf16 v[32:47], v[128:131], v[140:147], v158
    ds_read_b128 v[116:119], v154 offset:8064
    v_exp_f32 v88, v88
    v_exp_f32 v89, v89
    v_exp_f32 v90, v90
    v_exp_f32 v91, v91
    v_smfmac_f32_32x32x32_bf16 v[16:31], v[132:135], v[80:87], v158
    ds_read_b128 v[124:127], v156 offset:5376
    v_exp_f32 v92, v92
    v_exp_f32 v93, v93
    v_exp_f32 v94, v94
    v_exp_f32 v95, v95
    v_mfma_f32_32x32x16_bf16 v[48:63], v[112:115], v[4:7], v[48:63]
    ds_read_b128 v[128:131], v157 offset:5376
    v_exp_f32 v96, v96
    v_exp_f32 v97, v97
    v_exp_f32 v98, v98
    v_exp_f32 v99, v99
    v_mfma_f32_32x32x16_bf16 v[64:79], v[112:115], v[10:13], v[64:79]
    v_exp_f32 v100, v100
    v_exp_f32 v101, v101
    v_exp_f32 v102, v102
    v_exp_f32 v103, v103
    v_smfmac_f32_32x32x32_bf16 v[16:31], v[136:139], v[88:95], v158
    v_exp_f32 v140, v104
    v_exp_f32 v141, v105
    v_exp_f32 v142, v106
    v_exp_f32 v143, v107
    v_smfmac_f32_32x32x32_bf16 v[32:47], v[132:135], v[96:103], v158
    v_exp_f32 v144, v108
    v_exp_f32 v145, v109
    v_exp_f32 v146, v110
    v_exp_f32 v147, v111
    s_waitcnt lgkmcnt(0)
    v_mfma_f32_32x32x4_2b_bf16 v[80:111], v[122:123], v[8:9], 0
    ds_read_b64 v[120:121], v155 offset:10752
    v_exp_f32 v48, v48
    v_exp_f32 v49, v49
    v_exp_f32 v50, v50
    v_exp_f32 v51, v51
    v_exp_f32 v52, v52
    v_exp_f32 v53, v53
    v_exp_f32 v54, v54
    v_exp_f32 v55, v55
    v_smfmac_f32_32x32x32_bf16 v[32:47], v[136:139], v[140:147], v158
    ds_read_b128 v[112:115], v154 offset:10752
    v_exp_f32 v56, v56
    v_exp_f32 v57, v57
    v_exp_f32 v58, v58
    v_exp_f32 v59, v59
    v_smfmac_f32_32x32x32_bf16 v[16:31], v[124:127], v[48:55], v158
    ds_read_b128 v[132:135], v156 offset:8064
    v_exp_f32 v60, v60
    v_exp_f32 v61, v61
    v_exp_f32 v62, v62
    v_exp_f32 v63, v63
    v_mfma_f32_32x32x16_bf16 v[80:95], v[116:119], v[4:7], v[80:95]
    ds_read_b128 v[136:139], v157 offset:8064
    v_exp_f32 v64, v64
    v_exp_f32 v65, v65
    v_exp_f32 v66, v66
    v_exp_f32 v67, v67
    v_mfma_f32_32x32x16_bf16 v[96:111], v[116:119], v[10:13], v[96:111]
    v_exp_f32 v68, v68
    v_exp_f32 v69, v69
    v_exp_f32 v70, v70
    v_exp_f32 v71, v71
    v_smfmac_f32_32x32x32_bf16 v[16:31], v[128:131], v[56:63], v158
    v_exp_f32 v140, v72
    v_exp_f32 v141, v73
    v_exp_f32 v142, v74
    v_exp_f32 v143, v75
    v_smfmac_f32_32x32x32_bf16 v[32:47], v[124:127], v[64:71], v158
    v_exp_f32 v144, v76
    v_exp_f32 v145, v77
    v_exp_f32 v146, v78
    v_exp_f32 v147, v79
    s_waitcnt lgkmcnt(0)
    v_mfma_f32_32x32x4_2b_bf16 v[48:79], v[120:121], v[8:9], 0
    ds_read_b64 v[122:123], v155 offset:13440
    v_exp_f32 v80, v80
    v_exp_f32 v81, v81
    v_exp_f32 v82, v82
    v_exp_f32 v83, v83
    v_exp_f32 v84, v84
    v_exp_f32 v85, v85
    v_exp_f32 v86, v86
    v_exp_f32 v87, v87
    v_smfmac_f32_32x32x32_bf16 v[32:47], v[128:131], v[140:147], v158
    ds_read_b128 v[116:119], v154 offset:13440
    v_exp_f32 v88, v88
    v_exp_f32 v89, v89
    v_exp_f32 v90, v90
    v_exp_f32 v91, v91
    v_smfmac_f32_32x32x32_bf16 v[16:31], v[132:135], v[80:87], v158
    ds_read_b128 v[124:127], v156 offset:10752
    v_exp_f32 v92, v92
    v_exp_f32 v93, v93
    v_exp_f32 v94, v94
    v_exp_f32 v95, v95
    v_mfma_f32_32x32x16_bf16 v[48:63], v[112:115], v[4:7], v[48:63]
    ds_read_b128 v[128:131], v157 offset:10752
    v_exp_f32 v96, v96
    v_exp_f32 v97, v97
    v_exp_f32 v98, v98
    v_exp_f32 v99, v99
    v_mfma_f32_32x32x16_bf16 v[64:79], v[112:115], v[10:13], v[64:79]
    v_exp_f32 v100, v100
    v_exp_f32 v101, v101
    v_exp_f32 v102, v102
    v_exp_f32 v103, v103
    v_smfmac_f32_32x32x32_bf16 v[16:31], v[136:139], v[88:95], v158
    v_exp_f32 v140, v104
    v_exp_f32 v141, v105
    v_exp_f32 v142, v106
    v_exp_f32 v143, v107
    v_smfmac_f32_32x32x32_bf16 v[32:47], v[132:135], v[96:103], v158
    v_exp_f32 v144, v108
    v_exp_f32 v145, v109
    v_exp_f32 v146, v110
    v_exp_f32 v147, v111
    s_waitcnt lgkmcnt(0)
    v_mfma_f32_32x32x4_2b_bf16 v[80:111], v[122:123], v[8:9], 0
    ds_read_b64 v[120:121], v155 offset:16128
    v_exp_f32 v48, v48
    v_exp_f32 v49, v49
    v_exp_f32 v50, v50
    v_exp_f32 v51, v51
    v_exp_f32 v52, v52
    v_exp_f32 v53, v53
    v_exp_f32 v54, v54
    v_exp_f32 v55, v55
    v_smfmac_f32_32x32x32_bf16 v[32:47], v[136:139], v[140:147], v158
    ds_read_b128 v[112:115], v154 offset:16128
    v_exp_f32 v56, v56
    v_exp_f32 v57, v57
    v_exp_f32 v58, v58
    v_exp_f32 v59, v59
    v_smfmac_f32_32x32x32_bf16 v[16:31], v[124:127], v[48:55], v158
    ds_read_b128 v[132:135], v156 offset:13440
    v_exp_f32 v60, v60
    v_exp_f32 v61, v61
    v_exp_f32 v62, v62
    v_exp_f32 v63, v63
    v_mfma_f32_32x32x16_bf16 v[80:95], v[116:119], v[4:7], v[80:95]
    ds_read_b128 v[136:139], v157 offset:13440
    v_exp_f32 v64, v64
    v_exp_f32 v65, v65
    v_exp_f32 v66, v66
    v_exp_f32 v67, v67
    v_mfma_f32_32x32x16_bf16 v[96:111], v[116:119], v[10:13], v[96:111]
    v_exp_f32 v68, v68
    v_exp_f32 v69, v69
    v_exp_f32 v70, v70
    v_exp_f32 v71, v71
    v_smfmac_f32_32x32x32_bf16 v[16:31], v[128:131], v[56:63], v158
    v_exp_f32 v140, v72
    v_exp_f32 v141, v73
    v_exp_f32 v142, v74
    v_exp_f32 v143, v75
    v_smfmac_f32_32x32x32_bf16 v[32:47], v[124:127], v[64:71], v158
    v_exp_f32 v144, v76
    v_exp_f32 v145, v77
    v_exp_f32 v146, v78
    v_exp_f32 v147, v79
    s_waitcnt lgkmcnt(0)
    v_mfma_f32_32x32x4_2b_bf16 v[48:79], v[120:121], v[8:9], 0
    ds_read_b64 v[122:123], v155 offset:18816
    v_exp_f32 v80, v80
    v_exp_f32 v81, v81
    v_exp_f32 v82, v82
    v_exp_f32 v83, v83
    v_exp_f32 v84, v84
    v_exp_f32 v85, v85
    v_exp_f32 v86, v86
    v_exp_f32 v87, v87
    v_smfmac_f32_32x32x32_bf16 v[32:47], v[128:131], v[140:147], v158
    ds_read_b128 v[116:119], v154 offset:18816
    v_exp_f32 v88, v88
    v_exp_f32 v89, v89
    v_exp_f32 v90, v90
    v_exp_f32 v91, v91
    v_smfmac_f32_32x32x32_bf16 v[16:31], v[132:135], v[80:87], v158
    ds_read_b128 v[124:127], v156 offset:16128
    v_exp_f32 v92, v92
    v_exp_f32 v93, v93
    v_exp_f32 v94, v94
    v_exp_f32 v95, v95
    v_mfma_f32_32x32x16_bf16 v[48:63], v[112:115], v[4:7], v[48:63]
    ds_read_b128 v[128:131], v157 offset:16128
    v_exp_f32 v96, v96
    v_exp_f32 v97, v97
    v_exp_f32 v98, v98
    v_exp_f32 v99, v99
    v_mfma_f32_32x32x16_bf16 v[64:79], v[112:115], v[10:13], v[64:79]
    ds_read_b32 v3, v1 offset:12
    v_exp_f32 v100, v100
    v_exp_f32 v101, v101
    v_exp_f32 v102, v102
    v_exp_f32 v103, v103
    v_smfmac_f32_32x32x32_bf16 v[16:31], v[136:139], v[88:95], v158
    v_exp_f32 v140, v104
    v_exp_f32 v141, v105
    v_exp_f32 v142, v106
    v_exp_f32 v143, v107
    v_smfmac_f32_32x32x32_bf16 v[32:47], v[132:135], v[96:103], v158
    v_exp_f32 v144, v108
    v_exp_f32 v145, v109
    v_exp_f32 v146, v110
    v_exp_f32 v147, v111
    s_waitcnt lgkmcnt(0)
    v_add_u32 v154, s15, v154
    v_add_u32 v155, s15, v155
    v_readfirstlane_b32 s60, v3
    s_nop 0
    s_cmp_lt_u32 s60, s14
    s_cbranch_scc1 L_notfull0
L_full0:
    v_mfma_f32_32x32x4_2b_bf16 v[80:111], v[122:123], v[8:9], 0
    ds_read_b64 v[120:121], v155 offset:0
    v_exp_f32 v48, v48
    v_exp_f32 v49, v49
    v_exp_f32 v50, v50
    v_exp_f32 v51, v51
    v_exp_f32 v52, v52
    v_exp_f32 v53, v53
    v_exp_f32 v54, v54
    v_exp_f32 v55, v55
    v_smfmac_f32_32x32x32_bf16 v[32:47], v[136:139], v[140:147], v158
    ds_read_b128 v[112:115], v154 offset:0
    v_exp_f32 v56, v56
    v_exp_f32 v57, v57
    v_exp_f32 v58, v58
    v_exp_f32 v59, v59
    v_smfmac_f32_32x32x32_bf16 v[16:31], v[124:127], v[48:55], v158
    ds_read_b128 v[132:135], v156 offset:18816
    v_exp_f32 v60, v60
    v_exp_f32 v61, v61
    v_exp_f32 v62, v62
    v_exp_f32 v63, v63
    v_mfma_f32_32x32x16_bf16 v[80:95], v[116:119], v[4:7], v[80:95]
    ds_read_b128 v[136:139], v157 offset:18816
    v_exp_f32 v64, v64
    v_exp_f32 v65, v65
    v_exp_f32 v66, v66
    v_exp_f32 v67, v67
    v_mfma_f32_32x32x16_bf16 v[96:111], v[116:119], v[10:13], v[96:111]
    s_mov_b64 exec, 1
    ds_add_u32 v159, v2 offset:80
    s_mov_b64 exec, -1
    v_exp_f32 v68, v68
    v_exp_f32 v69, v69
    v_exp_f32 v70, v70
    v_exp_f32 v71, v71
    v_smfmac_f32_32x32x32_bf16 v[16:31], v[128:131], v[56:63], v158
    v_exp_f32 v140, v72
    v_exp_f32 v141, v73
    v_exp_f32 v142, v74
    v_exp_f32 v143, v75
    v_smfmac_f32_32x32x32_bf16 v[32:47], v[124:127], v[64:71], v158
    v_exp_f32 v144, v76
    v_exp_f32 v145, v77
    v_exp_f32 v146, v78
    v_exp_f32 v147, v79
    s_waitcnt lgkmcnt(0)
    v_mfma_f32_32x32x4_2b_bf16 v[48:79], v[120:121], v[8:9], 0
    ds_read_b64 v[122:123], v155 offset:2688
    v_exp_f32 v80, v80
    v_exp_f32 v81, v81
    v_exp_f32 v82, v82
    v_exp_f32 v83, v83
    v_exp_f32 v84, v84
    v_exp_f32 v85, v85
    v_exp_f32 v86, v86
    v_exp_f32 v87, v87
    v_smfmac_f32_32x32x32_bf16 v[32:47], v[128:131], v[140:147], v158
    ds_read_b128 v[116:119], v154 offset:2688
    v_exp_f32 v88, v88
    v_exp_f32 v89, v89
    v_exp_f32 v90, v90
    v_exp_f32 v91, v91
    v_add_u32 v156, s15, v156
    v_add_u32 v157, s15, v157
    v_smfmac_f32_32x32x32_bf16 v[16:31], v[132:135], v[80:87], v158
    ds_read_b128 v[124:127], v156 offset:0
    v_exp_f32 v92, v92
    v_exp_f32 v93, v93
    v_exp_f32 v94, v94
    v_exp_f32 v95, v95
    v_mfma_f32_32x32x16_bf16 v[48:63], v[112:115], v[4:7], v[48:63]
    ds_read_b128 v[128:131], v157 offset:0
    v_exp_f32 v96, v96
    v_exp_f32 v97, v97
    v_exp_f32 v98, v98
    v_exp_f32 v99, v99
    v_mfma_f32_32x32x16_bf16 v[64:79], v[112:115], v[10:13], v[64:79]
    v_exp_f32 v100, v100
    v_exp_f32 v101, v101
    v_exp_f32 v102, v102
    v_exp_f32 v103, v103
    v_smfmac_f32_32x32x32_bf16 v[16:31], v[136:139], v[88:95], v158
    v_exp_f32 v140, v104
    v_exp_f32 v141, v105
    v_exp_f32 v142, v106
    v_exp_f32 v143, v107
    s_add_u32 s13, s13, 1
    s_mov_b32 m0, s13
    s_cmp_lt_u32 s13, 7
    s_cselect_b32 s59, 2, 0
    s_add_u32 s14, s14, s59
    s_movrels_b32 s15, s80
    s_cmp_lt_u32 s13, 8
    v_smfmac_f32_32x32x32_bf16 v[32:47], v[132:135], v[96:103], v158
    v_exp_f32 v144, v108
    v_exp_f32 v145, v109
    v_exp_f32 v146, v110
    v_exp_f32 v147, v111
    s_cbranch_scc1 L_epoch
    s_nop 0
    v_smfmac_f32_32x32x32_bf16 v[32:47], v[136:139], v[140:147], v158
    s_waitcnt lgkmcnt(0)
L_norm:
    s_add_u32 s12, s12, 16
    v_cmp_nle_f32 vcc, s68, v28
    v_cmp_nge_f32 s[62:63], s69, v28
    v_rcp_f32 v147, v28
    s_or_b64 s[70:71], vcc, s[62:63]
    v_mul_f32 v16, v16, v147
    v_mul_f32 v17, v17, v147
    v_mul_f32 v18, v18, v147
    v_mul_f32 v19, v19, v147
    v_mul_f32 v20, v20, v147
    v_mul_f32 v21, v21, v147
    v_mul_f32 v22, v22, v147
    v_mul_f32 v23, v23, v147
    v_mul_f32 v24, v24, v147
    v_mul_f32 v25, v25, v147
    v_mul_f32 v26, v26, v147
    v_mul_f32 v27, v27, v147
    v_cvt_pk_bf16_f32 v48, v16, v17
    v_cvt_pk_bf16_f32 v49, v18, v19
    v_cvt_pk_bf16_f32 v50, v20, v21
    v_cvt_pk_bf16_f32 v51, v22, v23
    buffer_store_dwordx4 v[48:51], v149, s[40:43], s73 offen sc1
    v_rcp_f32 v148, v44
    v_cmp_nle_f32 vcc, s68, v44
    v_cmp_nge_f32 s[62:63], s69, v44
    v_mul_f32 v32, v32, v148
    v_mul_f32 v33, v33, v148
    v_mul_f32 v34, v34, v148
    v_mul_f32 v35, v35, v148
    v_mul_f32 v36, v36, v148
    v_mul_f32 v37, v37, v148
    v_mul_f32 v38, v38, v148
    v_mul_f32 v39, v39, v148
    v_mul_f32 v40, v40, v148
    v_mul_f32 v41, v41, v148
    v_mul_f32 v42, v42, v148
    v_mul_f32 v43, v43, v148
    v_cvt_pk_bf16_f32 v52, v32, v33
    v_cvt_pk_bf16_f32 v53, v34, v35
    v_cvt_pk_bf16_f32 v54, v36, v37
    v_cvt_pk_bf16_f32 v55, v38, v39
    buffer_store_dwordx4 v[52:55], v149, s[40:43], s73 offen offset:1024 sc1
    v_cvt_pk_bf16_f32 v56, v24, v25
    v_cvt_pk_bf16_f32 v57, v26, v27
    v_cvt_pk_bf16_f32 v58, v40, v41
    v_cvt_pk_bf16_f32 v59, v42, v43
    s_mov_b32 exec_hi, 0
    buffer_store_dwordx4 v[56:59], v149, s[40:43], s74 offen sc1
    s_mov_b64 exec, -1
    s_or_b64 s[70:71], s[70:71], vcc
    s_or_b64 s[70:71], s[70:71], s[62:63]
    s_cselect_b32 s72, 0x101, 1
    s_cmp_lg_u32 s57, 0
    s_cselect_b32 s72, 1, s72
    s_cselect_b32 s75, 0xff, -1
    v_mov_b32 v147, s72
    s_lshl_b32 s61, s57, 2
    s_add_u32 s61, s61, 4
    v_mov_b32 v60, s38
    v_mov_b32 v61, s39
    v_mov_b32 v62, 0
    s_mov_b64 exec, 1
    s_waitcnt vmcnt(0)
    ds_add_rtn_u32 v146, v1, v147 offset:56
    s_waitcnt lgkmcnt(0)
    v_readfirstlane_b32 s60, v146
    s_nop 0
    s_add_u32 s60, s60, s72
    s_and_b32 s59, s60, s75
    s_cmp_lg_u32 s59, s61
    s_cbranch_scc1 L_nlast
    buffer_store_dwordx2 v[60:61], v62, s[40:43], s79 offen sc1
L_nlast:
    s_mov_b64 exec, -1
L_w_33:
    ds_read_b32 v3, v1 offset:56
    s_waitcnt lgkmcnt(0)
    v_readfirstlane_b32 s60, v3
    s_nop 0
    s_and_b32 s59, s60, 0xff
    s_cmp_ge_u32 s59, s61
    s_cbranch_scc1 L_wd_34
    s_cmp_eq_u32 s76, 0
    s_cbranch_scc1 L_wd_34
    s_sub_u32 s76, s76, 1
    s_branch L_w_33
L_wd_34:
    s_cmp_lg_u32 s57, 0
    s_cbranch_scc1 L_tail
    s_cmp_lt_u32 s60, 0x100
    s_cbranch_scc1 L_tail
    v_mov_b32 v14, 0
    v_mov_b32 v15, 0
    v_mov_b32 v147, 2560
    v_cndmask_b32 v155, v155, v147, s[66:67]
    v_permlane32_swap_b32 v8, v14
    v_permlane32_swap_b32 v9, v15
    s_mov_b32 s57, 1
    v_mov_b32 v150, 0xff800000
    v_mov_b32 v151, 0xff800000
    s_mov_b32 s13, 0
L_mx_e:
    s_mov_b32 m0, s13
    s_nop 0
    s_movrels_b32 s15, s80
    s_sub_u32 s15, s15, 21504
    s_lshl1_add_u32 s61, s13, s12
    s_add_u32 s61, s61, 2
L_w_35:
    ds_read_b32 v3, v1 offset:12
    s_waitcnt lgkmcnt(0)
    v_readfirstlane_b32 s60, v3
    s_nop 0
    s_cmp_ge_u32 s60, s61
    s_cbranch_scc1 L_wd_36
    s_cmp_eq_u32 s76, 0
    s_cbranch_scc1 L_wd_36
    s_sub_u32 s76, s76, 1
    s_sleep 1
    s_branch L_w_35
L_wd_36:
    s_mov_b32 s14, 0
L_mx_t:
    ds_read_b128 v[112:115], v154
    ds_read_b64 v[120:121], v155
    s_waitcnt lgkmcnt(0)
    v_mfma_f32_32x32x16_bf16 v[48:63], v[112:115], v[4:7], 0
    v_mfma_f32_32x32x8_bf16 v[48:63], v[120:121], v[8:9], v[48:63]
    v_mfma_f32_32x32x16_bf16 v[64:79], v[112:115], v[10:13], 0
    v_mfma_f32_32x32x8_bf16 v[64:79], v[120:121], v[14:15], v[64:79]
    s_nop 9
    v_max3_f32 v150, v150, v48, v49
    v_max3_f32 v150, v150, v50, v51
    v_max3_f32 v150, v150, v52, v53
    v_max3_f32 v150, v150, v54, v55
    v_max3_f32 v150, v150, v56, v57
    v_max3_f32 v150, v150, v58, v59
    v_max3_f32 v150, v150, v60, v61
    v_max3_f32 v150, v150, v62, v63
    v_max3_f32 v151, v151, v64, v65
    v_max3_f32 v151, v151, v66, v67
    v_max3_f32 v151, v151, v68, v69
    v_max3_f32 v151, v151, v70, v71
    v_max3_f32 v151, v151, v72, v73
    v_max3_f32 v151, v151, v74, v75
    v_max3_f32 v151, v151, v76, v77
    v_max3_f32 v151, v151, v78, v79
    v_add_u32 v154, 2688, v154
    v_add_u32 v155, 2688, v155
    s_add_u32 s14, s14, 1
    s_cmp_lt_u32 s14, 8
    s_cbranch_scc1 L_mx_t
    s_mov_b64 exec, 1
    ds_add_u32 v159, v2 offset:80
    s_mov_b64 exec, -1
    v_add_u32 v154, s15, v154
    v_add_u32 v155, s15, v155
    s_add_u32 s13, s13, 1
    s_cmp_lt_u32 s13, 8
    s_cbranch_scc1 L_mx_e
    s_add_u32 s12, s12, 16
    v_mov_b32 v148, v150
    s_nop 1
    v_permlane32_swap_b32 v150, v148
    v_max_f32 v150, v150, v148
    v_sub_f32 v150, 0, v150
    v_and_b32 v148, 0xffff0000, v150
    v_sub_f32 v150, v150, v148
    v_and_b32 v147, 0xffff0000, v150
    v_sub_f32 v150, v150, v147
    v_lshrrev_b32 v148, 16, v148
    v_or_b32 v148, v148, v147
    v_lshrrev_b32 v147, 16, v150
    v_cndmask_b32 v8, v8, v148, s[66:67]
    v_cndmask_b32 v9, v9, v147, s[66:67]
    v_mov_b32 v148, v151
    s_nop 1
    v_permlane32_swap_b32 v151, v148
    v_max_f32 v151, v151, v148
    v_sub_f32 v151, 0, v151
    v_and_b32 v148, 0xffff0000, v151
    v_sub_f32 v151, v151, v148
    v_and_b32 v147, 0xffff0000, v151
    v_sub_f32 v151, v151, v147
    v_lshrrev_b32 v148, 16, v148
    v_or_b32 v148, v148, v147
    v_lshrrev_b32 v147, 16, v151
    v_cndmask_b32 v14, v14, v148, s[66:67]
    v_cndmask_b32 v15, v15, v147, s[66:67]
L_pass:
    s_add_u32 s61, s12, 2
    v_mov_b32 v16, 0
    v_mov_b32 v17, 0
    v_mov_b32 v18, 0
    v_mov_b32 v19, 0
    v_mov_b32 v20, 0
    v_mov_b32 v21, 0
    v_mov_b32 v22, 0
    v_mov_b32 v23, 0
    v_mov_b32 v24, 0
    v_mov_b32 v25, 0
    v_mov_b32 v26, 0
    v_mov_b32 v27, 0
    v_mov_b32 v28, 0
    v_mov_b32 v29, 0
    v_mov_b32 v30, 0
    v_mov_b32 v31, 0
    v_mov_b32 v32, 0
    v_mov_b32 v33, 0
    v_mov_b32 v34, 0
    v_mov_b32 v35, 0
    v_mov_b32 v36, 0
    v_mov_b32 v37, 0
    v_mov_b32 v38, 0
    v_mov_b32 v39, 0
    v_mov_b32 v40, 0
    v_mov_b32 v41, 0
    v_mov_b32 v42, 0
    v_mov_b32 v43, 0
    v_mov_b32 v44, 0
    v_mov_b32 v45, 0
    v_mov_b32 v46, 0
    v_mov_b32 v47, 0
    v_mov_b32 v104, 0
    v_mov_b32 v105, 0
    v_mov_b32 v106, 0
    v_mov_b32 v107, 0
    v_mov_b32 v108, 0
    v_mov_b32 v109, 0
    v_mov_b32 v110, 0
    v_mov_b32 v111, 0
    v_mov_b32 v136, 0
    v_mov_b32 v137, 0
    v_mov_b32 v138, 0
    v_mov_b32 v139, 0
L_w_37:
    ds_read_b32 v3, v1 offset:12
    s_waitcnt lgkmcnt(0)
    v_readfirstlane_b32 s60, v3
    s_nop 0
    s_cmp_ge_u32 s60, s61
    s_cbranch_scc1 L_wd_38
    s_cmp_eq_u32 s76, 0
    s_cbranch_scc1 L_wd_38
    s_sub_u32 s76, s76, 1
    s_sleep 0
    s_branch L_w_37
L_wd_38:
    ds_read_b128 v[112:115], v154 offset:0
    ds_read_b64 v[120:121], v155 offset:0
    ds_read_b128 v[116:119], v154 offset:2688
    ds_read_b64 v[122:123], v155 offset:2688
    ds_read_b128 v[124:127], v156
    ds_read_b128 v[128:131], v157
    s_mov_b32 s13, 0
    s_mov_b32 s15, 141824
    s_waitcnt lgkmcnt(4)
    v_mfma_f32_32x32x16_bf16 v[48:63], v[112:115], v[4:7], 0
    v_mfma_f32_32x32x8_bf16 v[48:63], v[120:121], v[8:9], v[48:63]
    s_add_u32 s14, s12, 4
    s_nop 7
    s_nop 1
.p2align 3
L_redo:
    v_mfma_f32_32x32x16_bf16 v[64:79], v[112:115], v[10:13], 0
    v_exp_f32 v80, v48
    v_exp_f32 v81, v49
    v_exp_f32 v82, v50
    v_exp_f32 v83, v51
    v_mfma_f32_32x32x8_bf16 v[64:79], v[120:121], v[14:15], v[64:79]
    v_exp_f32 v84, v52
    v_exp_f32 v85, v53
    v_exp_f32 v86, v54
    v_exp_f32 v87, v55
    v_smfmac_f32_32x32x32_bf16 v[32:47], v[136:139], v[104:111], v158
    v_exp_f32 v88, v56
    v_exp_f32 v89, v57
    v_exp_f32 v90, v58
    v_exp_f32 v91, v59
    s_waitcnt lgkmcnt(0)
    v_smfmac_f32_32x32x32_bf16 v[16:31], v[124:127], v[80:87], v158
    ds_read_b128 v[112:115], v154 offset:5376
    v_exp_f32 v92, v60
    v_exp_f32 v93, v61
    v_exp_f32 v94, v62
    v_exp_f32 v95, v63
    v_mfma_f32_32x32x16_bf16 v[48:63], v[116:119], v[4:7], 0
    ds_read_b64 v[120:121], v155 offset:5376
    v_exp_f32 v96, v64
    v_exp_f32 v97, v65
    v_exp_f32 v98, v66
    v_exp_f32 v99, v67
    v_mfma_f32_32x32x8_bf16 v[48:63], v[122:123], v[8:9], v[48:63]
    ds_read_b128 v[132:135], v156 offset:2688
    v_exp_f32 v100, v68
    v_exp_f32 v101, v69
    v_exp_f32 v102, v70
    v_exp_f32 v103, v71
    v_smfmac_f32_32x32x32_bf16 v[16:31], v[128:131], v[88:95], v158
    ds_read_b128 v[136:139], v157 offset:2688
    v_exp_f32 v104, v72
    v_exp_f32 v105, v73
    v_exp_f32 v106, v74
    v_exp_f32 v107, v75
    v_smfmac_f32_32x32x32_bf16 v[32:47], v[124:127], v[96:103], v158
    v_exp_f32 v108, v76
    v_exp_f32 v109, v77
    v_exp_f32 v110, v78
    v_exp_f32 v111, v79
    v_mfma_f32_32x32x16_bf16 v[64:79], v[116:119], v[10:13], 0
    v_exp_f32 v80, v48
    v_exp_f32 v81, v49
    v_exp_f32 v82, v50
    v_exp_f32 v83, v51
    v_mfma_f32_32x32x8_bf16 v[64:79], v[122:123], v[14:15], v[64:79]
    v_exp_f32 v84, v52
    v_exp_f32 v85, v53
    v_exp_f32 v86, v54
    v_exp_f32 v87, v55
    v_smfmac_f32_32x32x32_bf16 v[32:47], v[128:131], v[104:111], v158
    v_exp_f32 v88, v56
    v_exp_f32 v89, v57
    v_exp_f32 v90, v58
    v_exp_f32 v91, v59
    s_waitcnt lgkmcnt(0)
    v_smfmac_f32_32x32x32_bf16 v[16:31], v[132:135], v[80:87], v158
    ds_read_b128 v[116:119], v154 offset:8064
    v_exp_f32 v92, v60
    v_exp_f32 v93, v61
    v_exp_f32 v94, v62
    v_exp_f32 v95, v63
    v_mfma_f32_32x32x16_bf16 v[48:63], v[112:115], v[4:7], 0
    ds_read_b64 v[122:123], v155 offset:8064
    v_exp_f32 v96, v64
    v_exp_f32 v97, v65
    v_exp_f32 v98, v66
    v_exp_f32 v99, v67
    v_mfma_f32_32x32x8_bf16 v[48:63], v[120:121], v[8:9], v[48:63]
    ds_read_b128 v[124:127], v156 offset:5376
    v_exp_f32 v100, v68
    v_exp_f32 v101, v69
    v_exp_f32 v102, v70
    v_exp_f32 v103, v71
    v_smfmac_f32_32x32x32_bf16 v[16:31], v[136:139], v[88:95], v158
    ds_read_b128 v[128:131], v157 offset:5376
    v_exp_f32 v104, v72
    v_exp_f32 v105, v73
    v_exp_f32 v106, v74
    v_exp_f32 v107, v75
    v_smfmac_f32_32x32x32_bf16 v[32:47], v[132:135], v[96:103], v158
    v_exp_f32 v108, v76
    v_exp_f32 v109, v77
    v_exp_f32 v110, v78
    v_exp_f32 v111, v79
    v_mfma_f32_32x32x16_bf16 v[64:79], v[112:115], v[10:13], 0
    v_exp_f32 v80, v48
    v_exp_f32 v81, v49
    v_exp_f32 v82, v50
    v_exp_f32 v83, v51
    v_mfma_f32_32x32x8_bf16 v[64:79], v[120:121], v[14:15], v[64:79]
    v_exp_f32 v84, v52
    v_exp_f32 v85, v53
    v_exp_f32 v86, v54
    v_exp_f32 v87, v55
    v_smfmac_f32_32x32x32_bf16 v[32:47], v[136:139], v[104:111], v158
    v_exp_f32 v88, v56
    v_exp_f32 v89, v57
    v_exp_f32 v90, v58
    v_exp_f32 v91, v59
    s_waitcnt lgkmcnt(0)
    v_smfmac_f32_32x32x32_bf16 v[16:31], v[124:127], v[80:87], v158
    ds_read_b128 v[112:115], v154 offset:10752
    v_exp_f32 v92, v60
    v_exp_f32 v93, v61
    v_exp_f32 v94, v62
    v_exp_f32 v95, v63
    v_mfma_f32_32x32x16_bf16 v[48:63], v[116:119], v[4:7], 0
    ds_read_b64 v[120:121], v155 offset:10752
    v_exp_f32 v96, v64
    v_exp_f32 v97, v65
    v_exp_f32 v98, v66
    v_exp_f32 v99, v67
    v_mfma_f32_32x32x8_bf16 v[48:63], v[122:123], v[8:9], v[48:63]
    ds_read_b128 v[132:135], v156 offset:8064
    v_exp_f32 v100, v68
    v_exp_f32 v101, v69
    v_exp_f32 v102, v70
    v_exp_f32 v103, v71
    v_smfmac_f32_32x32x32_bf16 v[16:31], v[128:131], v[88:95], v158
    ds_read_b128 v[136:139], v157 offset:8064
    v_exp_f32 v104, v72
    v_exp_f32 v105, v73
    v_exp_f32 v106, v74
    v_exp_f32 v107, v75
    v_smfmac_f32_32x32x32_bf16 v[32:47], v[124:127], v[96:103], v158
    v_exp_f32 v108, v76
    v_exp_f32 v109, v77
    v_exp_f32 v110, v78
    v_exp_f32 v111, v79
    v_mfma_f32_32x32x16_bf16 v[64:79], v[116:119], v[10:13], 0
    v_exp_f32 v80, v48
    v_exp_f32 v81, v49
    v_exp_f32 v82, v50
    v_exp_f32 v83, v51
    v_mfma_f32_32x32x8_bf16 v[64:79], v[122:123], v[14:15], v[64:79]
    v_exp_f32 v84, v52
    v_exp_f32 v85, v53
    v_exp_f32 v86, v54
    v_exp_f32 v87, v55
    v_smfmac_f32_32x32x32_bf16 v[32:47], v[128:131], v[104:111], v158
    v_exp_f32 v88, v56
    v_exp_f32 v89, v57
    v_exp_f32 v90, v58
    v_exp_f32 v91, v59
    s_waitcnt lgkmcnt(0)
    v_smfmac_f32_32x32x32_bf16 v[16:31], v[132:135], v[80:87], v158
    ds_read_b128 v[116:119], v154 offset:13440
    v_exp_f32 v92, v60
    v_exp_f32 v93, v61
    v_exp_f32 v94, v62
    v_exp_f32 v95, v63
    v_mfma_f32_32x32x16_bf16 v[48:63], v[112:115], v[4:7], 0
    ds_read_b64 v[122:123], v155 offset:13440
    v_exp_f32 v96, v64
    v_exp_f32 v97, v65
    v_exp_f32 v98, v66
    v_exp_f32 v99, v67
    v_mfma_f32_32x32x8_bf16 v[48:63], v[120:121], v[8:9], v[48:63]
    ds_read_b128 v[124:127], v156 offset:10752
    v_exp_f32 v100, v68
    v_exp_f32 v101, v69
    v_exp_f32 v102, v70
    v_exp_f32 v103, v71
    v_smfmac_f32_32x32x32_bf16 v[16:31], v[136:139], v[88:95], v158
    ds_read_b128 v[128:131], v157 offset:10752
    v_exp_f32 v104, v72
    v_exp_f32 v105, v73
    v_exp_f32 v106, v74
    v_exp_f32 v107, v75
    v_smfmac_f32_32x32x32_bf16 v[32:47], v[132:135], v[96:103], v158
    v_exp_f32 v108, v76
    v_exp_f32 v109, v77
    v_exp_f32 v110, v78
    v_exp_f32 v111, v79
    v_mfma_f32_32x32x16_bf16 v[64:79], v[112:115], v[10:13], 0
    v_exp_f32 v80, v48
    v_exp_f32 v81, v49
    v_exp_f32 v82, v50
    v_exp_f32 v83, v51
    v_mfma_f32_32x32x8_bf16 v[64:79], v[120:121], v[14:15], v[64:79]
    v_exp_f32 v84, v52
    v_exp_f32 v85, v53
    v_exp_f32 v86, v54
    v_exp_f32 v87, v55
    v_smfmac_f32_32x32x32_bf16 v[32:47], v[136:139], v[104:111], v158
    v_exp_f32 v88, v56
    v_exp_f32 v89, v57
    v_exp_f32 v90, v58
    v_exp_f32 v91, v59
    s_waitcnt lgkmcnt(0)
    v_smfmac_f32_32x32x32_bf16 v[16:31], v[124:127], v[80:87], v158
    ds_read_b128 v[112:115], v154 offset:16128
    v_exp_f32 v92, v60
    v_exp_f32 v93, v61
    v_exp_f32 v94, v62
    v_exp_f32 v95, v63
    v_mfma_f32_32x32x16_bf16 v[48:63], v[116:119], v[4:7], 0
    ds_read_b64 v[120:121], v155 offset:16128
    v_exp_f32 v96, v64
    v_exp_f32 v97, v65
    v_exp_f32 v98, v66
    v_exp_f32 v99, v67
    v_mfma_f32_32x32x8_bf16 v[48:63], v[122:123], v[8:9], v[48:63]
    ds_read_b128 v[132:135], v156 offset:13440
    v_exp_f32 v100, v68
    v_exp_f32 v101, v69
    v_exp_f32 v102, v70
    v_exp_f32 v103, v71
    v_smfmac_f32_32x32x32_bf16 v[16:31], v[128:131], v[88:95], v158
    ds_read_b128 v[136:139], v157 offset:13440
    v_exp_f32 v104, v72
    v_exp_f32 v105, v73
    v_exp_f32 v106, v74
    v_exp_f32 v107, v75
    v_smfmac_f32_32x32x32_bf16 v[32:47], v[124:127], v[96:103], v158
    v_exp_f32 v108, v76
    v_exp_f32 v109, v77
    v_exp_f32 v110, v78
    v_exp_f32 v111, v79
    v_mfma_f32_32x32x16_bf16 v[64:79], v[116:119], v[10:13], 0
    v_exp_f32 v80, v48
    v_exp_f32 v81, v49
    v_exp_f32 v82, v50
    v_exp_f32 v83, v51
    v_mfma_f32_32x32x8_bf16 v[64:79], v[122:123], v[14:15], v[64:79]
    v_exp_f32 v84, v52
    v_exp_f32 v85, v53
    v_exp_f32 v86, v54
    v_exp_f32 v87, v55
    v_smfmac_f32_32x32x32_bf16 v[32:47], v[128:131], v[104:111], v158
    v_exp_f32 v88, v56
    v_exp_f32 v89, v57
    v_exp_f32 v90, v58
    v_exp_f32 v91, v59
    s_waitcnt lgkmcnt(0)
    v_smfmac_f32_32x32x32_bf16 v[16:31], v[132:135], v[80:87], v158
    ds_read_b128 v[116:119], v154 offset:18816
    v_exp_f32 v92, v60
    v_exp_f32 v93, v61
    v_exp_f32 v94, v62
    v_exp_f32 v95, v63
    v_mfma_f32_32x32x16_bf16 v[48:63], v[112:115], v[4:7], 0
    ds_read_b64 v[122:123], v155 offset:18816
    v_exp_f32 v96, v64
    v_exp_f32 v97, v65
    v_exp_f32 v98, v66
    v_exp_f32 v99, v67
    v_mfma_f32_32x32x8_bf16 v[48:63], v[120:121], v[8:9], v[48:63]
    ds_read_b128 v[124:127], v156 offset:16128
    v_exp_f32 v100, v68
    v_exp_f32 v101, v69
    v_exp_f32 v102, v70
    v_exp_f32 v103, v71
    v_smfmac_f32_32x32x32_bf16 v[16:31], v[136:139], v[88:95], v158
    ds_read_b128 v[128:131], v157 offset:16128
    ds_read_b32 v3, v1 offset:12
    v_exp_f32 v104, v72
    v_exp_f32 v105, v73
    v_exp_f32 v106, v74
    v_exp_f32 v107, v75
    v_smfmac_f32_32x32x32_bf16 v[32:47], v[132:135], v[96:103], v158
    v_exp_f32 v108, v76
    v_exp_f32 v109, v77
    v_exp_f32 v110, v78
    v_exp_f32 v111, v79
    v_mfma_f32_32x32x16_bf16 v[64:79], v[112:115], v[10:13], 0
    v_exp_f32 v80, v48
    v_exp_f32 v81, v49
    v_exp_f32 v82, v50
    v_exp_f32 v83, v51
    v_mfma_f32_32x32x8_bf16 v[64:79], v[120:121], v[14:15], v[64:79]
    v_exp_f32 v84, v52
    v_exp_f32 v85, v53
    v_exp_f32 v86, v54
    v_exp_f32 v87, v55
    v_smfmac_f32_32x32x32_bf16 v[32:47], v[136:139], v[104:111], v158
    v_exp_f32 v88, v56
    v_exp_f32 v89, v57
    v_exp_f32 v90, v58
    v_exp_f32 v91, v59
    s_waitcnt lgkmcnt(0)
    v_add_u32 v154, s15, v154
    v_add_u32 v155, s15, v155
    v_readfirstlane_b32 s60, v3
    s_nop 0
    s_cmp_lt_u32 s60, s14
    s_cbranch_scc1 L_notfull8
L_full8:
    v_smfmac_f32_32x32x32_bf16 v[16:31], v[124:127], v[80:87], v158
    ds_read_b128 v[112:115], v154 offset:0
    v_exp_f32 v92, v60
    v_exp_f32 v93, v61
    v_exp_f32 v94, v62
    v_exp_f32 v95, v63
    v_mfma_f32_32x32x16_bf16 v[48:63], v[116:119], v[4:7], 0
    ds_read_b64 v[120:121], v155 offset:0
    v_exp_f32 v96, v64
    v_exp_f32 v97, v65
    v_exp_f32 v98, v66
    v_exp_f32 v99, v67
    v_mfma_f32_32x32x8_bf16 v[48:63], v[122:123], v[8:9], v[48:63]
    ds_read_b128 v[132:135], v156 offset:18816
    v_exp_f32 v100, v68
    v_exp_f32 v101, v69
    v_exp_f32 v102, v70
    v_exp_f32 v103, v71
    v_smfmac_f32_32x32x32_bf16 v[16:31], v[128:131], v[88:95], v158
    ds_read_b128 v[136:139], v157 offset:18816
    s_mov_b64 exec, 1
    ds_add_u32 v159, v2 offset:80
    s_mov_b64 exec, -1
    v_exp_f32 v104, v72
    v_exp_f32 v105, v73
    v_exp_f32 v106, v74
    v_exp_f32 v107, v75
    v_smfmac_f32_32x32x32_bf16 v[32:47], v[124:127], v[96:103], v158
    v_exp_f32 v108, v76
    v_exp_f32 v109, v77
    v_exp_f32 v110, v78
    v_exp_f32 v111, v79
    v_mfma_f32_32x32x16_bf16 v[64:79], v[116:119], v[10:13], 0
    v_exp_f32 v80, v48
    v_exp_f32 v81, v49
    v_exp_f32 v82, v50
    v_exp_f32 v83, v51
    v_mfma_f32_32x32x8_bf16 v[64:79], v[122:123], v[14:15], v[64:79]
    v_exp_f32 v84, v52
    v_exp_f32 v85, v53
    v_exp_f32 v86, v54
    v_exp_f32 v87, v55
    v_smfmac_f32_32x32x32_bf16 v[32:47], v[128:131], v[104:111], v158
    v_exp_f32 v88, v56
    v_exp_f32 v89, v57
    v_exp_f32 v90, v58
    v_exp_f32 v91, v59
    s_waitcnt lgkmcnt(0)
    v_smfmac_f32_32x32x32_bf16 v[16:31], v[132:135], v[80:87], v158
    ds_read_b128 v[116:119], v154 offset:2688
    v_exp_f32 v92, v60
    v_exp_f32 v93, v61
    v_exp_f32 v94, v62
    v_exp_f32 v95, v63
    v_mfma_f32_32x32x16_bf16 v[48:63], v[112:115], v[4:7], 0
    ds_read_b64 v[122:123], v155 offset:2688
    v_exp_f32 v96, v64
    v_exp_f32 v97, v65
    v_exp_f32 v98, v66
    v_exp_f32 v99, v67
    v_add_u32 v156, s15, v156
    v_add_u32 v157, s15, v157
    v_mfma_f32_32x32x8_bf16 v[48:63], v[120:121], v[8:9], v[48:63]
    ds_read_b128 v[124:127], v156 offset:0
    v_exp_f32 v100, v68
    v_exp_f32 v101, v69
    v_exp_f32 v102, v70
    v_exp_f32 v103, v71
    v_smfmac_f32_32x32x32_bf16 v[16:31], v[136:139], v[88:95], v158
    ds_read_b128 v[128:131], v157 offset:0
    v_exp_f32 v104, v72
    v_exp_f32 v105, v73
    v_exp_f32 v106, v74
    v_exp_f32 v107, v75
    s_add_u32 s13, s13, 1
    s_mov_b32 m0, s13
    s_cmp_lt_u32 s13, 7
    s_cselect_b32 s59, 2, 0
    s_add_u32 s14, s14, s59
    s_movrels_b32 s15, s80
    s_cmp_lt_u32 s13, 8
    v_smfmac_f32_32x32x32_bf16 v[32:47], v[132:135], v[96:103], v158
    v_exp_f32 v108, v76
    v_exp_f32 v109, v77
    v_exp_f32 v110, v78
    v_exp_f32 v111, v79
    s_cbranch_scc1 L_redo
    s_nop 1
    v_smfmac_f32_32x32x32_bf16 v[32:47], v[136:139], v[104:111], v158
    s_waitcnt lgkmcnt(0)
    s_nop 7
    s_branch L_norm
L_qwait:
L_w_39:
    ds_read_b32 v3, v148 offset:32
    s_waitcnt lgkmcnt(0)
    v_readfirstlane_b32 s60, v3
    s_nop 0
    s_cmp_ge_u32 s60, s61
    s_cbranch_scc1 L_wd_40
    s_cmp_eq_u32 s76, 0
    s_cbranch_scc1 L_wd_40
    s_sub_u32 s76, s76, 1
    s_sleep 0
    s_branch L_w_39
L_wd_40:
    s_branch L_qgo
L_notfull0:
L_w_41:
    ds_read_b32 v3, v1 offset:12
    s_waitcnt lgkmcnt(0)
    v_readfirstlane_b32 s60, v3
    s_nop 0
    s_cmp_ge_u32 s60, s14
    s_cbranch_scc1 L_wd_42
    s_cmp_eq_u32 s76, 0
    s_cbranch_scc1 L_wd_42
    s_sub_u32 s76, s76, 1
    s_sleep 0
    s_branch L_w_41
L_wd_42:
    s_branch L_full0
L_notfull8:
L_w_43:
    ds_read_b32 v3, v1 offset:12
    s_waitcnt lgkmcnt(0)
    v_readfirstlane_b32 s60, v3
    s_nop 0
    s_cmp_ge_u32 s60, s14
    s_cbranch_scc1 L_wd_44
    s_cmp_eq_u32 s76, 0
    s_cbranch_scc1 L_wd_44
    s_sub_u32 s76, s76, 1
    s_sleep 0
    s_branch L_w_43
L_wd_44:
    s_branch L_full8
L_tail:
    s_setprio 2
    s_lshl_b32 s56, 1, s7
    v_mov_b32 v44, v152
    v_mov_b32 v45, v153
    v_add_u32 v46, 51200, v152
    v_add_u32 v47, 51200, v153
    s_add_u32 s80, s77, 0
    s_add_u32 s81, s77, 5120
    s_add_u32 s82, s77, 10240
    s_add_u32 s83, s77, 15360
    s_add_u32 s84, s77, 20480
    s_add_u32 s85, s77, 25600
    s_add_u32 s86, s77, 30720
    s_add_u32 s87, s77, 35840
    s_add_u32 s88, s77, 4096
    s_add_u32 s89, s77, 14336
    s_add_u32 s90, s77, 24576
    s_add_u32 s91, s77, 34816
    s_mov_b32 s44, s32
    s_mov_b32 s45, s33
    s_mov_b32 s46, 0x500000
    s_mov_b32 s47, 0x20000
    s_mul_i32 s12, s3, 2560
    v_and_b32 v53, 15, v0
    v_mul_u32_u24 v53, 160, v53
    v_lshrrev_b32 v54, 4, v0
    v_lshl_add_u32 v53, v54, 3, v53
    v_add_u32 v48, s12, v53
    v_lshlrev_b32 v53, 4, v0
    v_add_u32 v49, s12, v53
    v_add_u32 v53, 0, v0
    v_mul_u32_u24 v54, 52429, v53
    v_lshrrev_b32 v54, 19, v54
    v_mul_u32_u24 v55, 10, v54
    v_sub_u32 v55, v53, v55
    v_mul_u32_u24 v54, 2560, v54
    v_lshl_add_u32 v50, v55, 4, v54
    v_add_u32 v53, 64, v0
    v_mul_u32_u24 v54, 52429, v53
    v_lshrrev_b32 v54, 19, v54
    v_mul_u32_u24 v55, 10, v54
    v_sub_u32 v55, v53, v55
    v_mul_u32_u24 v54, 2560, v54
    v_lshl_add_u32 v51, v55, 4, v54
    v_add_u32 v53, 128, v0
    v_mul_u32_u24 v54, 52429, v53
    v_lshrrev_b32 v54, 19, v54
    v_mul_u32_u24 v55, 10, v54
    v_sub_u32 v55, v53, v55
    v_mul_u32_u24 v54, 2560, v54
    v_lshl_add_u32 v52, v55, 4, v54
    s_add_u32 s61, s57, 1
L_w_45:
    ds_read_b32 v3, v1 offset:60
    s_waitcnt lgkmcnt(0)
    v_readfirstlane_b32 s60, v3
    s_nop 0
    s_cmp_ge_u32 s60, s61
    s_cbranch_scc1 L_wd_46
    s_cmp_eq_u32 s76, 0
    s_cbranch_scc1 L_wd_46
    s_sub_u32 s76, s76, 1
    s_sleep 0
    s_branch L_w_45
L_wd_46:
L_trdy:
    ds_read_b32 v3, v1 offset:96
    s_waitcnt lgkmcnt(0)
    v_readfirstlane_b32 s60, v3
    s_nop 0
    s_or_b32 s60, s60, s56
    s_cmp_eq_u32 s60, 0xff
    s_cbranch_scc1 L_tgo
    s_cmp_eq_u32 s76, 0
    s_cbranch_scc1 L_tgo
    s_sub_u32 s76, s76, 1
    s_branch L_trdy
L_tgo:
    buffer_load_dwordx4 v[64:67], v164, s[40:43], s80 offen offset:0 sc1
    buffer_load_dwordx4 v[68:71], v164, s[40:43], s80 offen offset:2048 sc1
    buffer_load_dwordx4 v[72:75], v164, s[40:43], s81 offen offset:0 sc1
    buffer_load_dwordx4 v[76:79], v164, s[40:43], s81 offen offset:2048 sc1
    buffer_load_dwordx4 v[80:83], v164, s[40:43], s82 offen offset:0 sc1
    buffer_load_dwordx4 v[84:87], v164, s[40:43], s82 offen offset:2048 sc1
    buffer_load_dwordx4 v[88:91], v164, s[40:43], s83 offen offset:0 sc1
    buffer_load_dwordx4 v[92:95], v164, s[40:43], s83 offen offset:2048 sc1
    ds_read_b64_tr_b16 v[4:5], v44 offset:0
    ds_read_b64_tr_b16 v[6:7], v44 offset:1280
    ds_read_b64_tr_b16 v[8:9], v44 offset:32
    ds_read_b64_tr_b16 v[10:11], v44 offset:1312
    ds_read_b64_tr_b16 v[12:13], v44 offset:64
    ds_read_b64_tr_b16 v[14:15], v44 offset:1344
    ds_read_b64_tr_b16 v[16:17], v44 offset:96
    ds_read_b64_tr_b16 v[18:19], v44 offset:1376
    ds_read_b64_tr_b16 v[20:21], v44 offset:128
    ds_read_b64_tr_b16 v[22:23], v44 offset:1408
    ds_read_b64_tr_b16 v[24:25], v44 offset:6400
    ds_read_b64_tr_b16 v[26:27], v44 offset:7680
    s_waitcnt vmcnt(7) lgkmcnt(8)
    v_mfma_f32_16x16x32_bf16 v[144:147], v[4:7], v[64:67], 0
    ds_read_b64_tr_b16 v[28:29], v44 offset:6432
    ds_read_b64_tr_b16 v[30:31], v44 offset:7712
    buffer_load_dwordx4 v[96:99], v165, s[40:43], s88 offen sc1
    v_mfma_f32_16x16x32_bf16 v[148:151], v[8:11], v[64:67], 0
    ds_read_b64_tr_b16 v[32:33], v44 offset:6464
    ds_read_b64_tr_b16 v[34:35], v44 offset:7744
    s_waitcnt lgkmcnt(8)
    v_mfma_f32_16x16x32_bf16 v[152:155], v[12:15], v[64:67], 0
    ds_read_b64_tr_b16 v[36:37], v44 offset:6496
    ds_read_b64_tr_b16 v[38:39], v44 offset:7776
    v_mfma_f32_16x16x32_bf16 v[156:159], v[16:19], v[64:67], 0
    ds_read_b64_tr_b16 v[40:41], v44 offset:6528
    ds_read_b64_tr_b16 v[42:43], v44 offset:7808
    s_waitcnt lgkmcnt(8)
    v_mfma_f32_16x16x32_bf16 v[160:163], v[20:23], v[64:67], 0
    ds_read_b64_tr_b16 v[4:5], v44 offset:12800
    ds_read_b64_tr_b16 v[6:7], v44 offset:14080
    s_waitcnt vmcnt(7)
    v_mfma_f32_16x16x32_bf16 v[144:147], v[24:27], v[68:71], v[144:147]
    ds_read_b64_tr_b16 v[8:9], v44 offset:12832
    ds_read_b64_tr_b16 v[10:11], v44 offset:14112
    buffer_load_dwordx4 v[100:103], v165, s[40:43], s89 offen sc1
    s_waitcnt lgkmcnt(8)
    v_mfma_f32_16x16x32_bf16 v[148:151], v[28:31], v[68:71], v[148:151]
    ds_read_b64_tr_b16 v[12:13], v44 offset:12864
    ds_read_b64_tr_b16 v[14:15], v44 offset:14144
    v_mfma_f32_16x16x32_bf16 v[152:155], v[32:35], v[68:71], v[152:155]
    ds_read_b64_tr_b16 v[16:17], v44 offset:12896
    ds_read_b64_tr_b16 v[18:19], v44 offset:14176
    s_waitcnt lgkmcnt(8)
    v_mfma_f32_16x16x32_bf16 v[156:159], v[36:39], v[68:71], v[156:159]
    ds_read_b64_tr_b16 v[20:21], v44 offset:12928
    ds_read_b64_tr_b16 v[22:23], v44 offset:14208
    v_mfma_f32_16x16x32_bf16 v[160:163], v[40:43], v[68:71], v[160:163]
    ds_read_b64_tr_b16 v[24:25], v44 offset:19200
    ds_read_b64_tr_b16 v[26:27], v44 offset:20480
    s_waitcnt vmcnt(7) lgkmcnt(8)
    v_mfma_f32_16x16x32_bf16 v[144:147], v[4:7], v[72:75], v[144:147]
    ds_read_b64_tr_b16 v[28:29], v44 offset:19232
    ds_read_b64_tr_b16 v[30:31], v44 offset:20512
    buffer_load_dwordx4 v[104:107], v164, s[40:43], s84 offen offset:0 sc1
    v_mfma_f32_16x16x32_bf16 v[148:151], v[8:11], v[72:75], v[148:151]
    ds_read_b64_tr_b16 v[32:33], v44 offset:19264
    ds_read_b64_tr_b16 v[34:35], v44 offset:20544
    s_waitcnt lgkmcnt(8)
    v_mfma_f32_16x16x32_bf16 v[152:155], v[12:15], v[72:75], v[152:155]
    ds_read_b64_tr_b16 v[36:37], v44 offset:19296
    ds_read_b64_tr_b16 v[38:39], v44 offset:20576
    v_mfma_f32_16x16x32_bf16 v[156:159], v[16:19], v[72:75], v[156:159]
    ds_read_b64_tr_b16 v[40:41], v44 offset:19328
    ds_read_b64_tr_b16 v[42:43], v44 offset:20608
    s_waitcnt lgkmcnt(8)
    v_mfma_f32_16x16x32_bf16 v[160:163], v[20:23], v[72:75], v[160:163]
    ds_read_b64_tr_b16 v[4:5], v44 offset:25600
    ds_read_b64_tr_b16 v[6:7], v44 offset:26880
    s_waitcnt vmcnt(7)
    v_mfma_f32_16x16x32_bf16 v[144:147], v[24:27], v[76:79], v[144:147]
    ds_read_b64_tr_b16 v[8:9], v44 offset:25632
    ds_read_b64_tr_b16 v[10:11], v44 offset:26912
    buffer_load_dwordx4 v[108:111], v164, s[40:43], s84 offen offset:2048 sc1
    s_waitcnt lgkmcnt(8)
    v_mfma_f32_16x16x32_bf16 v[148:151], v[28:31], v[76:79], v[148:151]
    ds_read_b64_tr_b16 v[12:13], v44 offset:25664
    ds_read_b64_tr_b16 v[14:15], v44 offset:26944
    v_mfma_f32_16x16x32_bf16 v[152:155], v[32:35], v[76:79], v[152:155]
    ds_read_b64_tr_b16 v[16:17], v44 offset:25696
    ds_read_b64_tr_b16 v[18:19], v44 offset:26976
    s_waitcnt lgkmcnt(8)
    v_mfma_f32_16x16x32_bf16 v[156:159], v[36:39], v[76:79], v[156:159]
    ds_read_b64_tr_b16 v[20:21], v44 offset:25728
    ds_read_b64_tr_b16 v[22:23], v44 offset:27008
    v_mfma_f32_16x16x32_bf16 v[160:163], v[40:43], v[76:79], v[160:163]
    ds_read_b64_tr_b16 v[24:25], v44 offset:32000
    ds_read_b64_tr_b16 v[26:27], v44 offset:33280
    s_waitcnt vmcnt(7) lgkmcnt(8)
    v_mfma_f32_16x16x32_bf16 v[144:147], v[4:7], v[80:83], v[144:147]
    ds_read_b64_tr_b16 v[28:29], v44 offset:32032
    ds_read_b64_tr_b16 v[30:31], v44 offset:33312
    buffer_load_dwordx4 v[112:115], v164, s[40:43], s85 offen offset:0 sc1
    v_mfma_f32_16x16x32_bf16 v[148:151], v[8:11], v[80:83], v[148:151]
    ds_read_b64_tr_b16 v[32:33], v44 offset:32064
    ds_read_b64_tr_b16 v[34:35], v44 offset:33344
    s_waitcnt lgkmcnt(8)
    v_mfma_f32_16x16x32_bf16 v[152:155], v[12:15], v[80:83], v[152:155]
    ds_read_b64_tr_b16 v[36:37], v44 offset:32096
    ds_read_b64_tr_b16 v[38:39], v44 offset:33376
    v_mfma_f32_16x16x32_bf16 v[156:159], v[16:19], v[80:83], v[156:159]
    ds_read_b64_tr_b16 v[40:41], v44 offset:32128
    ds_read_b64_tr_b16 v[42:43], v44 offset:33408
    s_waitcnt lgkmcnt(8)
    v_mfma_f32_16x16x32_bf16 v[160:163], v[20:23], v[80:83], v[160:163]
    ds_read_b64_tr_b16 v[4:5], v44 offset:38400
    ds_read_b64_tr_b16 v[6:7], v44 offset:39680
    s_waitcnt vmcnt(7)
    v_mfma_f32_16x16x32_bf16 v[144:147], v[24:27], v[84:87], v[144:147]
    ds_read_b64_tr_b16 v[8:9], v44 offset:38432
    ds_read_b64_tr_b16 v[10:11], v44 offset:39712
    buffer_load_dwordx4 v[116:119], v164, s[40:43], s85 offen offset:2048 sc1
    s_waitcnt lgkmcnt(8)
    v_mfma_f32_16x16x32_bf16 v[148:151], v[28:31], v[84:87], v[148:151]
    ds_read_b64_tr_b16 v[12:13], v44 offset:38464
    ds_read_b64_tr_b16 v[14:15], v44 offset:39744
    v_mfma_f32_16x16x32_bf16 v[152:155], v[32:35], v[84:87], v[152:155]
    ds_read_b64_tr_b16 v[16:17], v44 offset:38496
    ds_read_b64_tr_b16 v[18:19], v44 offset:39776
    s_waitcnt lgkmcnt(8)
    v_mfma_f32_16x16x32_bf16 v[156:159], v[36:39], v[84:87], v[156:159]
    ds_read_b64_tr_b16 v[20:21], v44 offset:38528
    ds_read_b64_tr_b16 v[22:23], v44 offset:39808
    v_mfma_f32_16x16x32_bf16 v[160:163], v[40:43], v[84:87], v[160:163]
    ds_read_b64_tr_b16 v[24:25], v44 offset:44800
    ds_read_b64_tr_b16 v[26:27], v44 offset:46080
    s_waitcnt vmcnt(7) lgkmcnt(8)
    v_mfma_f32_16x16x32_bf16 v[144:147], v[4:7], v[88:91], v[144:147]
    ds_read_b64_tr_b16 v[28:29], v44 offset:44832
    ds_read_b64_tr_b16 v[30:31], v44 offset:46112
    buffer_load_dwordx4 v[120:123], v164, s[40:43], s86 offen offset:0 sc1
    v_mfma_f32_16x16x32_bf16 v[148:151], v[8:11], v[88:91], v[148:151]
    ds_read_b64_tr_b16 v[32:33], v44 offset:44864
    ds_read_b64_tr_b16 v[34:35], v44 offset:46144
    s_waitcnt lgkmcnt(8)
    v_mfma_f32_16x16x32_bf16 v[152:155], v[12:15], v[88:91], v[152:155]
    ds_read_b64_tr_b16 v[36:37], v44 offset:44896
    ds_read_b64_tr_b16 v[38:39], v44 offset:46176
    v_mfma_f32_16x16x32_bf16 v[156:159], v[16:19], v[88:91], v[156:159]
    ds_read_b64_tr_b16 v[40:41], v44 offset:44928
    ds_read_b64_tr_b16 v[42:43], v44 offset:46208
    s_waitcnt lgkmcnt(8)
    v_mfma_f32_16x16x32_bf16 v[160:163], v[20:23], v[88:91], v[160:163]
    ds_read_b64_tr_b16 v[4:5], v45 offset:0
    ds_read_b64_tr_b16 v[6:7], v45 offset:3200
    s_waitcnt vmcnt(7)
    v_mfma_f32_16x16x32_bf16 v[144:147], v[24:27], v[92:95], v[144:147]
    ds_read_b64_tr_b16 v[8:9], v45 offset:32
    ds_read_b64_tr_b16 v[10:11], v45 offset:3232
    buffer_load_dwordx4 v[124:127], v164, s[40:43], s86 offen offset:2048 sc1
    s_waitcnt lgkmcnt(8)
    v_mfma_f32_16x16x32_bf16 v[148:151], v[28:31], v[92:95], v[148:151]
    ds_read_b64_tr_b16 v[12:13], v45 offset:64
    ds_read_b64_tr_b16 v[14:15], v45 offset:3264
    v_mfma_f32_16x16x32_bf16 v[152:155], v[32:35], v[92:95], v[152:155]
    ds_read_b64_tr_b16 v[16:17], v45 offset:96
    ds_read_b64_tr_b16 v[18:19], v45 offset:3296
    s_waitcnt lgkmcnt(8)
    v_mfma_f32_16x16x32_bf16 v[156:159], v[36:39], v[92:95], v[156:159]
    ds_read_b64_tr_b16 v[20:21], v45 offset:128
    ds_read_b64_tr_b16 v[22:23], v45 offset:3328
    v_mfma_f32_16x16x32_bf16 v[160:163], v[40:43], v[92:95], v[160:163]
    ds_read_b64_tr_b16 v[24:25], v45 offset:25600
    ds_read_b64_tr_b16 v[26:27], v45 offset:28800
    s_waitcnt vmcnt(7) lgkmcnt(8)
    v_mfma_f32_16x16x32_bf16 v[144:147], v[4:7], v[96:99], v[144:147]
    ds_read_b64_tr_b16 v[28:29], v45 offset:25632
    ds_read_b64_tr_b16 v[30:31], v45 offset:28832
    buffer_load_dwordx4 v[128:131], v164, s[40:43], s87 offen offset:0 sc1
    v_mfma_f32_16x16x32_bf16 v[148:151], v[8:11], v[96:99], v[148:151]
    ds_read_b64_tr_b16 v[32:33], v45 offset:25664
    ds_read_b64_tr_b16 v[34:35], v45 offset:28864
    s_waitcnt lgkmcnt(8)
    v_mfma_f32_16x16x32_bf16 v[152:155], v[12:15], v[96:99], v[152:155]
    ds_read_b64_tr_b16 v[36:37], v45 offset:25696
    ds_read_b64_tr_b16 v[38:39], v45 offset:28896
    v_mfma_f32_16x16x32_bf16 v[156:159], v[16:19], v[96:99], v[156:159]
    ds_read_b64_tr_b16 v[40:41], v45 offset:25728
    ds_read_b64_tr_b16 v[42:43], v45 offset:28928
    s_waitcnt lgkmcnt(8)
    v_mfma_f32_16x16x32_bf16 v[160:163], v[20:23], v[96:99], v[160:163]
    ds_read_b64_tr_b16 v[4:5], v46 offset:0
    ds_read_b64_tr_b16 v[6:7], v46 offset:1280
    s_waitcnt vmcnt(7)
    v_mfma_f32_16x16x32_bf16 v[144:147], v[24:27], v[100:103], v[144:147]
    ds_read_b64_tr_b16 v[8:9], v46 offset:32
    ds_read_b64_tr_b16 v[10:11], v46 offset:1312
    buffer_load_dwordx4 v[132:135], v164, s[40:43], s87 offen offset:2048 sc1
    s_waitcnt lgkmcnt(8)
    v_mfma_f32_16x16x32_bf16 v[148:151], v[28:31], v[100:103], v[148:151]
    ds_read_b64_tr_b16 v[12:13], v46 offset:64
    ds_read_b64_tr_b16 v[14:15], v46 offset:1344
    v_mfma_f32_16x16x32_bf16 v[152:155], v[32:35], v[100:103], v[152:155]
    ds_read_b64_tr_b16 v[16:17], v46 offset:96
    ds_read_b64_tr_b16 v[18:19], v46 offset:1376
    s_waitcnt lgkmcnt(8)
    v_mfma_f32_16x16x32_bf16 v[156:159], v[36:39], v[100:103], v[156:159]
    ds_read_b64_tr_b16 v[20:21], v46 offset:128
    ds_read_b64_tr_b16 v[22:23], v46 offset:1408
    v_mfma_f32_16x16x32_bf16 v[160:163], v[40:43], v[100:103], v[160:163]
    ds_read_b64_tr_b16 v[24:25], v46 offset:6400
    ds_read_b64_tr_b16 v[26:27], v46 offset:7680
    s_waitcnt vmcnt(7) lgkmcnt(8)
    v_mfma_f32_16x16x32_bf16 v[144:147], v[4:7], v[104:107], v[144:147]
    ds_read_b64_tr_b16 v[28:29], v46 offset:6432
    ds_read_b64_tr_b16 v[30:31], v46 offset:7712
    buffer_load_dwordx4 v[136:139], v165, s[40:43], s90 offen sc1
    v_mfma_f32_16x16x32_bf16 v[148:151], v[8:11], v[104:107], v[148:151]
    ds_read_b64_tr_b16 v[32:33], v46 offset:6464
    ds_read_b64_tr_b16 v[34:35], v46 offset:7744
    s_waitcnt lgkmcnt(8)
    v_mfma_f32_16x16x32_bf16 v[152:155], v[12:15], v[104:107], v[152:155]
    ds_read_b64_tr_b16 v[36:37], v46 offset:6496
    ds_read_b64_tr_b16 v[38:39], v46 offset:7776
    v_mfma_f32_16x16x32_bf16 v[156:159], v[16:19], v[104:107], v[156:159]
    ds_read_b64_tr_b16 v[40:41], v46 offset:6528
    ds_read_b64_tr_b16 v[42:43], v46 offset:7808
    s_waitcnt lgkmcnt(8)
    v_mfma_f32_16x16x32_bf16 v[160:163], v[20:23], v[104:107], v[160:163]
    ds_read_b64_tr_b16 v[4:5], v46 offset:12800
    ds_read_b64_tr_b16 v[6:7], v46 offset:14080
    s_waitcnt vmcnt(7)
    v_mfma_f32_16x16x32_bf16 v[144:147], v[24:27], v[108:111], v[144:147]
    ds_read_b64_tr_b16 v[8:9], v46 offset:12832
    ds_read_b64_tr_b16 v[10:11], v46 offset:14112
    buffer_load_dwordx4 v[140:143], v165, s[40:43], s91 offen sc1
    s_waitcnt lgkmcnt(8)
    v_mfma_f32_16x16x32_bf16 v[148:151], v[28:31], v[108:111], v[148:151]
    ds_read_b64_tr_b16 v[12:13], v46 offset:12864
    ds_read_b64_tr_b16 v[14:15], v46 offset:14144
    v_mfma_f32_16x16x32_bf16 v[152:155], v[32:35], v[108:111], v[152:155]
    ds_read_b64_tr_b16 v[16:17], v46 offset:12896
    ds_read_b64_tr_b16 v[18:19], v46 offset:14176
    s_waitcnt lgkmcnt(8)
    v_mfma_f32_16x16x32_bf16 v[156:159], v[36:39], v[108:111], v[156:159]
    ds_read_b64_tr_b16 v[20:21], v46 offset:12928
    ds_read_b64_tr_b16 v[22:23], v46 offset:14208
    v_mfma_f32_16x16x32_bf16 v[160:163], v[40:43], v[108:111], v[160:163]
    ds_read_b64_tr_b16 v[24:25], v46 offset:19200
    ds_read_b64_tr_b16 v[26:27], v46 offset:20480
    s_waitcnt vmcnt(7) lgkmcnt(8)
    v_mfma_f32_16x16x32_bf16 v[144:147], v[4:7], v[112:115], v[144:147]
    ds_read_b64_tr_b16 v[28:29], v46 offset:19232
    ds_read_b64_tr_b16 v[30:31], v46 offset:20512
    v_mfma_f32_16x16x32_bf16 v[148:151], v[8:11], v[112:115], v[148:151]
    ds_read_b64_tr_b16 v[32:33], v46 offset:19264
    ds_read_b64_tr_b16 v[34:35], v46 offset:20544
    s_waitcnt lgkmcnt(8)
    v_mfma_f32_16x16x32_bf16 v[152:155], v[12:15], v[112:115], v[152:155]
    ds_read_b64_tr_b16 v[36:37], v46 offset:19296
    ds_read_b64_tr_b16 v[38:39], v46 offset:20576
    v_mfma_f32_16x16x32_bf16 v[156:159], v[16:19], v[112:115], v[156:159]
    ds_read_b64_tr_b16 v[40:41], v46 offset:19328
    ds_read_b64_tr_b16 v[42:43], v46 offset:20608
    s_waitcnt lgkmcnt(8)
    v_mfma_f32_16x16x32_bf16 v[160:163], v[20:23], v[112:115], v[160:163]
    ds_read_b64_tr_b16 v[4:5], v46 offset:25600
    ds_read_b64_tr_b16 v[6:7], v46 offset:26880
    s_waitcnt vmcnt(6)
    v_mfma_f32_16x16x32_bf16 v[144:147], v[24:27], v[116:119], v[144:147]
    ds_read_b64_tr_b16 v[8:9], v46 offset:25632
    ds_read_b64_tr_b16 v[10:11], v46 offset:26912
    s_waitcnt lgkmcnt(8)
    v_mfma_f32_16x16x32_bf16 v[148:151], v[28:31], v[116:119], v[148:151]
    ds_read_b64_tr_b16 v[12:13], v46 offset:25664
    ds_read_b64_tr_b16 v[14:15], v46 offset:26944
    v_mfma_f32_16x16x32_bf16 v[152:155], v[32:35], v[116:119], v[152:155]
    ds_read_b64_tr_b16 v[16:17], v46 offset:25696
    ds_read_b64_tr_b16 v[18:19], v46 offset:26976
    s_waitcnt lgkmcnt(8)
    v_mfma_f32_16x16x32_bf16 v[156:159], v[36:39], v[116:119], v[156:159]
    ds_read_b64_tr_b16 v[20:21], v46 offset:25728
    ds_read_b64_tr_b16 v[22:23], v46 offset:27008
    v_mfma_f32_16x16x32_bf16 v[160:163], v[40:43], v[116:119], v[160:163]
    ds_read_b64_tr_b16 v[24:25], v46 offset:32000
    ds_read_b64_tr_b16 v[26:27], v46 offset:33280
    s_waitcnt vmcnt(5) lgkmcnt(8)
    v_mfma_f32_16x16x32_bf16 v[144:147], v[4:7], v[120:123], v[144:147]
    ds_read_b64_tr_b16 v[28:29], v46 offset:32032
    ds_read_b64_tr_b16 v[30:31], v46 offset:33312
    v_mfma_f32_16x16x32_bf16 v[148:151], v[8:11], v[120:123], v[148:151]
    ds_read_b64_tr_b16 v[32:33], v46 offset:32064
    ds_read_b64_tr_b16 v[34:35], v46 offset:33344
    s_waitcnt lgkmcnt(8)
    v_mfma_f32_16x16x32_bf16 v[152:155], v[12:15], v[120:123], v[152:155]
    ds_read_b64_tr_b16 v[36:37], v46 offset:32096
    ds_read_b64_tr_b16 v[38:39], v46 offset:33376
    v_mfma_f32_16x16x32_bf16 v[156:159], v[16:19], v[120:123], v[156:159]
    ds_read_b64_tr_b16 v[40:41], v46 offset:32128
    ds_read_b64_tr_b16 v[42:43], v46 offset:33408
    s_waitcnt lgkmcnt(8)
    v_mfma_f32_16x16x32_bf16 v[160:163], v[20:23], v[120:123], v[160:163]
    ds_read_b64_tr_b16 v[4:5], v46 offset:38400
    ds_read_b64_tr_b16 v[6:7], v46 offset:39680
    s_waitcnt vmcnt(4)
    v_mfma_f32_16x16x32_bf16 v[144:147], v[24:27], v[124:127], v[144:147]
    ds_read_b64_tr_b16 v[8:9], v46 offset:38432
    ds_read_b64_tr_b16 v[10:11], v46 offset:39712
    s_waitcnt lgkmcnt(8)
    v_mfma_f32_16x16x32_bf16 v[148:151], v[28:31], v[124:127], v[148:151]
    ds_read_b64_tr_b16 v[12:13], v46 offset:38464
    ds_read_b64_tr_b16 v[14:15], v46 offset:39744
    v_mfma_f32_16x16x32_bf16 v[152:155], v[32:35], v[124:127], v[152:155]
    ds_read_b64_tr_b16 v[16:17], v46 offset:38496
    ds_read_b64_tr_b16 v[18:19], v46 offset:39776
    s_waitcnt lgkmcnt(8)
    v_mfma_f32_16x16x32_bf16 v[156:159], v[36:39], v[124:127], v[156:159]
    ds_read_b64_tr_b16 v[20:21], v46 offset:38528
    ds_read_b64_tr_b16 v[22:23], v46 offset:39808
    v_mfma_f32_16x16x32_bf16 v[160:163], v[40:43], v[124:127], v[160:163]
    ds_read_b64_tr_b16 v[24:25], v46 offset:44800
    ds_read_b64_tr_b16 v[26:27], v46 offset:46080
    s_waitcnt vmcnt(3) lgkmcnt(8)
    v_mfma_f32_16x16x32_bf16 v[144:147], v[4:7], v[128:131], v[144:147]
    ds_read_b64_tr_b16 v[28:29], v46 offset:44832
    ds_read_b64_tr_b16 v[30:31], v46 offset:46112
    v_mfma_f32_16x16x32_bf16 v[148:151], v[8:11], v[128:131], v[148:151]
    ds_read_b64_tr_b16 v[32:33], v46 offset:44864
    ds_read_b64_tr_b16 v[34:35], v46 offset:46144
    s_waitcnt lgkmcnt(8)
    v_mfma_f32_16x16x32_bf16 v[152:155], v[12:15], v[128:131], v[152:155]
    ds_read_b64_tr_b16 v[36:37], v46 offset:44896
    ds_read_b64_tr_b16 v[38:39], v46 offset:46176
    v_mfma_f32_16x16x32_bf16 v[156:159], v[16:19], v[128:131], v[156:159]
    ds_read_b64_tr_b16 v[40:41], v46 offset:44928
    ds_read_b64_tr_b16 v[42:43], v46 offset:46208
    s_waitcnt lgkmcnt(8)
    v_mfma_f32_16x16x32_bf16 v[160:163], v[20:23], v[128:131], v[160:163]
    ds_read_b64_tr_b16 v[4:5], v47 offset:0
    ds_read_b64_tr_b16 v[6:7], v47 offset:3200
    s_waitcnt vmcnt(2)
    v_mfma_f32_16x16x32_bf16 v[144:147], v[24:27], v[132:135], v[144:147]
    ds_read_b64_tr_b16 v[8:9], v47 offset:32
    ds_read_b64_tr_b16 v[10:11], v47 offset:3232
    s_waitcnt lgkmcnt(8)
    v_mfma_f32_16x16x32_bf16 v[148:151], v[28:31], v[132:135], v[148:151]
    ds_read_b64_tr_b16 v[12:13], v47 offset:64
    ds_read_b64_tr_b16 v[14:15], v47 offset:3264
    v_mfma_f32_16x16x32_bf16 v[152:155], v[32:35], v[132:135], v[152:155]
    ds_read_b64_tr_b16 v[16:17], v47 offset:96
    ds_read_b64_tr_b16 v[18:19], v47 offset:3296
    s_waitcnt lgkmcnt(8)
    v_mfma_f32_16x16x32_bf16 v[156:159], v[36:39], v[132:135], v[156:159]
    ds_read_b64_tr_b16 v[20:21], v47 offset:128
    ds_read_b64_tr_b16 v[22:23], v47 offset:3328
    v_mfma_f32_16x16x32_bf16 v[160:163], v[40:43], v[132:135], v[160:163]
    ds_read_b64_tr_b16 v[24:25], v47 offset:25600
    ds_read_b64_tr_b16 v[26:27], v47 offset:28800
    s_waitcnt vmcnt(1) lgkmcnt(8)
    v_mfma_f32_16x16x32_bf16 v[144:147], v[4:7], v[136:139], v[144:147]
    ds_read_b64_tr_b16 v[28:29], v47 offset:25632
    ds_read_b64_tr_b16 v[30:31], v47 offset:28832
    v_mfma_f32_16x16x32_bf16 v[148:151], v[8:11], v[136:139], v[148:151]
    ds_read_b64_tr_b16 v[32:33], v47 offset:25664
    ds_read_b64_tr_b16 v[34:35], v47 offset:28864
    s_waitcnt lgkmcnt(8)
    v_mfma_f32_16x16x32_bf16 v[152:155], v[12:15], v[136:139], v[152:155]
    ds_read_b64_tr_b16 v[36:37], v47 offset:25696
    ds_read_b64_tr_b16 v[38:39], v47 offset:28896
    v_mfma_f32_16x16x32_bf16 v[156:159], v[16:19], v[136:139], v[156:159]
    ds_read_b64_tr_b16 v[40:41], v47 offset:25728
    ds_read_b64_tr_b16 v[42:43], v47 offset:28928
    s_waitcnt lgkmcnt(8)
    v_mfma_f32_16x16x32_bf16 v[160:163], v[20:23], v[136:139], v[160:163]
    s_waitcnt vmcnt(0)
    v_mfma_f32_16x16x32_bf16 v[144:147], v[24:27], v[140:143], v[144:147]
    s_waitcnt lgkmcnt(4)
    v_mfma_f32_16x16x32_bf16 v[148:151], v[28:31], v[140:143], v[148:151]
    v_mfma_f32_16x16x32_bf16 v[152:155], v[32:35], v[140:143], v[152:155]
    s_waitcnt lgkmcnt(0)
    v_mfma_f32_16x16x32_bf16 v[156:159], v[36:39], v[140:143], v[156:159]
    v_mfma_f32_16x16x32_bf16 v[160:163], v[40:43], v[140:143], v[160:163]
    s_nop 1
    v_cvt_pk_bf16_f32 v4, v144, v145
    v_cvt_pk_bf16_f32 v5, v146, v147
    ds_write_b64 v48, v[4:5] offset:0
    v_cvt_pk_bf16_f32 v6, v148, v149
    v_cvt_pk_bf16_f32 v7, v150, v151
    ds_write_b64 v48, v[6:7] offset:32
    v_cvt_pk_bf16_f32 v8, v152, v153
    v_cvt_pk_bf16_f32 v9, v154, v155
    ds_write_b64 v48, v[8:9] offset:64
    v_cvt_pk_bf16_f32 v10, v156, v157
    v_cvt_pk_bf16_f32 v11, v158, v159
    ds_write_b64 v48, v[10:11] offset:96
    v_cvt_pk_bf16_f32 v12, v160, v161
    v_cvt_pk_bf16_f32 v13, v162, v163
    ds_write_b64 v48, v[12:13] offset:128
    ds_read_b128 v[16:19], v49 offset:0
    ds_read_b128 v[20:23], v49 offset:1024
    ds_read_b128 v[24:27], v49 offset:2048
    s_waitcnt lgkmcnt(2)
    buffer_store_dwordx4 v[16:19], v50, s[44:47], s78 offen
    s_waitcnt lgkmcnt(1)
    buffer_store_dwordx4 v[20:23], v51, s[44:47], s78 offen
    s_waitcnt lgkmcnt(0)
    s_mov_b32 exec_hi, 0
    buffer_store_dwordx4 v[24:27], v52, s[44:47], s78 offen
    s_mov_b64 exec, -1
    s_endpgm
L_h_b1:
    s_setprio 0
    s_add_u32 s10, s3, 3
    s_and_b32 s10, s10, 3
    s_lshl_b32 s11, s4, 5
    s_add_u32 s11, s11, s5
    s_getpc_b64 s[52:53]
L_pc:
    s_add_u32 s52, s52, L_tables-L_pc
    s_addc_u32 s53, s53, 0
    s_mov_b32 s54, 100352
    s_mov_b32 s55, 0x20000
    v_lshlrev_b32 v4, 4, v0
    v_lshrrev_b32 v5, 4, v0
    v_and_b32 v6, 15, v0
    v_lshl_add_u32 v8, v5, 6, v6
    v_lshlrev_b32 v7, 6, v0
    v_lshrrev_b32 v9, 5, v0
    v_and_b32 v10, 31, v0
    v_cmp_lt_u32 s[66:67], 31, v0
    s_mul_i32 s71, s10, 3
    s_cmp_eq_u32 s10, 3
    s_cselect_b32 s71, 8, s71
    s_mul_i32 s14, s6, 10
    s_mul_i32 s15, s7, 321
    s_add_u32 s14, s14, s15
    s_and_b32 s70, s14, 1
    s_add_u32 s70, s70, s71
    s_lshr_b32 s14, s14, 1
    s_lshl_b32 s78, s14, 2
    s_mul_i32 s14, s10, 328704
    s_add_u32 s78, s78, s14
    s_add_u32 s79, s78, 164352
    s_mul_i32 s14, s10, 3072
    s_mul_i32 s77, s11, 11392
    s_add_u32 s77, s77, s14
    s_add_u32 s77, s77, 3145728
    s_lshl_b32 s81, s7, 5
    s_add_u32 s81, s81, s6
    s_mul_i32 s81, s81, 12416
    s_add_u32 s81, s81, s14
    s_add_u32 s81, s81, 6291456
    s_add_u32 s88, s14, 118784
    v_add_u32 v150, s88, v4
    s_mul_i32 s14, s7, 1408
    s_mul_i32 s15, s6, 40
    s_add_u32 s14, s14, s15
    s_mul_i32 s15, s10, 729088
    s_add_u32 s14, s14, s15
    s_add_u32 s80, s14, 3145728
    s_mul_i32 s82, s11, 48
    s_add_u32 s82, s82, 6291456
    s_add_u32 s83, s82, 397312
    s_add_u32 s84, s82, 794624
    s_add_u32 s85, s82, 1191936
    s_lshl_b32 s12, s10, 8
    s_add_u32 s12, s12, s11
    s_mul_i32 s86, s12, 2560
    s_add_u32 s86, s86, 1280
    s_add_u32 s87, s86, 2621440
    v_mul_u32_u24 v165, 40, v10
    v_lshl_add_u32 v165, v9, 3, v165
    v_mul_u32_u24 v148, 320, v9
    v_add_u32 v148, v148, v10
    s_lshl_b32 s14, s10, 2
    s_add_u32 s14, s14, 21504
    v_lshl_add_u32 v148, v148, 4, s14
    s_lshl_b32 s14, s10, 5
    v_add_u32 v11, s14, v10
    v_mul_u32_u24 v149, 5632, v9
    v_lshl_add_u32 v149, v11, 2, v149
    v_add_u32 v149, 118784, v149
    v_lshlrev_b32 v157, 5, v8
    s_lshl_b32 s14, s70, 1
    s_add_u32 s14, s14, 118784
    v_add_u32 v157, s14, v157
    v_mul_u32_u24 v158, 48, v8
    s_lshl_b32 s14, s71, 2
    s_add_u32 s14, s14, 118784
    v_add_u32 v158, s14, v158
    v_mul_u32_u24 v12, 1589248, v9
    v_mov_b32 v13, 640
    v_mov_b32 v14, 0
    v_add_u32 v15, 0, v0
    v_mul_u32_u24 v16, 43691, v15
    v_lshrrev_b32 v16, 17, v16
    v_mul_u32_u24 v17, 3, v16
    v_sub_u32 v17, v15, v17
    v_mul_u32_u24 v16, 11392, v16
    v_lshl_add_u32 v154, v17, 4, v16
    v_add_u32 v15, 0, v11
    v_min_u32 v16, 320, v15
    v_mul_u32_u24 v17, 52429, v16
    v_lshrrev_b32 v17, 19, v17
    v_min_u32 v17, 31, v17
    v_mul_u32_u24 v17, 12376, v17
    v_lshl_add_u32 v16, v16, 2, v12
    v_add_u32 v159, v16, v17
    v_sub_u32 v16, 640, v15
    v_cmp_lt_u32 vcc, 320, v15
    v_cndmask_b32 v16, v15, v16, s[66:67]
    s_nop 0
    v_cndmask_b32 v17, v16, v13, vcc
    v_cmp_eq_u32 vcc, 640, v16
    v_lshlrev_b32 v162, 4, v17
    s_nop 0
    v_cndmask_b32 v16, v16, v14, vcc
    v_lshlrev_b32 v151, 4, v16
    v_add_u32 v15, 64, v0
    v_mul_u32_u24 v16, 43691, v15
    v_lshrrev_b32 v16, 17, v16
    v_mul_u32_u24 v17, 3, v16
    v_sub_u32 v17, v15, v17
    v_mul_u32_u24 v16, 11392, v16
    v_lshl_add_u32 v155, v17, 4, v16
    v_add_u32 v15, 128, v11
    v_min_u32 v16, 320, v15
    v_mul_u32_u24 v17, 52429, v16
    v_lshrrev_b32 v17, 19, v17
    v_min_u32 v17, 31, v17
    v_mul_u32_u24 v17, 12376, v17
    v_lshl_add_u32 v16, v16, 2, v12
    v_add_u32 v160, v16, v17
    v_sub_u32 v16, 640, v15
    v_cmp_lt_u32 vcc, 320, v15
    v_cndmask_b32 v16, v15, v16, s[66:67]
    s_nop 0
    v_cndmask_b32 v17, v16, v13, vcc
    v_cmp_eq_u32 vcc, 640, v16
    v_lshlrev_b32 v163, 4, v17
    s_nop 0
    v_cndmask_b32 v16, v16, v14, vcc
    v_lshlrev_b32 v152, 4, v16
    v_add_u32 v15, 128, v0
    v_mul_u32_u24 v16, 43691, v15
    v_lshrrev_b32 v16, 17, v16
    v_mul_u32_u24 v17, 3, v16
    v_sub_u32 v17, v15, v17
    v_mul_u32_u24 v16, 11392, v16
    v_lshl_add_u32 v156, v17, 4, v16
    v_add_u32 v15, 256, v11
    v_min_u32 v16, 320, v15
    v_mul_u32_u24 v17, 52429, v16
    v_lshrrev_b32 v17, 19, v17
    v_min_u32 v17, 31, v17
    v_mul_u32_u24 v17, 12376, v17
    v_lshl_add_u32 v16, v16, 2, v12
    v_add_u32 v161, v16, v17
    v_sub_u32 v16, 640, v15
    v_cmp_lt_u32 vcc, 320, v15
    v_cndmask_b32 v16, v15, v16, s[66:67]
    s_nop 0
    v_cndmask_b32 v17, v16, v13, vcc
    v_cmp_eq_u32 vcc, 640, v16
    v_lshlrev_b32 v164, 4, v17
    s_nop 0
    v_cndmask_b32 v16, v16, v14, vcc
    v_lshlrev_b32 v153, 4, v16
    s_mov_b32 s44, s26
    s_mov_b32 s45, s27
    s_mov_b32 s46, 0x280000
    s_mov_b32 s47, 0x20000
    s_mul_i32 s12, s12, 1280
    v_add_u32 v128, s12, v4
    v_add_u32 v129, 1024, v128
    v_add_u32 v130, 1310464, v128
    v_cmp_lt_u32 vcc, 15, v0
    v_add_u32 v131, 1024, v130
    s_mul_i32 s13, s10, 2560
    s_add_u32 s13, s13, 124928
    v_cndmask_b32 v129, v129, v130, vcc
    v_bfe_u32 v130, v0, 2, 2
    v_lshl_add_u32 v130, v9, 2, v130
    v_mul_u32_u24 v130, 40, v130
    v_and_b32 v15, 3, v0
    v_lshlrev_b32 v15, 3, v15
    v_bfe_u32 v16, v0, 4, 1
    v_cmp_eq_u32 vcc, 1, v16
    v_mov_b32 v16, 32
    v_lshrrev_b32 v5, 1, v0
    v_cndmask_b32 v15, v15, v16, vcc
    v_add3_u32 v130, v130, v15, s13
    v_mul_u32_u24 v5, 5136, v5
    v_and_b32 v6, 1, v0
    v_lshl_add_u32 v5, v6, 4, v5
    s_lshl_b32 s14, s10, 11
    s_add_u32 s14, s14, 118784
    v_add_u32 v6, s14, v4
L_w_47:
    ds_read_b32 v3, v1 offset:12
    s_waitcnt lgkmcnt(0)
    v_readfirstlane_b32 s60, v3
    s_nop 0
    s_cmp_ge_u32 s60, 4
    s_cbranch_scc1 L_wd_48
    s_cmp_eq_u32 s76, 0
    s_cbranch_scc1 L_wd_48
    s_sub_u32 s76, s76, 1
    s_sleep 3
    s_branch L_w_47
L_wd_48:
    s_mov_b32 s59, 0
    buffer_load_dwordx4 v[8:11], v4, s[52:55], s59 offen offset:0
    buffer_load_dwordx4 v[12:15], v4, s[52:55], s59 offen offset:1024
    buffer_load_dwordx4 v[16:19], v4, s[52:55], s59 offen offset:2048
    buffer_load_dwordx4 v[20:23], v4, s[52:55], s59 offen offset:3072
    s_mov_b32 s59, 4096
    buffer_load_dwordx4 v[24:27], v4, s[52:55], s59 offen offset:0
    buffer_load_dwordx4 v[28:31], v4, s[52:55], s59 offen offset:1024
    buffer_load_dwordx4 v[32:35], v4, s[52:55], s59 offen offset:2048
    buffer_load_dwordx4 v[36:39], v4, s[52:55], s59 offen offset:3072
    s_mov_b32 s59, 8192
    buffer_load_dwordx4 v[40:43], v4, s[52:55], s59 offen offset:0
    buffer_load_dwordx4 v[44:47], v4, s[52:55], s59 offen offset:1024
    buffer_load_dwordx4 v[48:51], v4, s[52:55], s59 offen offset:2048
    buffer_load_dwordx4 v[52:55], v4, s[52:55], s59 offen offset:3072
    s_mov_b32 s59, 12288
    buffer_load_dwordx4 v[56:59], v4, s[52:55], s59 offen offset:0
    buffer_load_dwordx4 v[60:63], v4, s[52:55], s59 offen offset:1024
    buffer_load_dwordx4 v[64:67], v4, s[52:55], s59 offen offset:2048
    buffer_load_dwordx4 v[68:71], v4, s[52:55], s59 offen offset:3072
    s_mov_b32 s59, 16384
    buffer_load_dwordx4 v[72:75], v4, s[52:55], s59 offen offset:0
    buffer_load_dwordx4 v[76:79], v4, s[52:55], s59 offen offset:1024
    s_mov_b32 m0, s13
    s_nop 0
    buffer_load_dwordx4 v128, s[44:47], 0 offen lds
    s_add_u32 m0, m0, 1024
    s_nop 0
    buffer_load_dwordx4 v129, s[44:47], 0 offen lds
    s_add_u32 m0, m0, 1024
    s_mov_b32 exec_hi, 0
    buffer_load_dwordx4 v131, s[44:47], 0 offen lds
    s_mov_b64 exec, -1
    s_mov_b32 s44, s28
    s_mov_b32 s45, s29
    s_mov_b32 s46, 0x141000
    s_mov_b32 s47, 0x20000
    s_mov_b32 s48, s30
    s_mov_b32 s49, s31
    s_mov_b32 s50, 0x141000
    s_mov_b32 s51, 0x20000
    s_waitcnt vmcnt(0)
    ds_read_b64_tr_b16 v[80:81], v130 offset:0
    ds_read_b64_tr_b16 v[82:83], v130 offset:320
    ds_read_b64_tr_b16 v[84:85], v130 offset:640
    ds_read_b64_tr_b16 v[86:87], v130 offset:960
    ds_read_b64_tr_b16 v[88:89], v130 offset:1280
    ds_read_b64_tr_b16 v[90:91], v130 offset:1600
    ds_read_b64_tr_b16 v[92:93], v130 offset:1920
    ds_read_b64_tr_b16 v[94:95], v130 offset:2240
    s_waitcnt vmcnt(0) lgkmcnt(0)
    buffer_load_dwordx4 v[132:135], v5, s[44:47], s78 offen
    buffer_load_dwordx4 v[136:139], v5, s[44:47], s79 offen
    buffer_load_dwordx4 v[140:143], v5, s[48:51], s78 offen
    buffer_load_dwordx4 v[144:147], v5, s[48:51], s79 offen
    s_setprio 2
    v_mfma_f32_32x32x16_bf16 v[96:111], v[80:83], v[8:11], 0
    v_mfma_f32_32x32x16_bf16 v[112:127], v[80:83], v[24:27], 0
    v_mfma_f32_32x32x16_bf16 v[96:111], v[84:87], v[12:15], v[96:111]
    v_mfma_f32_32x32x16_bf16 v[112:127], v[84:87], v[28:31], v[112:127]
    v_mfma_f32_32x32x16_bf16 v[96:111], v[88:91], v[16:19], v[96:111]
    v_mfma_f32_32x32x16_bf16 v[112:127], v[88:91], v[8:11], v[112:127]
    v_mfma_f32_32x32x16_bf16 v[96:111], v[92:95], v[20:23], v[96:111]
    v_mfma_f32_32x32x16_bf16 v[112:127], v[92:95], v[12:15], v[112:127]
    s_nop 11
    v_mul_f32 v80, v112, v44
    v_mul_f32 v81, v96, v44
    v_fma_f32 v96, v96, v32, v80
    v_fma_f32 v112, v112, v32, -v81
    v_mul_f32 v82, v113, v45
    v_mul_f32 v83, v97, v45
    v_fma_f32 v97, v97, v33, v82
    v_fma_f32 v113, v113, v33, -v83
    v_mul_f32 v80, v114, v46
    v_mul_f32 v81, v98, v46
    v_fma_f32 v98, v98, v34, v80
    v_fma_f32 v114, v114, v34, -v81
    v_mul_f32 v82, v115, v47
    v_mul_f32 v83, v99, v47
    v_fma_f32 v99, v99, v35, v82
    v_fma_f32 v115, v115, v35, -v83
    v_mul_f32 v80, v116, v48
    v_mul_f32 v81, v100, v48
    v_fma_f32 v100, v100, v36, v80
    v_fma_f32 v116, v116, v36, -v81
    v_mul_f32 v82, v117, v49
    v_mul_f32 v83, v101, v49
    v_fma_f32 v101, v101, v37, v82
    v_fma_f32 v117, v117, v37, -v83
    v_mul_f32 v80, v118, v50
    v_mul_f32 v81, v102, v50
    v_fma_f32 v102, v102, v38, v80
    v_fma_f32 v118, v118, v38, -v81
    v_mul_f32 v82, v119, v51
    v_mul_f32 v83, v103, v51
    v_fma_f32 v103, v103, v39, v82
    v_fma_f32 v119, v119, v39, -v83
    v_mul_f32 v80, v120, v52
    v_mul_f32 v81, v104, v52
    v_fma_f32 v104, v104, v40, v80
    v_fma_f32 v120, v120, v40, -v81
    v_mul_f32 v82, v121, v53
    v_mul_f32 v83, v105, v53
    v_fma_f32 v105, v105, v41, v82
    v_fma_f32 v121, v121, v41, -v83
    v_mul_f32 v80, v122, v54
    v_mul_f32 v81, v106, v54
    v_fma_f32 v106, v106, v42, v80
    v_fma_f32 v122, v122, v42, -v81
    v_mul_f32 v82, v123, v55
    v_mul_f32 v83, v107, v55
    v_fma_f32 v107, v107, v43, v82
    v_fma_f32 v123, v123, v43, -v83
    v_cvt_pk_bf16_f32 v80, v96, v97
    v_cvt_pk_bf16_f32 v81, v98, v99
    v_cvt_pk_bf16_f32 v82, v100, v101
    v_cvt_pk_bf16_f32 v83, v102, v103
    v_cvt_pk_bf16_f32 v84, v112, v113
    v_cvt_pk_bf16_f32 v85, v114, v115
    v_cvt_pk_bf16_f32 v86, v116, v117
    v_cvt_pk_bf16_f32 v87, v118, v119
    v_cvt_pk_bf16_f32 v88, v104, v105
    v_cvt_pk_bf16_f32 v89, v106, v107
    v_cvt_pk_bf16_f32 v90, v120, v121
    v_cvt_pk_bf16_f32 v91, v122, v123
    v_mfma_f32_32x32x16_bf16 v[96:111], v[56:59], v[80:83], 0
    v_mfma_f32_32x32x16_bf16 v[112:127], v[64:67], v[80:83], 0
    v_mfma_f32_32x32x16_bf16 v[96:111], v[60:63], v[84:87], v[96:111]
    v_mfma_f32_32x32x16_bf16 v[112:127], v[56:59], v[84:87], v[112:127]
    v_mfma_f32_32x32x16_bf16 v[96:111], v[68:71], v[88:91], v[96:111]
    v_mfma_f32_32x32x16_bf16 v[112:127], v[72:75], v[88:91], v[112:127]
    s_nop 11
    v_cvt_pk_bf16_f32 v32, v96, v112
    ds_write_b32 v148, v32 offset:0
    v_cvt_pk_bf16_f32 v33, v97, v113
    ds_write_b32 v148, v33 offset:512
    v_cvt_pk_bf16_f32 v34, v98, v114
    ds_write_b32 v148, v34 offset:1024
    v_cvt_pk_bf16_f32 v35, v99, v115
    ds_write_b32 v148, v35 offset:1536
    v_cvt_pk_bf16_f32 v36, v100, v116
    ds_write_b32 v148, v36 offset:2048
    v_cvt_pk_bf16_f32 v37, v101, v117
    ds_write_b32 v148, v37 offset:2560
    v_cvt_pk_bf16_f32 v38, v102, v118
    ds_write_b32 v148, v38 offset:3072
    v_cvt_pk_bf16_f32 v39, v103, v119
    ds_write_b32 v148, v39 offset:3584
    v_cvt_pk_bf16_f32 v40, v104, v120
    ds_write_b32 v148, v40 offset:4096
    v_cvt_pk_bf16_f32 v41, v105, v121
    ds_write_b32 v148, v41 offset:4608
    s_setprio 0
    s_mov_b64 exec, 1
    ds_add_u32 v1, v2 offset:20
    s_mov_b64 exec, -1
L_w_49:
    ds_read_b32 v3, v1 offset:20
    s_waitcnt lgkmcnt(0)
    v_readfirstlane_b32 s60, v3
    s_nop 0
    s_cmp_ge_u32 s60, 4
    s_cbranch_scc1 L_wd_50
    s_cmp_eq_u32 s76, 0
    s_cbranch_scc1 L_wd_50
    s_sub_u32 s76, s76, 1
    s_sleep 2
    s_branch L_w_49
L_wd_50:
    ds_read_b128 v[80:83], v151 offset:21504
    ds_read_b128 v[84:87], v152 offset:21504
    ds_read_b128 v[88:91], v153 offset:21504
    s_waitcnt lgkmcnt(2)
    v_mfma_f32_32x32x16_bf16 v[96:111], v[76:79], v[80:83], 0
    s_waitcnt lgkmcnt(1)
    v_mfma_f32_32x32x16_bf16 v[112:127], v[76:79], v[84:87], 0
    s_waitcnt lgkmcnt(0)
    v_mfma_f32_32x32x16_bf16 v[32:47], v[76:79], v[88:91], 0
    s_nop 7
    v_cvt_pk_bf16_f32 v80, v96, v97
    ds_write_b32 v149, v80 offset:0
    v_cvt_pk_bf16_f32 v81, v98, v99
    ds_write_b32 v149, v81 offset:1408
    v_cvt_pk_bf16_f32 v82, v100, v101
    ds_write_b32 v149, v82 offset:2816
    v_cvt_pk_bf16_f32 v83, v102, v103
    ds_write_b32 v149, v83 offset:4224
    v_cvt_pk_bf16_f32 v84, v112, v113
    ds_write_b32 v149, v84 offset:512
    v_cvt_pk_bf16_f32 v85, v114, v115
    ds_write_b32 v149, v85 offset:1920
    v_cvt_pk_bf16_f32 v86, v116, v117
    ds_write_b32 v149, v86 offset:3328
    v_cvt_pk_bf16_f32 v87, v118, v119
    ds_write_b32 v149, v87 offset:4736
    s_cmp_eq_u32 s10, 3
    s_cbranch_scc1 L_b1_sk
    v_cvt_pk_bf16_f32 v88, v32, v33
    ds_write_b32 v149, v88 offset:1024
    v_cvt_pk_bf16_f32 v89, v34, v35
    ds_write_b32 v149, v89 offset:2432
    v_cvt_pk_bf16_f32 v90, v36, v37
    ds_write_b32 v149, v90 offset:3840
    v_cvt_pk_bf16_f32 v91, v38, v39
    ds_write_b32 v149, v91 offset:5248
L_b1_sk:
    s_setprio 0
    s_mov_b64 exec, 1
    ds_add_u32 v1, v2 offset:20
    s_mov_b64 exec, -1
L_w_51:
    ds_read_b32 v3, v1 offset:20
    s_waitcnt lgkmcnt(0)
    v_readfirstlane_b32 s60, v3
    s_nop 0
    s_cmp_ge_u32 s60, 8
    s_cbranch_scc1 L_wd_52
    s_cmp_eq_u32 s76, 0
    s_cbranch_scc1 L_wd_52
    s_sub_u32 s76, s76, 1
    s_sleep 2
    s_branch L_w_51
L_wd_52:
    ds_read_b128 v[80:83], v150 offset:0
    ds_read_b128 v[84:87], v150 offset:1024
    ds_read_b128 v[88:91], v150 offset:2048
    s_waitcnt lgkmcnt(2)
    buffer_store_dwordx4 v[80:83], v4, s[40:43], s77 offen offset:0 sc1
    s_waitcnt lgkmcnt(1)
    buffer_store_dwordx4 v[84:87], v4, s[40:43], s77 offen offset:1024 sc1
    s_cmp_eq_u32 s10, 3
    s_cbranch_scc1 L_b1_s2
    s_waitcnt lgkmcnt(0)
    buffer_store_dwordx4 v[88:91], v4, s[40:43], s77 offen offset:2048 sc1
L_b1_s2:
    v_mov_b32 v60, 0
    v_mov_b32 v61, 0
    v_mov_b32 v62, 0
    v_mov_b32 v63, 0
    v_mov_b32 v64, 0
    v_mov_b32 v65, 0
    v_mov_b32 v66, 0
    v_mov_b32 v67, 0
    v_mov_b32 v68, 0
    v_mov_b32 v69, 0
    v_mov_b32 v70, 0
    v_mov_b32 v71, 0
    v_mov_b32 v72, 0
    v_mov_b32 v73, 0
    v_mov_b32 v74, 0
    v_mov_b32 v75, 0
    v_mov_b32 v76, 0
    v_mov_b32 v77, 0
    v_mov_b32 v78, 0
    v_mov_b32 v79, 0
    v_mov_b32 v80, 0
    v_mov_b32 v81, 0
    v_mov_b32 v82, 0
    v_mov_b32 v83, 0
    s_lshl_b32 s58, s2, 6
    s_add_u32 s58, s58, 65536
    v_mov_b32 v52, s38
    v_mov_b32 v53, s39
    v_mov_b32 v54, 0
    s_mov_b64 exec, 1
    s_setprio 2
    s_waitcnt vmcnt(0) lgkmcnt(0)
    ds_add_rtn_u32 v3, v1, v2 offset:20
    s_waitcnt lgkmcnt(0)
    v_readfirstlane_b32 s60, v3
    s_nop 0
    s_cmp_lg_u32 s60, 11
    s_cbranch_scc1 L_nl_53
    buffer_store_dwordx2 v[52:53], v54, s[40:43], s58 offen sc1
L_nl_53:
    s_mov_b64 exec, -1
    s_setprio 0
L_w_54:
    ds_read_b32 v3, v1 offset:20
    s_waitcnt lgkmcnt(0)
    v_readfirstlane_b32 s60, v3
    s_nop 0
    s_cmp_ge_u32 s60, 12
    s_cbranch_scc1 L_wd_55
    s_cmp_eq_u32 s76, 0
    s_cbranch_scc1 L_wd_55
    s_sub_u32 s76, s76, 1
    s_sleep 2
    s_branch L_w_54
L_wd_55:
    ds_write_b128 v6, v[132:135] offset:0
    ds_write_b128 v6, v[136:139] offset:1024
    ds_write_b128 v6, v[140:143] offset:8192
    ds_write_b128 v6, v[144:147] offset:9216
    s_lshl_b32 s59, s7, 13
    s_add_u32 s59, s59, 34816
    buffer_load_dwordx4 v[8:11], v4, s[52:55], s59 offen offset:0
    buffer_load_dwordx4 v[12:15], v4, s[52:55], s59 offen offset:1024
    buffer_load_dwordx4 v[16:19], v4, s[52:55], s59 offen offset:2048
    buffer_load_dwordx4 v[20:23], v4, s[52:55], s59 offen offset:3072
    s_add_u32 s59, s59, 4096
    buffer_load_dwordx4 v[24:27], v4, s[52:55], s59 offen offset:0
    buffer_load_dwordx4 v[28:31], v4, s[52:55], s59 offen offset:1024
    buffer_load_dwordx4 v[32:35], v4, s[52:55], s59 offen offset:2048
    buffer_load_dwordx4 v[36:39], v4, s[52:55], s59 offen offset:3072
    s_mov_b32 s59, 32768
    buffer_load_dwordx4 v[40:43], v4, s[52:55], s59 offen offset:0
    buffer_load_dwordx4 v[44:47], v4, s[52:55], s59 offen offset:1024
    s_mov_b64 exec, 1
    ds_add_u32 v1, v2 offset:20
    s_mov_b64 exec, -1
L_w_56:
    ds_read_b32 v3, v1 offset:20
    s_waitcnt lgkmcnt(0)
    v_readfirstlane_b32 s60, v3
    s_nop 0
    s_cmp_ge_u32 s60, 16
    s_cbranch_scc1 L_wd_57
    s_cmp_eq_u32 s76, 0
    s_cbranch_scc1 L_wd_57
    s_sub_u32 s76, s76, 1
    s_sleep 2
    s_branch L_w_56
L_wd_57:
    ds_read_u16_d16_hi v60, v157 offset:0
    ds_read_u16_d16_hi v61, v157 offset:512
    ds_read_u16_d16_hi v62, v157 offset:1024
    ds_read_u16_d16_hi v63, v157 offset:1536
    ds_read_u16_d16_hi v64, v157 offset:8192
    ds_read_u16_d16_hi v65, v157 offset:8704
    ds_read_u16_d16_hi v66, v157 offset:9216
    ds_read_u16_d16_hi v67, v157 offset:9728
    ds_read_u16_d16_hi v68, v157 offset:2
    ds_read_u16_d16_hi v69, v157 offset:514
    ds_read_u16_d16_hi v70, v157 offset:1026
    ds_read_u16_d16_hi v71, v157 offset:1538
    ds_read_u16_d16_hi v72, v157 offset:8194
    ds_read_u16_d16_hi v73, v157 offset:8706
    ds_read_u16_d16_hi v74, v157 offset:9218
    ds_read_u16_d16_hi v75, v157 offset:9730
    ds_read_u16_d16_hi v76, v157 offset:4
    ds_read_u16_d16_hi v77, v157 offset:516
    ds_read_u16_d16_hi v78, v157 offset:1028
    ds_read_u16_d16_hi v79, v157 offset:1540
    ds_read_u16_d16_hi v80, v157 offset:8196
    ds_read_u16_d16_hi v81, v157 offset:8708
    ds_read_u16_d16_hi v82, v157 offset:9220
    ds_read_u16_d16_hi v83, v157 offset:9732
    s_lshl_b32 s72, s10, 12
    s_add_u32 s72, s72, 65536
L_p_58:
    buffer_load_dwordx2 v[52:53], v7, s[40:43], s72 offen sc1
    s_waitcnt vmcnt(0)
    v_cmp_ne_u64 vcc, s[38:39], v[52:53]
    s_cbranch_vccz L_pd_59
    s_cmp_eq_u32 s76, 0
    s_cbranch_scc1 L_pd_59
    s_sub_u32 s76, s76, 1
    s_sleep 2
    s_branch L_p_58
L_pd_59:
    s_mov_b64 exec, 1
    ds_add_u32 v1, v2 offset:20
    s_mov_b64 exec, -1
L_w_60:
    ds_read_b32 v3, v1 offset:20
    s_waitcnt lgkmcnt(0)
    v_readfirstlane_b32 s60, v3
    s_nop 0
    s_cmp_ge_u32 s60, 20
    s_cbranch_scc1 L_wd_61
    s_cmp_eq_u32 s76, 0
    s_cbranch_scc1 L_wd_61
    s_sub_u32 s76, s76, 1
    s_sleep 1
    s_branch L_w_60
L_wd_61:
    s_mov_b32 m0, s88
    s_nop 0
    buffer_load_dwordx4 v154, s[40:43], s80 offen sc1 lds
    s_add_u32 m0, m0, 1024
    s_nop 0
    buffer_load_dwordx4 v155, s[40:43], s80 offen sc1 lds
    s_add_u32 m0, m0, 1024
    s_nop 0
    buffer_load_dwordx4 v156, s[40:43], s80 offen sc1 lds
    s_waitcnt vmcnt(0)
    s_mov_b64 exec, 1
    ds_add_u32 v1, v2 offset:20
    s_mov_b64 exec, -1
L_w_62:
    ds_read_b32 v3, v1 offset:20
    s_waitcnt lgkmcnt(0)
    v_readfirstlane_b32 s60, v3
    s_nop 0
    s_cmp_ge_u32 s60, 24
    s_cbranch_scc1 L_wd_63
    s_cmp_eq_u32 s76, 0
    s_cbranch_scc1 L_wd_63
    s_sub_u32 s76, s76, 1
    s_sleep 2
    s_branch L_w_62
L_wd_63:
    ds_read_b32 v84, v158 offset:0
    ds_read_b32 v85, v158 offset:768
    ds_read_b32 v86, v158 offset:1536
    ds_read_b32 v87, v158 offset:2304
    ds_read_b32 v88, v158 offset:4
    ds_read_b32 v89, v158 offset:772
    ds_read_b32 v90, v158 offset:1540
    ds_read_b32 v91, v158 offset:2308
    ds_read_b32 v92, v158 offset:8
    ds_read_b32 v93, v158 offset:776
    ds_read_b32 v94, v158 offset:1544
    ds_read_b32 v95, v158 offset:2312
    s_mov_b64 exec, 1
    ds_add_u32 v1, v2 offset:20
    s_mov_b64 exec, -1
    s_waitcnt lgkmcnt(1)
    s_setprio 2
    s_cmp_lt_u32 s10, 2
    s_cbranch_scc1 L_b2_3
    s_cmp_eq_u32 s10, 2
    s_cbranch_scc1 L_b2_2
    s_cmp_eq_u32 s6, 31
    s_cbranch_scc1 L_b2_3
L_b2_2:
    v_mfma_f32_16x16x32_bf16 v[96:99], v[84:87], v[8:11], 0
    v_mfma_f32_16x16x32_bf16 v[100:103], v[84:87], v[12:15], 0
    v_mfma_f32_16x16x32_bf16 v[104:107], v[88:91], v[8:11], 0
    v_mfma_f32_16x16x32_bf16 v[108:111], v[88:91], v[12:15], 0
    s_nop 5
    v_mul_f32 v48, v100, v20
    v_mul_f32 v49, v96, v20
    v_fma_f32 v96, v96, v16, v48
    v_fma_f32 v100, v100, v16, -v49
    v_mul_f32 v50, v101, v21
    v_mul_f32 v51, v97, v21
    v_fma_f32 v97, v97, v17, v50
    v_fma_f32 v101, v101, v17, -v51
    v_mul_f32 v48, v102, v22
    v_mul_f32 v49, v98, v22
    v_fma_f32 v98, v98, v18, v48
    v_fma_f32 v102, v102, v18, -v49
    v_mul_f32 v50, v103, v23
    v_mul_f32 v51, v99, v23
    v_fma_f32 v99, v99, v19, v50
    v_fma_f32 v103, v103, v19, -v51
    v_cvt_pk_bf16_f32 v84, v96, v97
    v_cvt_pk_bf16_f32 v85, v98, v99
    v_cvt_pk_bf16_f32 v86, v100, v101
    v_cvt_pk_bf16_f32 v87, v102, v103
    v_mul_f32 v48, v108, v20
    v_mul_f32 v49, v104, v20
    v_fma_f32 v104, v104, v16, v48
    v_fma_f32 v108, v108, v16, -v49
    v_mul_f32 v50, v109, v21
    v_mul_f32 v51, v105, v21
    v_fma_f32 v105, v105, v17, v50
    v_fma_f32 v109, v109, v17, -v51
    v_mul_f32 v48, v110, v22
    v_mul_f32 v49, v106, v22
    v_fma_f32 v106, v106, v18, v48
    v_fma_f32 v110, v110, v18, -v49
    v_mul_f32 v50, v111, v23
    v_mul_f32 v51, v107, v23
    v_fma_f32 v107, v107, v19, v50
    v_fma_f32 v111, v111, v19, -v51
    v_cvt_pk_bf16_f32 v88, v104, v105
    v_cvt_pk_bf16_f32 v89, v106, v107
    v_cvt_pk_bf16_f32 v90, v108, v109
    v_cvt_pk_bf16_f32 v91, v110, v111
    v_mfma_f32_16x16x32_bf16 v[96:99], v[40:43], v[84:87], 0
    v_mfma_f32_16x16x32_bf16 v[100:103], v[44:47], v[84:87], 0
    v_mfma_f32_16x16x32_bf16 v[104:107], v[40:43], v[88:91], 0
    v_mfma_f32_16x16x32_bf16 v[108:111], v[44:47], v[88:91], 0
    s_nop 5
    v_mul_f32 v48, v100, v64
    v_mul_f32 v49, v96, v64
    v_fma_f32 v96, v96, v60, -v48
    v_fma_f32 v100, v100, v60, v49
    v_mul_f32 v50, v101, v65
    v_mul_f32 v51, v97, v65
    v_fma_f32 v97, v97, v61, -v50
    v_fma_f32 v101, v101, v61, v51
    v_mul_f32 v48, v102, v66
    v_mul_f32 v49, v98, v66
    v_fma_f32 v98, v98, v62, -v48
    v_fma_f32 v102, v102, v62, v49
    v_mul_f32 v50, v103, v67
    v_mul_f32 v51, v99, v67
    v_fma_f32 v99, v99, v63, -v50
    v_fma_f32 v103, v103, v63, v51
    v_cvt_pk_bf16_f32 v84, v100, v101
    v_cvt_pk_bf16_f32 v85, v102, v103
    v_cvt_pk_bf16_f32 v86, v96, v97
    v_cvt_pk_bf16_f32 v87, v98, v99
    v_mul_f32 v48, v108, v72
    v_mul_f32 v49, v104, v72
    v_fma_f32 v104, v104, v68, -v48
    v_fma_f32 v108, v108, v68, v49
    v_mul_f32 v50, v109, v73
    v_mul_f32 v51, v105, v73
    v_fma_f32 v105, v105, v69, -v50
    v_fma_f32 v109, v109, v69, v51
    v_mul_f32 v48, v110, v74
    v_mul_f32 v49, v106, v74
    v_fma_f32 v106, v106, v70, -v48
    v_fma_f32 v110, v110, v70, v49
    v_mul_f32 v50, v111, v75
    v_mul_f32 v51, v107, v75
    v_fma_f32 v107, v107, v71, -v50
    v_fma_f32 v111, v111, v71, v51
    v_cvt_pk_bf16_f32 v88, v108, v109
    v_cvt_pk_bf16_f32 v89, v110, v111
    v_cvt_pk_bf16_f32 v90, v104, v105
    v_cvt_pk_bf16_f32 v91, v106, v107
    v_mfma_f32_16x16x32_bf16 v[96:99], v[84:87], v[44:47], 0
    v_mfma_f32_16x16x32_bf16 v[100:103], v[84:87], v[40:43], 0
    v_mfma_f32_16x16x32_bf16 v[104:107], v[88:91], v[44:47], 0
    v_mfma_f32_16x16x32_bf16 v[108:111], v[88:91], v[40:43], 0
    s_nop 5
    v_mul_f32 v48, v100, v28
    v_mul_f32 v49, v96, v28
    v_fma_f32 v96, v96, v24, -v48
    v_fma_f32 v100, v100, v24, v49
    v_mul_f32 v50, v101, v29
    v_mul_f32 v51, v97, v29
    v_fma_f32 v97, v97, v25, -v50
    v_fma_f32 v101, v101, v25, v51
    v_mul_f32 v48, v102, v30
    v_mul_f32 v49, v98, v30
    v_fma_f32 v98, v98, v26, -v48
    v_fma_f32 v102, v102, v26, v49
    v_mul_f32 v50, v103, v31
    v_mul_f32 v51, v99, v31
    v_fma_f32 v99, v99, v27, -v50
    v_fma_f32 v103, v103, v27, v51
    v_cvt_pk_bf16_f32 v84, v96, v97
    v_cvt_pk_bf16_f32 v85, v98, v99
    v_cvt_pk_bf16_f32 v86, v100, v101
    v_cvt_pk_bf16_f32 v87, v102, v103
    v_mul_f32 v48, v108, v28
    v_mul_f32 v49, v104, v28
    v_fma_f32 v104, v104, v24, -v48
    v_fma_f32 v108, v108, v24, v49
    v_mul_f32 v50, v109, v29
    v_mul_f32 v51, v105, v29
    v_fma_f32 v105, v105, v25, -v50
    v_fma_f32 v109, v109, v25, v51
    v_mul_f32 v48, v110, v30
    v_mul_f32 v49, v106, v30
    v_fma_f32 v106, v106, v26, -v48
    v_fma_f32 v110, v110, v26, v49
    v_mul_f32 v50, v111, v31
    v_mul_f32 v51, v107, v31
    v_fma_f32 v107, v107, v27, -v50
    v_fma_f32 v111, v111, v27, v51
    v_cvt_pk_bf16_f32 v88, v104, v105
    v_cvt_pk_bf16_f32 v89, v106, v107
    v_cvt_pk_bf16_f32 v90, v108, v109
    v_cvt_pk_bf16_f32 v91, v110, v111
    v_mfma_f32_16x16x32_bf16 v[96:99], v[32:35], v[84:87], 0
    v_mfma_f32_16x16x32_bf16 v[100:103], v[36:39], v[84:87], 0
    v_mfma_f32_16x16x32_bf16 v[104:107], v[32:35], v[88:91], 0
    v_mfma_f32_16x16x32_bf16 v[108:111], v[36:39], v[88:91], 0
L_w_64:
    ds_read_b32 v3, v1 offset:20
    s_waitcnt lgkmcnt(0)
    v_readfirstlane_b32 s60, v3
    s_nop 0
    s_cmp_ge_u32 s60, 28
    s_cbranch_scc1 L_wd_65
    s_cmp_eq_u32 s76, 0
    s_cbranch_scc1 L_wd_65
    s_sub_u32 s76, s76, 1
    s_sleep 1
    s_branch L_w_64
L_wd_65:
    v_cvt_pk_bf16_f32 v120, v96, v100
    ds_write_b32 v158, v120 offset:0
    v_cvt_pk_bf16_f32 v121, v97, v101
    ds_write_b32 v158, v121 offset:768
    v_cvt_pk_bf16_f32 v122, v98, v102
    ds_write_b32 v158, v122 offset:1536
    v_cvt_pk_bf16_f32 v123, v99, v103
    ds_write_b32 v158, v123 offset:2304
    v_cvt_pk_bf16_f32 v124, v104, v108
    ds_write_b32 v158, v124 offset:4
    v_cvt_pk_bf16_f32 v125, v105, v109
    ds_write_b32 v158, v125 offset:772
    v_cvt_pk_bf16_f32 v126, v106, v110
    ds_write_b32 v158, v126 offset:1540
    v_cvt_pk_bf16_f32 v127, v107, v111
    ds_write_b32 v158, v127 offset:2308
    s_branch L_b2_e
L_b2_3:
    v_mfma_f32_16x16x32_bf16 v[96:99], v[84:87], v[8:11], 0
    v_mfma_f32_16x16x32_bf16 v[100:103], v[84:87], v[12:15], 0
    v_mfma_f32_16x16x32_bf16 v[104:107], v[88:91], v[8:11], 0
    v_mfma_f32_16x16x32_bf16 v[108:111], v[88:91], v[12:15], 0
    v_mfma_f32_16x16x32_bf16 v[112:115], v[92:95], v[8:11], 0
    v_mfma_f32_16x16x32_bf16 v[116:119], v[92:95], v[12:15], 0
    s_nop 3
    v_mul_f32 v48, v100, v20
    v_mul_f32 v49, v96, v20
    v_fma_f32 v96, v96, v16, v48
    v_fma_f32 v100, v100, v16, -v49
    v_mul_f32 v50, v101, v21
    v_mul_f32 v51, v97, v21
    v_fma_f32 v97, v97, v17, v50
    v_fma_f32 v101, v101, v17, -v51
    v_mul_f32 v48, v102, v22
    v_mul_f32 v49, v98, v22
    v_fma_f32 v98, v98, v18, v48
    v_fma_f32 v102, v102, v18, -v49
    v_mul_f32 v50, v103, v23
    v_mul_f32 v51, v99, v23
    v_fma_f32 v99, v99, v19, v50
    v_fma_f32 v103, v103, v19, -v51
    v_cvt_pk_bf16_f32 v84, v96, v97
    v_cvt_pk_bf16_f32 v85, v98, v99
    v_cvt_pk_bf16_f32 v86, v100, v101
    v_cvt_pk_bf16_f32 v87, v102, v103
    v_mul_f32 v48, v108, v20
    v_mul_f32 v49, v104, v20
    v_fma_f32 v104, v104, v16, v48
    v_fma_f32 v108, v108, v16, -v49
    v_mul_f32 v50, v109, v21
    v_mul_f32 v51, v105, v21
    v_fma_f32 v105, v105, v17, v50
    v_fma_f32 v109, v109, v17, -v51
    v_mul_f32 v48, v110, v22
    v_mul_f32 v49, v106, v22
    v_fma_f32 v106, v106, v18, v48
    v_fma_f32 v110, v110, v18, -v49
    v_mul_f32 v50, v111, v23
    v_mul_f32 v51, v107, v23
    v_fma_f32 v107, v107, v19, v50
    v_fma_f32 v111, v111, v19, -v51
    v_cvt_pk_bf16_f32 v88, v104, v105
    v_cvt_pk_bf16_f32 v89, v106, v107
    v_cvt_pk_bf16_f32 v90, v108, v109
    v_cvt_pk_bf16_f32 v91, v110, v111
    v_mul_f32 v48, v116, v20
    v_mul_f32 v49, v112, v20
    v_fma_f32 v112, v112, v16, v48
    v_fma_f32 v116, v116, v16, -v49
    v_mul_f32 v50, v117, v21
    v_mul_f32 v51, v113, v21
    v_fma_f32 v113, v113, v17, v50
    v_fma_f32 v117, v117, v17, -v51
    v_mul_f32 v48, v118, v22
    v_mul_f32 v49, v114, v22
    v_fma_f32 v114, v114, v18, v48
    v_fma_f32 v118, v118, v18, -v49
    v_mul_f32 v50, v119, v23
    v_mul_f32 v51, v115, v23
    v_fma_f32 v115, v115, v19, v50
    v_fma_f32 v119, v119, v19, -v51
    v_cvt_pk_bf16_f32 v92, v112, v113
    v_cvt_pk_bf16_f32 v93, v114, v115
    v_cvt_pk_bf16_f32 v94, v116, v117
    v_cvt_pk_bf16_f32 v95, v118, v119
    v_mfma_f32_16x16x32_bf16 v[96:99], v[40:43], v[84:87], 0
    v_mfma_f32_16x16x32_bf16 v[100:103], v[44:47], v[84:87], 0
    v_mfma_f32_16x16x32_bf16 v[104:107], v[40:43], v[88:91], 0
    v_mfma_f32_16x16x32_bf16 v[108:111], v[44:47], v[88:91], 0
    v_mfma_f32_16x16x32_bf16 v[112:115], v[40:43], v[92:95], 0
    v_mfma_f32_16x16x32_bf16 v[116:119], v[44:47], v[92:95], 0
    s_nop 3
    v_mul_f32 v48, v100, v64
    v_mul_f32 v49, v96, v64
    v_fma_f32 v96, v96, v60, -v48
    v_fma_f32 v100, v100, v60, v49
    v_mul_f32 v50, v101, v65
    v_mul_f32 v51, v97, v65
    v_fma_f32 v97, v97, v61, -v50
    v_fma_f32 v101, v101, v61, v51
    v_mul_f32 v48, v102, v66
    v_mul_f32 v49, v98, v66
    v_fma_f32 v98, v98, v62, -v48
    v_fma_f32 v102, v102, v62, v49
    v_mul_f32 v50, v103, v67
    v_mul_f32 v51, v99, v67
    v_fma_f32 v99, v99, v63, -v50
    v_fma_f32 v103, v103, v63, v51
    v_cvt_pk_bf16_f32 v84, v100, v101
    v_cvt_pk_bf16_f32 v85, v102, v103
    v_cvt_pk_bf16_f32 v86, v96, v97
    v_cvt_pk_bf16_f32 v87, v98, v99
    v_mul_f32 v48, v108, v72
    v_mul_f32 v49, v104, v72
    v_fma_f32 v104, v104, v68, -v48
    v_fma_f32 v108, v108, v68, v49
    v_mul_f32 v50, v109, v73
    v_mul_f32 v51, v105, v73
    v_fma_f32 v105, v105, v69, -v50
    v_fma_f32 v109, v109, v69, v51
    v_mul_f32 v48, v110, v74
    v_mul_f32 v49, v106, v74
    v_fma_f32 v106, v106, v70, -v48
    v_fma_f32 v110, v110, v70, v49
    v_mul_f32 v50, v111, v75
    v_mul_f32 v51, v107, v75
    v_fma_f32 v107, v107, v71, -v50
    v_fma_f32 v111, v111, v71, v51
    v_cvt_pk_bf16_f32 v88, v108, v109
    v_cvt_pk_bf16_f32 v89, v110, v111
    v_cvt_pk_bf16_f32 v90, v104, v105
    v_cvt_pk_bf16_f32 v91, v106, v107
    v_mul_f32 v48, v116, v80
    v_mul_f32 v49, v112, v80
    v_fma_f32 v112, v112, v76, -v48
    v_fma_f32 v116, v116, v76, v49
    v_mul_f32 v50, v117, v81
    v_mul_f32 v51, v113, v81
    v_fma_f32 v113, v113, v77, -v50
    v_fma_f32 v117, v117, v77, v51
    v_mul_f32 v48, v118, v82
    v_mul_f32 v49, v114, v82
    v_fma_f32 v114, v114, v78, -v48
    v_fma_f32 v118, v118, v78, v49
    v_mul_f32 v50, v119, v83
    v_mul_f32 v51, v115, v83
    v_fma_f32 v115, v115, v79, -v50
    v_fma_f32 v119, v119, v79, v51
    v_cvt_pk_bf16_f32 v92, v116, v117
    v_cvt_pk_bf16_f32 v93, v118, v119
    v_cvt_pk_bf16_f32 v94, v112, v113
    v_cvt_pk_bf16_f32 v95, v114, v115
    v_mfma_f32_16x16x32_bf16 v[96:99], v[84:87], v[44:47], 0
    v_mfma_f32_16x16x32_bf16 v[100:103], v[84:87], v[40:43], 0
    v_mfma_f32_16x16x32_bf16 v[104:107], v[88:91], v[44:47], 0
    v_mfma_f32_16x16x32_bf16 v[108:111], v[88:91], v[40:43], 0
    v_mfma_f32_16x16x32_bf16 v[112:115], v[92:95], v[44:47], 0
    v_mfma_f32_16x16x32_bf16 v[116:119], v[92:95], v[40:43], 0
    s_nop 3
    v_mul_f32 v48, v100, v28
    v_mul_f32 v49, v96, v28
    v_fma_f32 v96, v96, v24, -v48
    v_fma_f32 v100, v100, v24, v49
    v_mul_f32 v50, v101, v29
    v_mul_f32 v51, v97, v29
    v_fma_f32 v97, v97, v25, -v50
    v_fma_f32 v101, v101, v25, v51
    v_mul_f32 v48, v102, v30
    v_mul_f32 v49, v98, v30
    v_fma_f32 v98, v98, v26, -v48
    v_fma_f32 v102, v102, v26, v49
    v_mul_f32 v50, v103, v31
    v_mul_f32 v51, v99, v31
    v_fma_f32 v99, v99, v27, -v50
    v_fma_f32 v103, v103, v27, v51
    v_cvt_pk_bf16_f32 v84, v96, v97
    v_cvt_pk_bf16_f32 v85, v98, v99
    v_cvt_pk_bf16_f32 v86, v100, v101
    v_cvt_pk_bf16_f32 v87, v102, v103
    v_mul_f32 v48, v108, v28
    v_mul_f32 v49, v104, v28
    v_fma_f32 v104, v104, v24, -v48
    v_fma_f32 v108, v108, v24, v49
    v_mul_f32 v50, v109, v29
    v_mul_f32 v51, v105, v29
    v_fma_f32 v105, v105, v25, -v50
    v_fma_f32 v109, v109, v25, v51
    v_mul_f32 v48, v110, v30
    v_mul_f32 v49, v106, v30
    v_fma_f32 v106, v106, v26, -v48
    v_fma_f32 v110, v110, v26, v49
    v_mul_f32 v50, v111, v31
    v_mul_f32 v51, v107, v31
    v_fma_f32 v107, v107, v27, -v50
    v_fma_f32 v111, v111, v27, v51
    v_cvt_pk_bf16_f32 v88, v104, v105
    v_cvt_pk_bf16_f32 v89, v106, v107
    v_cvt_pk_bf16_f32 v90, v108, v109
    v_cvt_pk_bf16_f32 v91, v110, v111
    v_mul_f32 v48, v116, v28
    v_mul_f32 v49, v112, v28
    v_fma_f32 v112, v112, v24, -v48
    v_fma_f32 v116, v116, v24, v49
    v_mul_f32 v50, v117, v29
    v_mul_f32 v51, v113, v29
    v_fma_f32 v113, v113, v25, -v50
    v_fma_f32 v117, v117, v25, v51
    v_mul_f32 v48, v118, v30
    v_mul_f32 v49, v114, v30
    v_fma_f32 v114, v114, v26, -v48
    v_fma_f32 v118, v118, v26, v49
    v_mul_f32 v50, v119, v31
    v_mul_f32 v51, v115, v31
    v_fma_f32 v115, v115, v27, -v50
    v_fma_f32 v119, v119, v27, v51
    v_cvt_pk_bf16_f32 v92, v112, v113
    v_cvt_pk_bf16_f32 v93, v114, v115
    v_cvt_pk_bf16_f32 v94, v116, v117
    v_cvt_pk_bf16_f32 v95, v118, v119
    v_mfma_f32_16x16x32_bf16 v[96:99], v[32:35], v[84:87], 0
    v_mfma_f32_16x16x32_bf16 v[100:103], v[36:39], v[84:87], 0
    v_mfma_f32_16x16x32_bf16 v[104:107], v[32:35], v[88:91], 0
    v_mfma_f32_16x16x32_bf16 v[108:111], v[36:39], v[88:91], 0
    v_mfma_f32_16x16x32_bf16 v[112:115], v[32:35], v[92:95], 0
    v_mfma_f32_16x16x32_bf16 v[116:119], v[36:39], v[92:95], 0
L_w_66:
    ds_read_b32 v3, v1 offset:20
    s_waitcnt lgkmcnt(0)
    v_readfirstlane_b32 s60, v3
    s_nop 0
    s_cmp_ge_u32 s60, 28
    s_cbranch_scc1 L_wd_67
    s_cmp_eq_u32 s76, 0
    s_cbranch_scc1 L_wd_67
    s_sub_u32 s76, s76, 1
    s_sleep 1
    s_branch L_w_66
L_wd_67:
    v_cvt_pk_bf16_f32 v120, v96, v100
    ds_write_b32 v158, v120 offset:0
    v_cvt_pk_bf16_f32 v121, v97, v101
    ds_write_b32 v158, v121 offset:768
    v_cvt_pk_bf16_f32 v122, v98, v102
    ds_write_b32 v158, v122 offset:1536
    v_cvt_pk_bf16_f32 v123, v99, v103
    ds_write_b32 v158, v123 offset:2304
    v_cvt_pk_bf16_f32 v124, v104, v108
    ds_write_b32 v158, v124 offset:4
    v_cvt_pk_bf16_f32 v125, v105, v109
    ds_write_b32 v158, v125 offset:772
    v_cvt_pk_bf16_f32 v126, v106, v110
    ds_write_b32 v158, v126 offset:1540
    v_cvt_pk_bf16_f32 v127, v107, v111
    ds_write_b32 v158, v127 offset:2308
    v_cvt_pk_bf16_f32 v128, v112, v116
    ds_write_b32 v158, v128 offset:8
    v_cvt_pk_bf16_f32 v129, v113, v117
    ds_write_b32 v158, v129 offset:776
    v_cvt_pk_bf16_f32 v130, v114, v118
    ds_write_b32 v158, v130 offset:1544
    v_cvt_pk_bf16_f32 v131, v115, v119
    ds_write_b32 v158, v131 offset:2312
L_b2_e:
    s_setprio 0
    s_mov_b64 exec, 1
    ds_add_u32 v1, v2 offset:20
    s_mov_b64 exec, -1
L_w_68:
    ds_read_b32 v3, v1 offset:20
    s_waitcnt lgkmcnt(0)
    v_readfirstlane_b32 s60, v3
    s_nop 0
    s_cmp_ge_u32 s60, 32
    s_cbranch_scc1 L_wd_69
    s_cmp_eq_u32 s76, 0
    s_cbranch_scc1 L_wd_69
    s_sub_u32 s76, s76, 1
    s_sleep 2
    s_branch L_w_68
L_wd_69:
    ds_read_b128 v[120:123], v150 offset:0
    ds_read_b128 v[124:127], v150 offset:1024
    ds_read_b128 v[128:131], v150 offset:2048
    s_waitcnt lgkmcnt(2)
    buffer_store_dwordx4 v[120:123], v4, s[40:43], s81 offen offset:0 sc1
    s_waitcnt lgkmcnt(1)
    buffer_store_dwordx4 v[124:127], v4, s[40:43], s81 offen offset:1024 sc1
    s_waitcnt lgkmcnt(0)
    buffer_store_dwordx4 v[128:131], v4, s[40:43], s81 offen offset:2048 sc1
    s_lshl_b32 s58, s2, 6
    s_add_u32 s58, s58, 81920
    v_mov_b32 v100, s38
    v_mov_b32 v101, s39
    v_mov_b32 v102, 0
    s_mov_b64 exec, 1
    s_setprio 2
    s_waitcnt vmcnt(0) lgkmcnt(0)
    ds_add_rtn_u32 v3, v1, v2 offset:20
    s_waitcnt lgkmcnt(0)
    v_readfirstlane_b32 s60, v3
    s_nop 0
    s_cmp_lg_u32 s60, 35
    s_cbranch_scc1 L_nl_70
    buffer_store_dwordx2 v[100:101], v102, s[40:43], s58 offen sc1
L_nl_70:
    s_mov_b64 exec, -1
    s_setprio 0
L_w_71:
    ds_read_b32 v3, v1 offset:20
    s_waitcnt lgkmcnt(0)
    v_readfirstlane_b32 s60, v3
    s_nop 0
    s_cmp_ge_u32 s60, 36
    s_cbranch_scc1 L_wd_72
    s_cmp_eq_u32 s76, 0
    s_cbranch_scc1 L_wd_72
    s_sub_u32 s76, s76, 1
    s_sleep 2
    s_branch L_w_71
L_wd_72:
    s_mov_b32 s59, 0
    buffer_load_dwordx4 v[8:11], v4, s[52:55], s59 offen offset:0
    buffer_load_dwordx4 v[12:15], v4, s[52:55], s59 offen offset:1024
    buffer_load_dwordx4 v[16:19], v4, s[52:55], s59 offen offset:2048
    buffer_load_dwordx4 v[20:23], v4, s[52:55], s59 offen offset:3072
    s_mov_b32 s59, 4096
    buffer_load_dwordx4 v[24:27], v4, s[52:55], s59 offen offset:0
    buffer_load_dwordx4 v[28:31], v4, s[52:55], s59 offen offset:1024
    s_mov_b32 s59, 18432
    buffer_load_dwordx4 v[32:35], v4, s[52:55], s59 offen offset:0
    buffer_load_dwordx4 v[36:39], v4, s[52:55], s59 offen offset:1024
    buffer_load_dwordx4 v[40:43], v4, s[52:55], s59 offen offset:2048
    buffer_load_dwordx4 v[44:47], v4, s[52:55], s59 offen offset:3072
    s_mov_b32 s59, 22528
    buffer_load_dwordx4 v[48:51], v4, s[52:55], s59 offen offset:0
    buffer_load_dwordx4 v[52:55], v4, s[52:55], s59 offen offset:1024
    buffer_load_dwordx4 v[56:59], v4, s[52:55], s59 offen offset:2048
    buffer_load_dwordx4 v[60:63], v4, s[52:55], s59 offen offset:3072
    s_mov_b32 s59, 26624
    buffer_load_dwordx4 v[64:67], v4, s[52:55], s59 offen offset:0
    buffer_load_dwordx4 v[68:71], v4, s[52:55], s59 offen offset:1024
    buffer_load_dwordx4 v[72:75], v4, s[52:55], s59 offen offset:2048
    buffer_load_dwordx4 v[76:79], v4, s[52:55], s59 offen offset:3072
    s_mov_b32 s59, 30720
    buffer_load_dwordx4 v[80:83], v4, s[52:55], s59 offen offset:0
    buffer_load_dwordx4 v[84:87], v4, s[52:55], s59 offen offset:1024
    s_mov_b32 s44, s32
    s_mov_b32 s45, s33
    s_mov_b32 s46, 0x500000
    s_mov_b32 s47, 0x20000
    s_lshl_b32 s72, s10, 12
    s_add_u32 s72, s72, 81920
L_p_73:
    buffer_load_dwordx2 v[104:105], v7, s[40:43], s72 offen sc1
    s_waitcnt vmcnt(0)
    v_cmp_ne_u64 vcc, s[38:39], v[104:105]
    s_cbranch_vccz L_pd_74
    s_cmp_eq_u32 s76, 0
    s_cbranch_scc1 L_pd_74
    s_sub_u32 s76, s76, 1
    s_sleep 2
    s_branch L_p_73
L_pd_74:
    s_mov_b64 exec, 1
    ds_add_u32 v1, v2 offset:20
    s_mov_b64 exec, -1
L_w_75:
    ds_read_b32 v3, v1 offset:20
    s_waitcnt lgkmcnt(0)
    v_readfirstlane_b32 s60, v3
    s_nop 0
    s_cmp_ge_u32 s60, 40
    s_cbranch_scc1 L_wd_76
    s_cmp_eq_u32 s76, 0
    s_cbranch_scc1 L_wd_76
    s_sub_u32 s76, s76, 1
    s_sleep 1
    s_branch L_w_75
L_wd_76:
    buffer_load_dword v88, v159, s[40:43], s82 offen sc1
    buffer_load_dword v89, v159, s[40:43], s83 offen sc1
    buffer_load_dword v90, v159, s[40:43], s84 offen sc1
    buffer_load_dword v91, v159, s[40:43], s85 offen sc1
    buffer_load_dword v92, v160, s[40:43], s82 offen sc1
    buffer_load_dword v93, v160, s[40:43], s83 offen sc1
    buffer_load_dword v94, v160, s[40:43], s84 offen sc1
    buffer_load_dword v95, v160, s[40:43], s85 offen sc1
    buffer_load_dword v96, v161, s[40:43], s82 offen sc1
    buffer_load_dword v97, v161, s[40:43], s83 offen sc1
    buffer_load_dword v98, v161, s[40:43], s84 offen sc1
    buffer_load_dword v99, v161, s[40:43], s85 offen sc1
L_w_77:
    ds_read_b128 v[100:103], v1 offset:80
    s_waitcnt lgkmcnt(0)
    v_min3_u32 v100, v100, v101, v102
    v_min_u32 v100, v100, v103
    s_nop 0
    v_readfirstlane_b32 s60, v100
    s_nop 0
    s_cmp_ge_u32 s60, 8
    s_cbranch_scc1 L_wd_78
    s_cmp_eq_u32 s76, 0
    s_cbranch_scc1 L_wd_78
    s_sub_u32 s76, s76, 1
    s_sleep 2
    s_branch L_w_77
L_wd_78:
    s_waitcnt vmcnt(8)
    v_mfma_f32_32x32x16_bf16 v[100:115], v[32:35], v[88:91], 0
    s_waitcnt vmcnt(4)
    v_mfma_f32_32x32x16_bf16 v[116:131], v[32:35], v[92:95], 0
    s_waitcnt vmcnt(0)
    v_mfma_f32_32x32x16_bf16 v[132:147], v[32:35], v[96:99], 0
    s_mov_b32 s62, 1
    s_mov_b32 s63, 1
    s_cmp_eq_u32 s10, 0
    s_cbranch_scc1 L_b3_f0
    s_cmp_eq_u32 s10, 2
    s_cbranch_scc1 L_b3_f2
    s_branch L_b3_fd
L_b3_f0:
    s_nop 11
    v_mul_f32 v3, 0.5, v100
    v_mul_f32 v7, 0.5, v100
    s_nop 1
    v_permlane32_swap_b32 v3, v7
    v_add_f32 v3, v3, v7
    v_cndmask_b32 v100, v100, v3, s[62:63]
    v_mul_f32 v3, 0.5, v101
    v_mul_f32 v7, 0.5, v101
    s_nop 1
    v_permlane32_swap_b32 v3, v7
    v_add_f32 v3, v3, v7
    v_cndmask_b32 v101, v101, v3, s[62:63]
    v_mul_f32 v3, 0.5, v102
    v_mul_f32 v7, 0.5, v102
    s_nop 1
    v_permlane32_swap_b32 v3, v7
    v_add_f32 v3, v3, v7
    v_cndmask_b32 v102, v102, v3, s[62:63]
    v_mul_f32 v3, 0.5, v103
    v_mul_f32 v7, 0.5, v103
    s_nop 1
    v_permlane32_swap_b32 v3, v7
    v_add_f32 v3, v3, v7
    v_cndmask_b32 v103, v103, v3, s[62:63]
    v_mul_f32 v3, 0.5, v104
    v_mul_f32 v7, 0.5, v104
    s_nop 1
    v_permlane32_swap_b32 v3, v7
    v_add_f32 v3, v3, v7
    v_cndmask_b32 v104, v104, v3, s[62:63]
    v_mul_f32 v3, 0.5, v105
    v_mul_f32 v7, 0.5, v105
    s_nop 1
    v_permlane32_swap_b32 v3, v7
    v_add_f32 v3, v3, v7
    v_cndmask_b32 v105, v105, v3, s[62:63]
    v_mul_f32 v3, 0.5, v106
    v_mul_f32 v7, 0.5, v106
    s_nop 1
    v_permlane32_swap_b32 v3, v7
    v_add_f32 v3, v3, v7
    v_cndmask_b32 v106, v106, v3, s[62:63]
    v_mul_f32 v3, 0.5, v107
    v_mul_f32 v7, 0.5, v107
    s_nop 1
    v_permlane32_swap_b32 v3, v7
    v_add_f32 v3, v3, v7
    v_cndmask_b32 v107, v107, v3, s[62:63]
    s_branch L_b3_fd
L_b3_f2:
    s_nop 11
    v_mul_f32 v3, 0.5, v132
    v_mul_f32 v7, 0.5, v132
    s_nop 1
    v_permlane32_swap_b32 v3, v7
    v_add_f32 v3, v3, v7
    v_cndmask_b32 v132, v132, v3, s[62:63]
    v_mul_f32 v3, 0.5, v133
    v_mul_f32 v7, 0.5, v133
    s_nop 1
    v_permlane32_swap_b32 v3, v7
    v_add_f32 v3, v3, v7
    v_cndmask_b32 v133, v133, v3, s[62:63]
    v_mul_f32 v3, 0.5, v134
    v_mul_f32 v7, 0.5, v134
    s_nop 1
    v_permlane32_swap_b32 v3, v7
    v_add_f32 v3, v3, v7
    v_cndmask_b32 v134, v134, v3, s[62:63]
    v_mul_f32 v3, 0.5, v135
    v_mul_f32 v7, 0.5, v135
    s_nop 1
    v_permlane32_swap_b32 v3, v7
    v_add_f32 v3, v3, v7
    v_cndmask_b32 v135, v135, v3, s[62:63]
    v_mul_f32 v3, 0.5, v136
    v_mul_f32 v7, 0.5, v136
    s_nop 1
    v_permlane32_swap_b32 v3, v7
    v_add_f32 v3, v3, v7
    v_cndmask_b32 v136, v136, v3, s[62:63]
    v_mul_f32 v3, 0.5, v137
    v_mul_f32 v7, 0.5, v137
    s_nop 1
    v_permlane32_swap_b32 v3, v7
    v_add_f32 v3, v3, v7
    v_cndmask_b32 v137, v137, v3, s[62:63]
    v_mul_f32 v3, 0.5, v138
    v_mul_f32 v7, 0.5, v138
    s_nop 1
    v_permlane32_swap_b32 v3, v7
    v_add_f32 v3, v3, v7
    v_cndmask_b32 v138, v138, v3, s[62:63]
    v_mul_f32 v3, 0.5, v139
    v_mul_f32 v7, 0.5, v139
    s_nop 1
    v_permlane32_swap_b32 v3, v7
    v_add_f32 v3, v3, v7
    v_cndmask_b32 v139, v139, v3, s[62:63]
L_b3_fd:
    s_nop 8
    v_cvt_pk_bf16_f32 v88, v100, v101
    v_cvt_pk_bf16_f32 v89, v102, v103
    v_cvt_pk_bf16_f32 v90, v104, v105
    v_cvt_pk_bf16_f32 v91, v106, v107
    ds_write_b128 v162, v[88:91] offset:21504
    v_cvt_pk_bf16_f32 v92, v116, v117
    v_cvt_pk_bf16_f32 v93, v118, v119
    v_cvt_pk_bf16_f32 v94, v120, v121
    v_cvt_pk_bf16_f32 v95, v122, v123
    ds_write_b128 v163, v[92:95] offset:21504
    v_cvt_pk_bf16_f32 v96, v132, v133
    v_cvt_pk_bf16_f32 v97, v134, v135
    v_cvt_pk_bf16_f32 v98, v136, v137
    v_cvt_pk_bf16_f32 v99, v138, v139
    ds_write_b128 v164, v[96:99] offset:21504
    s_mov_b64 exec, 1
    ds_add_u32 v1, v2 offset:20
    s_mov_b64 exec, -1
L_w_79:
    ds_read_b32 v3, v1 offset:20
    s_waitcnt lgkmcnt(0)
    v_readfirstlane_b32 s60, v3
    s_nop 0
    s_cmp_ge_u32 s60, 44
    s_cbranch_scc1 L_wd_80
    s_cmp_eq_u32 s76, 0
    s_cbranch_scc1 L_wd_80
    s_sub_u32 s76, s76, 1
    s_sleep 2
    s_branch L_w_79
L_wd_80:
    ds_read_b32 v88, v148 offset:0
    ds_read_b32 v89, v148 offset:512
    ds_read_b32 v90, v148 offset:1024
    ds_read_b32 v91, v148 offset:1536
    ds_read_b32 v92, v148 offset:2048
    ds_read_b32 v93, v148 offset:2560
    ds_read_b32 v94, v148 offset:3072
    ds_read_b32 v95, v148 offset:3584
    ds_read_b32 v96, v148 offset:4096
    ds_read_b32 v97, v148 offset:4608
    s_mov_b64 exec, 1
    ds_add_u32 v1, v2 offset:20
    s_mov_b64 exec, -1
    s_waitcnt lgkmcnt(0)
    v_mfma_f32_32x32x16_bf16 v[100:115], v[88:91], v[36:39], 0
    v_mfma_f32_32x32x16_bf16 v[116:131], v[88:91], v[44:47], 0
    v_mfma_f32_32x32x16_bf16 v[100:115], v[92:95], v[40:43], v[100:115]
    v_mfma_f32_32x32x16_bf16 v[116:131], v[92:95], v[48:51], v[116:131]
    v_mfma_f32_32x32x8_bf16 v[100:115], v[96:97], v[52:53], v[100:115]
    v_mfma_f32_32x32x8_bf16 v[116:131], v[96:97], v[54:55], v[116:131]
    s_nop 11
    v_mul_f32 v88, v116, v72
    v_mul_f32 v89, v100, v72
    v_fma_f32 v100, v100, v56, -v88
    v_fma_f32 v116, v116, v56, v89
    v_mul_f32 v90, v117, v73
    v_mul_f32 v91, v101, v73
    v_fma_f32 v101, v101, v57, -v90
    v_fma_f32 v117, v117, v57, v91
    v_mul_f32 v88, v118, v74
    v_mul_f32 v89, v102, v74
    v_fma_f32 v102, v102, v58, -v88
    v_fma_f32 v118, v118, v58, v89
    v_mul_f32 v90, v119, v75
    v_mul_f32 v91, v103, v75
    v_fma_f32 v103, v103, v59, -v90
    v_fma_f32 v119, v119, v59, v91
    v_mul_f32 v88, v120, v76
    v_mul_f32 v89, v104, v76
    v_fma_f32 v104, v104, v60, -v88
    v_fma_f32 v120, v120, v60, v89
    v_mul_f32 v90, v121, v77
    v_mul_f32 v91, v105, v77
    v_fma_f32 v105, v105, v61, -v90
    v_fma_f32 v121, v121, v61, v91
    v_mul_f32 v88, v122, v78
    v_mul_f32 v89, v106, v78
    v_fma_f32 v106, v106, v62, -v88
    v_fma_f32 v122, v122, v62, v89
    v_mul_f32 v90, v123, v79
    v_mul_f32 v91, v107, v79
    v_fma_f32 v107, v107, v63, -v90
    v_fma_f32 v123, v123, v63, v91
    v_mul_f32 v88, v124, v80
    v_mul_f32 v89, v108, v80
    v_fma_f32 v108, v108, v64, -v88
    v_fma_f32 v124, v124, v64, v89
    v_mul_f32 v90, v125, v81
    v_mul_f32 v91, v109, v81
    v_fma_f32 v109, v109, v65, -v90
    v_fma_f32 v125, v125, v65, v91
    v_mul_f32 v88, v126, v82
    v_mul_f32 v89, v110, v82
    v_fma_f32 v110, v110, v66, -v88
    v_fma_f32 v126, v126, v66, v89
    v_mul_f32 v90, v127, v83
    v_mul_f32 v91, v111, v83
    v_fma_f32 v111, v111, v67, -v90
    v_fma_f32 v127, v127, v67, v91
    v_mul_f32 v88, v128, v84
    v_mul_f32 v89, v112, v84
    v_fma_f32 v112, v112, v68, -v88
    v_fma_f32 v128, v128, v68, v89
    v_mul_f32 v90, v129, v85
    v_mul_f32 v91, v113, v85
    v_fma_f32 v113, v113, v69, -v90
    v_fma_f32 v129, v129, v69, v91
    v_mul_f32 v88, v130, v86
    v_mul_f32 v89, v114, v86
    v_fma_f32 v114, v114, v70, -v88
    v_fma_f32 v130, v130, v70, v89
    v_mul_f32 v90, v131, v87
    v_mul_f32 v91, v115, v87
    v_fma_f32 v115, v115, v71, -v90
    v_fma_f32 v131, v131, v71, v91
    v_cvt_pk_bf16_f32 v132, v100, v101
    v_cvt_pk_bf16_f32 v133, v102, v103
    v_cvt_pk_bf16_f32 v134, v104, v105
    v_cvt_pk_bf16_f32 v135, v106, v107
    v_cvt_pk_bf16_f32 v136, v108, v109
    v_cvt_pk_bf16_f32 v137, v110, v111
    v_cvt_pk_bf16_f32 v138, v112, v113
    v_cvt_pk_bf16_f32 v139, v114, v115
    v_cvt_pk_bf16_f32 v140, v116, v117
    v_cvt_pk_bf16_f32 v141, v118, v119
    v_cvt_pk_bf16_f32 v142, v120, v121
    v_cvt_pk_bf16_f32 v143, v122, v123
    v_cvt_pk_bf16_f32 v144, v124, v125
    v_cvt_pk_bf16_f32 v145, v126, v127
    v_cvt_pk_bf16_f32 v146, v128, v129
    v_cvt_pk_bf16_f32 v147, v130, v131
    v_mfma_f32_32x32x16_bf16 v[100:115], v[132:135], v[8:11], 0
    v_mfma_f32_32x32x16_bf16 v[116:131], v[132:135], v[16:19], 0
    v_mfma_f32_32x32x16_bf16 v[100:115], v[136:139], v[12:15], v[100:115]
    v_mfma_f32_32x32x16_bf16 v[116:131], v[136:139], v[20:23], v[116:131]
    v_mfma_f32_32x32x16_bf16 v[100:115], v[140:143], v[24:27], v[100:115]
    v_mfma_f32_32x32x16_bf16 v[116:131], v[140:143], v[8:11], v[116:131]
    v_mfma_f32_32x32x16_bf16 v[100:115], v[144:147], v[28:31], v[100:115]
    v_mfma_f32_32x32x16_bf16 v[116:131], v[144:147], v[12:15], v[116:131]
L_w_81:
    ds_read_b32 v3, v1 offset:20
    s_waitcnt lgkmcnt(0)
    v_readfirstlane_b32 s60, v3
    s_nop 0
    s_cmp_ge_u32 s60, 48
    s_cbranch_scc1 L_wd_82
    s_cmp_eq_u32 s76, 0
    s_cbranch_scc1 L_wd_82
    s_sub_u32 s76, s76, 1
    s_sleep 0
    s_branch L_w_81
L_wd_82:
    s_mul_i32 s12, s10, 2560
    s_add_u32 s12, s12, 21504
    v_add_u32 v165, s12, v165
    v_add_u32 v5, s12, v4
    v_add_u32 v6, 2621184, v4
    v_add_u32 v3, 1024, v4
    v_cmp_lt_u32 vcc, 15, v0
    v_add_u32 v7, 1024, v6
    s_nop 0
    v_cndmask_b32 v6, v3, v6, vcc
    v_cvt_pk_bf16_f32 v88, v100, v101
    v_cvt_pk_bf16_f32 v89, v102, v103
    ds_write_b64 v165, v[88:89] offset:0
    v_cvt_pk_bf16_f32 v90, v104, v105
    v_cvt_pk_bf16_f32 v91, v106, v107
    ds_write_b64 v165, v[90:91] offset:16
    v_cvt_pk_bf16_f32 v92, v108, v109
    v_cvt_pk_bf16_f32 v93, v110, v111
    s_mov_b32 exec_hi, 0
    ds_write_b64 v165, v[92:93] offset:32
    s_mov_b64 exec, -1
    v_cvt_pk_bf16_f32 v94, v116, v117
    v_cvt_pk_bf16_f32 v95, v118, v119
    ds_write_b64 v165, v[94:95] offset:1280
    v_cvt_pk_bf16_f32 v96, v120, v121
    v_cvt_pk_bf16_f32 v97, v122, v123
    ds_write_b64 v165, v[96:97] offset:1296
    v_cvt_pk_bf16_f32 v98, v124, v125
    v_cvt_pk_bf16_f32 v99, v126, v127
    s_mov_b32 exec_hi, 0
    ds_write_b64 v165, v[98:99] offset:1312
    s_mov_b64 exec, -1
    ds_read_b128 v[8:11], v5 offset:0
    ds_read_b128 v[12:15], v5 offset:1024
    ds_read_b128 v[16:19], v5 offset:2048
    s_waitcnt lgkmcnt(2)
    buffer_store_dwordx4 v[8:11], v4, s[44:47], s86 offen sc1
    s_waitcnt lgkmcnt(1)
    buffer_store_dwordx4 v[12:15], v6, s[44:47], s86 offen sc1
    s_waitcnt lgkmcnt(0)
    s_mov_b32 exec_hi, 0
    buffer_store_dwordx4 v[16:19], v7, s[44:47], s86 offen sc1
    s_mov_b64 exec, -1
    s_endpgm
L_loader:
    v_mov_b32 v4, 0
    v_lshl_add_u32 v5, v0, 2, v1
    ds_write_b32 v5, v4
    s_waitcnt lgkmcnt(0)
    s_barrier
    s_setprio 3
    v_lshlrev_b32 v6, 4, v0
    v_lshlrev_b32 v7, 6, v0
    s_mul_i32 s12, s7, 160
    v_add_u32 v8, 0, v0
    v_mul_u32_u24 v9, 52429, v8
    v_lshrrev_b32 v9, 19, v9
    v_mul_u32_u24 v16, 10, v9
    v_sub_u32 v16, v8, v16
    v_mul_u32_u24 v9, 1280, v9
    v_lshlrev_b32 v16, 4, v16
    v_add3_u32 v10, v9, v16, s12
    v_add_u32 v8, 64, v0
    v_mul_u32_u24 v9, 52429, v8
    v_lshrrev_b32 v9, 19, v9
    v_mul_u32_u24 v16, 10, v9
    v_sub_u32 v16, v8, v16
    v_mul_u32_u24 v9, 1280, v9
    v_lshlrev_b32 v16, 4, v16
    v_add3_u32 v11, v9, v16, s12
    v_subrev_u32 v11, 1024, v11
    v_add_u32 v8, 128, v0
    v_mul_u32_u24 v9, 52429, v8
    v_lshrrev_b32 v9, 19, v9
    v_mul_u32_u24 v16, 10, v9
    v_sub_u32 v16, v8, v16
    v_mul_u32_u24 v9, 1280, v9
    v_lshlrev_b32 v16, 4, v16
    v_add3_u32 v12, v9, v16, s12
    v_subrev_u32 v12, 2048, v12
    v_add_u32 v8, 192, v0
    v_mul_u32_u24 v9, 52429, v8
    v_lshrrev_b32 v9, 19, v9
    v_mul_u32_u24 v16, 10, v9
    v_sub_u32 v16, v8, v16
    v_mul_u32_u24 v9, 1280, v9
    v_lshlrev_b32 v16, 4, v16
    v_add3_u32 v13, v9, v16, s12
    v_subrev_u32 v13, 3072, v13
    v_add_u32 v8, 256, v0
    v_mul_u32_u24 v9, 52429, v8
    v_lshrrev_b32 v9, 19, v9
    v_mul_u32_u24 v16, 10, v9
    v_sub_u32 v16, v8, v16
    v_mul_u32_u24 v9, 1280, v9
    v_lshlrev_b32 v16, 4, v16
    v_add3_u32 v14, v9, v16, s12
    s_load_dwordx2 s[38:39], s[36:37], 0
    s_mov_b32 s40, s36
    s_mov_b32 s41, s37
    s_mov_b32 s42, 0xa00000
    s_mov_b32 s43, 0x20000
    v_mov_b32 v15, 2
    v_lshrrev_b32 v24, 4, v0
    v_and_b32 v25, 15, v0
    v_add_u32 v24, 0, v24
    s_mul_i32 s13, s6, 81920
    v_add_u32 v26, 0, v24
    v_xor_b32 v27, v26, v25
    v_mul_u32_u24 v26, 1280, v26
    v_lshlrev_b32 v27, 4, v27
    v_add3_u32 v32, v26, v27, s13
    v_add_u32 v26, 4, v24
    v_xor_b32 v27, v26, v25
    v_mul_u32_u24 v26, 1280, v26
    v_lshlrev_b32 v27, 4, v27
    v_add3_u32 v33, v26, v27, s13
    v_subrev_u32 v33, 1024, v33
    v_add_u32 v26, 8, v24
    v_xor_b32 v27, v26, v25
    v_mul_u32_u24 v26, 1280, v26
    v_lshlrev_b32 v27, 4, v27
    v_add3_u32 v34, v26, v27, s13
    v_subrev_u32 v34, 2048, v34
    v_add_u32 v26, 12, v24
    v_xor_b32 v27, v26, v25
    v_mul_u32_u24 v26, 1280, v26
    v_lshlrev_b32 v27, 4, v27
    v_add3_u32 v35, v26, v27, s13
    v_subrev_u32 v35, 3072, v35
    s_mul_i32 s12, s7, 160
    s_and_b32 s12, s12, 0xffffffc0
    v_add_u32 v26, 0, v0
    v_mul_u32_u24 v27, 43691, v26
    v_lshrrev_b32 v27, 19, v27
    v_mul_u32_u24 v28, 12, v27
    v_sub_u32 v28, v26, v28
    v_mul_u32_u24 v27, 1280, v27
    v_lshlrev_b32 v28, 4, v28
    v_add3_u32 v36, v27, v28, s12
    v_add_u32 v26, 64, v0
    v_mul_u32_u24 v27, 43691, v26
    v_lshrrev_b32 v27, 19, v27
    v_mul_u32_u24 v28, 12, v27
    v_sub_u32 v28, v26, v28
    v_mul_u32_u24 v27, 1280, v27
    v_lshlrev_b32 v28, 4, v28
    v_add3_u32 v37, v27, v28, s12
    v_subrev_u32 v37, 1024, v37
    v_add_u32 v26, 128, v0
    v_mul_u32_u24 v27, 43691, v26
    v_lshrrev_b32 v27, 19, v27
    v_mul_u32_u24 v28, 12, v27
    v_sub_u32 v28, v26, v28
    v_mul_u32_u24 v27, 1280, v27
    v_lshlrev_b32 v28, 4, v28
    v_add3_u32 v38, v27, v28, s12
    v_subrev_u32 v38, 2048, v38
    s_mov_b32 s44, s16
    s_mov_b32 s45, s17
    s_mov_b32 s46, 0x280000
    s_mov_b32 s47, 0x20000
    s_mov_b32 s48, s18
    s_mov_b32 s49, s19
    s_mov_b32 s50, 0xc8000
    s_mov_b32 s51, 0x20000
    s_mov_b32 s14, 0
    s_mov_b32 s57, 0
    s_mov_b32 s58, 0
    s_waitcnt lgkmcnt(0)
    s_mul_i32 s38, s38, 0x9E3779B1
    s_add_u32 s38, s38, 0x7F4A7C15
    s_mul_i32 s39, s39, 0x2C9277B5
    s_add_u32 s39, s39, 0x5851F42D
L_w_83:
    ds_read_b32 v3, v1 offset:28
    s_waitcnt lgkmcnt(0)
    v_readfirstlane_b32 s60, v3
    s_nop 0
    s_cmp_ge_u32 s60, 6
    s_cbranch_scc1 L_wd_84
    s_cmp_eq_u32 s76, 0
    s_cbranch_scc1 L_wd_84
    s_sub_u32 s76, s76, 1
    s_sleep 0
    s_branch L_w_83
L_wd_84:
    s_add_u32 s12, s8, 2
    s_cmp_ge_u32 s12, 5
    s_cselect_b32 s13, 5, 0
    s_sub_u32 s12, s12, s13
    s_lshl_b32 s15, s12, 8
    s_cmp_eq_u32 s9, 0
    s_cbranch_scc1 L_us_85
    s_add_u32 m0, s14, 32768
    s_add_u32 s13, s15, 0
    buffer_load_dwordx4 v32, s[44:47], s13 offen offset:0 lds
    buffer_load_dwordx4 v33, s[44:47], s13 offen offset:1024 lds
    buffer_load_dwordx4 v34, s[44:47], s13 offen offset:2048 lds
    buffer_load_dwordx4 v35, s[44:47], s13 offen offset:3072 lds
L_us_85:
    s_cmp_eq_u32 s9, 1
    s_cbranch_scc1 L_us_86
    s_add_u32 m0, s14, 36864
    s_add_u32 s13, s15, 20480
    buffer_load_dwordx4 v32, s[44:47], s13 offen offset:0 lds
    buffer_load_dwordx4 v33, s[44:47], s13 offen offset:1024 lds
    buffer_load_dwordx4 v34, s[44:47], s13 offen offset:2048 lds
    buffer_load_dwordx4 v35, s[44:47], s13 offen offset:3072 lds
L_us_86:
    s_cmp_eq_u32 s9, 2
    s_cbranch_scc1 L_us_87
    s_add_u32 m0, s14, 40960
    s_add_u32 s13, s15, 40960
    buffer_load_dwordx4 v32, s[44:47], s13 offen offset:0 lds
    buffer_load_dwordx4 v33, s[44:47], s13 offen offset:1024 lds
    buffer_load_dwordx4 v34, s[44:47], s13 offen offset:2048 lds
    buffer_load_dwordx4 v35, s[44:47], s13 offen offset:3072 lds
L_us_87:
    s_cmp_eq_u32 s9, 3
    s_cbranch_scc1 L_us_88
    s_add_u32 m0, s14, 45056
    s_add_u32 s13, s15, 61440
    buffer_load_dwordx4 v32, s[44:47], s13 offen offset:0 lds
    buffer_load_dwordx4 v33, s[44:47], s13 offen offset:1024 lds
    buffer_load_dwordx4 v34, s[44:47], s13 offen offset:2048 lds
    buffer_load_dwordx4 v35, s[44:47], s13 offen offset:3072 lds
L_us_88:
L_w_89:
    ds_read_b32 v3, v1 offset:28
    s_waitcnt lgkmcnt(0)
    v_readfirstlane_b32 s60, v3
    s_nop 0
    s_cmp_ge_u32 s60, 6
    s_cbranch_scc1 L_wd_90
    s_cmp_eq_u32 s76, 0
    s_cbranch_scc1 L_wd_90
    s_sub_u32 s76, s76, 1
    s_sleep 0
    s_branch L_w_89
L_wd_90:
L_w_91:
    ds_read_b32 v3, v1 offset:4
    s_waitcnt lgkmcnt(0)
    v_readfirstlane_b32 s60, v3
    s_nop 0
    s_cmp_ge_u32 s60, 2
    s_cbranch_scc1 L_wd_92
    s_cmp_eq_u32 s76, 0
    s_cbranch_scc1 L_wd_92
    s_sub_u32 s76, s76, 1
    s_sleep 0
    s_branch L_w_91
L_wd_92:
    s_mul_i32 s13, s12, 163840
    s_add_u32 m0, s57, 137728
    s_add_u32 s13, s13, s58
    buffer_load_dwordx4 v36, s[48:51], s13 offen offset:0 lds
    buffer_load_dwordx4 v37, s[48:51], s13 offen offset:1024 lds
    buffer_load_dwordx4 v38, s[48:51], s13 offen offset:2048 lds
    s_add_u32 m0, m0, 3072
    s_add_u32 s13, s13, 20480
    buffer_load_dwordx4 v36, s[48:51], s13 offen offset:0 lds
    buffer_load_dwordx4 v37, s[48:51], s13 offen offset:1024 lds
    buffer_load_dwordx4 v38, s[48:51], s13 offen offset:2048 lds
    s_add_u32 m0, m0, 3072
    s_add_u32 s13, s13, 20480
    buffer_load_dwordx4 v36, s[48:51], s13 offen offset:0 lds
    buffer_load_dwordx4 v37, s[48:51], s13 offen offset:1024 lds
    buffer_load_dwordx4 v38, s[48:51], s13 offen offset:2048 lds
    s_add_u32 m0, m0, 3072
    s_add_u32 s13, s13, 20480
    buffer_load_dwordx4 v36, s[48:51], s13 offen offset:0 lds
    buffer_load_dwordx4 v37, s[48:51], s13 offen offset:1024 lds
    buffer_load_dwordx4 v38, s[48:51], s13 offen offset:2048 lds
    s_add_u32 m0, m0, 3072
    s_add_u32 s13, s13, 20480
    buffer_load_dwordx4 v36, s[48:51], s13 offen offset:0 lds
    buffer_load_dwordx4 v37, s[48:51], s13 offen offset:1024 lds
    buffer_load_dwordx4 v38, s[48:51], s13 offen offset:2048 lds
    s_add_u32 m0, m0, 3072
    s_add_u32 s13, s13, 20480
    buffer_load_dwordx4 v36, s[48:51], s13 offen offset:0 lds
    buffer_load_dwordx4 v37, s[48:51], s13 offen offset:1024 lds
    buffer_load_dwordx4 v38, s[48:51], s13 offen offset:2048 lds
    s_add_u32 m0, m0, 3072
    s_add_u32 s13, s13, 20480
    buffer_load_dwordx4 v36, s[48:51], s13 offen offset:0 lds
    buffer_load_dwordx4 v37, s[48:51], s13 offen offset:1024 lds
    buffer_load_dwordx4 v38, s[48:51], s13 offen offset:2048 lds
    s_add_u32 m0, m0, 3072
    s_add_u32 s13, s13, 20480
    buffer_load_dwordx4 v36, s[48:51], s13 offen offset:0 lds
    buffer_load_dwordx4 v37, s[48:51], s13 offen offset:1024 lds
    buffer_load_dwordx4 v38, s[48:51], s13 offen offset:2048 lds
    s_waitcnt vmcnt(0)
    s_mov_b64 exec, 1
    ds_add_u32 v1, v15 offset:40
    s_mov_b64 exec, -1
    s_mov_b32 s44, s24
    s_mov_b32 s45, s25
    s_mov_b32 s46, 0xc8000
    s_mov_b32 s47, 0x20000
    s_mov_b32 s80, 0
    s_mov_b32 s81, 141824
    s_mov_b32 s82, 32768
    s_mov_b32 s83, 54272
    s_mov_b32 s84, 75776
    s_mov_b32 s85, 97280
    s_mov_b32 s86, 0
    s_mov_b32 s87, 141824
    s_mov_b32 s12, 0
    s_mov_b32 s57, 0
    s_mov_b32 s68, 8
    s_mov_b32 s88, 4096
    s_mov_b32 s89, 8192
    s_mov_b32 s90, 12288
    s_mov_b32 s91, 16384
    s_lshl_b32 s58, s4, 11
    s_add_u32 s58, s58, 4096
    v_and_b32 v8, 0x7ff, v7
L_w_93:
    ds_read_b32 v3, v1 offset:44
    s_waitcnt lgkmcnt(0)
    v_readfirstlane_b32 s60, v3
    s_nop 0
    s_cmp_ge_u32 s60, 2
    s_cbranch_scc1 L_wd_94
    s_cmp_eq_u32 s76, 0
    s_cbranch_scc1 L_wd_94
    s_sub_u32 s76, s76, 1
    s_sleep 1
    s_branch L_w_93
L_wd_94:
L_p_95:
    buffer_load_dwordx2 v[18:19], v8, s[40:43], s58 offen sc1
    s_waitcnt vmcnt(0)
    v_cmp_ne_u64 vcc, s[38:39], v[18:19]
    s_cbranch_vccz L_pd_96
    s_cmp_eq_u32 s76, 0
    s_cbranch_scc1 L_pd_96
    s_sub_u32 s76, s76, 1
    s_sleep 2
    s_branch L_p_95
L_pd_96:
L_w_97:
    ds_read_b128 v[20:23], v1 offset:64
    s_waitcnt lgkmcnt(0)
    v_min3_u32 v20, v20, v21, v22
    v_min_u32 v20, v20, v23
    s_nop 0
    v_readfirstlane_b32 s60, v20
    s_nop 0
    s_cmp_ge_u32 s60, 2
    s_cbranch_scc1 L_wd_98
    s_cmp_eq_u32 s76, 0
    s_cbranch_scc1 L_wd_98
    s_sub_u32 s76, s76, 1
    s_sleep 0
    s_branch L_w_97
L_wd_98:
    s_add_u32 s13, s4, s12
    s_and_b32 s13, s13, 7
    s_mul_i32 s58, s13, 21504
    s_mov_b32 m0, 0
    s_add_u32 s58, s58, 131072
    buffer_load_dwordx4 v6, s[40:43], s58 offen offset:0 sc1 lds
    buffer_load_dwordx4 v6, s[40:43], s58 offen offset:1024 sc1 lds
    buffer_load_dwordx4 v6, s[40:43], s58 offen offset:2048 sc1 lds
    buffer_load_dwordx4 v6, s[40:43], s58 offen offset:3072 sc1 lds
    s_add_u32 m0, m0, 4096
    s_add_u32 s58, s58, 4096
    buffer_load_dwordx4 v6, s[40:43], s58 offen offset:0 sc1 lds
    buffer_load_dwordx4 v6, s[40:43], s58 offen offset:1024 sc1 lds
    buffer_load_dwordx4 v6, s[40:43], s58 offen offset:2048 sc1 lds
    buffer_load_dwordx4 v6, s[40:43], s58 offen offset:3072 sc1 lds
    s_add_u32 m0, m0, 4096
    s_add_u32 s58, s58, 4096
    buffer_load_dwordx4 v6, s[40:43], s58 offen offset:0 sc1 lds
    buffer_load_dwordx4 v6, s[40:43], s58 offen offset:1024 sc1 lds
    buffer_load_dwordx4 v6, s[40:43], s58 offen offset:2048 sc1 lds
    buffer_load_dwordx4 v6, s[40:43], s58 offen offset:3072 sc1 lds
    s_add_u32 m0, m0, 4096
    s_add_u32 s58, s58, 4096
    buffer_load_dwordx4 v6, s[40:43], s58 offen offset:0 sc1 lds
    buffer_load_dwordx4 v6, s[40:43], s58 offen offset:1024 sc1 lds
    buffer_load_dwordx4 v6, s[40:43], s58 offen offset:2048 sc1 lds
    buffer_load_dwordx4 v6, s[40:43], s58 offen offset:3072 sc1 lds
    s_add_u32 m0, m0, 4096
    s_add_u32 s58, s58, 4096
    buffer_load_dwordx4 v6, s[40:43], s58 offen offset:0 sc1 lds
    buffer_load_dwordx4 v6, s[40:43], s58 offen offset:1024 sc1 lds
    buffer_load_dwordx4 v6, s[40:43], s58 offen offset:2048 sc1 lds
    buffer_load_dwordx4 v6, s[40:43], s58 offen offset:3072 sc1 lds
    s_add_u32 m0, m0, 4096
    s_add_u32 s58, s58, 4096
    buffer_load_dwordx4 v6, s[40:43], s58 offen offset:0 sc1 lds
    s_add_u32 s12, s12, 1
    buffer_load_dwordx2 v[40:41], v7, s[40:43], s88 offen sc1
    buffer_load_dwordx2 v[42:43], v7, s[40:43], s89 offen sc1
    buffer_load_dwordx2 v[44:45], v7, s[40:43], s90 offen sc1
    buffer_load_dwordx2 v[46:47], v7, s[40:43], s91 offen sc1
    s_waitcnt vmcnt(4)
    s_mov_b64 exec, 1
    ds_add_u32 v1, v15 offset:12
    s_mov_b64 exec, -1
    s_waitcnt vmcnt(0)
    v_cmp_ne_u64 vcc, s[38:39], v[40:41]
    v_cmp_ne_u64 s[62:63], s[38:39], v[42:43]
    s_nop 0
    s_or_b64 vcc, vcc, s[62:63]
    v_cmp_ne_u64 s[62:63], s[38:39], v[44:45]
    s_nop 0
    s_or_b64 vcc, vcc, s[62:63]
    v_cmp_ne_u64 s[62:63], s[38:39], v[46:47]
    s_nop 0
    s_or_b64 vcc, vcc, s[62:63]
    s_cbranch_vccz L_ld_all
L_p_99:
    buffer_load_dwordx2 v[40:41], v7, s[40:43], s88 offen sc1
    buffer_load_dwordx2 v[42:43], v7, s[40:43], s89 offen sc1
    buffer_load_dwordx2 v[44:45], v7, s[40:43], s90 offen sc1
    buffer_load_dwordx2 v[46:47], v7, s[40:43], s91 offen sc1
    s_waitcnt vmcnt(0)
    v_cmp_ne_u64 vcc, s[38:39], v[40:41]
    v_cmp_ne_u64 s[62:63], s[38:39], v[42:43]
    s_nop 0
    s_or_b64 vcc, vcc, s[62:63]
    v_cmp_ne_u64 s[62:63], s[38:39], v[44:45]
    s_nop 0
    s_or_b64 vcc, vcc, s[62:63]
    v_cmp_ne_u64 s[62:63], s[38:39], v[46:47]
    s_nop 0
    s_or_b64 vcc, vcc, s[62:63]
    s_cbranch_vccz L_pd_100
    s_cmp_eq_u32 s76, 0
    s_cbranch_scc1 L_pd_100
    s_sub_u32 s76, s76, 1
    s_sleep 1
    s_branch L_p_99
L_pd_100:
L_ld_all:
L_w_101:
    ds_read_b128 v[20:23], v1 offset:64
    s_waitcnt lgkmcnt(0)
    v_min3_u32 v20, v20, v21, v22
    v_min_u32 v20, v20, v23
    s_nop 0
    v_readfirstlane_b32 s60, v20
    s_nop 0
    s_cmp_ge_u32 s60, 3
    s_cbranch_scc1 L_wd_102
    s_cmp_eq_u32 s76, 0
    s_cbranch_scc1 L_wd_102
    s_sub_u32 s76, s76, 1
    s_sleep 0
    s_branch L_w_101
L_wd_102:
    s_add_u32 s13, s4, s12
    s_and_b32 s13, s13, 7
    s_mul_i32 s58, s13, 21504
    s_mov_b32 m0, 141824
    s_add_u32 s58, s58, 131072
    buffer_load_dwordx4 v6, s[40:43], s58 offen offset:0 sc1 lds
    buffer_load_dwordx4 v6, s[40:43], s58 offen offset:1024 sc1 lds
    buffer_load_dwordx4 v6, s[40:43], s58 offen offset:2048 sc1 lds
    buffer_load_dwordx4 v6, s[40:43], s58 offen offset:3072 sc1 lds
    s_add_u32 m0, m0, 4096
    s_add_u32 s58, s58, 4096
    buffer_load_dwordx4 v6, s[40:43], s58 offen offset:0 sc1 lds
    buffer_load_dwordx4 v6, s[40:43], s58 offen offset:1024 sc1 lds
    buffer_load_dwordx4 v6, s[40:43], s58 offen offset:2048 sc1 lds
    buffer_load_dwordx4 v6, s[40:43], s58 offen offset:3072 sc1 lds
    s_add_u32 m0, m0, 4096
    s_add_u32 s58, s58, 4096
    buffer_load_dwordx4 v6, s[40:43], s58 offen offset:0 sc1 lds
    buffer_load_dwordx4 v6, s[40:43], s58 offen offset:1024 sc1 lds
    buffer_load_dwordx4 v6, s[40:43], s58 offen offset:2048 sc1 lds
    buffer_load_dwordx4 v6, s[40:43], s58 offen offset:3072 sc1 lds
    s_add_u32 m0, m0, 4096
    s_add_u32 s58, s58, 4096
    buffer_load_dwordx4 v6, s[40:43], s58 offen offset:0 sc1 lds
    buffer_load_dwordx4 v6, s[40:43], s58 offen offset:1024 sc1 lds
    buffer_load_dwordx4 v6, s[40:43], s58 offen offset:2048 sc1 lds
    buffer_load_dwordx4 v6, s[40:43], s58 offen offset:3072 sc1 lds
    s_add_u32 m0, m0, 4096
    s_add_u32 s58, s58, 4096
    buffer_load_dwordx4 v6, s[40:43], s58 offen offset:0 sc1 lds
    buffer_load_dwordx4 v6, s[40:43], s58 offen offset:1024 sc1 lds
    buffer_load_dwordx4 v6, s[40:43], s58 offen offset:2048 sc1 lds
    buffer_load_dwordx4 v6, s[40:43], s58 offen offset:3072 sc1 lds
    s_add_u32 m0, m0, 4096
    s_add_u32 s58, s58, 4096
    buffer_load_dwordx4 v6, s[40:43], s58 offen offset:0 sc1 lds
    s_add_u32 s12, s12, 1
    s_mov_b64 exec, 1
    ds_add_u32 v1, v2 offset:104
    s_mov_b64 exec, -1
L_w_103:
    ds_read_b128 v[20:23], v1 offset:64
    s_waitcnt lgkmcnt(0)
    v_min3_u32 v20, v20, v21, v22
    v_min_u32 v20, v20, v23
    s_nop 0
    v_readfirstlane_b32 s60, v20
    s_nop 0
    s_cmp_ge_u32 s60, 5
    s_cbranch_scc1 L_wd_104
    s_cmp_eq_u32 s76, 0
    s_cbranch_scc1 L_wd_104
    s_sub_u32 s76, s76, 1
    s_sleep 0
    s_branch L_w_103
L_wd_104:
    s_setprio 0
L_ld_p:
    s_mov_b32 m0, s12
    s_nop 0
    s_movrels_b32 s14, s80
    s_add_u32 s13, s4, s12
    s_and_b32 s13, s13, 7
    s_mul_i32 s58, s13, 21504
    s_mov_b32 m0, s14
    s_add_u32 s58, s58, 131072
    buffer_load_dwordx4 v6, s[40:43], s58 offen offset:0 sc1 lds
    buffer_load_dwordx4 v6, s[40:43], s58 offen offset:1024 sc1 lds
    buffer_load_dwordx4 v6, s[40:43], s58 offen offset:2048 sc1 lds
    buffer_load_dwordx4 v6, s[40:43], s58 offen offset:3072 sc1 lds
    s_add_u32 m0, m0, 4096
    s_add_u32 s58, s58, 4096
    buffer_load_dwordx4 v6, s[40:43], s58 offen offset:0 sc1 lds
    buffer_load_dwordx4 v6, s[40:43], s58 offen offset:1024 sc1 lds
    buffer_load_dwordx4 v6, s[40:43], s58 offen offset:2048 sc1 lds
    buffer_load_dwordx4 v6, s[40:43], s58 offen offset:3072 sc1 lds
    s_add_u32 m0, m0, 4096
    s_add_u32 s58, s58, 4096
    buffer_load_dwordx4 v6, s[40:43], s58 offen offset:0 sc1 lds
    buffer_load_dwordx4 v6, s[40:43], s58 offen offset:1024 sc1 lds
    buffer_load_dwordx4 v6, s[40:43], s58 offen offset:2048 sc1 lds
    buffer_load_dwordx4 v6, s[40:43], s58 offen offset:3072 sc1 lds
    s_add_u32 m0, m0, 4096
    s_add_u32 s58, s58, 4096
    buffer_load_dwordx4 v6, s[40:43], s58 offen offset:0 sc1 lds
    buffer_load_dwordx4 v6, s[40:43], s58 offen offset:1024 sc1 lds
    buffer_load_dwordx4 v6, s[40:43], s58 offen offset:2048 sc1 lds
    buffer_load_dwordx4 v6, s[40:43], s58 offen offset:3072 sc1 lds
    s_add_u32 m0, m0, 4096
    s_add_u32 s58, s58, 4096
    buffer_load_dwordx4 v6, s[40:43], s58 offen offset:0 sc1 lds
    buffer_load_dwordx4 v6, s[40:43], s58 offen offset:1024 sc1 lds
    buffer_load_dwordx4 v6, s[40:43], s58 offen offset:2048 sc1 lds
    buffer_load_dwordx4 v6, s[40:43], s58 offen offset:3072 sc1 lds
    s_add_u32 m0, m0, 4096
    s_add_u32 s58, s58, 4096
    buffer_load_dwordx4 v6, s[40:43], s58 offen offset:0 sc1 lds
    s_add_u32 s12, s12, 1
    s_waitcnt vmcnt(21)
    s_mov_b64 exec, 1
    ds_add_u32 v1, v15 offset:12
    s_mov_b64 exec, -1
    s_cmp_lt_u32 s12, 6
    s_cbranch_scc1 L_ld_p
    s_waitcnt vmcnt(0)
    s_mov_b64 exec, 1
    ds_add_u32 v1, v15 offset:12
    s_mov_b64 exec, -1
L_w_105:
    ds_read_b128 v[20:23], v1 offset:80
    s_waitcnt lgkmcnt(0)
    v_min3_u32 v20, v20, v21, v22
    v_min_u32 v20, v20, v23
    s_nop 0
    v_readfirstlane_b32 s60, v20
    s_nop 0
    s_cmp_ge_u32 s60, 1
    s_cbranch_scc1 L_wd_106
    s_cmp_eq_u32 s76, 0
    s_cbranch_scc1 L_wd_106
    s_sub_u32 s76, s76, 1
    s_sleep 12
    s_branch L_w_105
L_wd_106:
    s_add_u32 s13, s4, s12
    s_and_b32 s13, s13, 7
    s_mul_i32 s58, s13, 21504
    s_mov_b32 m0, 0
    s_add_u32 s58, s58, 131072
    buffer_load_dwordx4 v6, s[40:43], s58 offen offset:0 sc1 lds
    buffer_load_dwordx4 v6, s[40:43], s58 offen offset:1024 sc1 lds
    buffer_load_dwordx4 v6, s[40:43], s58 offen offset:2048 sc1 lds
    buffer_load_dwordx4 v6, s[40:43], s58 offen offset:3072 sc1 lds
    s_add_u32 m0, m0, 4096
    s_add_u32 s58, s58, 4096
    buffer_load_dwordx4 v6, s[40:43], s58 offen offset:0 sc1 lds
    buffer_load_dwordx4 v6, s[40:43], s58 offen offset:1024 sc1 lds
    buffer_load_dwordx4 v6, s[40:43], s58 offen offset:2048 sc1 lds
    buffer_load_dwordx4 v6, s[40:43], s58 offen offset:3072 sc1 lds
    s_add_u32 m0, m0, 4096
    s_add_u32 s58, s58, 4096
    buffer_load_dwordx4 v6, s[40:43], s58 offen offset:0 sc1 lds
    buffer_load_dwordx4 v6, s[40:43], s58 offen offset:1024 sc1 lds
    buffer_load_dwordx4 v6, s[40:43], s58 offen offset:2048 sc1 lds
    buffer_load_dwordx4 v6, s[40:43], s58 offen offset:3072 sc1 lds
    s_add_u32 m0, m0, 4096
    s_add_u32 s58, s58, 4096
    buffer_load_dwordx4 v6, s[40:43], s58 offen offset:0 sc1 lds
    buffer_load_dwordx4 v6, s[40:43], s58 offen offset:1024 sc1 lds
    buffer_load_dwordx4 v6, s[40:43], s58 offen offset:2048 sc1 lds
    buffer_load_dwordx4 v6, s[40:43], s58 offen offset:3072 sc1 lds
    s_add_u32 m0, m0, 4096
    s_add_u32 s58, s58, 4096
    buffer_load_dwordx4 v6, s[40:43], s58 offen offset:0 sc1 lds
    buffer_load_dwordx4 v6, s[40:43], s58 offen offset:1024 sc1 lds
    buffer_load_dwordx4 v6, s[40:43], s58 offen offset:2048 sc1 lds
    buffer_load_dwordx4 v6, s[40:43], s58 offen offset:3072 sc1 lds
    s_add_u32 m0, m0, 4096
    s_add_u32 s58, s58, 4096
    buffer_load_dwordx4 v6, s[40:43], s58 offen offset:0 sc1 lds
    s_add_u32 s12, s12, 1
    s_waitcnt vmcnt(0)
    s_mov_b64 exec, 1
    ds_add_u32 v1, v15 offset:12
    s_mov_b64 exec, -1
L_w_107:
    ds_read_b128 v[20:23], v1 offset:80
    s_waitcnt lgkmcnt(0)
    v_min3_u32 v20, v20, v21, v22
    v_min_u32 v20, v20, v23
    s_nop 0
    v_readfirstlane_b32 s60, v20
    s_nop 0
    s_cmp_ge_u32 s60, 2
    s_cbranch_scc1 L_wd_108
    s_cmp_eq_u32 s76, 0
    s_cbranch_scc1 L_wd_108
    s_sub_u32 s76, s76, 1
    s_sleep 12
    s_branch L_w_107
L_wd_108:
    s_add_u32 s13, s4, s12
    s_and_b32 s13, s13, 7
    s_mul_i32 s58, s13, 21504
    s_mov_b32 m0, 141824
    s_add_u32 s58, s58, 131072
    buffer_load_dwordx4 v6, s[40:43], s58 offen offset:0 sc1 lds
    buffer_load_dwordx4 v6, s[40:43], s58 offen offset:1024 sc1 lds
    buffer_load_dwordx4 v6, s[40:43], s58 offen offset:2048 sc1 lds
    buffer_load_dwordx4 v6, s[40:43], s58 offen offset:3072 sc1 lds
    s_add_u32 m0, m0, 4096
    s_add_u32 s58, s58, 4096
    buffer_load_dwordx4 v6, s[40:43], s58 offen offset:0 sc1 lds
    buffer_load_dwordx4 v6, s[40:43], s58 offen offset:1024 sc1 lds
    buffer_load_dwordx4 v6, s[40:43], s58 offen offset:2048 sc1 lds
    buffer_load_dwordx4 v6, s[40:43], s58 offen offset:3072 sc1 lds
    s_add_u32 m0, m0, 4096
    s_add_u32 s58, s58, 4096
    buffer_load_dwordx4 v6, s[40:43], s58 offen offset:0 sc1 lds
    buffer_load_dwordx4 v6, s[40:43], s58 offen offset:1024 sc1 lds
    buffer_load_dwordx4 v6, s[40:43], s58 offen offset:2048 sc1 lds
    buffer_load_dwordx4 v6, s[40:43], s58 offen offset:3072 sc1 lds
    s_add_u32 m0, m0, 4096
    s_add_u32 s58, s58, 4096
    buffer_load_dwordx4 v6, s[40:43], s58 offen offset:0 sc1 lds
    buffer_load_dwordx4 v6, s[40:43], s58 offen offset:1024 sc1 lds
    buffer_load_dwordx4 v6, s[40:43], s58 offen offset:2048 sc1 lds
    buffer_load_dwordx4 v6, s[40:43], s58 offen offset:3072 sc1 lds
    s_add_u32 m0, m0, 4096
    s_add_u32 s58, s58, 4096
    buffer_load_dwordx4 v6, s[40:43], s58 offen offset:0 sc1 lds
    buffer_load_dwordx4 v6, s[40:43], s58 offen offset:1024 sc1 lds
    buffer_load_dwordx4 v6, s[40:43], s58 offen offset:2048 sc1 lds
    buffer_load_dwordx4 v6, s[40:43], s58 offen offset:3072 sc1 lds
    s_add_u32 m0, m0, 4096
    s_add_u32 s58, s58, 4096
    buffer_load_dwordx4 v6, s[40:43], s58 offen offset:0 sc1 lds
    s_add_u32 s12, s12, 1
    s_waitcnt vmcnt(0)
    s_mov_b64 exec, 1
    ds_add_u32 v1, v15 offset:12
    s_mov_b64 exec, -1
    s_branch L_ld_wo
L_ld_e:
    s_sub_u32 s61, s12, 1
L_w_109:
    ds_read_b128 v[20:23], v1 offset:80
    s_waitcnt lgkmcnt(0)
    v_min3_u32 v20, v20, v21, v22
    v_min_u32 v20, v20, v23
    s_nop 0
    v_readfirstlane_b32 s60, v20
    s_nop 0
    s_cmp_ge_u32 s60, s61
    s_cbranch_scc1 L_wd_110
    s_cmp_eq_u32 s76, 0
    s_cbranch_scc1 L_wd_110
    s_sub_u32 s76, s76, 1
    s_sleep 4
    s_branch L_w_109
L_wd_110:
    s_and_b32 m0, s12, 7
    s_nop 0
    s_movrels_b32 s14, s80
    s_add_u32 s13, s4, s12
    s_and_b32 s13, s13, 7
    s_mul_i32 s58, s13, 21504
    s_mov_b32 m0, s14
    s_add_u32 s58, s58, 131072
    buffer_load_dwordx4 v6, s[40:43], s58 offen offset:0 sc1 lds
    buffer_load_dwordx4 v6, s[40:43], s58 offen offset:1024 sc1 lds
    buffer_load_dwordx4 v6, s[40:43], s58 offen offset:2048 sc1 lds
    buffer_load_dwordx4 v6, s[40:43], s58 offen offset:3072 sc1 lds
    s_add_u32 m0, m0, 4096
    s_add_u32 s58, s58, 4096
    buffer_load_dwordx4 v6, s[40:43], s58 offen offset:0 sc1 lds
    buffer_load_dwordx4 v6, s[40:43], s58 offen offset:1024 sc1 lds
    buffer_load_dwordx4 v6, s[40:43], s58 offen offset:2048 sc1 lds
    buffer_load_dwordx4 v6, s[40:43], s58 offen offset:3072 sc1 lds
    s_add_u32 m0, m0, 4096
    s_add_u32 s58, s58, 4096
    buffer_load_dwordx4 v6, s[40:43], s58 offen offset:0 sc1 lds
    buffer_load_dwordx4 v6, s[40:43], s58 offen offset:1024 sc1 lds
    buffer_load_dwordx4 v6, s[40:43], s58 offen offset:2048 sc1 lds
    buffer_load_dwordx4 v6, s[40:43], s58 offen offset:3072 sc1 lds
    s_add_u32 m0, m0, 4096
    s_add_u32 s58, s58, 4096
    buffer_load_dwordx4 v6, s[40:43], s58 offen offset:0 sc1 lds
    buffer_load_dwordx4 v6, s[40:43], s58 offen offset:1024 sc1 lds
    buffer_load_dwordx4 v6, s[40:43], s58 offen offset:2048 sc1 lds
    buffer_load_dwordx4 v6, s[40:43], s58 offen offset:3072 sc1 lds
    s_add_u32 m0, m0, 4096
    s_add_u32 s58, s58, 4096
    buffer_load_dwordx4 v6, s[40:43], s58 offen offset:0 sc1 lds
    buffer_load_dwordx4 v6, s[40:43], s58 offen offset:1024 sc1 lds
    buffer_load_dwordx4 v6, s[40:43], s58 offen offset:2048 sc1 lds
    buffer_load_dwordx4 v6, s[40:43], s58 offen offset:3072 sc1 lds
    s_add_u32 m0, m0, 4096
    s_add_u32 s58, s58, 4096
    buffer_load_dwordx4 v6, s[40:43], s58 offen offset:0 sc1 lds
    s_add_u32 s12, s12, 1
    s_waitcnt vmcnt(0)
    s_mov_b64 exec, 1
    ds_add_u32 v1, v15 offset:12
    s_mov_b64 exec, -1
    s_cmp_lt_u32 s12, s68
    s_cbranch_scc1 L_ld_e
L_ld_wo:
    s_sub_u32 s69, s68, 8
    s_add_u32 s61, s69, 3
L_w_111:
    ds_read_b128 v[20:23], v1 offset:80
    s_waitcnt lgkmcnt(0)
    v_min3_u32 v20, v20, v21, v22
    v_min_u32 v20, v20, v23
    s_nop 0
    v_readfirstlane_b32 s60, v20
    s_nop 0
    s_cmp_ge_u32 s60, s61
    s_cbranch_scc1 L_wd_112
    s_cmp_eq_u32 s76, 0
    s_cbranch_scc1 L_wd_112
    s_sub_u32 s76, s76, 1
    s_sleep 16
    s_branch L_w_111
L_wd_112:
    s_mov_b32 m0, 32768
    s_mov_b32 s15, 0
    s_mov_b32 s59, 2
L_wo_113:
    buffer_load_dwordx4 v10, s[44:47], s15 offen offset:0 lds
    buffer_load_dwordx4 v11, s[44:47], s15 offen offset:1024 lds
    buffer_load_dwordx4 v12, s[44:47], s15 offen offset:2048 lds
    buffer_load_dwordx4 v13, s[44:47], s15 offen offset:3072 lds
    s_add_u32 m0, m0, 4096
    s_nop 0
    buffer_load_dwordx4 v14, s[44:47], s15 offen lds
    s_add_u32 m0, m0, 1024
    s_add_u32 s15, s15, 40960
    buffer_load_dwordx4 v10, s[44:47], s15 offen offset:0 lds
    buffer_load_dwordx4 v11, s[44:47], s15 offen offset:1024 lds
    buffer_load_dwordx4 v12, s[44:47], s15 offen offset:2048 lds
    buffer_load_dwordx4 v13, s[44:47], s15 offen offset:3072 lds
    s_add_u32 m0, m0, 4096
    s_sub_u32 s59, s59, 1
    buffer_load_dwordx4 v14, s[44:47], s15 offen lds
    s_add_u32 m0, m0, 1024
    s_add_u32 s15, s15, 40960
    s_cmp_lg_u32 s59, 0
    s_cbranch_scc1 L_wo_113
    s_add_u32 s61, s69, 4
L_w_114:
    ds_read_b128 v[20:23], v1 offset:80
    s_waitcnt lgkmcnt(0)
    v_min3_u32 v20, v20, v21, v22
    v_min_u32 v20, v20, v23
    s_nop 0
    v_readfirstlane_b32 s60, v20
    s_nop 0
    s_cmp_ge_u32 s60, s61
    s_cbranch_scc1 L_wd_115
    s_cmp_eq_u32 s76, 0
    s_cbranch_scc1 L_wd_115
    s_sub_u32 s76, s76, 1
    s_sleep 16
    s_branch L_w_114
L_wd_115:
    s_mov_b32 m0, 53248
    s_mov_b32 s15, 163840
    s_mov_b32 s59, 2
L_wo_116:
    buffer_load_dwordx4 v10, s[44:47], s15 offen offset:0 lds
    buffer_load_dwordx4 v11, s[44:47], s15 offen offset:1024 lds
    buffer_load_dwordx4 v12, s[44:47], s15 offen offset:2048 lds
    buffer_load_dwordx4 v13, s[44:47], s15 offen offset:3072 lds
    s_add_u32 m0, m0, 4096
    s_nop 0
    buffer_load_dwordx4 v14, s[44:47], s15 offen lds
    s_add_u32 m0, m0, 1024
    s_add_u32 s15, s15, 40960
    buffer_load_dwordx4 v10, s[44:47], s15 offen offset:0 lds
    buffer_load_dwordx4 v11, s[44:47], s15 offen offset:1024 lds
    buffer_load_dwordx4 v12, s[44:47], s15 offen offset:2048 lds
    buffer_load_dwordx4 v13, s[44:47], s15 offen offset:3072 lds
    s_add_u32 m0, m0, 4096
    s_sub_u32 s59, s59, 1
    buffer_load_dwordx4 v14, s[44:47], s15 offen lds
    s_add_u32 m0, m0, 1024
    s_add_u32 s15, s15, 40960
    s_cmp_lg_u32 s59, 0
    s_cbranch_scc1 L_wo_116
    s_add_u32 s61, s69, 5
L_w_117:
    ds_read_b128 v[20:23], v1 offset:80
    s_waitcnt lgkmcnt(0)
    v_min3_u32 v20, v20, v21, v22
    v_min_u32 v20, v20, v23
    s_nop 0
    v_readfirstlane_b32 s60, v20
    s_nop 0
    s_cmp_ge_u32 s60, s61
    s_cbranch_scc1 L_wd_118
    s_cmp_eq_u32 s76, 0
    s_cbranch_scc1 L_wd_118
    s_sub_u32 s76, s76, 1
    s_sleep 16
    s_branch L_w_117
L_wd_118:
    s_mov_b32 m0, 73728
    s_mov_b32 s15, 327680
    s_mov_b32 s59, 2
L_wo_119:
    buffer_load_dwordx4 v10, s[44:47], s15 offen offset:0 lds
    buffer_load_dwordx4 v11, s[44:47], s15 offen offset:1024 lds
    buffer_load_dwordx4 v12, s[44:47], s15 offen offset:2048 lds
    buffer_load_dwordx4 v13, s[44:47], s15 offen offset:3072 lds
    s_add_u32 m0, m0, 4096
    s_nop 0
    buffer_load_dwordx4 v14, s[44:47], s15 offen lds
    s_add_u32 m0, m0, 1024
    s_add_u32 s15, s15, 40960
    buffer_load_dwordx4 v10, s[44:47], s15 offen offset:0 lds
    buffer_load_dwordx4 v11, s[44:47], s15 offen offset:1024 lds
    buffer_load_dwordx4 v12, s[44:47], s15 offen offset:2048 lds
    buffer_load_dwordx4 v13, s[44:47], s15 offen offset:3072 lds
    s_add_u32 m0, m0, 4096
    s_sub_u32 s59, s59, 1
    buffer_load_dwordx4 v14, s[44:47], s15 offen lds
    s_add_u32 m0, m0, 1024
    s_add_u32 s15, s15, 40960
    s_cmp_lg_u32 s59, 0
    s_cbranch_scc1 L_wo_119
    s_add_u32 s61, s69, 6
L_w_120:
    ds_read_b128 v[20:23], v1 offset:80
    s_waitcnt lgkmcnt(0)
    v_min3_u32 v20, v20, v21, v22
    v_min_u32 v20, v20, v23
    s_nop 0
    v_readfirstlane_b32 s60, v20
    s_nop 0
    s_cmp_ge_u32 s60, s61
    s_cbranch_scc1 L_wd_121
    s_cmp_eq_u32 s76, 0
    s_cbranch_scc1 L_wd_121
    s_sub_u32 s76, s76, 1
    s_sleep 16
    s_branch L_w_120
L_wd_121:
    s_mov_b32 m0, 94208
    s_mov_b32 s15, 491520
    s_mov_b32 s59, 2
L_wo_122:
    buffer_load_dwordx4 v10, s[44:47], s15 offen offset:0 lds
    buffer_load_dwordx4 v11, s[44:47], s15 offen offset:1024 lds
    buffer_load_dwordx4 v12, s[44:47], s15 offen offset:2048 lds
    buffer_load_dwordx4 v13, s[44:47], s15 offen offset:3072 lds
    s_add_u32 m0, m0, 4096
    s_nop 0
    buffer_load_dwordx4 v14, s[44:47], s15 offen lds
    s_add_u32 m0, m0, 1024
    s_add_u32 s15, s15, 40960
    buffer_load_dwordx4 v10, s[44:47], s15 offen offset:0 lds
    buffer_load_dwordx4 v11, s[44:47], s15 offen offset:1024 lds
    buffer_load_dwordx4 v12, s[44:47], s15 offen offset:2048 lds
    buffer_load_dwordx4 v13, s[44:47], s15 offen offset:3072 lds
    s_add_u32 m0, m0, 4096
    s_sub_u32 s59, s59, 1
    buffer_load_dwordx4 v14, s[44:47], s15 offen lds
    s_add_u32 m0, m0, 1024
    s_add_u32 s15, s15, 40960
    s_cmp_lg_u32 s59, 0
    s_cbranch_scc1 L_wo_122
L_w_123:
    ds_read_b32 v3, v1 offset:20
    s_waitcnt lgkmcnt(0)
    v_readfirstlane_b32 s60, v3
    s_nop 0
    s_cmp_ge_u32 s60, 36
    s_cbranch_scc1 L_wd_124
    s_cmp_eq_u32 s76, 0
    s_cbranch_scc1 L_wd_124
    s_sub_u32 s76, s76, 1
    s_sleep 16
    s_branch L_w_123
L_wd_124:
    s_mov_b32 m0, 114688
    s_mov_b32 s15, 655360
    s_mov_b32 s59, 2
L_wo_125:
    buffer_load_dwordx4 v10, s[44:47], s15 offen offset:0 lds
    buffer_load_dwordx4 v11, s[44:47], s15 offen offset:1024 lds
    buffer_load_dwordx4 v12, s[44:47], s15 offen offset:2048 lds
    buffer_load_dwordx4 v13, s[44:47], s15 offen offset:3072 lds
    s_add_u32 m0, m0, 4096
    s_nop 0
    buffer_load_dwordx4 v14, s[44:47], s15 offen lds
    s_add_u32 m0, m0, 1024
    s_add_u32 s15, s15, 40960
    buffer_load_dwordx4 v10, s[44:47], s15 offen offset:0 lds
    buffer_load_dwordx4 v11, s[44:47], s15 offen offset:1024 lds
    buffer_load_dwordx4 v12, s[44:47], s15 offen offset:2048 lds
    buffer_load_dwordx4 v13, s[44:47], s15 offen offset:3072 lds
    s_add_u32 m0, m0, 4096
    s_sub_u32 s59, s59, 1
    buffer_load_dwordx4 v14, s[44:47], s15 offen lds
    s_add_u32 m0, m0, 1024
    s_add_u32 s15, s15, 40960
    s_cmp_lg_u32 s59, 0
    s_cbranch_scc1 L_wo_125
    s_cmp_lg_u32 s57, 0
    s_cbranch_scc1 L_ld_b2
    s_cmp_lg_u32 s2, 0
    s_cbranch_scc1 L_ld_b2
    s_mov_b32 s58, 0
    v_mov_b32 v18, s38
    v_mov_b32 v19, s39
    v_mov_b32 v20, 0
    s_mov_b64 exec, 1
    buffer_store_dwordx2 v[18:19], v20, s[40:43], s58 offen sc1
    s_mov_b64 exec, -1
L_ld_b2:
    s_lshl_b32 s61, s57, 2
    s_add_u32 s61, s61, 4
    s_waitcnt vmcnt(0)
    s_mov_b64 exec, 1
    ds_add_u32 v1, v2 offset:60
    s_mov_b64 exec, -1
    s_mul_i32 s62, s57, 16
    s_add_u32 s62, s62, 8
    s_lshl_b32 s58, s6, 9
    s_add_u32 s58, s58, 98304
    v_and_b32 v8, 7, v0
    v_lshlrev_b32 v8, 6, v8
    s_lshl_b32 s69, 1, s7
L_w_126:
    ds_read_b128 v[20:23], v1 offset:80
    s_waitcnt lgkmcnt(0)
    v_min3_u32 v20, v20, v21, v22
    v_min_u32 v20, v20, v23
    s_nop 0
    v_readfirstlane_b32 s60, v20
    s_nop 0
    s_cmp_ge_u32 s60, s62
    s_cbranch_scc1 L_wd_127
    s_cmp_eq_u32 s76, 0
    s_cbranch_scc1 L_wd_127
    s_sub_u32 s76, s76, 1
    s_sleep 4
    s_branch L_w_126
L_wd_127:
    s_setprio 1
L_w_128:
    ds_read_b32 v3, v1 offset:56
    s_waitcnt lgkmcnt(0)
    v_readfirstlane_b32 s60, v3
    s_nop 0
    s_and_b32 s59, s60, 0xff
    s_cmp_ge_u32 s59, s61
    s_cbranch_scc1 L_wd_129
    s_cmp_eq_u32 s76, 0
    s_cbranch_scc1 L_wd_129
    s_sub_u32 s76, s76, 1
    s_branch L_w_128
L_wd_129:
    s_cmp_lg_u32 s57, 0
    s_cbranch_scc1 L_ld_ok
    s_cmp_lt_u32 s60, 0x100
    s_cbranch_scc1 L_ld_ok
    s_mov_b32 s57, 1
    s_mov_b32 s68, 24
    s_setprio 0
    s_branch L_ld_e
L_ld_ok:
L_ld_r:
    buffer_load_dwordx2 v[40:41], v8, s[40:43], s58 offen sc1
    s_waitcnt vmcnt(0)
    v_cmp_eq_u64 vcc, s[38:39], v[40:41]
    s_nop 1
    s_and_b32 s60, vcc_lo, 0xff
    s_or_b32 s60, s60, s69
    s_cmp_eq_u32 s60, 0xff
    s_cbranch_scc1 L_ld_x
    s_cmp_eq_u32 s76, 0
    s_cbranch_scc1 L_ld_x
    s_sub_u32 s76, s76, 1
    s_branch L_ld_r
L_ld_x:
    v_mov_b32 v20, 0xff
    ds_write_b32 v1, v20 offset:96
    s_endpgm
L_exit:
    s_endpgm
.p2align 8
.type L_tables,@object
L_tables:
.long 0x3f803f80,0x3f803f80,0x3f803f80,0x3f803f80,0x3f7b3f80,0x3f553f6d,0xbe48248d,0xbf0ebec4
.long 0x3f6d3f80,0x3ec43f35,0xbf6dbf80,0xbec4bf35,0x3f553f80,0xbe483ec4,0x3f0ea554,0x3f7b3f6d
.long 0x3f353f80,0xbf35248d,0x3f353f80,0xbf35248d,0x3f0e3f80,0xbf7bbec4,0xbf55248d,0xbe48bf6d
.long 0x3ec43f80,0xbf6dbf35,0xbec4bf80,0x3f6d3f35,0x3e483f80,0xbf0ebf6d,0x3f7ba554,0xbf553ec4
.long 0x248d3f80,0xa554bf80,0x248d3f80,0xa554bf80,0xbe483f80,0x3f0ebf6d,0xbf7b248d,0x3f553ec4
.long 0xbec43f80,0x3f6dbf35,0x3ec4bf80,0xbf6d3f35,0xbf0e3f80,0x3f7bbec4,0x3f55a554,0x3e48bf6d
.long 0xbf353f80,0x3f35a554,0xbf353f80,0x3f35a554,0xbf553f80,0x3e483ec4,0xbf0e248d,0xbf7b3f6d
.long 0xbf6d3f80,0xbec43f35,0x3f6dbf80,0x3ec4bf35,0xbf7b3f80,0xbf553f6d,0x3e48a554,0x3f0ebec4
.long 0xbf803f80,0xbf803f80,0xbf803f80,0xbf803f80,0xbf7b3f80,0xbf553f6d,0x3e48248d,0x3f0ebec4
.long 0xbf6d3f80,0xbec43f35,0x3f6dbf80,0x3ec4bf35,0xbf553f80,0x3e483ec4,0xbf0ea554,0xbf7b3f6d
.long 0xbf353f80,0x3f35248d,0xbf353f80,0x3f35248d,0xbf0e3f80,0x3f7bbec4,0x3f55248d,0x3e48bf6d
.long 0xbec43f80,0x3f6dbf35,0x3ec4bf80,0xbf6d3f35,0xbe483f80,0x3f0ebf6d,0xbf7ba554,0x3f553ec4
.long 0xa5543f80,0x248dbf80,0xa5543f80,0x248dbf80,0x3e483f80,0xbf0ebf6d,0x3f7b248d,0xbf553ec4
.long 0x3ec43f80,0xbf6dbf35,0xbec4bf80,0x3f6d3f35,0x3f0e3f80,0xbf7bbec4,0xbf55a554,0xbe48bf6d
.long 0x3f353f80,0xbf35a554,0x3f353f80,0xbf35a554,0x3f553f80,0xbe483ec4,0x3f0e248d,0x3f7b3f6d
.long 0x3f6d3f80,0x3ec43f35,0xbf6dbf80,0xbec4bf35,0x3f7b3f80,0x3f553f6d,0xbe48a554,0xbf0ebec4
.long 0x3f803f80,0x3f803f80,0x3f803f80,0x3f803f80,0x3f0e3f35,0x3e483ec4,0xbf55bf35,0xbf7bbf6d
.long 0xbec4248d,0xbf6dbf35,0x3ec4a554,0x3f6d3f35,0xbf7bbf35,0xbf0ebf6d,0x3e483f35,0xbf55bec4
.long 0xbf35bf80,0x3f35a554,0xbf35bf80,0x3f35a554,0x3e48bf35,0x3f553f6d,0x3f7b3f35,0xbf0e3ec4
.long 0x3f6da554,0xbec43f35,0xbf6d248d,0x3ec4bf35,0x3f553f35,0xbf7bbec4,0x3f0ebf35,0xbe483f6d
.long 0x248d3f80,0xa554bf80,0x248d3f80,0xa554bf80,0xbf553f35,0x3f7bbec4,0xbf0ebf35,0x3e483f6d
.long 0xbf6d248d,0x3ec43f35,0x3f6da554,0xbec4bf35,0xbe48bf35,0xbf553f6d,0xbf7b3f35,0x3f0e3ec4
.long 0x3f35bf80,0xbf35248d,0x3f35bf80,0xbf35248d,0x3f7bbf35,0x3f0ebf6d,0xbe483f35,0x3f55bec4
.long 0x3ec4a554,0x3f6dbf35,0xbec4248d,0xbf6d3f35,0xbf0e3f35,0xbe483ec4,0x3f55bf35,0x3f7bbf6d
.long 0xbf803f80,0xbf803f80,0xbf803f80,0xbf803f80,0xbf0e3f35,0xbe483ec4,0x3f55bf35,0x3f7bbf6d
.long 0x3ec4248d,0x3f6dbf35,0xbec4a554,0xbf6d3f35,0x3f7bbf35,0x3f0ebf6d,0xbe483f35,0x3f55bec4
.long 0x3f35bf80,0xbf35a554,0x3f35bf80,0xbf35a554,0xbe48bf35,0xbf553f6d,0xbf7b3f35,0x3f0e3ec4
.long 0xbf6da554,0x3ec43f35,0x3f6d248d,0xbec4bf35,0xbf553f35,0x3f7bbec4,0xbf0ebf35,0x3e483f6d
.long 0xa5543f80,0x248dbf80,0xa5543f80,0x248dbf80,0x3f553f35,0xbf7bbec4,0x3f0ebf35,0xbe483f6d
.long 0x3f6d248d,0xbec43f35,0xbf6da554,0x3ec4bf35,0x3e48bf35,0x3f553f6d,0x3f7b3f35,0xbf0e3ec4
.long 0xbf35bf80,0x3f35248d,0xbf35bf80,0x3f35248d,0xbf7bbf35,0xbf0ebf6d,0x3e483f35,0xbf55bec4
.long 0xbec4a554,0xbf6dbf35,0x3ec4248d,0x3f6d3f35,0x3f0e3f35,0x3e483ec4,0xbf55bf35,0xbf7bbf6d
.long 0x3f803f80,0x3f803f80,0x3f803f80,0x3f803f80,0xbf7bbf80,0xbf55bf6d,0x3e48a554,0x3f0e3ec4
.long 0x3f6d3f80,0x3ec43f35,0xbf6dbf80,0xbec4bf35,0xbf55bf80,0x3e48bec4,0xbf0e248d,0xbf7bbf6d
.long 0x3f353f80,0xbf35248d,0x3f353f80,0xbf35248d,0xbf0ebf80,0x3f7b3ec4,0x3f55a554,0x3e483f6d
.long 0x3ec43f80,0xbf6dbf35,0xbec4bf80,0x3f6d3f35,0xbe48bf80,0x3f0e3f6d,0xbf7b248d,0x3f55bec4
.long 0x248d3f80,0xa554bf80,0x248d3f80,0xa554bf80,0x3e48bf80,0xbf0e3f6d,0x3f7ba554,0xbf55bec4
.long 0xbec43f80,0x3f6dbf35,0x3ec4bf80,0xbf6d3f35,0x3f0ebf80,0xbf7b3ec4,0xbf55248d,0xbe483f6d
.long 0xbf353f80,0x3f35a554,0xbf353f80,0x3f35a554,0x3f55bf80,0xbe48bec4,0x3f0ea554,0x3f7bbf6d
.long 0xbf6d3f80,0xbec43f35,0x3f6dbf80,0x3ec4bf35,0x3f7bbf80,0x3f55bf6d,0xbe48248d,0xbf0e3ec4
.long 0xbf803f80,0xbf803f80,0xbf803f80,0xbf803f80,0x3f7bbf80,0x3f55bf6d,0xbe48a554,0xbf0e3ec4
.long 0xbf6d3f80,0xbec43f35,0x3f6dbf80,0x3ec4bf35,0x3f55bf80,0xbe48bec4,0x3f0e248d,0x3f7bbf6d
.long 0xbf353f80,0x3f35248d,0xbf353f80,0x3f35248d,0x3f0ebf80,0xbf7b3ec4,0xbf55a554,0xbe483f6d
.long 0xbec43f80,0x3f6dbf35,0x3ec4bf80,0xbf6d3f35,0x3e48bf80,0xbf0e3f6d,0x3f7b248d,0xbf55bec4
.long 0xa5543f80,0x248dbf80,0xa5543f80,0x248dbf80,0xbe48bf80,0x3f0e3f6d,0xbf7ba554,0x3f55bec4
.long 0x3ec43f80,0xbf6dbf35,0xbec4bf80,0x3f6d3f35,0xbf0ebf80,0x3f7b3ec4,0x3f55248d,0x3e483f6d
.long 0x3f353f80,0xbf35a554,0x3f353f80,0xbf35a554,0xbf55bf80,0x3e48bec4,0xbf0ea554,0xbf7bbf6d
.long 0x3f6d3f80,0x3ec43f35,0xbf6dbf80,0xbec4bf35,0xbf7bbf80,0xbf55bf6d,0x3e48248d,0x3f0e3ec4
.long 0x3f803f80,0x3f803f80,0x3f803f80,0x3f803f80,0xbf0ebf35,0xbe48bec4,0x3f553f35,0x3f7b3f6d
.long 0xbec4248d,0xbf6dbf35,0x3ec4a554,0x3f6d3f35,0x3f7b3f35,0x3f0e3f6d,0xbe48bf35,0x3f553ec4
.long 0xbf35bf80,0x3f35a554,0xbf35bf80,0x3f35a554,0xbe483f35,0xbf55bf6d,0xbf7bbf35,0x3f0ebec4
.long 0x3f6da554,0xbec43f35,0xbf6d248d,0x3ec4bf35,0xbf55bf35,0x3f7b3ec4,0xbf0e3f35,0x3e48bf6d
.long 0x248d3f80,0xa554bf80,0x248d3f80,0xa554bf80,0x3f55bf35,0xbf7b3ec4,0x3f0e3f35,0xbe48bf6d
.long 0xbf6d248d,0x3ec43f35,0x3f6da554,0xbec4bf35,0x3e483f35,0x3f55bf6d,0x3f7bbf35,0xbf0ebec4
.long 0x3f35bf80,0xbf35248d,0x3f35bf80,0xbf35248d,0xbf7b3f35,0xbf0e3f6d,0x3e48bf35,0xbf553ec4
.long 0x3ec4a554,0x3f6dbf35,0xbec4248d,0xbf6d3f35,0x3f0ebf35,0x3e48bec4,0xbf553f35,0xbf7b3f6d
.long 0xbf803f80,0xbf803f80,0xbf803f80,0xbf803f80,0x3f0ebf35,0x3e48bec4,0xbf553f35,0xbf7b3f6d
.long 0x3ec4248d,0x3f6dbf35,0xbec4a554,0xbf6d3f35,0xbf7b3f35,0xbf0e3f6d,0x3e48bf35,0xbf553ec4
.long 0x3f35bf80,0xbf35a554,0x3f35bf80,0xbf35a554,0x3e483f35,0x3f55bf6d,0x3f7bbf35,0xbf0ebec4
.long 0xbf6da554,0x3ec43f35,0x3f6d248d,0xbec4bf35,0x3f55bf35,0xbf7b3ec4,0x3f0e3f35,0xbe48bf6d
.long 0xa5543f80,0x248dbf80,0xa5543f80,0x248dbf80,0xbf55bf35,0x3f7b3ec4,0xbf0e3f35,0x3e48bf6d
.long 0x3f6d248d,0xbec43f35,0xbf6da554,0x3ec4bf35,0xbe483f35,0xbf55bf6d,0xbf7bbf35,0x3f0ebec4
.long 0xbf35bf80,0x3f35248d,0xbf35bf80,0x3f35248d,0x3f7b3f35,0x3f0e3f6d,0xbe48bf35,0x3f553ec4
.long 0xbec4a554,0xbf6dbf35,0x3ec4248d,0x3f6d3f35,0xbf0ebf35,0xbe48bec4,0x3f553f35,0x3f7b3f6d
.long 0x0,0x0,0x0,0x0,0x3e480000,0x3f0e3ec4,0x3f7b3f80,0x3f553f6d
.long 0x3ec40000,0x3f6d3f35,0xbec4250d,0xbf6dbf35,0x3f0e0000,0x3f7b3f6d,0xbf55bf80,0x3e48bec4
.long 0x3f350000,0x3f353f80,0x3f350000,0x3f353f80,0x3f550000,0x3e483f6d,0x3f0e3f80,0xbf7bbec4
.long 0x3f6d0000,0xbec43f35,0xbf6d250d,0x3ec4bf35,0x3f7b0000,0xbf553ec4,0xbe48bf80,0x3f0e3f6d
.long 0x3f800000,0xbf80250d,0x3f800000,0xbf80250d,0x3f7b0000,0xbf55bec4,0xbe483f80,0x3f0ebf6d
.long 0x3f6d0000,0xbec4bf35,0xbf6d250d,0x3ec43f35,0x3f550000,0x3e48bf6d,0x3f0ebf80,0xbf7b3ec4
.long 0x3f350000,0x3f35bf80,0x3f350000,0x3f35bf80,0x3f0e0000,0x3f7bbf6d,0xbf553f80,0x3e483ec4
.long 0x3ec40000,0x3f6dbf35,0xbec4250d,0xbf6d3f35,0x3e480000,0x3f0ebec4,0x3f7bbf80,0x3f55bf6d
.long 0x250d0000,0x250d0000,0x250d0000,0x250d0000,0xbe480000,0xbf0e3ec4,0xbf7b3f80,0xbf553f6d
.long 0xbec40000,0xbf6d3f35,0x3ec4250d,0x3f6dbf35,0xbf0e0000,0xbf7b3f6d,0x3f55bf80,0xbe48bec4
.long 0xbf350000,0xbf353f80,0xbf350000,0xbf353f80,0xbf550000,0xbe483f6d,0xbf0e3f80,0x3f7bbec4
.long 0xbf6d0000,0x3ec43f35,0x3f6d250d,0xbec4bf35,0xbf7b0000,0x3f553ec4,0x3e48bf80,0xbf0e3f6d
.long 0xbf800000,0x3f80250d,0xbf800000,0x3f80250d,0xbf7b0000,0x3f55bec4,0x3e483f80,0xbf0ebf6d
.long 0xbf6d0000,0x3ec4bf35,0x3f6d250d,0xbec43f35,0xbf550000,0xbe48bf6d,0xbf0ebf80,0x3f7b3ec4
.long 0xbf350000,0xbf35bf80,0xbf350000,0xbf35bf80,0xbf0e0000,0xbf7bbf6d,0x3f553f80,0xbe483ec4
.long 0xbec40000,0xbf6dbf35,0x3ec4250d,0x3f6d3f35,0xbe480000,0xbf0ebec4,0xbf7bbf80,0xbf55bf6d
.long 0x0,0x0,0x0,0x0,0x3f553f35,0x3f7b3f6d,0x3f0e3f35,0x3e483ec4
.long 0x3f6d3f80,0x3ec43f35,0xbf6dbf80,0xbec4bf35,0x3e483f35,0xbf55bec4,0x3f7b3f35,0x3f0e3f6d
.long 0xbf35250d,0xbf35bf80,0xbf35250d,0xbf35bf80,0xbf7bbf35,0x3f0ebec4,0x3e48bf35,0x3f553f6d
.long 0xbec4bf80,0x3f6d3f35,0x3ec43f80,0xbf6dbf35,0x3f0ebf35,0xbe483f6d,0xbf55bf35,0x3f7b3ec4
.long 0x3f800000,0xbf80250d,0x3f800000,0xbf80250d,0x3f0e3f35,0xbe48bf6d,0xbf553f35,0x3f7bbec4
.long 0xbec43f80,0x3f6dbf35,0x3ec4bf80,0xbf6d3f35,0xbf7b3f35,0x3f0e3ec4,0x3e483f35,0x3f55bf6d
.long 0xbf35250d,0xbf353f80,0xbf35250d,0xbf353f80,0x3e48bf35,0xbf553ec4,0x3f7bbf35,0x3f0ebf6d
.long 0x3f6dbf80,0x3ec4bf35,0xbf6d3f80,0xbec43f35,0x3f55bf35,0x3f7bbf6d,0x3f0ebf35,0x3e48bec4
.long 0x250d0000,0x250d0000,0x250d0000,0x250d0000,0xbf553f35,0xbf7b3f6d,0xbf0e3f35,0xbe483ec4
.long 0xbf6d3f80,0xbec43f35,0x3f6dbf80,0x3ec4bf35,0xbe483f35,0x3f55bec4,0xbf7b3f35,0xbf0e3f6d
.long 0x3f35250d,0x3f35bf80,0x3f35250d,0x3f35bf80,0x3f7bbf35,0xbf0ebec4,0xbe48bf35,0xbf553f6d
.long 0x3ec4bf80,0xbf6d3f35,0xbec43f80,0x3f6dbf35,0xbf0ebf35,0x3e483f6d,0x3f55bf35,0xbf7b3ec4
.long 0xbf800000,0x3f80250d,0xbf800000,0x3f80250d,0xbf0e3f35,0x3e48bf6d,0x3f553f35,0xbf7bbec4
.long 0x3ec43f80,0xbf6dbf35,0xbec4bf80,0x3f6d3f35,0x3f7b3f35,0xbf0e3ec4,0xbe483f35,0xbf55bf6d
.long 0x3f35250d,0x3f353f80,0x3f35250d,0x3f353f80,0xbe48bf35,0x3f553ec4,0xbf7bbf35,0xbf0ebf6d
.long 0xbf6dbf80,0xbec4bf35,0x3f6d3f80,0x3ec43f35,0xbf55bf35,0xbf7bbf6d,0xbf0ebf35,0xbe48bec4
.long 0x0,0x0,0x0,0x0,0xbe48250d,0xbf0ebec4,0xbf7bbf80,0xbf55bf6d
.long 0x3ec40000,0x3f6d3f35,0xbec4250d,0xbf6dbf35,0xbf0e250d,0xbf7bbf6d,0x3f553f80,0xbe483ec4
.long 0x3f350000,0x3f353f80,0x3f350000,0x3f353f80,0xbf55250d,0xbe48bf6d,0xbf0ebf80,0x3f7b3ec4
.long 0x3f6d0000,0xbec43f35,0xbf6d250d,0x3ec4bf35,0xbf7b250d,0x3f55bec4,0x3e483f80,0xbf0ebf6d
.long 0x3f800000,0xbf80250d,0x3f800000,0xbf80250d,0xbf7b250d,0x3f553ec4,0x3e48bf80,0xbf0e3f6d
.long 0x3f6d0000,0xbec4bf35,0xbf6d250d,0x3ec43f35,0xbf55250d,0xbe483f6d,0xbf0e3f80,0x3f7bbec4
.long 0x3f350000,0x3f35bf80,0x3f350000,0x3f35bf80,0xbf0e250d,0xbf7b3f6d,0x3f55bf80,0xbe48bec4
.long 0x3ec40000,0x3f6dbf35,0xbec4250d,0xbf6d3f35,0xbe48250d,0xbf0e3ec4,0xbf7b3f80,0xbf553f6d
.long 0x250d0000,0x250d0000,0x250d0000,0x250d0000,0x3e48250d,0x3f0ebec4,0x3f7bbf80,0x3f55bf6d
.long 0xbec40000,0xbf6d3f35,0x3ec4250d,0x3f6dbf35,0x3f0e250d,0x3f7bbf6d,0xbf553f80,0x3e483ec4
.long 0xbf350000,0xbf353f80,0xbf350000,0xbf353f80,0x3f55250d,0x3e48bf6d,0x3f0ebf80,0xbf7b3ec4
.long 0xbf6d0000,0x3ec43f35,0x3f6d250d,0xbec4bf35,0x3f7b250d,0xbf55bec4,0xbe483f80,0x3f0ebf6d
.long 0xbf800000,0x3f80250d,0xbf800000,0x3f80250d,0x3f7b250d,0xbf553ec4,0xbe48bf80,0x3f0e3f6d
.long 0xbf6d0000,0x3ec4bf35,0x3f6d250d,0xbec43f35,0x3f55250d,0x3e483f6d,0x3f0e3f80,0xbf7bbec4
.long 0xbf350000,0xbf35bf80,0xbf350000,0xbf35bf80,0x3f0e250d,0x3f7b3f6d,0xbf55bf80,0x3e48bec4
.long 0xbec40000,0xbf6dbf35,0x3ec4250d,0x3f6d3f35,0x3e48250d,0x3f0e3ec4,0x3f7b3f80,0x3f553f6d
.long 0x0,0x0,0x0,0x0,0xbf55bf35,0xbf7bbf6d,0xbf0ebf35,0xbe48bec4
.long 0x3f6d3f80,0x3ec43f35,0xbf6dbf80,0xbec4bf35,0xbe48bf35,0x3f553ec4,0xbf7bbf35,0xbf0ebf6d
.long 0xbf35250d,0xbf35bf80,0xbf35250d,0xbf35bf80,0x3f7b3f35,0xbf0e3ec4,0xbe483f35,0xbf55bf6d
.long 0xbec4bf80,0x3f6d3f35,0x3ec43f80,0xbf6dbf35,0xbf0e3f35,0x3e48bf6d,0x3f553f35,0xbf7bbec4
.long 0x3f800000,0xbf80250d,0x3f800000,0xbf80250d,0xbf0ebf35,0x3e483f6d,0x3f55bf35,0xbf7b3ec4
.long 0xbec43f80,0x3f6dbf35,0x3ec4bf80,0xbf6d3f35,0x3f7bbf35,0xbf0ebec4,0xbe48bf35,0xbf553f6d
.long 0xbf35250d,0xbf353f80,0xbf35250d,0xbf353f80,0xbe483f35,0x3f55bec4,0xbf7b3f35,0xbf0e3f6d
.long 0x3f6dbf80,0x3ec4bf35,0xbf6d3f80,0xbec43f35,0xbf553f35,0xbf7b3f6d,0xbf0e3f35,0xbe483ec4
.long 0x250d0000,0x250d0000,0x250d0000,0x250d0000,0x3f55bf35,0x3f7bbf6d,0x3f0ebf35,0x3e48bec4
.long 0xbf6d3f80,0xbec43f35,0x3f6dbf80,0x3ec4bf35,0x3e48bf35,0xbf553ec4,0x3f7bbf35,0x3f0ebf6d
.long 0x3f35250d,0x3f35bf80,0x3f35250d,0x3f35bf80,0xbf7b3f35,0x3f0e3ec4,0x3e483f35,0x3f55bf6d
.long 0x3ec4bf80,0xbf6d3f35,0xbec43f80,0x3f6dbf35,0x3f0e3f35,0xbe48bf6d,0xbf553f35,0x3f7bbec4
.long 0xbf800000,0x3f80250d,0xbf800000,0x3f80250d,0x3f0ebf35,0xbe483f6d,0xbf55bf35,0x3f7b3ec4
.long 0x3ec43f80,0xbf6dbf35,0xbec4bf80,0x3f6d3f35,0xbf7bbf35,0x3f0ebec4,0x3e48bf35,0x3f553f6d
.long 0x3f35250d,0x3f353f80,0x3f35250d,0x3f353f80,0x3e483f35,0xbf55bec4,0x3f7b3f35,0x3f0e3f6d
.long 0xbf6dbf80,0xbec4bf35,0x3f6d3f80,0x3ec43f35,0x3f553f35,0x3f7b3f6d,0x3f0e3f35,0x3e483ec4
.long 0x80008000,0x80008000,0x80008000,0x80008000,0xbe488000,0xbf0ebec4,0xbf7bbf80,0xbf55bf6d
.long 0xbec48000,0xbf6dbf35,0x3ec4a50d,0x3f6d3f35,0xbf0e8000,0xbf7bbf6d,0x3f553f80,0xbe483ec4
.long 0xbf358000,0xbf35bf80,0xbf358000,0xbf35bf80,0xbf558000,0xbe48bf6d,0xbf0ebf80,0x3f7b3ec4
.long 0xbf6d8000,0x3ec4bf35,0x3f6da50d,0xbec43f35,0xbf7b8000,0x3f55bec4,0x3e483f80,0xbf0ebf6d
.long 0xbf808000,0x3f80a50d,0xbf808000,0x3f80a50d,0xbf7b8000,0x3f553ec4,0x3e48bf80,0xbf0e3f6d
.long 0xbf6d8000,0x3ec43f35,0x3f6da50d,0xbec4bf35,0xbf558000,0xbe483f6d,0xbf0e3f80,0x3f7bbec4
.long 0xbf358000,0xbf353f80,0xbf358000,0xbf353f80,0xbf0e8000,0xbf7b3f6d,0x3f55bf80,0xbe48bec4
.long 0xbec48000,0xbf6d3f35,0x3ec4a50d,0x3f6dbf35,0xbe488000,0xbf0e3ec4,0xbf7b3f80,0xbf553f6d
.long 0xa50d8000,0xa50d8000,0xa50d8000,0xa50d8000,0x3e488000,0x3f0ebec4,0x3f7bbf80,0x3f55bf6d
.long 0x3ec48000,0x3f6dbf35,0xbec4a50d,0xbf6d3f35,0x3f0e8000,0x3f7bbf6d,0xbf553f80,0x3e483ec4
.long 0x3f358000,0x3f35bf80,0x3f358000,0x3f35bf80,0x3f558000,0x3e48bf6d,0x3f0ebf80,0xbf7b3ec4
.long 0x3f6d8000,0xbec4bf35,0xbf6da50d,0x3ec43f35,0x3f7b8000,0xbf55bec4,0xbe483f80,0x3f0ebf6d
.long 0x3f808000,0xbf80a50d,0x3f808000,0xbf80a50d,0x3f7b8000,0xbf553ec4,0xbe48bf80,0x3f0e3f6d
.long 0x3f6d8000,0xbec43f35,0xbf6da50d,0x3ec4bf35,0x3f558000,0x3e483f6d,0x3f0e3f80,0xbf7bbec4
.long 0x3f358000,0x3f353f80,0x3f358000,0x3f353f80,0x3f0e8000,0x3f7b3f6d,0xbf55bf80,0x3e48bec4
.long 0x3ec48000,0x3f6d3f35,0xbec4a50d,0xbf6dbf35,0x3e488000,0x3f0e3ec4,0x3f7b3f80,0x3f553f6d
.long 0x80008000,0x80008000,0x80008000,0x80008000,0xbf55bf35,0xbf7bbf6d,0xbf0ebf35,0xbe48bec4
.long 0xbf6dbf80,0xbec4bf35,0x3f6d3f80,0x3ec43f35,0xbe48bf35,0x3f553ec4,0xbf7bbf35,0xbf0ebf6d
.long 0x3f35a50d,0x3f353f80,0x3f35a50d,0x3f353f80,0x3f7b3f35,0xbf0e3ec4,0xbe483f35,0xbf55bf6d
.long 0x3ec43f80,0xbf6dbf35,0xbec4bf80,0x3f6d3f35,0xbf0e3f35,0x3e48bf6d,0x3f553f35,0xbf7bbec4
.long 0xbf808000,0x3f80a50d,0xbf808000,0x3f80a50d,0xbf0ebf35,0x3e483f6d,0x3f55bf35,0xbf7b3ec4
.long 0x3ec4bf80,0xbf6d3f35,0xbec43f80,0x3f6dbf35,0x3f7bbf35,0xbf0ebec4,0xbe48bf35,0xbf553f6d
.long 0x3f35a50d,0x3f35bf80,0x3f35a50d,0x3f35bf80,0xbe483f35,0x3f55bec4,0xbf7b3f35,0xbf0e3f6d
.long 0xbf6d3f80,0xbec43f35,0x3f6dbf80,0x3ec4bf35,0xbf553f35,0xbf7b3f6d,0xbf0e3f35,0xbe483ec4
.long 0xa50d8000,0xa50d8000,0xa50d8000,0xa50d8000,0x3f55bf35,0x3f7bbf6d,0x3f0ebf35,0x3e48bec4
.long 0x3f6dbf80,0x3ec4bf35,0xbf6d3f80,0xbec43f35,0x3e48bf35,0xbf553ec4,0x3f7bbf35,0x3f0ebf6d
.long 0xbf35a50d,0xbf353f80,0xbf35a50d,0xbf353f80,0xbf7b3f35,0x3f0e3ec4,0x3e483f35,0x3f55bf6d
.long 0xbec43f80,0x3f6dbf35,0x3ec4bf80,0xbf6d3f35,0x3f0e3f35,0xbe48bf6d,0xbf553f35,0x3f7bbec4
.long 0x3f808000,0xbf80a50d,0x3f808000,0xbf80a50d,0x3f0ebf35,0xbe483f6d,0xbf55bf35,0x3f7b3ec4
.long 0xbec4bf80,0x3f6d3f35,0x3ec43f80,0xbf6dbf35,0xbf7bbf35,0x3f0ebec4,0x3e48bf35,0x3f553f6d
.long 0xbf35a50d,0xbf35bf80,0xbf35a50d,0xbf35bf80,0x3e483f35,0xbf55bec4,0x3f7b3f35,0x3f0e3f6d
.long 0x3f6d3f80,0x3ec43f35,0xbf6dbf80,0xbec4bf35,0x3f553f35,0x3f7b3f6d,0x3f0e3f35,0x3e483ec4
.long 0x80008000,0x80008000,0x80008000,0x80008000,0x3e48a50d,0x3f0e3ec4,0x3f7b3f80,0x3f553f6d
.long 0xbec48000,0xbf6dbf35,0x3ec4a50d,0x3f6d3f35,0x3f0ea50d,0x3f7b3f6d,0xbf55bf80,0x3e48bec4
.long 0xbf358000,0xbf35bf80,0xbf358000,0xbf35bf80,0x3f55a50d,0x3e483f6d,0x3f0e3f80,0xbf7bbec4
.long 0xbf6d8000,0x3ec4bf35,0x3f6da50d,0xbec43f35,0x3f7ba50d,0xbf553ec4,0xbe48bf80,0x3f0e3f6d
.long 0xbf808000,0x3f80a50d,0xbf808000,0x3f80a50d,0x3f7ba50d,0xbf55bec4,0xbe483f80,0x3f0ebf6d
.long 0xbf6d8000,0x3ec43f35,0x3f6da50d,0xbec4bf35,0x3f55a50d,0x3e48bf6d,0x3f0ebf80,0xbf7b3ec4
.long 0xbf358000,0xbf353f80,0xbf358000,0xbf353f80,0x3f0ea50d,0x3f7bbf6d,0xbf553f80,0x3e483ec4
.long 0xbec48000,0xbf6d3f35,0x3ec4a50d,0x3f6dbf35,0x3e48a50d,0x3f0ebec4,0x3f7bbf80,0x3f55bf6d
.long 0xa50d8000,0xa50d8000,0xa50d8000,0xa50d8000,0xbe48a50d,0xbf0e3ec4,0xbf7b3f80,0xbf553f6d
.long 0x3ec48000,0x3f6dbf35,0xbec4a50d,0xbf6d3f35,0xbf0ea50d,0xbf7b3f6d,0x3f55bf80,0xbe48bec4
.long 0x3f358000,0x3f35bf80,0x3f358000,0x3f35bf80,0xbf55a50d,0xbe483f6d,0xbf0e3f80,0x3f7bbec4
.long 0x3f6d8000,0xbec4bf35,0xbf6da50d,0x3ec43f35,0xbf7ba50d,0x3f553ec4,0x3e48bf80,0xbf0e3f6d
.long 0x3f808000,0xbf80a50d,0x3f808000,0xbf80a50d,0xbf7ba50d,0x3f55bec4,0x3e483f80,0xbf0ebf6d
.long 0x3f6d8000,0xbec43f35,0xbf6da50d,0x3ec4bf35,0xbf55a50d,0xbe48bf6d,0xbf0ebf80,0x3f7b3ec4
.long 0x3f358000,0x3f353f80,0x3f358000,0x3f353f80,0xbf0ea50d,0xbf7bbf6d,0x3f553f80,0xbe483ec4
.long 0x3ec48000,0x3f6d3f35,0xbec4a50d,0xbf6dbf35,0xbe48a50d,0xbf0ebec4,0xbf7bbf80,0xbf55bf6d
.long 0x80008000,0x80008000,0x80008000,0x80008000,0x3f553f35,0x3f7b3f6d,0x3f0e3f35,0x3e483ec4
.long 0xbf6dbf80,0xbec4bf35,0x3f6d3f80,0x3ec43f35,0x3e483f35,0xbf55bec4,0x3f7b3f35,0x3f0e3f6d
.long 0x3f35a50d,0x3f353f80,0x3f35a50d,0x3f353f80,0xbf7bbf35,0x3f0ebec4,0x3e48bf35,0x3f553f6d
.long 0x3ec43f80,0xbf6dbf35,0xbec4bf80,0x3f6d3f35,0x3f0ebf35,0xbe483f6d,0xbf55bf35,0x3f7b3ec4
.long 0xbf808000,0x3f80a50d,0xbf808000,0x3f80a50d,0x3f0e3f35,0xbe48bf6d,0xbf553f35,0x3f7bbec4
.long 0x3ec4bf80,0xbf6d3f35,0xbec43f80,0x3f6dbf35,0xbf7b3f35,0x3f0e3ec4,0x3e483f35,0x3f55bf6d
.long 0x3f35a50d,0x3f35bf80,0x3f35a50d,0x3f35bf80,0x3e48bf35,0xbf553ec4,0x3f7bbf35,0x3f0ebf6d
.long 0xbf6d3f80,0xbec43f35,0x3f6dbf80,0x3ec4bf35,0x3f55bf35,0x3f7bbf6d,0x3f0ebf35,0x3e48bec4
.long 0xa50d8000,0xa50d8000,0xa50d8000,0xa50d8000,0xbf553f35,0xbf7b3f6d,0xbf0e3f35,0xbe483ec4
.long 0x3f6dbf80,0x3ec4bf35,0xbf6d3f80,0xbec43f35,0xbe483f35,0x3f55bec4,0xbf7b3f35,0xbf0e3f6d
.long 0xbf35a50d,0xbf353f80,0xbf35a50d,0xbf353f80,0x3f7bbf35,0xbf0ebec4,0xbe48bf35,0xbf553f6d
.long 0xbec43f80,0x3f6dbf35,0x3ec4bf80,0xbf6d3f35,0xbf0ebf35,0x3e483f6d,0x3f55bf35,0xbf7b3ec4
.long 0x3f808000,0xbf80a50d,0x3f808000,0xbf80a50d,0xbf0e3f35,0x3e48bf6d,0x3f553f35,0xbf7bbec4
.long 0xbec4bf80,0x3f6d3f35,0x3ec43f80,0xbf6dbf35,0x3f7b3f35,0xbf0e3ec4,0xbe483f35,0xbf55bf6d
.long 0xbf35a50d,0xbf35bf80,0xbf35a50d,0xbf35bf80,0xbe48bf35,0x3f553ec4,0xbf7bbf35,0xbf0ebf6d
.long 0x3f6d3f80,0x3ec43f35,0xbf6dbf80,0xbec4bf35,0xbf55bf35,0xbf7bbf6d,0xbf0ebf35,0xbe48bec4
.long 0x3f800000,0x3f800000,0x3f800000,0x3f800000,0x3f800000,0x3f7ffcd7,0x3f7ff35e,0x3f7fe394
.long 0x3f800000,0x3f7ff35e,0x3f7fcd79,0x3f7f8e56,0x3f800000,0x3f7fe394,0x3f7f8e56,0x3f7f0059
.long 0x3f800000,0x3f7fcd79,0x3f7f35f9,0x3f7e39bc,0x3f800000,0x3f7fb10f,0x3f7ec46d,0x3f7d3aac
.long 0x3f800000,0x3f7f8e56,0x3f7e39bc,0x3f7c0361,0x3f800000,0x3f7f654e,0x3f7d95f4,0x3f7a9421
.long 0x3f800000,0x3f7f35f9,0x3f7cd925,0x3f78ed3c,0x3f800000,0x3f7f0059,0x3f7c0361,0x3f770f11
.long 0x3f800000,0x3f7ec46d,0x3f7b14be,0x3f74fa0b,0x3f800000,0x3f7e8238,0x3f7a0d54,0x3f72ae9e
.long 0x3f800000,0x3f7e39bc,0x3f78ed3c,0x3f702d4f,0x3f800000,0x3f7deafa,0x3f77b493,0x3f6d76aa
.long 0x3f800000,0x3f7d95f4,0x3f766377,0x3f6a8b4b,0x3f800000,0x3f7d3aac,0x3f74fa0b,0x3f676bd8
.long 0x3f800000,0x3f7cd925,0x3f737871,0x3f641901,0x3f800000,0x3f7c7160,0x3f71decf,0x3f609384
.long 0x3f800000,0x3f7c0361,0x3f702d4f,0x3f5cdc29,0x3f800000,0x3f7b8f2a,0x3f6e641a,0x3f58f3c4
.long 0x3f800000,0x3f7b14be,0x3f6c835e,0x3f54db31,0x3f800000,0x3f7a9421,0x3f6a8b4b,0x3f50935b
.long 0x3f800000,0x3f7a0d54,0x3f687c12,0x3f4c1d35,0x3f800000,0x3f79805c,0x3f6655e7,0x3f4779bc
.long 0x3f800000,0x3f78ed3c,0x3f641901,0x3f42a9f7,0x3f800000,0x3f7853f8,0x3f61c598,0x3f3daef9
.long 0x3f800000,0x3f77b493,0x3f5f5be6,0x3f3889dc,0x3f800000,0x3f770f11,0x3f5cdc29,0x3f333bc6
.long 0x3f800000,0x3f766377,0x3f5a46a0,0x3f2dc5e3,0x3f800000,0x3f75b1c9,0x3f579b8c,0x3f28296a
.long 0x3f800000,0x3f74fa0b,0x3f54db31,0x3f226799,0x3f800000,0x3f743c41,0x3f5205d4,0x3f1c81b9
.long 0x3f800000,0x3f800000,0x3f800000,0x3f800000,0x3f7fcd79,0x3f7fb10f,0x3f7f8e56,0x3f7f654e
.long 0x3f7f35f9,0x3f7ec46d,0x3f7e39bc,0x3f7d95f4,0x3f7e39bc,0x3f7d3aac,0x3f7c0361,0x3f7a9421
.long 0x3f7cd925,0x3f7b14be,0x3f78ed3c,0x3f766377,0x3f7b14be,0x3f7853f8,0x3f74fa0b,0x3f710908
.long 0x3f78ed3c,0x3f74fa0b,0x3f702d4f,0x3f6a8b4b,0x3f766377,0x3f710908,0x3f6a8b4b,0x3f62f219
.long 0x3f737871,0x3f6c835e,0x3f641901,0x3f5a46a0,0x3f702d4f,0x3f676bd8,0x3f5cdc29,0x3f50935b
.long 0x3f6c835e,0x3f61c598,0x3f54db31,0x3f45e403,0x3f687c12,0x3f5b941a,0x3f4c1d35,0x3f3a4582
.long 0x3f641901,0x3f54db31,0x3f42a9f7,0x3f2dc5e3,0x3f5f5be6,0x3f4d9f02,0x3f3889dc,0x3f207440
.long 0x3f5a46a0,0x3f45e403,0x3f2dc5e3,0x3f1260b2,0x3f54db31,0x3f3daef9,0x3f226799,0x3f039c3d
.long 0x3f4f1bbd,0x3f3504f3,0x3f167918,0x3ee87171,0x3f490a88,0x3f2beb4a,0x3f0a04f8,0x3ec8917e
.long 0x3f42a9f7,0x3f226799,0x3efa2c90,0x3ea7bf25,0x3f3bfc8f,0x3f187fc0,0x3edf7108,0x3e862210
.long 0x3f3504f3,0x3f0e39da,0x3ec3ef15,0x3e47c5c2,0x3f2dc5e3,0x3f039c3d,0x3ea7bf25,0x3e0255f4
.long 0x3f26423a,0x3ef15aea,0x3e8afa3e,0x3d712283,0x3f1e7cf1,0x3edae880,0x3e5b73dc,0xbc20d8d2
.long 0x3f167918,0x3ec3ef15,0x3e20305b,0xbda0af2a,0x3f0e39da,0x3eac7cd4,0x3dc8bd36,0xbe164083
.long 0x3f05c277,0x3e94a031,0x3d20cee7,0xbe5b73dc,0x3efa2c90,0x3e78cfcc,0xbca0d6d6,0xbe8fcefe
.long 0x3ee87171,0x3e47c5c2,0xbda0af2a,0xbeb13641,0x3ed65a92,0x3e164083,0xbe0c4cf7,0xbed1c759
.long 0x3ec3ef15,0x3dc8bd36,0xbe47c5c2,0xbef15aea,0x3eb13641,0x3d48fb30,0xbe814693,0xbf07e565
.long 0x3f800000,0x3f800000,0x3f800000,0x3f800000,0x3f7f35f9,0x3f7f0059,0x3f7ec46d,0x3f7e8238
.long 0x3f7cd925,0x3f7c0361,0x3f7b14be,0x3f7a0d54,0x3f78ed3c,0x3f770f11,0x3f74fa0b,0x3f72ae9e
.long 0x3f737871,0x3f702d4f,0x3f6c835e,0x3f687c12,0x3f6c835e,0x3f676bd8,0x3f61c598,0x3f5b941a
.long 0x3f641901,0x3f5cdc29,0x3f54db31,0x3f4c1d35,0x3f5a46a0,0x3f50935b,0x3f45e403,0x3f3a4582
.long 0x3f4f1bbd,0x3f42a9f7,0x3f3504f3,0x3f26423a,0x3f42a9f7,0x3f333bc6,0x3f226799,0x3f104f0e
.long 0x3f3504f3,0x3f226799,0x3f0e39da,0x3ef15aea,0x3f26423a,0x3f104f0e,0x3ef15aea,0x3ebf47d7
.long 0x3f167918,0x3efa2c90,0x3ec3ef15,0x3e8afa3e,0x3f05c277,0x3ed1c759,0x3e94a031,0x3e2a1c3f
.long 0x3ee87171,0x3ea7bf25,0x3e47c5c2,0x3d712283,0x3ec3ef15,0x3e78cfcc,0x3dc8bd36,0xbd48fb30
.long 0x3e9e377a,0x3e20305b,0x248d3132,0xbe20305b,0x3e6f0c4d,0x3d8ca1f2,0xbdc8bd36,0xbe862210
.long 0x3e20305b,0xbca0d6d6,0xbe47c5c2,0xbeba9be1,0x3da0af2a,0xbddcbd0d,0xbe94a031,0xbeece91a
.long 0x248d3132,0xbe47c5c2,0xbec3ef15,0xbf0e39da,0xbda0af2a,0xbe8fcefe,0xbef15aea,0xbf2456f1
.long 0xbe20305b,0xbeba9be1,0xbf0e39da,0xbf3889dc,0xbe6f0c4d,0xbee3f40d,0xbf226799,0xbf4a965e
.long 0xbe9e377a,0xbf05c277,0xbf3504f3,0xbf5a46a0,0xbec3ef15,0xbf187fc0,0xbf45e403,0xbf676bd8
.long 0xbee87171,0xbf2a0c73,0xbf54db31,0xbf71decf,0xbf05c277,0xbf3a4582,0xbf61c598,0xbf79805c
.long 0xbf167918,0xbf490a88,0xbf6c835e,0xbf7e39bc,0xbf26423a,0xbf563e03,0xbf74fa0b,0xbf7ffcd7
.long 0xbf3504f3,0xbf61c598,0xbf7b14be,0xbf7ec46d,0xbf42a9f7,0xbf6b8a3d,0xbf7ec46d,0xbf7a9421
.long 0x3f800000,0x3f800000,0x3f800000,0x3f800000,0x3f7e39bc,0x3f7deafa,0x3f7d95f4,0x3f7d3aac
.long 0x3f78ed3c,0x3f77b493,0x3f766377,0x3f74fa0b,0x3f702d4f,0x3f6d76aa,0x3f6a8b4b,0x3f676bd8
.long 0x3f641901,0x3f5f5be6,0x3f5a46a0,0x3f54db31,0x3f54db31,0x3f4d9f02,0x3f45e403,0x3f3daef9
.long 0x3f42a9f7,0x3f3889dc,0x3f2dc5e3,0x3f226799,0x3f2dc5e3,0x3f207440,0x3f1260b2,0x3f039c3d
.long 0x3f167918,0x3f05c277,0x3ee87171,0x3ec3ef15,0x3efa2c90,0x3ed1c759,0x3ea7bf25,0x3e78cfcc
.long 0x3ec3ef15,0x3e94a031,0x3e47c5c2,0x3dc8bd36,0x3e8afa3e,0x3e2a1c3f,0x3d712283,0xbd48fb30
.long 0x3e20305b,0x3d20cee7,0xbda0af2a,0xbe47c5c2,0x3d20cee7,0xbdb4b86a,0xbe5b73dc,0xbeac7cd4
.long 0xbda0af2a,0xbe5b73dc,0xbeb13641,0xbef15aea,0xbe47c5c2,0xbeac7cd4,0xbef15aea,0xbf187fc0
.long 0xbe9e377a,0xbee87171,0xbf167918,0xbf3504f3,0xbed65a92,0xbf104f0e,0xbf316e2c,0xbf4d9f02
.long 0xbf05c277,0xbf2a0c73,0xbf490a88,0xbf61c598,0xbf1e7cf1,0xbf4105b8,0xbf5cdc29,0xbf710908
.long 0xbf3504f3,0xbf54db31,0xbf6c835e,0xbf7b14be,0xbf490a88,0xbf653a48,0xbf77b493,0xbf7fb10f
.long 0xbf5a46a0,0xbf71decf,0xbf7e39bc,0xbf7ec46d,0xbf687c12,0xbf7a9421,0xbf7ff35e,0xbf7853f8
.long 0xbf737871,0xbf7f35f9,0xbf7cd925,0xbf6c835e,0xbf7b14be,0xbf7fb10f,0xbf74fa0b,0xbf5b941a
.long 0xbf7f35f9,0xbf7c0361,0xbf687c12,0xbf45e403,0xbf7fcd79,0xbf743c41,0xbf579b8c,0xbf2beb4a
.long 0xbf7cd925,0xbf687c12,0xbf42a9f7,0xbf0e39da,0xbf766377,0xbf58f3c4,0xbf2a0c73,0xbedae880
.long 0xbf6c835e,0xbf45e403,0xbf0e39da,0xbe94a031,0xbf5f5be6,0xbf2f9c32,0xbedf7108,0xbe164083
.long 0x3f800000,0x3f800000,0x3f800000,0x3f800000,0x3f7cd925,0x3f7c7160,0x3f7c0361,0x3f7b8f2a
.long 0x3f737871,0x3f71decf,0x3f702d4f,0x3f6e641a,0x3f641901,0x3f609384,0x3f5cdc29,0x3f58f3c4
.long 0x3f4f1bbd,0x3f490a88,0x3f42a9f7,0x3f3bfc8f,0x3f3504f3,0x3f2beb4a,0x3f226799,0x3f187fc0
.long 0x3f167918,0x3f0a04f8,0x3efa2c90,0x3edf7108,0x3ee87171,0x3ec8917e,0x3ea7bf25,0x3e862210
.long 0x3e9e377a,0x3e6f0c4d,0x3e20305b,0x3da0af2a,0x3e20305b,0x3d8ca1f2,0xbca0d6d6,0xbddcbd0d
.long 0x248d3132,0xbdc8bd36,0xbe47c5c2,0xbe94a031,0xbe20305b,0xbe862210,0xbeba9be1,0xbeece91a
.long 0xbe9e377a,0xbed65a92,0xbf05c277,0xbf1e7cf1,0xbee87171,0xbf104f0e,0xbf2a0c73,0xbf4105b8
.long 0xbf167918,0xbf316e2c,0xbf490a88,0xbf5cdc29,0xbf3504f3,0xbf4d9f02,0xbf61c598,0xbf710908
.long 0xbf4f1bbd,0xbf641901,0xbf737871,0xbf7cd925,0xbf641901,0xbf743c41,0xbf7d95f4,0xbf7fe394
.long 0xbf737871,0xbf7d95f4,0xbf7fcd79,0xbf7a0d54,0xbf7cd925,0xbf7fe394,0xbf7a0d54,0xbf6b8a3d
.long 0xbf800000,0xbf7b14be,0xbf6c835e,0xbf54db31,0xbf7cd925,0xbf6f4ba8,0xbf579b8c,0xbf36c9a9
.long 0xbf737871,0xbf5cdc29,0xbf3bfc8f,0xbf1260b2,0xbf641901,0xbf444969,0xbf1a82a4,0xbed1c759
.long 0xbf4f1bbd,0xbf26423a,0xbee87171,0xbe6f0c4d,0xbf3504f3,0xbf039c3d,0xbe94a031,0xbd48fb30
.long 0xbf167918,0xbeba9be1,0xbdf0b772,0x3e0c4cf7,0xbee87171,0xbe519f65,0x3d712283,0x3ea2fd52
.long 0xbe9e377a,0xbd20cee7,0x3e6f0c4d,0x3efa2c90,0xbe20305b,0x3e0255f4,0x3ecd2ef3,0x3f2456f1
.long 0xa553c9ca,0x3e94a031,0x3f0e39da,0x3f45e403,0x3e20305b,0x3ee3f40d,0x3f316e2c,0x3f609384
.long 0x0,0x0,0x0,0x0,0x0,0x0,0x0,0x0
.long 0x0,0x0,0x0,0x0,0x0,0x0,0x0,0x0
.long 0x0,0x0,0x0,0x0,0x0,0x0,0x0,0x0
.long 0x0,0x0,0x0,0x0,0x0,0x0,0x0,0x80000000
.long 0x0,0x80000000,0x80000000,0x80000000,0x80000000,0x80000000,0x80000000,0x80000000
.long 0x80000000,0x80000000,0x80000000,0x80000000,0x80000000,0x80000000,0x80000000,0x80000000
.long 0x80000000,0x80000000,0x80000000,0x80000000,0x80000000,0x80000000,0x80000000,0x80000000
.long 0x80000000,0x80000000,0x80000000,0x80000000,0x80000000,0x80000000,0x80000000,0x80000000
.long 0x80000000,0x80000000,0x80000000,0x80000000,0x80000000,0x80000000,0x80000000,0x80000000
.long 0x80000000,0x80000000,0x80000000,0x80000000,0x80000000,0x80000000,0x80000000,0x80000000
.long 0x80000000,0x80000000,0x80000000,0x80000000,0x80000000,0x80000000,0x80000000,0x0
.long 0x80000000,0x80000000,0x0,0x0,0x80000000,0x0,0x0,0x0
.long 0x80000000,0x0,0x0,0x0,0x0,0x0,0x0,0x0
.long 0x0,0x0,0x0,0x0,0x0,0x0,0x0,0x0
.long 0x0,0x0,0x0,0x0,0x0,0x0,0x0,0x0
.long 0x0,0x0,0x0,0x0,0x0,0x0,0x0,0x0
.long 0x0,0x0,0x0,0x0,0x0,0x3c20d8d2,0x3ca0d6d6,0x3cf13d4c
.long 0x0,0x3ca0d6d6,0x3d20cee7,0x3d712283,0x0,0x3cf13d4c,0x3d712283,0x3db4b86a
.long 0x0,0x3d20cee7,0x3da0af2a,0x3df0b772,0x0,0x3d48fb30,0x3dc8bd36,0x3e164083
.long 0x0,0x3d712283,0x3df0b772,0x3e3403f1,0x0,0x3d8ca1f2,0x3e0c4cf7,0x3e519f65
.long 0x0,0x3da0af2a,0x3e20305b,0x3e6f0c4d,0x0,0x3db4b86a,0x3e3403f1,0x3e862210
.long 0x0,0x3dc8bd36,0x3e47c5c2,0x3e94a031,0x0,0x3ddcbd0d,0x3e5b73dc,0x3ea2fd52
.long 0x0,0x3df0b772,0x3e6f0c4d,0x3eb13641,0x0,0x3e0255f4,0x3e814693,0x3ebf47d7
.long 0x0,0x3e0c4cf7,0x3e8afa3e,0x3ecd2ef3,0x0,0x3e164083,0x3e94a031,0x3edae880
.long 0x0,0x3e20305b,0x3e9e377a,0x3ee87171,0x0,0x3e2a1c3f,0x3ea7bf25,0x3ef5c6c5
.long 0x0,0x3e3403f1,0x3eb13641,0x3f0172c3,0x0,0x3e3de731,0x3eba9be1,0x3f07e565
.long 0x0,0x3e47c5c2,0x3ec3ef15,0x3f0e39da,0x0,0x3e519f65,0x3ecd2ef3,0x3f146eba
.long 0x0,0x3e5b73dc,0x3ed65a92,0x3f1a82a4,0x0,0x3e6542e9,0x3edf7108,0x3f207440
.long 0x0,0x3e6f0c4d,0x3ee87171,0x3f26423a,0x0,0x3e78cfcc,0x3ef15aea,0x3f2beb4a
.long 0x0,0x3e814693,0x3efa2c90,0x3f316e2c,0x0,0x3e862210,0x3f0172c3,0x3f36c9a9
.long 0x0,0x3e8afa3e,0x3f05c277,0x3f3bfc8f,0x0,0x3e8fcefe,0x3f0a04f8,0x3f4105b8
.long 0x0,0x3e94a031,0x3f0e39da,0x3f45e403,0x0,0x3e996dba,0x3f1260b2,0x3f4a965e
.long 0x0,0x0,0x0,0x0,0x3d20cee7,0x3d48fb30,0x3d712283,0x3d8ca1f2
.long 0x3da0af2a,0x3dc8bd36,0x3df0b772,0x3e0c4cf7,0x3df0b772,0x3e164083,0x3e3403f1,0x3e519f65
.long 0x3e20305b,0x3e47c5c2,0x3e6f0c4d,0x3e8afa3e,0x3e47c5c2,0x3e78cfcc,0x3e94a031,0x3eac7cd4
.long 0x3e6f0c4d,0x3e94a031,0x3eb13641,0x3ecd2ef3,0x3e8afa3e,0x3eac7cd4,0x3ecd2ef3,0x3eece91a
.long 0x3e9e377a,0x3ec3ef15,0x3ee87171,0x3f05c277,0x3eb13641,0x3edae880,0x3f0172c3,0x3f146eba
.long 0x3ec3ef15,0x3ef15aea,0x3f0e39da,0x3f226799,0x3ed65a92,0x3f039c3d,0x3f1a82a4,0x3f2f9c32
.long 0x3ee87171,0x3f0e39da,0x3f26423a,0x3f3bfc8f,0x3efa2c90,0x3f187fc0,0x3f316e2c,0x3f4779bc
.long 0x3f05c277,0x3f226799,0x3f3bfc8f,0x3f5205d4,0x3f0e39da,0x3f2beb4a,0x3f45e403,0x3f5b941a
.long 0x3f167918,0x3f3504f3,0x3f4f1bbd,0x3f641901,0x3f1e7cf1,0x3f3daef9,0x3f579b8c,0x3f6b8a3d
.long 0x3f26423a,0x3f45e403,0x3f5f5be6,0x3f71decf,0x3f2dc5e3,0x3f4d9f02,0x3f6655e7,0x3f770f11
.long 0x3f3504f3,0x3f54db31,0x3f6c835e,0x3f7b14be,0x3f3bfc8f,0x3f5b941a,0x3f71decf,0x3f7deafa
.long 0x3f42a9f7,0x3f61c598,0x3f766377,0x3f7f8e56,0x3f490a88,0x3f676bd8,0x3f7a0d54,0x3f7ffcd7
.long 0x3f4f1bbd,0x3f6c835e,0x3f7cd925,0x3f7f35f9,0x3f54db31,0x3f710908,0x3f7ec46d,0x3f7d3aac
.long 0x3f5a46a0,0x3f74fa0b,0x3f7fcd79,0x3f7a0d54,0x3f5f5be6,0x3f7853f8,0x3f7ff35e,0x3f75b1c9
.long 0x3f641901,0x3f7b14be,0x3f7f35f9,0x3f702d4f,0x3f687c12,0x3f7d3aac,0x3f7d95f4,0x3f698690
.long 0x3f6c835e,0x3f7ec46d,0x3f7b14be,0x3f61c598,0x3f702d4f,0x3f7fb10f,0x3f77b493,0x3f58f3c4
.long 0x0,0x0,0x0,0x0,0x3da0af2a,0x3db4b86a,0x3dc8bd36,0x3ddcbd0d
.long 0x3e20305b,0x3e3403f1,0x3e47c5c2,0x3e5b73dc,0x3e6f0c4d,0x3e862210,0x3e94a031,0x3ea2fd52
.long 0x3e9e377a,0x3eb13641,0x3ec3ef15,0x3ed65a92,0x3ec3ef15,0x3edae880,0x3ef15aea,0x3f039c3d
.long 0x3ee87171,0x3f0172c3,0x3f0e39da,0x3f1a82a4,0x3f05c277,0x3f146eba,0x3f226799,0x3f2f9c32
.long 0x3f167918,0x3f26423a,0x3f3504f3,0x3f42a9f7,0x3f26423a,0x3f36c9a9,0x3f45e403,0x3f53731f
.long 0x3f3504f3,0x3f45e403,0x3f54db31,0x3f61c598,0x3f42a9f7,0x3f53731f,0x3f61c598,0x3f6d76aa
.long 0x3f4f1bbd,0x3f5f5be6,0x3f6c835e,0x3f766377,0x3f5a46a0,0x3f698690,0x3f74fa0b,0x3f7c7160
.long 0x3f641901,0x3f71decf,0x3f7b14be,0x3f7f8e56,0x3f6c835e,0x3f7853f8,0x3f7ec46d,0x3f7fb10f
.long 0x3f737871,0x3f7cd925,0x3f800000,0x3f7cd925,0x3f78ed3c,0x3f7f654e,0x3f7ec46d,0x3f770f11
.long 0x3f7cd925,0x3f7ff35e,0x3f7b14be,0x3f6e641a,0x3f7f35f9,0x3f7e8238,0x3f74fa0b,0x3f62f219
.long 0x3f800000,0x3f7b14be,0x3f6c835e,0x3f54db31,0x3f7f35f9,0x3f75b1c9,0x3f61c598,0x3f444969
.long 0x3f7cd925,0x3f6e641a,0x3f54db31,0x3f316e2c,0x3f78ed3c,0x3f653a48,0x3f45e403,0x3f1c81b9
.long 0x3f737871,0x3f5a46a0,0x3f3504f3,0x3f05c277,0x3f6c835e,0x3f4d9f02,0x3f226799,0x3edae880
.long 0x3f641901,0x3f3f5cb5,0x3f0e39da,0x3ea7bf25,0x3f5a46a0,0x3f2f9c32,0x3ef15aea,0x3e6542e9
.long 0x3f4f1bbd,0x3f1e7cf1,0x3ec3ef15,0x3df0b772,0x3f42a9f7,0x3f0c2124,0x3e94a031,0x3c20d8d2
.long 0x3f3504f3,0x3ef15aea,0x3e47c5c2,0xbdc8bd36,0x3f26423a,0x3ec8917e,0x3dc8bd36,0xbe519f65
.long 0x0,0x0,0x0,0x0,0x3df0b772,0x3e0255f4,0x3e0c4cf7,0x3e164083
.long 0x3e6f0c4d,0x3e814693,0x3e8afa3e,0x3e94a031,0x3eb13641,0x3ebf47d7,0x3ecd2ef3,0x3edae880
.long 0x3ee87171,0x3efa2c90,0x3f05c277,0x3f0e39da,0x3f0e39da,0x3f187fc0,0x3f226799,0x3f2beb4a
.long 0x3f26423a,0x3f316e2c,0x3f3bfc8f,0x3f45e403,0x3f3bfc8f,0x3f4779bc,0x3f5205d4,0x3f5b941a
.long 0x3f4f1bbd,0x3f5a46a0,0x3f641901,0x3f6c835e,0x3f5f5be6,0x3f698690,0x3f71decf,0x3f7853f8
.long 0x3f6c835e,0x3f74fa0b,0x3f7b14be,0x3f7ec46d,0x3f766377,0x3f7c7160,0x3f7f8e56,0x3f7fb10f
.long 0x3f7cd925,0x3f7fcd79,0x3f7f35f9,0x3f7b14be,0x3f7fcd79,0x3f7f0059,0x3f7a0d54,0x3f710908
.long 0x3f7f35f9,0x3f7a0d54,0x3f702d4f,0x3f61c598,0x3f7b14be,0x3f710908,0x3f61c598,0x3f4d9f02
.long 0x3f737871,0x3f641901,0x3f4f1bbd,0x3f3504f3,0x3f687c12,0x3f53731f,0x3f3889dc,0x3f187fc0
.long 0x3f5a46a0,0x3f3f5cb5,0x3f1e7cf1,0x3ef15aea,0x3f490a88,0x3f28296a,0x3f0172c3,0x3eac7cd4
.long 0x3f3504f3,0x3f0e39da,0x3ec3ef15,0x3e47c5c2,0x3f1e7cf1,0x3ee3f40d,0x3e814693,0x3d48fb30
.long 0x3f05c277,0x3ea7bf25,0x3df0b772,0xbdc8bd36,0x3ed65a92,0x3e519f65,0xbca0d6d6,0xbe78cfcc
.long 0x3e9e377a,0x3da0af2a,0xbe20305b,0xbec3ef15,0x3e47c5c2,0xbd48fb30,0xbe94a031,0xbf039c3d
.long 0x3da0af2a,0xbe3403f1,0xbed65a92,0xbf226799,0xbd20cee7,0xbe996dba,0xbf0a04f8,0xbf3daef9
.long 0xbe20305b,0xbed65a92,0xbf26423a,0xbf54db31,0xbe8afa3e,0xbf07e565,0xbf3f5cb5,0xbf676bd8
.long 0xbec3ef15,0xbf226799,0xbf54db31,0xbf74fa0b,0xbefa2c90,0xbf3a4582,0xbf6655e7,0xbf7d3aac
.long 0x0,0x0,0x0,0x0,0x3e20305b,0x3e2a1c3f,0x3e3403f1,0x3e3de731
.long 0x3e9e377a,0x3ea7bf25,0x3eb13641,0x3eba9be1,0x3ee87171,0x3ef5c6c5,0x3f0172c3,0x3f07e565
.long 0x3f167918,0x3f1e7cf1,0x3f26423a,0x3f2dc5e3,0x3f3504f3,0x3f3daef9,0x3f45e403,0x3f4d9f02
.long 0x3f4f1bbd,0x3f579b8c,0x3f5f5be6,0x3f6655e7,0x3f641901,0x3f6b8a3d,0x3f71decf,0x3f770f11
.long 0x3f737871,0x3f78ed3c,0x3f7cd925,0x3f7f35f9,0x3f7cd925,0x3f7f654e,0x3f7ff35e,0x3f7e8238
.long 0x3f800000,0x3f7ec46d,0x3f7b14be,0x3f74fa0b,0x3f7cd925,0x3f770f11,0x3f6e641a,0x3f62f219
.long 0x3f737871,0x3f687c12,0x3f5a46a0,0x3f490a88,0x3f641901,0x3f53731f,0x3f3f5cb5,0x3f28296a
.long 0x3f4f1bbd,0x3f3889dc,0x3f1e7cf1,0x3f0172c3,0x3f3504f3,0x3f187fc0,0x3ef15aea,0x3eac7cd4
.long 0x3f167918,0x3ee87171,0x3e9e377a,0x3e20305b,0x3ee87171,0x3e996dba,0x3e0c4cf7,0xbcf13d4c
.long 0x3e9e377a,0x3e0c4cf7,0xbd20cee7,0xbe5b73dc,0x3e20305b,0xbcf13d4c,0xbe5b73dc,0xbec8917e
.long 0x250d3132,0xbe47c5c2,0xbec3ef15,0xbf0e39da,0xbe20305b,0xbeb5eb4f,0xbf0a04f8,0xbf333bc6
.long 0xbe9e377a,0xbf0172c3,0xbf2dc5e3,0xbf5205d4,0xbee87171,0xbf2456f1,0xbf4c1d35,0xbf698690
.long 0xbf167918,0xbf42a9f7,0xbf641901,0xbf78ed3c,0xbf3504f3,0xbf5b941a,0xbf74fa0b,0xbf7fb10f
.long 0xbf4f1bbd,0xbf6e641a,0xbf7e39bc,0xbf7d95f4,0xbf641901,0xbf7a9421,0xbf7f8e56,0xbf72ae9e
.long 0xbf737871,0xbf7fcd79,0xbf78ed3c,0xbf5f5be6,0xbf7cd925,0xbf7deafa,0xbf6a8b4b,0xbf444969
.long 0xbf800000,0xbf74fa0b,0xbf54db31,0xbf226799,0xbf7cd925,0xbf653a48,0xbf3889dc,0xbef5c6c5
.long 0x0,0x0,0x0,0x0,0x0,0x0,0x0,0x0
.long 0x0,0x0,0x0,0x0,0x0,0x0,0x0,0x0
.long 0x0,0x0,0x0,0x0,0x0,0x0,0x0,0x0
.long 0x0,0x0,0x0,0x0,0x0,0x0,0x0,0x0
.long 0x0,0x0,0x0,0x0,0x0,0x0,0x0,0x0
.long 0x0,0x0,0x0,0x0,0x0,0x0,0x0,0x0
.long 0x0,0x0,0x0,0x0,0x0,0x0,0x0,0x0
.long 0x0,0x0,0x0,0x80000000,0x0,0x0,0x80000000,0x80000000
.long 0x0,0x80000000,0x80000000,0x80000000,0x80000000,0x80000000,0x80000000,0x80000000
.long 0x80000000,0x80000000,0x80000000,0x80000000,0x80000000,0x80000000,0x80000000,0x80000000
.long 0x80000000,0x80000000,0x80000000,0x80000000,0x80000000,0x80000000,0x80000000,0x80000000
.long 0x80000000,0x80000000,0x80000000,0x80000000,0x80000000,0x80000000,0x80000000,0x80000000
.long 0x80000000,0x80000000,0x80000000,0x80000000,0x80000000,0x80000000,0x80000000,0x80000000
.long 0x80000000,0x80000000,0x80000000,0x80000000,0x80000000,0x80000000,0x80000000,0x80000000
.long 0x80000000,0x80000000,0x80000000,0x0,0x80000000,0x80000000,0x80000000,0x0
.long 0x80000000,0x80000000,0x0,0x0,0x80000000,0x0,0x0,0x0
.long 0x3f803f80,0x3f803f80,0x3f803f80,0x3f803f80,0x3f733f80,0x3f163f4f,0xbf73bf4f,0xbf73bf80
.long 0x3f4f3f80,0xbe9e3e9e,0x3f4f3e9e,0x3f4f3f80,0x3f163f80,0xbf73be9e,0xbf163e9e,0xbf16bf80
.long 0xbf803f80,0xbf803f80,0xbf803f80,0xbf803f80,0xbf733f80,0xbf163f4f,0x3f73bf4f,0x3f73bf80
.long 0xbf4f3f80,0x3e9e3e9e,0xbf4f3e9e,0xbf4f3f80,0xbf163f80,0x3f73be9e,0x3f163e9e,0x3f16bf80
.long 0x3e9e3f80,0xbf4fbf4f,0x3e9ebf4f,0x3e9e3f80,0x248d3f80,0xa554bf80,0x248d3f80,0xa554bf80
.long 0xbe9e3f80,0x3f4fbf4f,0xbe9ebf4f,0xbe9e3f80,0xbf163f80,0x3f73be9e,0x3f163e9e,0x3f16bf80
.long 0xbe9e3f80,0x3f4fbf4f,0xbe9ebf4f,0xbe9e3f80,0xa5543f80,0x248dbf80,0xa5543f80,0x248dbf80
.long 0x3e9e3f80,0xbf4fbf4f,0x3e9ebf4f,0x3e9e3f80,0x3f163f80,0xbf73be9e,0xbf163e9e,0xbf16bf80
.long 0xbf4f3f80,0x3e9e3e9e,0xbf4f3e9e,0xbf4f3f80,0xbf733f80,0xbf163f4f,0x3f73bf4f,0x3f73bf80
.long 0x80000000,0x80000000,0x80000000,0x80000000,0x80000000,0x80000000,0x8000,0x8000
.long 0x3f4f3f80,0xbe9e3e9e,0x3f4f3e9e,0x3f4f3f80,0x3f733f80,0x3f163f4f,0xbf73bf4f,0xbf73bf80
.long 0x0,0x0,0x0,0x0,0x0,0x0,0x80008000,0x80008000
.long 0x80000000,0x0,0x80000000,0x80000000,0x80000000,0x8000,0x0,0x8000
.long 0x80000000,0x8000,0x80008000,0x80000000,0x80000000,0x8000,0x80000000,0x8000
.long 0x0,0x80000000,0x0,0x0,0x0,0x80008000,0x80000000,0x80008000
.long 0x0,0x80008000,0x8000,0x0,0x0,0x80008000,0x0,0x80008000
.long 0x3f803f80,0x3f803f80,0x3f803f80,0x3f803f80,0x248d3e9e,0xbf16be9e,0xbf16bf4f,0xa554be9e
.long 0xbf80bf4f,0xbe9ebf4f,0xbe9e3e9e,0xbf80bf4f,0xa554bf4f,0x3f733f4f,0x3f733e9e,0x248d3f4f
.long 0xbf803f80,0xbf803f80,0xbf803f80,0xbf803f80,0xa5543e9e,0x3f16be9e,0x3f16bf4f,0x248dbe9e
.long 0x3f80bf4f,0x3e9ebf4f,0x3e9e3e9e,0x3f80bf4f,0x248dbf4f,0xbf733f4f,0xbf733e9e,0xa5543f4f
.long 0x3f803e9e,0xbf4f3e9e,0xbf4fbf4f,0x3f803e9e,0x248d3f80,0xa554bf80,0x248d3f80,0xa554bf80
.long 0xbf803e9e,0x3f4f3e9e,0x3f4fbf4f,0xbf803e9e,0xa554bf4f,0xbf733f4f,0xbf733e9e,0x248d3f4f
.long 0xbf803e9e,0x3f4f3e9e,0x3f4fbf4f,0xbf803e9e,0xa5543f80,0x248dbf80,0xa5543f80,0x248dbf80
.long 0x3f803e9e,0xbf4f3e9e,0xbf4fbf4f,0x3f803e9e,0x248dbf4f,0x3f733f4f,0x3f733e9e,0xa5543f4f
.long 0x3f80bf4f,0x3e9ebf4f,0x3e9e3e9e,0x3f80bf4f,0x248d3e9e,0x3f16be9e,0x3f16bf4f,0xa554be9e
.long 0x80000000,0x80000000,0x80000000,0x80000000,0x80000000,0x8000,0x8000,0x8000
.long 0xbf80bf4f,0xbe9ebf4f,0xbe9e3e9e,0xbf80bf4f,0xa5543e9e,0xbf16be9e,0xbf16bf4f,0x248dbe9e
.long 0x0,0x0,0x0,0x0,0x0,0x80008000,0x80008000,0x80008000
.long 0x8000,0x8000,0x0,0x8000,0x8000,0x80000000,0x80000000,0x80000000
.long 0x80000000,0x0,0x8000,0x80000000,0x80000000,0x8000,0x80000000,0x8000
.long 0x80008000,0x80008000,0x80000000,0x80008000,0x80008000,0x0,0x0,0x0
.long 0x0,0x80000000,0x80008000,0x0,0x0,0x80008000,0x0,0x80008000
.long 0x0,0x0,0x0,0x0,0x3e9e0000,0x3f4f3f16,0x3e9e3f16,0xbe9e250d
.long 0x3f160000,0x3f733f73,0xbf16bf73,0x3f160000,0x3f4f0000,0x3e9e3f73,0x3f4f3f73,0xbf4f250d
.long 0x250d0000,0x250d0000,0x250d0000,0x250d0000,0xbe9e0000,0xbf4f3f16,0xbe9e3f16,0x3e9e250d
.long 0xbf160000,0xbf733f73,0x3f16bf73,0xbf160000,0xbf4f0000,0xbe9e3f73,0xbf4f3f73,0x3f4f250d
.long 0x3f730000,0xbf163f16,0xbf73bf16,0x3f730000,0x3f800000,0xbf80250d,0x3f800000,0xbf80250d
.long 0x3f730000,0xbf16bf16,0xbf733f16,0x3f730000,0x3f4f0000,0x3e9ebf73,0x3f4fbf73,0xbf4f250d
.long 0xbf730000,0x3f163f16,0x3f73bf16,0xbf730000,0xbf800000,0x3f80250d,0xbf800000,0x3f80250d
.long 0xbf730000,0x3f16bf16,0x3f733f16,0xbf730000,0xbf4f0000,0xbe9ebf73,0xbf4fbf73,0x3f4f250d
.long 0x3f160000,0x3f73bf73,0xbf163f73,0x3f160000,0x3e9e0000,0x3f4fbf16,0x3e9ebf16,0xbe9e250d
.long 0x0,0x0,0x0,0x0,0x80000000,0x80000000,0x80000000,0x0
.long 0xbf160000,0xbf73bf73,0x3f163f73,0xbf160000,0xbe9e0000,0xbf4fbf16,0xbe9ebf16,0x3e9e250d
.long 0x0,0x0,0x0,0x0,0x0,0x0,0x0,0x80000000
.long 0x80000000,0x80000000,0x8000,0x80000000,0x80000000,0x80000000,0x80000000,0x0
.long 0x80000000,0x0,0x8000,0x80000000,0x80000000,0x0,0x80000000,0x0
.long 0x0,0x0,0x80008000,0x0,0x0,0x0,0x0,0x80000000
.long 0x0,0x80000000,0x80008000,0x0,0x0,0x80000000,0x0,0x80000000
.long 0x0,0x0,0x0,0x0,0x3f803f73,0x3f4f3f73,0xbf4fbf16,0xbf80bf73
.long 0x250d3f16,0xbf73bf16,0x3f733f73,0x250d3f16,0xbf80bf16,0x3e9ebf16,0xbe9ebf73,0x3f803f16
.long 0x250d0000,0x250d0000,0x250d0000,0x250d0000,0xbf803f73,0xbf4f3f73,0x3f4fbf16,0x3f80bf73
.long 0x3f16,0x3f73bf16,0xbf733f73,0x3f16,0x3f80bf16,0xbe9ebf16,0x3e9ebf73,0xbf803f16
.long 0xbf73,0x3f163f73,0xbf163f16,0xbf73,0x3f800000,0xbf80250d,0x3f800000,0xbf80250d
.long 0x250d3f73,0x3f16bf73,0xbf16bf16,0x250d3f73,0xbf803f16,0x3e9e3f16,0xbe9e3f73,0x3f80bf16
.long 0x250dbf73,0xbf163f73,0x3f163f16,0x250dbf73,0xbf800000,0x3f80250d,0xbf800000,0x3f80250d
.long 0x3f73,0xbf16bf73,0x3f16bf16,0x3f73,0x3f803f16,0xbe9e3f16,0x3e9e3f73,0xbf80bf16
.long 0xbf16,0xbf733f16,0x3f73bf73,0xbf16,0x3f80bf73,0x3f4fbf73,0xbf4f3f16,0xbf803f73
.long 0x0,0x0,0x0,0x0,0x80000000,0x80000000,0x8000,0x8000
.long 0x250dbf16,0x3f733f16,0xbf73bf73,0x250dbf16,0xbf80bf73,0xbf4fbf73,0x3f4f3f16,0x3f803f73
.long 0x0,0x0,0x0,0x0,0x0,0x0,0x80008000,0x80008000
.long 0x0,0x8000,0x80000000,0x0,0x8000,0x80008000,0x8000,0x80000000
.long 0x8000,0x80000000,0x0,0x8000,0x80000000,0x0,0x80000000,0x0
.long 0x0,0x80008000,0x0,0x0,0x80008000,0x8000,0x80008000,0x0
.long 0x8000,0x0,0x80000000,0x8000,0x0,0x80000000,0x0,0x80000000
.long 0x80008000,0x80008000,0x80008000,0x80008000,0xbe9e8000,0xbf4fbf16,0xbe9ebf16,0x3e9ea50d
.long 0xbf168000,0xbf73bf73,0x3f163f73,0xbf168000,0xbf4f8000,0xbe9ebf73,0xbf4fbf73,0x3f4fa50d
.long 0xa50d8000,0xa50d8000,0xa50d8000,0xa50d8000,0x3e9e8000,0x3f4fbf16,0x3e9ebf16,0xbe9ea50d
.long 0x3f168000,0x3f73bf73,0xbf163f73,0x3f168000,0x3f4f8000,0x3e9ebf73,0x3f4fbf73,0xbf4fa50d
.long 0xbf738000,0x3f16bf16,0x3f733f16,0xbf738000,0xbf808000,0x3f80a50d,0xbf808000,0x3f80a50d
.long 0xbf738000,0x3f163f16,0x3f73bf16,0xbf738000,0xbf4f8000,0xbe9e3f73,0xbf4f3f73,0x3f4fa50d
.long 0x3f738000,0xbf16bf16,0xbf733f16,0x3f738000,0x3f808000,0xbf80a50d,0x3f808000,0xbf80a50d
.long 0x3f738000,0xbf163f16,0xbf73bf16,0x3f738000,0x3f4f8000,0x3e9e3f73,0x3f4f3f73,0xbf4fa50d
.long 0xbf168000,0xbf733f73,0x3f16bf73,0xbf168000,0xbe9e8000,0xbf4f3f16,0xbe9e3f16,0x3e9ea50d
.long 0x80008000,0x80008000,0x80008000,0x80008000,0x8000,0x8000,0x8000,0x80008000
.long 0x3f168000,0x3f733f73,0xbf16bf73,0x3f168000,0x3e9e8000,0x3f4f3f16,0x3e9e3f16,0xbe9ea50d
.long 0x80008000,0x80008000,0x80008000,0x80008000,0x80008000,0x80008000,0x80008000,0x8000
.long 0x8000,0x8000,0x80000000,0x8000,0x8000,0x8000,0x8000,0x80008000
.long 0x8000,0x80008000,0x80000000,0x8000,0x8000,0x80008000,0x8000,0x80008000
.long 0x80008000,0x80008000,0x0,0x80008000,0x80008000,0x80008000,0x80008000,0x8000
.long 0x80008000,0x8000,0x0,0x80008000,0x80008000,0x8000,0x80008000,0x8000
.long 0x80008000,0x80008000,0x80008000,0x80008000,0xbf80bf73,0xbf4fbf73,0x3f4f3f16,0x3f803f73
.long 0xa50dbf16,0x3f733f16,0xbf73bf73,0xa50dbf16,0x3f803f16,0xbe9e3f16,0x3e9e3f73,0xbf80bf16
.long 0xa50d8000,0xa50d8000,0xa50d8000,0xa50d8000,0x3f80bf73,0x3f4fbf73,0xbf4f3f16,0xbf803f73
.long 0x8000bf16,0xbf733f16,0x3f73bf73,0x8000bf16,0xbf803f16,0x3e9e3f16,0xbe9e3f73,0x3f80bf16
.long 0x80003f73,0xbf16bf73,0x3f16bf16,0x80003f73,0xbf808000,0x3f80a50d,0xbf808000,0x3f80a50d
.long 0xa50dbf73,0xbf163f73,0x3f163f16,0xa50dbf73,0x3f80bf16,0xbe9ebf16,0x3e9ebf73,0xbf803f16
.long 0xa50d3f73,0x3f16bf73,0xbf16bf16,0xa50d3f73,0x3f808000,0xbf80a50d,0x3f808000,0xbf80a50d
.long 0x8000bf73,0x3f163f73,0xbf163f16,0x8000bf73,0xbf80bf16,0x3e9ebf16,0xbe9ebf73,0x3f803f16
.long 0x80003f16,0x3f73bf16,0xbf733f73,0x80003f16,0xbf803f73,0xbf4f3f73,0x3f4fbf16,0x3f80bf73
.long 0x80008000,0x80008000,0x80008000,0x80008000,0x8000,0x8000,0x80000000,0x80000000
.long 0xa50d3f16,0xbf73bf16,0x3f733f73,0xa50d3f16,0x3f803f73,0x3f4f3f73,0xbf4fbf16,0xbf80bf73
.long 0x80008000,0x80008000,0x80008000,0x80008000,0x80008000,0x80008000,0x0,0x0
.long 0x80008000,0x80000000,0x8000,0x80008000,0x80000000,0x0,0x80000000,0x8000
.long 0x80000000,0x8000,0x80008000,0x80000000,0x8000,0x80008000,0x8000,0x80008000
.long 0x80008000,0x0,0x80008000,0x80008000,0x0,0x80000000,0x0,0x80008000
.long 0x80000000,0x80008000,0x8000,0x80000000,0x80008000,0x8000,0x80008000,0x8000
.long 0x3f803f80,0x3f803f80,0x0,0x0,0x3f163e9e,0x3f733f4f,0xbf4fbf73,0xbe9ebf16
.long 0xbe9ebf4f,0x3f4f3e9e,0xbf73bf16,0xbf16bf73,0xbf73bf4f,0x3f16be9e,0xbe9e3f16,0xbf4fbf73
.long 0xbf803f80,0xbf803f80,0x250d0000,0x250d0000,0xbf163e9e,0xbf733f4f,0x3f4fbf73,0x3e9ebf16
.long 0x3e9ebf4f,0xbf4f3e9e,0x3f73bf16,0x3f16bf73,0x3f73bf4f,0xbf16be9e,0x3e9e3f16,0x3f4fbf73
.long 0xbf4f3e9e,0x3e9ebf4f,0x3f163f73,0xbf73bf16,0x248d3f80,0xa554bf80,0x3f800000,0xbf80250d
.long 0x3f4f3e9e,0xbe9ebf4f,0x3f16bf73,0xbf733f16,0x3f73bf4f,0xbf16be9e,0xbe9ebf16,0xbf4f3f73
.long 0x3f4f3e9e,0xbe9ebf4f,0xbf163f73,0x3f73bf16,0xa5543f80,0x248dbf80,0xbf800000,0x3f80250d
.long 0xbf4f3e9e,0x3e9ebf4f,0xbf16bf73,0x3f733f16,0xbf73bf4f,0x3f16be9e,0x3e9ebf16,0x3f4f3f73
.long 0x3e9ebf4f,0xbf4f3e9e,0xbf733f16,0xbf163f73,0xbf163e9e,0xbf733f4f,0xbf4f3f73,0xbe9e3f16
.long 0x80000000,0x80000000,0x0,0x0,0x80000000,0x80000000,0x8000,0x8000
.long 0xbe9ebf4f,0x3f4f3e9e,0x3f733f16,0x3f163f73,0x3f163e9e,0x3f733f4f,0x3f4f3f73,0x3e9e3f16
.long 0x0,0x0,0x0,0x0,0x0,0x0,0x80008000,0x80008000
.long 0x8000,0x80000000,0x8000,0x8000,0x8000,0x80008000,0x0,0x8000
.long 0x0,0x80008000,0x80000000,0x8000,0x80000000,0x8000,0x80000000,0x0
.long 0x80008000,0x0,0x80008000,0x80008000,0x80008000,0x8000,0x80000000,0x80008000
.long 0x80000000,0x8000,0x0,0x80008000,0x0,0x80008000,0x0,0x80000000
.long 0x0,0x0,0x0,0x0,0x0,0x0,0x80008000,0x80008000
.long 0x80008000,0x0,0x80008000,0x80008000,0x80008000,0x8000,0x80000000,0x80008000
.long 0x80000000,0x80000000,0x0,0x0,0x80000000,0x80000000,0x8000,0x8000
.long 0x8000,0x80000000,0x8000,0x8000,0x8000,0x80008000,0x0,0x8000
.long 0x80000000,0x8000,0x0,0x80008000,0x0,0x80008000,0x0,0x80000000
.long 0x0,0x80008000,0x8000,0x80000000,0x8000,0x80008000,0x80008000,0x80000000
.long 0x0,0x80008000,0x80000000,0x8000,0x80000000,0x8000,0x80000000,0x0
.long 0x80000000,0x8000,0x80008000,0x0,0x80008000,0x8000,0x8000,0x0
.long 0x8000,0x80000000,0x80000000,0x80000000,0x80000000,0x80000000,0x80000000,0x80000000
.long 0x80000000,0x80000000,0x0,0x0,0x80000000,0x80000000,0x8000,0x8000
.long 0x80008000,0x0,0x0,0x0,0x0,0x0,0x0,0x0
.long 0x0,0x0,0x0,0x0,0x0,0x0,0x80008000,0x80008000
.long 0x8000,0x80000000,0x8000,0x8000,0x8000,0x80008000,0x0,0x8000
.long 0x0,0x80008000,0x80000000,0x8000,0x80000000,0x8000,0x80000000,0x0
.long 0x80008000,0x0,0x80008000,0x80008000,0x80008000,0x8000,0x80000000,0x80008000
.long 0x80000000,0x8000,0x0,0x80008000,0x0,0x80008000,0x0,0x80000000
.long 0x80008000,0x80008000,0x3f803f80,0x3f803f80,0x3f4f3f73,0x3e9e3f16,0x3f163e9e,0x3f733f4f
.long 0x3f733f16,0x3f163f73,0xbe9ebf4f,0x3f4f3e9e,0x3e9ebf16,0x3f4f3f73,0xbf73bf4f,0x3f16be9e
.long 0xa50d8000,0xa50d8000,0xbf803f80,0xbf803f80,0xbf4f3f73,0xbe9e3f16,0xbf163e9e,0xbf733f4f
.long 0xbf733f16,0xbf163f73,0x3e9ebf4f,0xbf4f3e9e,0xbe9ebf16,0xbf4f3f73,0x3f73bf4f,0xbf16be9e
.long 0xbf16bf73,0x3f733f16,0xbf4f3e9e,0x3e9ebf4f,0xbf808000,0x3f80a50d,0x248d3f80,0xa554bf80
.long 0xbf163f73,0x3f73bf16,0x3f4f3e9e,0xbe9ebf4f,0x3e9e3f16,0x3f4fbf73,0x3f73bf4f,0xbf16be9e
.long 0x3f16bf73,0xbf733f16,0x3f4f3e9e,0xbe9ebf4f,0x3f808000,0xbf80a50d,0xa5543f80,0x248dbf80
.long 0x3f163f73,0xbf73bf16,0xbf4f3e9e,0x3e9ebf4f,0xbe9e3f16,0xbf4fbf73,0xbf73bf4f,0x3f16be9e
.long 0x3f73bf16,0x3f16bf73,0x3e9ebf4f,0xbf4f3e9e,0x3f4fbf73,0x3e9ebf16,0xbf163e9e,0xbf733f4f
.long 0x80008000,0x80008000,0x80000000,0x80000000,0x80000000,0x80000000,0x80000000,0x80000000
.long 0xbf73bf16,0xbf16bf73,0xbe9ebf4f,0x3f4f3e9e,0xbf4fbf73,0xbe9ebf16,0x3f163e9e,0x3f733f4f
.long 0x80008000,0x80008000,0x0,0x0,0x0,0x0,0x0,0x0
.long 0x80000000,0x80000000,0x8000,0x80000000,0x80008000,0x80000000,0x8000,0x80008000
.long 0x8000,0x80000000,0x0,0x80008000,0x8000,0x80008000,0x80000000,0x8000
.long 0x0,0x0,0x80008000,0x0,0x8000,0x0,0x80008000,0x8000
.long 0x80008000,0x0,0x80000000,0x8000,0x80008000,0x8000,0x0,0x80008000
.long 0x80008000,0x80008000,0x0,0x0,0x0,0x0,0x0,0x0
.long 0x0,0x0,0x80008000,0x0,0x8000,0x0,0x80008000,0x8000
.long 0x80008000,0x80008000,0x80000000,0x80000000,0x80000000,0x80000000,0x80000000,0x80000000
.long 0x80000000,0x80000000,0x8000,0x80000000,0x80008000,0x80000000,0x8000,0x80008000
.long 0x80008000,0x0,0x80000000,0x8000,0x80008000,0x8000,0x0,0x80008000
.long 0x80000000,0x8000,0x0,0x80008000,0x0,0x8000,0x8000,0x80008000
.long 0x8000,0x80000000,0x0,0x80008000,0x8000,0x80008000,0x80000000,0x8000
.long 0x0,0x80008000,0x80000000,0x8000,0x80000000,0x80008000,0x80008000,0x8000
.long 0x8000,0x8000,0x8000,0x80000000,0x8000,0x8000,0x80000000,0x80000000
.long 0x80008000,0x80008000,0x80000000,0x80000000,0x80000000,0x80000000,0x80000000,0x80000000
.long 0x80008000,0x80008000,0x80008000,0x0,0x80008000,0x80008000,0x0,0x0
.long 0x80008000,0x80008000,0x0,0x0,0x0,0x0,0x0,0x0
.long 0x80000000,0x80000000,0x8000,0x80000000,0x80008000,0x80000000,0x8000,0x80008000
.long 0x8000,0x80000000,0x0,0x80008000,0x8000,0x80008000,0x80000000,0x8000
.long 0x0,0x0,0x80008000,0x0,0x8000,0x0,0x80008000,0x8000
.long 0x80008000,0x0,0x80000000,0x8000,0x80008000,0x8000,0x0,0x80008000
.long 0x3f003f00,0x3f003f00,0x3f003f00,0x3f003f00,0x3f00bf00,0x3f00bf00,0x3f00bf00,0x3f00bf00
.long 0xbf003f00,0xa4803f35,0x3f003f00,0x3f352480,0x3f003f00,0x3f352480,0x3f00bf00,0x2480bf35
.long 0x3f003f00,0xbf00bf00,0x3f003f00,0xbf00bf00,0x3f00bf00,0xbf003f00,0x3f00bf00,0xbf003f00
.long 0xbf003f00,0x2500bf35,0x3f003f00,0xbf35a688,0x3f003f00,0xbf35a500,0x3f00bf00,0xa6883f35
.long 0x3f003f00,0x3f00bf00,0xbf00bf00,0xbf003f00,0x3f00bf00,0xbf00bf00,0xbf003f00,0x3f003f00
.long 0xbf003f00,0x3f352480,0xbf00bf00,0xa5403f35,0x3f003f00,0x2480bf35,0xbf003f00,0x3f352540
.long 0x3f003f00,0xbf003f00,0xbf00bf00,0x3f00bf00,0x3f00bf00,0x3f003f00,0xbf003f00,0xbf00bf00
.long 0xbf003f00,0xbf35a540,0xbf00bf00,0xa540bf35,0x3f003f00,0xa5403f35,0xbf003f00,0xbf352540
.long 0x0,0x80008000,0x0,0x80008000,0x8000,0x80000000,0x8000,0x80000000
.long 0x80000000,0x8000,0x0,0x80008000,0x0,0x80008000,0x8000,0x80000000
.long 0x0,0x0,0x0,0x0,0x8000,0x8000,0x8000,0x8000
.long 0x80000000,0x80000000,0x0,0x0,0x0,0x0,0x8000,0x8000
.long 0x0,0x80000000,0x80008000,0x8000,0x8000,0x0,0x80000000,0x80008000
.long 0x80000000,0x80008000,0x80008000,0x80008000,0x0,0x80000000,0x80000000,0x80000000
.long 0x0,0x8000,0x80008000,0x80000000,0x8000,0x80008000,0x80000000,0x0
.long 0x80000000,0x0,0x80008000,0x80000000,0x0,0x8000,0x80000000,0x0
.long 0x3f003f00,0x3f003f00,0x3f003f00,0x3f003f00,0xbf003f00,0xbf003f00,0xbf003f00,0xbf003f00
.long 0xbf003f00,0xbf352480,0xbf00bf00,0xa480bf35,0xbf00bf00,0xa480bf35,0x3f00bf00,0x3f35a480
.long 0x3f003f00,0xbf00bf00,0x3f003f00,0xbf00bf00,0xbf003f00,0x3f00bf00,0xbf003f00,0x3f00bf00
.long 0xbf003f00,0x3f35a500,0xbf00bf00,0x26883f35,0xbf00bf00,0x25003f35,0x3f00bf00,0xbf352688
.long 0x3f003f00,0xbf003f00,0xbf00bf00,0x3f00bf00,0xbf003f00,0xbf00bf00,0x3f00bf00,0x3f003f00
.long 0xbf003f00,0xa480bf35,0x3f003f00,0xbf352540,0xbf00bf00,0x3f35a480,0xbf003f00,0xa540bf35
.long 0x3f003f00,0x3f00bf00,0xbf00bf00,0xbf003f00,0xbf003f00,0x3f003f00,0x3f00bf00,0xbf00bf00
.long 0xbf003f00,0x25403f35,0x3f003f00,0x3f352540,0xbf00bf00,0xbf352540,0xbf003f00,0xa5403f35
.long 0x0,0x80008000,0x0,0x80008000,0x80000000,0x8000,0x80000000,0x8000
.long 0x80000000,0x8000,0x80008000,0x0,0x80008000,0x0,0x8000,0x80000000
.long 0x0,0x0,0x0,0x0,0x80000000,0x80000000,0x80000000,0x80000000
.long 0x80000000,0x80000000,0x80008000,0x80008000,0x80008000,0x80008000,0x8000,0x8000
.long 0x0,0x8000,0x80008000,0x80000000,0x80000000,0x0,0x8000,0x80008000
.long 0x80000000,0x0,0x0,0x0,0x80008000,0x80000000,0x80000000,0x80000000
.long 0x0,0x80000000,0x80008000,0x8000,0x80000000,0x80008000,0x8000,0x0
.long 0x80000000,0x80008000,0x0,0x80000000,0x80008000,0x8000,0x80000000,0x80008000
.long 0xbf803f80,0x3f803f80,0xbf803f80,0x3f803f80,0x3f803f80,0x3f80bf80,0x3f803f80,0x3f80bf80
.long 0xbf803f80,0x25003fb5,0xbf80bf80,0xbfb52500,0x3f803f80,0x3fb5a500,0xbf803f80,0x25003fb5
.long 0x3f803f80,0xbf803f80,0x3f803f80,0xbf803f80,0xbf803f80,0xbf80bf80,0xbf803f80,0xbf80bf80
.long 0x3f803f80,0xbfb52500,0xbf803f80,0xa500bfb5,0xbf803f80,0xa500bfb5,0xbf80bf80,0x3fb5a500
.long 0xbf803f80,0xbf803f80,0x3f80bf80,0x3f80bf80,0x3f803f80,0x3f803f80,0xbf80bf80,0xbf80bf80
.long 0xbf803f80,0xbfb52500,0x3f803f80,0x25c03fb5,0x3f803f80,0x25003fb5,0x3f80bf80,0x3fb5a5c0
.long 0x3f803f80,0xbf80bf80,0xbf80bf80,0x3f803f80,0xbf803f80,0x3f80bf80,0x3f80bf80,0xbf803f80
.long 0x3f803f80,0xa500bfb5,0x3f80bf80,0xbfb525c0,0xbf803f80,0x3fb5a500,0x3f803f80,0xa5c0bfb5
.long 0x80000000,0x80008000,0x80000000,0x80008000,0x0,0x80000000,0x0,0x80000000
.long 0x80000000,0x80008000,0x80008000,0x8000,0x0,0x80000000,0x80000000,0x80008000
.long 0x0,0x8000,0x0,0x8000,0x80000000,0x0,0x80000000,0x0
.long 0x0,0x8000,0x80000000,0x0,0x80000000,0x0,0x80008000,0x80000000
.long 0x80000000,0x8000,0x8000,0x80000000,0x0,0x80008000,0x80008000,0x0
.long 0x80000000,0x8000,0x0,0x8000,0x0,0x80008000,0x8000,0x80008000
.long 0x0,0x0,0x80008000,0x80008000,0x80000000,0x80000000,0x8000,0x8000
.long 0x0,0x0,0x8000,0x0,0x80000000,0x80000000,0x0,0x80000000
.long 0xbf803f80,0x3f803f80,0xbf803f80,0x3f803f80,0x3f803f80,0x3f80bf80,0x3f803f80,0x3f80bf80
.long 0x3f80bf80,0xa580bfb5,0x3f803f80,0x3fb5a5c0,0xbf80bf80,0xbfb52580,0x3f80bf80,0xa5c0bfb5
.long 0x3f803f80,0xbf803f80,0x3f803f80,0xbf803f80,0xbf803f80,0xbf80bf80,0xbf803f80,0xbf80bf80
.long 0xbf80bf80,0x3fb5a580,0x3f80bf80,0x25c03fb5,0x3f80bf80,0x25803fb5,0x3f803f80,0xbfb525c0
.long 0xbf803f80,0xbf803f80,0x3f80bf80,0x3f80bf80,0x3f803f80,0x3f803f80,0xbf80bf80,0xbf80bf80
.long 0x3f80bf80,0x3fb5a708,0xbf80bf80,0x25c0bfb5,0xbf80bf80,0xa708bfb5,0xbf803f80,0xbfb5a5c0
.long 0x3f803f80,0xbf80bf80,0xbf80bf80,0x3f803f80,0xbf803f80,0x3f80bf80,0x3f80bf80,0xbf803f80
.long 0xbf80bf80,0x27083fb5,0xbf803f80,0x3fb525c0,0x3f80bf80,0xbfb52708,0xbf80bf80,0xa5c03fb5
.long 0x80000000,0x80008000,0x80000000,0x80008000,0x0,0x80000000,0x0,0x80000000
.long 0x8000,0x80000000,0x0,0x80000000,0x80008000,0x0,0x8000,0x0
.long 0x0,0x8000,0x0,0x8000,0x80000000,0x0,0x80000000,0x0
.long 0x80008000,0x80008000,0x8000,0x80008000,0x8000,0x8000,0x0,0x8000
.long 0x80000000,0x8000,0x8000,0x80000000,0x0,0x80008000,0x80008000,0x0
.long 0x8000,0x80000000,0x80008000,0x0,0x80008000,0x0,0x80000000,0x8000
.long 0x0,0x0,0x80008000,0x80008000,0x80000000,0x80000000,0x8000,0x8000
.long 0x80008000,0x80008000,0x80000000,0x80000000,0x8000,0x8000,0x80008000,0x80008000
.long 0x80003f80,0x80003f80,0x80003f80,0x80003f80,0x80003f80,0xbe9e3f73,0xbf163f4f,0xbf4f3f16
.long 0x80003f80,0xbf163f4f,0xbf733e9e,0xbf73be9e,0x80003f80,0xbf4f3f16,0xbf73be9e,0xbe9ebf73
.long 0x80003f80,0xbf733e9e,0xbf16bf4f,0x3f16bf4f,0x80003f80,0xbf80248d,0xa50dbf80,0x3f80a554
.long 0x80003f80,0xbf73be9e,0x3f16bf4f,0x3f163f4f,0x80003f80,0xbf4fbf16,0x3f73be9e,0xbe9e3f73
.long 0x80003f80,0xbf16bf4f,0x3f733e9e,0xbf733e9e,0x80003f80,0xbe9ebf73,0x3f163f4f,0xbf4fbf16
.long 0x80003f80,0xa50dbf80,0x80003f80,0xa50dbf80,0x80003f80,0x3e9ebf73,0xbf163f4f,0x3f4fbf16
.long 0x80003f80,0x3f16bf4f,0xbf733e9e,0x3f733e9e,0x80003f80,0x3f4fbf16,0xbf73be9e,0x3e9e3f73
.long 0x80003f80,0x3f73be9e,0xbf16bf4f,0xbf163f4f,0x80003f80,0x3f80a554,0xa50dbf80,0xbf80248d
.long 0x80003f80,0x3f733e9e,0x3f16bf4f,0xbf16bf4f,0x80003f80,0x3f4f3f16,0x3f73be9e,0x3e9ebf73
.long 0x80003f80,0x3f163f4f,0x3f733e9e,0x3f73be9e,0x80003f80,0x3e9e3f73,0x3f163f4f,0x3f4f3f16
.long 0x80000000,0x80000000,0x80000000,0x80000000,0x80000000,0x80000000,0x80000000,0x80000000
.long 0x80000000,0x80000000,0x80000000,0x80008000,0x80000000,0x80000000,0x80008000,0x80008000
.long 0x80000000,0x80000000,0x80008000,0x8000,0x80000000,0x80000000,0x80008000,0x8000
.long 0x80000000,0x80008000,0x8000,0x0,0x80000000,0x80008000,0x8000,0x80000000
.long 0x80000000,0x80008000,0x0,0x80000000,0x80000000,0x80008000,0x0,0x80008000
.long 0x80000000,0x80008000,0x80000000,0x80008000,0x80000000,0x8000,0x80000000,0x8000
.long 0x80003f80,0x80003f80,0x80003f80,0x80003f80,0xa50dbf80,0x3e9ebf73,0x3f16bf4f,0x3f4fbf16
.long 0x80003f80,0xbf163f4f,0xbf733e9e,0xbf73be9e,0xa50dbf80,0x3f4fbf16,0x3f733e9e,0x3e9e3f73
.long 0x80003f80,0xbf733e9e,0xbf16bf4f,0x3f16bf4f,0xa50dbf80,0x3f80a554,0x80003f80,0xbf80248d
.long 0x80003f80,0xbf73be9e,0x3f16bf4f,0x3f163f4f,0xa50dbf80,0x3f4f3f16,0xbf733e9e,0x3e9ebf73
.long 0x80003f80,0xbf16bf4f,0x3f733e9e,0xbf733e9e,0xa50dbf80,0x3e9e3f73,0xbf16bf4f,0x3f4f3f16
.long 0x80003f80,0xa50dbf80,0x80003f80,0xa50dbf80,0xa50dbf80,0xbe9e3f73,0x3f16bf4f,0xbf4f3f16
.long 0x80003f80,0x3f16bf4f,0xbf733e9e,0x3f733e9e,0xa50dbf80,0xbf4f3f16,0x3f733e9e,0xbe9ebf73
.long 0x80003f80,0x3f73be9e,0xbf16bf4f,0xbf163f4f,0xa50dbf80,0xbf80248d,0x80003f80,0x3f80a554
.long 0x80003f80,0x3f733e9e,0x3f16bf4f,0xbf16bf4f,0xa50dbf80,0xbf4fbf16,0xbf733e9e,0xbe9e3f73
.long 0x80003f80,0x3f163f4f,0x3f733e9e,0x3f73be9e,0xa50dbf80,0xbe9ebf73,0xbf16bf4f,0xbf4fbf16
.long 0x80000000,0x80000000,0x80000000,0x80000000,0x80008000,0x8000,0x8000,0x8000
.long 0x80000000,0x80000000,0x80000000,0x80008000,0x80008000,0x8000,0x0,0x0
.long 0x80000000,0x80000000,0x80008000,0x8000,0x80008000,0x8000,0x80000000,0x80000000
.long 0x80000000,0x80008000,0x8000,0x0,0x80008000,0x0,0x80000000,0x8000
.long 0x80000000,0x80008000,0x0,0x80000000,0x80008000,0x0,0x80008000,0x0
.long 0x80000000,0x80008000,0x80000000,0x80008000,0x80008000,0x80000000,0x8000,0x80000000
.long 0x80003f80,0x80003f80,0x80003f80,0x80003f80,0xbf733e9e,0xbf80248d,0xbf73be9e,0xbf4fbf16
.long 0xbf16bf4f,0xa50dbf80,0x3f16bf4f,0x3f73be9e,0x3f16bf4f,0x3f80a554,0x3f163f4f,0xbe9e3f73
.long 0x3f733e9e,0x80003f80,0xbf733e9e,0xbf16bf4f,0x80003f80,0xbf80248d,0xa50dbf80,0x3f80a554
.long 0xbf733e9e,0xa50dbf80,0x3f733e9e,0xbf163f4f,0xbf16bf4f,0x3f80a554,0xbf163f4f,0xbe9ebf73
.long 0x3f16bf4f,0x80003f80,0xbf16bf4f,0x3f733e9e,0x3f733e9e,0xbf80248d,0x3f73be9e,0xbf4f3f16
.long 0x80003f80,0xa50dbf80,0x80003f80,0xa50dbf80,0xbf733e9e,0x3f80a554,0xbf73be9e,0x3f4f3f16
.long 0xbf16bf4f,0x80003f80,0x3f16bf4f,0xbf733e9e,0x3f16bf4f,0xbf80248d,0x3f163f4f,0x3e9ebf73
.long 0x3f733e9e,0xa50dbf80,0xbf733e9e,0x3f163f4f,0x80003f80,0x3f80a554,0xa50dbf80,0xbf80248d
.long 0xbf733e9e,0x80003f80,0x3f733e9e,0x3f16bf4f,0xbf16bf4f,0xbf80248d,0xbf163f4f,0x3e9e3f73
.long 0x3f16bf4f,0xa50dbf80,0xbf16bf4f,0xbf73be9e,0x3f733e9e,0x3f80a554,0x3f73be9e,0x3f4fbf16
.long 0x80000000,0x80000000,0x80000000,0x80000000,0x80000000,0x80000000,0x80008000,0x80008000
.long 0x80008000,0x80008000,0x8000,0x8000,0x8000,0x8000,0x0,0x80000000
.long 0x0,0x80000000,0x80000000,0x80008000,0x80000000,0x80000000,0x80008000,0x8000
.long 0x80000000,0x80008000,0x0,0x80000000,0x80008000,0x8000,0x80000000,0x80008000
.long 0x8000,0x80000000,0x80008000,0x0,0x0,0x80000000,0x8000,0x80000000
.long 0x80000000,0x80008000,0x80000000,0x80008000,0x80000000,0x8000,0x80008000,0x0
.long 0x80003f80,0x80003f80,0x80003f80,0x80003f80,0x3f73be9e,0x3f80a554,0x3f733e9e,0x3f4f3f16
.long 0xbf16bf4f,0xa50dbf80,0x3f16bf4f,0x3f73be9e,0xbf163f4f,0xbf80248d,0xbf16bf4f,0x3e9ebf73
.long 0x3f733e9e,0x80003f80,0xbf733e9e,0xbf16bf4f,0xa50dbf80,0x3f80a554,0x80003f80,0xbf80248d
.long 0xbf733e9e,0xa50dbf80,0x3f733e9e,0xbf163f4f,0x3f163f4f,0xbf80248d,0x3f16bf4f,0x3e9e3f73
.long 0x3f16bf4f,0x80003f80,0xbf16bf4f,0x3f733e9e,0xbf73be9e,0x3f80a554,0xbf733e9e,0x3f4fbf16
.long 0x80003f80,0xa50dbf80,0x80003f80,0xa50dbf80,0x3f73be9e,0xbf80248d,0x3f733e9e,0xbf4fbf16
.long 0xbf16bf4f,0x80003f80,0x3f16bf4f,0xbf733e9e,0xbf163f4f,0x3f80a554,0xbf16bf4f,0xbe9e3f73
.long 0x3f733e9e,0xa50dbf80,0xbf733e9e,0x3f163f4f,0xa50dbf80,0xbf80248d,0x80003f80,0x3f80a554
.long 0xbf733e9e,0x80003f80,0x3f733e9e,0x3f16bf4f,0x3f163f4f,0x3f80a554,0x3f16bf4f,0xbe9ebf73
.long 0x3f16bf4f,0xa50dbf80,0xbf16bf4f,0xbf73be9e,0xbf73be9e,0xbf80248d,0xbf733e9e,0xbf4f3f16
.long 0x80000000,0x80000000,0x80000000,0x80000000,0x8000,0x8000,0x0,0x0
.long 0x80008000,0x80008000,0x8000,0x8000,0x80000000,0x80000000,0x80008000,0x8000
.long 0x0,0x80000000,0x80000000,0x80008000,0x80008000,0x8000,0x80000000,0x80000000
.long 0x80000000,0x80008000,0x0,0x80000000,0x0,0x80000000,0x8000,0x0
.long 0x8000,0x80000000,0x80008000,0x0,0x80008000,0x8000,0x80000000,0x8000
.long 0x80000000,0x80008000,0x80000000,0x80008000,0x8000,0x80000000,0x0,0x80008000
.long 0x3f800000,0x3f800000,0x3f800000,0x3f800000,0x3f800000,0x3f733e9e,0x3f4f3f16,0x3f163f4f
.long 0x3f800000,0x3f4f3f16,0x3e9e3f73,0xbe9e3f73,0x3f800000,0x3f163f4f,0xbe9e3f73,0xbf733e9e
.long 0x3f800000,0x3e9e3f73,0xbf4f3f16,0xbf4fbf16,0x3f800000,0x248d3f80,0xbf80250d,0xa554bf80
.long 0x3f800000,0xbe9e3f73,0xbf4fbf16,0x3f4fbf16,0x3f800000,0xbf163f4f,0xbe9ebf73,0x3f733e9e
.long 0x3f800000,0xbf4f3f16,0x3e9ebf73,0x3e9e3f73,0x3f800000,0xbf733e9e,0x3f4fbf16,0xbf163f4f
.long 0x3f800000,0xbf80250d,0x3f800000,0xbf80250d,0x3f800000,0xbf73be9e,0x3f4f3f16,0xbf16bf4f
.long 0x3f800000,0xbf4fbf16,0x3e9e3f73,0x3e9ebf73,0x3f800000,0xbf16bf4f,0xbe9e3f73,0x3f73be9e
.long 0x3f800000,0xbe9ebf73,0xbf4f3f16,0x3f4f3f16,0x3f800000,0xa554bf80,0xbf80250d,0x248d3f80
.long 0x3f800000,0x3e9ebf73,0xbf4fbf16,0xbf4f3f16,0x3f800000,0x3f16bf4f,0xbe9ebf73,0xbf73be9e
.long 0x3f800000,0x3f4fbf16,0x3e9ebf73,0xbe9ebf73,0x3f800000,0x3f73be9e,0x3f4fbf16,0x3f16bf4f
.long 0x0,0x0,0x0,0x0,0x0,0x0,0x0,0x0
.long 0x0,0x0,0x0,0x80000000,0x0,0x0,0x80000000,0x80000000
.long 0x0,0x0,0x80000000,0x80008000,0x0,0x0,0x80000000,0x80008000
.long 0x0,0x80000000,0x80008000,0x8000,0x0,0x80000000,0x80008000,0x0
.long 0x0,0x80000000,0x8000,0x0,0x0,0x80000000,0x8000,0x80000000
.long 0x0,0x80000000,0x0,0x80000000,0x0,0x80008000,0x0,0x80008000
.long 0x3f800000,0x3f800000,0x3f800000,0x3f800000,0xbf80250d,0xbf73be9e,0xbf4fbf16,0xbf16bf4f
.long 0x3f800000,0x3f4f3f16,0x3e9e3f73,0xbe9e3f73,0xbf80250d,0xbf16bf4f,0x3e9ebf73,0x3f73be9e
.long 0x3f800000,0x3e9e3f73,0xbf4f3f16,0xbf4fbf16,0xbf80250d,0xa554bf80,0x3f800000,0x248d3f80
.long 0x3f800000,0xbe9e3f73,0xbf4fbf16,0x3f4fbf16,0xbf80250d,0x3f16bf4f,0x3e9e3f73,0xbf73be9e
.long 0x3f800000,0xbf4f3f16,0x3e9ebf73,0x3e9e3f73,0xbf80250d,0x3f73be9e,0xbf4f3f16,0x3f16bf4f
.long 0x3f800000,0xbf80250d,0x3f800000,0xbf80250d,0xbf80250d,0x3f733e9e,0xbf4fbf16,0x3f163f4f
.long 0x3f800000,0xbf4fbf16,0x3e9e3f73,0x3e9ebf73,0xbf80250d,0x3f163f4f,0x3e9ebf73,0xbf733e9e
.long 0x3f800000,0xbe9ebf73,0xbf4f3f16,0x3f4f3f16,0xbf80250d,0x248d3f80,0x3f800000,0xa554bf80
.long 0x3f800000,0x3e9ebf73,0xbf4fbf16,0xbf4f3f16,0xbf80250d,0xbf163f4f,0x3e9e3f73,0x3f733e9e
.long 0x3f800000,0x3f4fbf16,0x3e9ebf73,0xbe9ebf73,0xbf80250d,0xbf733e9e,0xbf4f3f16,0xbf163f4f
.long 0x0,0x0,0x0,0x0,0x80000000,0x80008000,0x80008000,0x80008000
.long 0x0,0x0,0x0,0x80000000,0x80000000,0x80008000,0x8000,0x8000
.long 0x0,0x0,0x80000000,0x80008000,0x80000000,0x80008000,0x0,0x0
.long 0x0,0x80000000,0x80008000,0x8000,0x80000000,0x8000,0x0,0x80008000
.long 0x0,0x80000000,0x8000,0x0,0x80000000,0x8000,0x80000000,0x8000
.long 0x0,0x80000000,0x0,0x80000000,0x80000000,0x0,0x80008000,0x0
.long 0x3f800000,0x3f800000,0x3f800000,0x3f800000,0x3e9e3f73,0x248d3f80,0xbe9e3f73,0xbf163f4f
.long 0xbf4f3f16,0xbf80250d,0xbf4fbf16,0xbe9ebf73,0xbf4fbf16,0xa554bf80,0x3f4fbf16,0x3f733e9e
.long 0x3e9ebf73,0x3f800000,0x3e9e3f73,0xbf4f3f16,0x3f800000,0x248d3f80,0xbf80250d,0xa554bf80
.long 0x3e9e3f73,0xbf80250d,0x3e9ebf73,0x3f4f3f16,0xbf4f3f16,0xa554bf80,0x3f4f3f16,0xbf733e9e
.long 0xbf4fbf16,0x3f800000,0xbf4f3f16,0x3e9ebf73,0x3e9ebf73,0x248d3f80,0xbe9ebf73,0x3f163f4f
.long 0x3f800000,0xbf80250d,0x3f800000,0xbf80250d,0x3e9e3f73,0xa554bf80,0xbe9e3f73,0x3f16bf4f
.long 0xbf4f3f16,0x3f800000,0xbf4fbf16,0x3e9e3f73,0xbf4fbf16,0x248d3f80,0x3f4fbf16,0xbf73be9e
.long 0x3e9ebf73,0xbf80250d,0x3e9e3f73,0x3f4fbf16,0x3f800000,0xa554bf80,0xbf80250d,0x248d3f80
.long 0x3e9e3f73,0x3f800000,0x3e9ebf73,0xbf4fbf16,0xbf4f3f16,0x248d3f80,0x3f4f3f16,0x3f73be9e
.long 0xbf4fbf16,0xbf80250d,0xbf4f3f16,0xbe9e3f73,0x3e9ebf73,0xa554bf80,0xbe9ebf73,0xbf16bf4f
.long 0x0,0x0,0x0,0x0,0x0,0x0,0x80000000,0x80000000
.long 0x80000000,0x80000000,0x80008000,0x80008000,0x80008000,0x80008000,0x8000,0x0
.long 0x8000,0x0,0x0,0x80000000,0x0,0x0,0x80000000,0x80008000
.long 0x0,0x80000000,0x8000,0x0,0x80000000,0x80008000,0x0,0x80000000
.long 0x80008000,0x0,0x80000000,0x8000,0x8000,0x0,0x80008000,0x0
.long 0x0,0x80000000,0x0,0x80000000,0x0,0x80008000,0x80000000,0x8000
.long 0x3f800000,0x3f800000,0x3f800000,0x3f800000,0xbe9ebf73,0xa554bf80,0x3e9ebf73,0x3f16bf4f
.long 0xbf4f3f16,0xbf80250d,0xbf4fbf16,0xbe9ebf73,0x3f4f3f16,0x248d3f80,0xbf4f3f16,0xbf73be9e
.long 0x3e9ebf73,0x3f800000,0x3e9e3f73,0xbf4f3f16,0xbf80250d,0xa554bf80,0x3f800000,0x248d3f80
.long 0x3e9e3f73,0xbf80250d,0x3e9ebf73,0x3f4f3f16,0x3f4fbf16,0x248d3f80,0xbf4fbf16,0x3f73be9e
.long 0xbf4fbf16,0x3f800000,0xbf4f3f16,0x3e9ebf73,0xbe9e3f73,0xa554bf80,0x3e9e3f73,0xbf16bf4f
.long 0x3f800000,0xbf80250d,0x3f800000,0xbf80250d,0xbe9ebf73,0x248d3f80,0x3e9ebf73,0xbf163f4f
.long 0xbf4f3f16,0x3f800000,0xbf4fbf16,0x3e9e3f73,0x3f4f3f16,0xa554bf80,0xbf4f3f16,0x3f733e9e
.long 0x3e9ebf73,0xbf80250d,0x3e9e3f73,0x3f4fbf16,0xbf80250d,0x248d3f80,0x3f800000,0xa554bf80
.long 0x3e9e3f73,0x3f800000,0x3e9ebf73,0xbf4fbf16,0x3f4fbf16,0xa554bf80,0xbf4fbf16,0xbf733e9e
.long 0xbf4fbf16,0xbf80250d,0xbf4f3f16,0xbe9e3f73,0xbe9e3f73,0x248d3f80,0x3e9e3f73,0x3f163f4f
.long 0x0,0x0,0x0,0x0,0x80008000,0x80008000,0x8000,0x8000
.long 0x80000000,0x80000000,0x80008000,0x80008000,0x0,0x0,0x80000000,0x80008000
.long 0x8000,0x0,0x0,0x80000000,0x80000000,0x80008000,0x0,0x0
.long 0x0,0x80000000,0x8000,0x0,0x8000,0x0,0x80008000,0x8000
.long 0x80008000,0x0,0x80000000,0x8000,0x80000000,0x80008000,0x0,0x80008000
.long 0x0,0x80000000,0x0,0x80000000,0x80008000,0x0,0x8000,0x80000000
.long 0x80003f80,0x80003f80,0x3f800000,0x3f800000,0xbf16bf4f,0xbe9ebf73,0xbf4f3f16,0xbf733e9e
.long 0x3f733e9e,0x3f163f4f,0x3e9ebf73,0x3f4fbf16,0xbf733e9e,0xbf4fbf16,0x3e9e3f73,0xbf163f4f
.long 0x3f16bf4f,0x3f733e9e,0xbf4fbf16,0x3e9ebf73,0x80003f80,0xbf80248d,0x3f800000,0x248d3f80
.long 0xbf16bf4f,0x3f73be9e,0xbf4f3f16,0xbe9ebf73,0x3f733e9e,0xbf4f3f16,0x3e9ebf73,0x3f163f4f
.long 0xbf733e9e,0x3f16bf4f,0x3e9e3f73,0xbf4fbf16,0x3f16bf4f,0xbe9e3f73,0xbf4fbf16,0x3f733e9e
.long 0x80003f80,0xa50dbf80,0x3f800000,0xbf80250d,0xbf16bf4f,0x3e9e3f73,0xbf4f3f16,0x3f73be9e
.long 0x3f733e9e,0xbf16bf4f,0x3e9ebf73,0xbf4f3f16,0xbf733e9e,0x3f4f3f16,0x3e9e3f73,0x3f16bf4f
.long 0x3f16bf4f,0xbf73be9e,0xbf4fbf16,0xbe9e3f73,0x80003f80,0x3f80a554,0x3f800000,0xa554bf80
.long 0xbf16bf4f,0xbf733e9e,0xbf4f3f16,0x3e9e3f73,0x3f733e9e,0x3f4fbf16,0x3e9ebf73,0xbf16bf4f
.long 0xbf733e9e,0xbf163f4f,0x3e9e3f73,0x3f4f3f16,0x3f16bf4f,0x3e9ebf73,0xbf4fbf16,0xbf73be9e
.long 0x80000000,0x80000000,0x0,0x0,0x80008000,0x80008000,0x80000000,0x80000000
.long 0x0,0x0,0x8000,0x8000,0x80000000,0x80008000,0x0,0x80000000
.long 0x8000,0x0,0x80008000,0x8000,0x80000000,0x80000000,0x0,0x0
.long 0x80008000,0x8000,0x80000000,0x80008000,0x0,0x80000000,0x8000,0x0
.long 0x80000000,0x8000,0x0,0x80008000,0x8000,0x80000000,0x80008000,0x0
.long 0x80000000,0x80008000,0x0,0x80000000,0x80008000,0x0,0x80000000,0x8000
.long 0x80003f80,0x80003f80,0x3f800000,0x3f800000,0x3f163f4f,0x3e9e3f73,0x3f4fbf16,0x3f73be9e
.long 0x3f733e9e,0x3f163f4f,0x3e9ebf73,0x3f4fbf16,0x3f73be9e,0x3f4f3f16,0xbe9ebf73,0x3f16bf4f
.long 0x3f16bf4f,0x3f733e9e,0xbf4fbf16,0x3e9ebf73,0xa50dbf80,0x3f80a554,0xbf80250d,0xa554bf80
.long 0xbf16bf4f,0x3f73be9e,0xbf4f3f16,0xbe9ebf73,0xbf73be9e,0x3f4fbf16,0xbe9e3f73,0xbf16bf4f
.long 0xbf733e9e,0x3f16bf4f,0x3e9e3f73,0xbf4fbf16,0xbf163f4f,0x3e9ebf73,0x3f4f3f16,0xbf73be9e
.long 0x80003f80,0xa50dbf80,0x3f800000,0xbf80250d,0x3f163f4f,0xbe9ebf73,0x3f4fbf16,0xbf733e9e
.long 0x3f733e9e,0xbf16bf4f,0x3e9ebf73,0xbf4f3f16,0x3f73be9e,0xbf4fbf16,0xbe9ebf73,0xbf163f4f
.long 0x3f16bf4f,0xbf73be9e,0xbf4fbf16,0xbe9e3f73,0xa50dbf80,0xbf80248d,0xbf80250d,0x248d3f80
.long 0xbf16bf4f,0xbf733e9e,0xbf4f3f16,0x3e9e3f73,0xbf73be9e,0xbf4f3f16,0xbe9e3f73,0x3f163f4f
.long 0xbf733e9e,0xbf163f4f,0x3e9e3f73,0x3f4f3f16,0xbf163f4f,0xbe9e3f73,0x3f4f3f16,0x3f733e9e
.long 0x80000000,0x80000000,0x0,0x0,0x0,0x0,0x8000,0x8000
.long 0x0,0x0,0x8000,0x8000,0x8000,0x0,0x80008000,0x8000
.long 0x8000,0x0,0x80008000,0x8000,0x80008000,0x8000,0x80000000,0x80008000
.long 0x80008000,0x8000,0x80000000,0x80008000,0x80008000,0x8000,0x80000000,0x80008000
.long 0x80000000,0x8000,0x0,0x80008000,0x80000000,0x8000,0x0,0x80008000
.long 0x80000000,0x80008000,0x0,0x80000000,0x0,0x80008000,0x8000,0x80000000
.long 0x354ccccd,0x354ccccd,0x354ccccd,0x354ccccd,0x354ccccd,0x354cca46,0x354cc2b2,0x354cb610
.long 0x354ccccd,0x354cc2b2,0x354ca461,0x354c71de,0x354ccccd,0x354cb610,0x354c71de,0x354c0047
.long 0x354ccccd,0x354ca461,0x354c2b2e,0x354b6163,0x354ccccd,0x354c8da6,0x354bd057,0x354a9556
.long 0x354ccccd,0x354c71de,0x354b6163,0x35499c4e,0x354ccccd,0x354c510b,0x354ade5d,0x35487681
.long 0x354ccccd,0x354c2b2e,0x354a4751,0x35472430,0x354ccccd,0x354c0047,0x35499c4e,0x3545a5a8
.long 0x354ccccd,0x354bd057,0x3548dd65,0x3543fb3c,0x354ccccd,0x354b9b60,0x35480aaa,0x3542254b
.long 0x354ccccd,0x354b6163,0x35472430,0x3540243f,0x354ccccd,0x354b2261,0x35462a0f,0x353df888
.long 0x354ccccd,0x354ade5d,0x35451c60,0x353ba2a3,0x354ccccd,0x354a9556,0x3543fb3c,0x35392313
.long 0x354ccccd,0x354a4751,0x3542c6c0,0x35367a67,0x354ccccd,0x3549f44d,0x35417f0c,0x3533a936
.long 0x354ccccd,0x35499c4e,0x3540243f,0x3530b021,0x354ccccd,0x35493f55,0x353eb67b,0x352d8fd0
.long 0x0,0x0,0x0,0x0,0x0,0x0,0x0,0x0
.long 0x0,0x0,0x0,0x0,0x0,0x0,0x0,0x0
.long 0x0,0x0,0x0,0x0,0x0,0x0,0x0,0x0
.long 0x0,0x0,0x0,0x0,0x0,0x0,0x0,0x0
.long 0x0,0x0,0x0,0x0,0x0,0x0,0x0,0x0
.long 0x0,0x0,0x0,0x0,0x0,0x0,0x0,0x0
.long 0x354ccccd,0x354ccccd,0x354ccccd,0x354ccccd,0x354ca461,0x354c8da6,0x354c71de,0x354c510b
.long 0x354c2b2e,0x354bd057,0x354b6163,0x354ade5d,0x354b6163,0x354a9556,0x35499c4e,0x35487681
.long 0x354a4751,0x3548dd65,0x35472430,0x35451c60,0x3548dd65,0x3546a993,0x3543fb3c,0x3540d407
.long 0x35472430,0x3543fb3c,0x3540243f,0x353ba2a3,0x35451c60,0x3540d407,0x353ba2a3,0x35358e7a
.long 0x3542c6c0,0x353d35e5,0x35367a67,0x352e9ee7,0x3540243f,0x35392313,0x3530b021,0x3526dc49
.long 0x353d35e5,0x35349e13,0x352a48f4,0x351e5003,0x3539fcdb,0x352fa9af,0x35234a91,0x35150468
.long 0x35367a67,0x352a48f4,0x351bbb2c,0x350b04b5,0x3532afeb,0x35247f35,0x3513a17d,0x35005d00
.long 0x352e9ee7,0x351e5003,0x350b04b5,0x34ea3450,0x352a48f4,0x3517bf2e,0x3501ec7b,0x34d29394
.long 0x3525afca,0x3510d0c3,0x34f0c1c0,0x34b9f45b,0x3520d539,0x35098908,0x34dcd4c0,0x34a07465
.long 0x351bbb2c,0x3501ec7b,0x34c823a7,0x34863284,0x351663a6,0x34f3ff99,0x34b2c0d3,0x34569ce7
.long 0x0,0x0,0x0,0x0,0x0,0x0,0x0,0x0
.long 0x0,0x0,0x0,0x0,0x0,0x0,0x0,0x80000000
.long 0x0,0x0,0x0,0x80000000,0x0,0x0,0x0,0x80000000
.long 0x0,0x0,0x0,0x80000000,0x0,0x0,0x80000000,0x80000000
.long 0x0,0x0,0x80000000,0x80000000,0x0,0x0,0x80000000,0x80000000
.long 0x0,0x0,0x80000000,0x80000000,0x0,0x0,0x80000000,0x80000000
.long 0x354ccccd,0x354ccccd,0x354ccccd,0x354ccccd,0x354c2b2e,0x354c0047,0x354bd057,0x354b9b60
.long 0x354a4751,0x35499c4e,0x3548dd65,0x35480aaa,0x35472430,0x3545a5a8,0x3543fb3c,0x3542254b
.long 0x3542c6c0,0x3540243f,0x353d35e5,0x3539fcdb,0x353d35e5,0x35392313,0x35349e13,0x352fa9af
.long 0x35367a67,0x3530b021,0x352a48f4,0x35234a91,0x352e9ee7,0x3526dc49,0x351e5003,0x35150468
.long 0x3525afca,0x351bbb2c,0x3510d0c3,0x350501c8,0x351bbb2c,0x350f6305,0x3501ec7b,0x34e6e4e3
.long 0x3510d0c3,0x3501ec7b,0x34e38fc3,0x34c11588,0x350501c8,0x34e6e4e3,0x34c11588,0x34990646
.long 0x34f0c1c0,0x34c823a7,0x349cbf44,0x345e5d30,0x34d603f2,0x34a7d2ae,0x346dcd1c,0x34081699
.long 0x34b9f45b,0x34863284,0x341fd168,0x3340e869,0x349cbf44,0x34470ca3,0x33a0975e,0xb320c8f3
.long 0x347d2590,0x340026af,0x1a61e84f,0xb40026af,0x343f3d0b,0x3361031c,0xb3a0975e,0xb4569ce7
.long 0x340026af,0xb280abdf,0xb41fd168,0xb4954980,0x33808c21,0xb3b0973e,0xb46dcd1c,0xb4bd8748
.long 0x0,0x80000000,0x80000000,0x80000000,0x80000000,0x80000000,0x80000000,0x80000000
.long 0x80000000,0x80000000,0x80000000,0x80000000,0x80000000,0x80000000,0x80000000,0x80000000
.long 0x80000000,0x80000000,0x80000000,0x80000000,0x80000000,0x80000000,0x80000000,0x80000000
.long 0x80000000,0x80000000,0x80000000,0x80000000,0x80000000,0x80000000,0x80000000,0x80000000
.long 0x80000000,0x80000000,0x80000000,0x80000000,0x80000000,0x80000000,0x80000000,0x80000000
.long 0x80000000,0x80000000,0x80000000,0x80000000,0x80000000,0x80000000,0x80000000,0x80000000
.long 0x354ccccd,0x354ccccd,0x354ccccd,0x354ccccd,0x354b6163,0x354b2261,0x354ade5d,0x354a9556
.long 0x35472430,0x35462a0f,0x35451c60,0x3543fb3c,0x3540243f,0x353df888,0x353ba2a3,0x35392313
.long 0x35367a67,0x3532afeb,0x352e9ee7,0x352a48f4,0x352a48f4,0x35247f35,0x351e5003,0x3517bf2e
.long 0x351bbb2c,0x3513a17d,0x350b04b5,0x3501ec7b,0x350b04b5,0x35005d00,0x34ea3450,0x34d29394
.long 0x34f0c1c0,0x34d603f2,0x34b9f45b,0x349cbf44,0x34c823a7,0x34a7d2ae,0x34863284,0x34470ca3
.long 0x349cbf44,0x346dcd1c,0x341fd168,0x33a0975e,0x345e5d30,0x34081699,0x3340e869,0xb320c8f3
.long 0x340026af,0x3300a585,0xb3808c21,0xb41fd168,0x3300a585,0xb3909388,0xb42f8fe3,0xb489fd76
.long 0xb3808c21,0xb42f8fe3,0xb48dc501,0xb4c11588,0xb41fd168,0xb489fd76,0xb4c11588,0xb4f3ff99
.long 0xb47d2590,0xb4b9f45b,0xb4f0c1c0,0xb510d0c3,0xb4ab7ba8,0xb4e6e4e3,0xb50df1bd,0xb5247f35
.long 0xb4d603f2,0xb50809f5,0xb520d539,0xb5349e13,0xb4fd94b5,0xb51a6af9,0xb530b021,0xb540d407
.long 0x80000000,0x80000000,0x80000000,0x80000000,0x80000000,0x80000000,0x80000000,0x80000000
.long 0x80000000,0x80000000,0x80000000,0x80000000,0x80000000,0x80000000,0x80000000,0x80000000
.long 0x80000000,0x80000000,0x80000000,0x80000000,0x80000000,0x80000000,0x80000000,0x80000000
.long 0x80000000,0x80000000,0x80000000,0x80000000,0x80000000,0x80000000,0x80000000,0x80000000
.long 0x80000000,0x80000000,0x80000000,0x80000000,0x80000000,0x80000000,0x80000000,0x80000000
.long 0x80000000,0x80000000,0x80000000,0x80000000,0x80000000,0x80000000,0x80000000,0x80000000
.long 0x354ccccd,0x354ccccd,0x354ccccd,0x354ccccd,0x354a4751,0x3549f44d,0x35499c4e,0x35493f55
.long 0x3542c6c0,0x35417f0c,0x3540243f,0x353eb67b,0x35367a67,0x3533a936,0x3530b021,0x352d8fd0
.long 0x3525afca,0x3520d539,0x351bbb2c,0x351663a6,0x3510d0c3,0x35098908,0x3501ec7b,0x34f3ff99
.long 0x34f0c1c0,0x34dcd4c0,0x34c823a7,0x34b2c0d3,0x34b9f45b,0x34a07465,0x34863284,0x34569ce7
.long 0x347d2590,0x343f3d0b,0x340026af,0x33808c21,0x340026af,0x3361031c,0xb280abdf,0xb3b0973e
.long 0x1a61e84f,0xb3a0975e,0xb41fd168,0xb46dcd1c,0xb40026af,0xb4569ce7,0xb4954980,0xb4bd8748
.long 0xb47d2590,0xb4ab7ba8,0xb4d603f2,0xb4fd94b5,0xb4b9f45b,0xb4e6e4e3,0xb50809f5,0xb51a6af9
.long 0xb4f0c1c0,0xb50df1bd,0xb520d539,0xb530b021,0xb510d0c3,0xb5247f35,0xb5349e13,0xb540d407
.long 0xb525afca,0xb5367a67,0xb542c6c0,0xb54a4751,0xb5367a67,0xb5436367,0xb54ade5d,0xb54cb610
.long 0xb542c6c0,0xb54ade5d,0xb54ca461,0xb5480aaa,0xb54a4751,0xb54cb610,0xb5480aaa,0xb53c6e97
.long 0x80000000,0x80000000,0x80000000,0x80000000,0x80000000,0x80000000,0x80000000,0x80000000
.long 0x80000000,0x80000000,0x80000000,0x80000000,0x80000000,0x80000000,0x80000000,0x80000000
.long 0x80000000,0x80000000,0x80000000,0x80000000,0x80000000,0x80000000,0x80000000,0x80000000
.long 0x80000000,0x80000000,0x80000000,0x0,0x80000000,0x80000000,0x0,0x0
.long 0x80000000,0x80000000,0x0,0x0,0x80000000,0x0,0x0,0x0
.long 0x80000000,0x0,0x0,0x0,0x0,0x0,0x0,0x0
.long 0x354ccccd,0x354ccccd,0x354ccccd,0x354ccccd,0x3548dd65,0x35487681,0x35480aaa,0x354799e3
.long 0x353d35e5,0x353ba2a3,0x3539fcdb,0x353844b9,0x352a48f4,0x3526dc49,0x35234a91,0x351f9496
.long 0x3510d0c3,0x350b04b5,0x350501c8,0x34fd94b5,0x34e38fc3,0x34d29394,0x34c11588,0x34af2067
.long 0x349cbf44,0x34863284,0x345e5d30,0x342f8fe3,0x341fd168,0x33d08986,0x3340e869,0xb200ad75
.long 0x1a61e84f,0xb3808c21,0xb40026af,0xb43f3d0b,0xb41fd168,0xb46617fd,0xb4954980,0xb4b65cd7
.long 0xb49cbf44,0xb4c11588,0xb4e38fc3,0xb501ec7b,0xb4e38fc3,0xb50378c1,0xb513a17d,0xb52211e5
.long 0xb510d0c3,0xb520d539,0xb52e9ee7,0xb539fcdb,0xb52a48f4,0xb53761d3,0xb5417f0c,0xb5487681
.long 0xb53d35e5,0xb5462a0f,0xb54b6163,0xb54cc2b2,0xb548dd65,0xb54c8da6,0xb54bd057,0xb546a993
.long 0xb54ccccd,0xb54a4751,0xb542c6c0,0xb5367a67,0xb548dd65,0xb53f6fba,0xb530b021,0xb51d0787
.long 0xb53d35e5,0xb52c7c70,0xb51663a6,0xb4f7376d,0xb52a48f4,0xb5123aee,0xb4ea3450,0xb4a7d2ae
.long 0x80000000,0x80000000,0x80000000,0x80000000,0x80000000,0x80000000,0x80000000,0x0
.long 0x80000000,0x80000000,0x0,0x0,0x80000000,0x0,0x0,0x0
.long 0x80000000,0x0,0x0,0x0,0x0,0x0,0x0,0x0
.long 0x0,0x0,0x0,0x0,0x0,0x0,0x0,0x0
.long 0x0,0x0,0x0,0x0,0x0,0x0,0x0,0x0
.long 0x0,0x0,0x0,0x0,0x0,0x0,0x0,0x0
.long 0x354ccccd,0x354ccccd,0x354ccccd,0x354ccccd,0x35472430,0x3546a993,0x35462a0f,0x3545a5a8
.long 0x35367a67,0x35349e13,0x3532afeb,0x3530b021,0x351bbb2c,0x3517bf2e,0x3513a17d,0x350f6305
.long 0x34f0c1c0,0x34e38fc3,0x34d603f2,0x34c823a7,0x349cbf44,0x3489fd76,0x346dcd1c,0x34470ca3
.long 0x340026af,0x33a0975e,0x3300a585,0xb280abdf,0xb3808c21,0xb3f06739,0xb42f8fe3,0xb46617fd
.long 0xb47d2590,0xb49cbf44,0xb4b9f45b,0xb4d603f2,0xb4d603f2,0xb4f3ff99,0xb50809f5,0xb5150468
.long 0xb510d0c3,0xb51e5003,0xb52a48f4,0xb5349e13,0xb52e9ee7,0xb5392313,0xb5417f0c,0xb54799e3
.long 0xb542c6c0,0xb548dd65,0xb54c2b2e,0xb54ca461,0xb54c2b2e,0xb54c8da6,0xb5499c4e,0xb5436367
.long 0xb54a4751,0xb543fb3c,0xb539fcdb,0xb52c7c70,0xb53d35e5,0xb52fa9af,0xb51e5003,0xb5098908
.long 0xb525afca,0xb510d0c3,0xb4f0c1c0,0xb4b9f45b,0xb50501c8,0xb4d29394,0xb4954980,0xb427b2b7
.long 0xb4b9f45b,0xb46dcd1c,0xb3c092c2,0x3340e869,0xb43f3d0b,0xb320c8f3,0x33e07b24,0x34826442
.long 0x80000000,0x0,0x0,0x0,0x0,0x0,0x0,0x0
.long 0x0,0x0,0x0,0x0,0x0,0x0,0x0,0x0
.long 0x0,0x0,0x0,0x0,0x0,0x0,0x0,0x0
.long 0x0,0x0,0x0,0x0,0x0,0x0,0x0,0x0
.long 0x0,0x0,0x0,0x0,0x0,0x0,0x0,0x0
.long 0x0,0x0,0x0,0x80000000,0x0,0x0,0x80000000,0x80000000
.long 0x354ccccd,0x354ccccd,0x354ccccd,0x354ccccd,0x35451c60,0x35448e3a,0x3543fb3c,0x35436367
.long 0x352e9ee7,0x352c7c70,0x352a48f4,0x352804aa,0x350b04b5,0x35068788,0x3501ec7b,0x34fa6928
.long 0x34b9f45b,0x34ab7ba8,0x349cbf44,0x348dc501,0x341fd168,0x33f06739,0x33a0975e,0x3320c8f3
.long 0xb3808c21,0xb3e07b24,0xb41fd168,0xb44ed752,0xb48dc501,0xb4a7d2ae,0xb4c11588,0xb4d96f08
.long 0xb4f0c1c0,0xb50501c8,0xb510d0c3,0xb51bbb2c,0xb520d539,0xb52b64d0,0xb5349e13,0xb53c6e97
.long 0xb53d35e5,0xb543fb3c,0xb548dd65,0xb54bd057,0xb54b6163,0xb54cca46,0xb54bd057,0xb5487681
.long 0xb54a4751,0xb5451c60,0xb53d35e5,0xb532afeb,0xb539fcdb,0xb52d8fd0,0xb51e5003,0xb50c7cf5
.long 0xb51bbb2c,0xb50809f5,0xb4e38fc3,0xb4b2c0d3,0xb4e38fc3,0xb4af2067,0xb46dcd1c,0xb3f06739
.long 0xb47d2590,0xb40026af,0x9b296e3c,0x340026af,0xb300a585,0x33d08986,0x346dcd1c,0x34b65cd7
.long 0x343f3d0b,0x34a42590,0x34e38fc3,0x350df1bd,0x34c823a7,0x350378c1,0x351e5003,0x3533a936
.long 0x0,0x0,0x0,0x0,0x0,0x0,0x0,0x0
.long 0x0,0x0,0x0,0x0,0x0,0x0,0x0,0x0
.long 0x0,0x0,0x0,0x0,0x0,0x0,0x0,0x0
.long 0x0,0x0,0x0,0x80000000,0x0,0x0,0x80000000,0x80000000
.long 0x0,0x80000000,0x80000000,0x80000000,0x80000000,0x80000000,0x80000000,0x80000000
.long 0x80000000,0x80000000,0x80000000,0x80000000,0x80000000,0x80000000,0x80000000,0x80000000
.long 0x0,0x0,0x0,0x0,0x0,0x3200ad75,0x3280abdf,0x32c0fdd6
.long 0x0,0x3280abdf,0x3300a585,0x3340e869,0x0,0x32c0fdd6,0x3340e869,0x33909388
.long 0x0,0x3300a585,0x33808c21,0x33c092c2,0x0,0x3320c8f3,0x33a0975e,0x33f06739
.long 0x0,0x3340e869,0x33c092c2,0x34100327,0x0,0x3361031c,0x33e07b24,0x3427b2b7
.long 0x0,0x33808c21,0x340026af,0x343f3d0b,0x0,0x33909388,0x34100327,0x34569ce7
.long 0x0,0x33a0975e,0x341fd168,0x346dcd1c,0x0,0x33b0973e,0x342f8fe3,0x34826442
.long 0x0,0x33c092c2,0x343f3d0b,0x348dc501,0x0,0x33d08986,0x344ed752,0x34990646
.long 0x0,0x33e07b24,0x345e5d30,0x34a42590,0x0,0x33f06739,0x346dcd1c,0x34af2067
.long 0x0,0x340026af,0x347d2590,0x34b9f45b,0x0,0x34081699,0x34863284,0x34c49f04
.long 0x0,0x34100327,0x348dc501,0x34cf1e05,0x0,0x3417ec27,0x34954980,0x34d96f08
.long 0x0,0x0,0x0,0x0,0x0,0x0,0x0,0x0
.long 0x0,0x0,0x0,0x0,0x0,0x0,0x0,0x0
.long 0x0,0x0,0x0,0x0,0x0,0x0,0x0,0x0
.long 0x0,0x0,0x0,0x0,0x0,0x0,0x0,0x0
.long 0x0,0x0,0x0,0x0,0x0,0x0,0x0,0x0
.long 0x0,0x0,0x0,0x0,0x0,0x0,0x0,0x0
.long 0x0,0x0,0x0,0x0,0x3300a585,0x3320c8f3,0x3340e869,0x3361031c
.long 0x33808c21,0x33a0975e,0x33c092c2,0x33e07b24,0x33c092c2,0x33f06739,0x34100327,0x3427b2b7
.long 0x340026af,0x341fd168,0x343f3d0b,0x345e5d30,0x341fd168,0x34470ca3,0x346dcd1c,0x3489fd76
.long 0x343f3d0b,0x346dcd1c,0x348dc501,0x34a42590,0x345e5d30,0x3489fd76,0x34a42590,0x34bd8748
.long 0x347d2590,0x349cbf44,0x34b9f45b,0x34d603f2,0x348dc501,0x34af2067,0x34cf1e05,0x34ed7df6
.long 0x349cbf44,0x34c11588,0x34e38fc3,0x3501ec7b,0x34ab7ba8,0x34d29394,0x34f7376d,0x350c7cf5
.long 0x34b9f45b,0x34e38fc3,0x350501c8,0x351663a6,0x34c823a7,0x34f3ff99,0x350df1bd,0x351f9496
.long 0x34d603f2,0x3501ec7b,0x351663a6,0x352804aa,0x34e38fc3,0x35098908,0x351e5003,0x352fa9af
.long 0x34f0c1c0,0x3510d0c3,0x3525afca,0x35367a67,0x34fd94b5,0x3517bf2e,0x352c7c70,0x353c6e97
.long 0x350501c8,0x351e5003,0x3532afeb,0x35417f0c,0x350b04b5,0x35247f35,0x353844b9,0x3545a5a8
.long 0x0,0x0,0x0,0x0,0x0,0x0,0x0,0x0
.long 0x0,0x0,0x0,0x0,0x0,0x0,0x0,0x0
.long 0x0,0x0,0x0,0x0,0x0,0x0,0x0,0x0
.long 0x0,0x0,0x0,0x0,0x0,0x0,0x0,0x0
.long 0x0,0x0,0x0,0x0,0x0,0x0,0x0,0x0
.long 0x0,0x0,0x0,0x0,0x0,0x0,0x0,0x0
.long 0x0,0x0,0x0,0x0,0x33808c21,0x33909388,0x33a0975e,0x33b0973e
.long 0x340026af,0x34100327,0x341fd168,0x342f8fe3,0x343f3d0b,0x34569ce7,0x346dcd1c,0x34826442
.long 0x347d2590,0x348dc501,0x349cbf44,0x34ab7ba8,0x349cbf44,0x34af2067,0x34c11588,0x34d29394
.long 0x34b9f45b,0x34cf1e05,0x34e38fc3,0x34f7376d,0x34d603f2,0x34ed7df6,0x3501ec7b,0x350c7cf5
.long 0x34f0c1c0,0x350501c8,0x3510d0c3,0x351bbb2c,0x350501c8,0x35123aee,0x351e5003,0x352928e5
.long 0x3510d0c3,0x351e5003,0x352a48f4,0x35349e13,0x351bbb2c,0x352928e5,0x35349e13,0x353df888
.long 0x3525afca,0x3532afeb,0x353d35e5,0x35451c60,0x352e9ee7,0x353ad20d,0x3543fb3c,0x3549f44d
.long 0x35367a67,0x35417f0c,0x3548dd65,0x354c71de,0x353d35e5,0x3546a993,0x354bd057,0x354c8da6
.long 0x3542c6c0,0x354a4751,0x354ccccd,0x354a4751,0x35472430,0x354c510b,0x354bd057,0x3545a5a8
.long 0x354a4751,0x354cc2b2,0x3548dd65,0x353eb67b,0x354c2b2e,0x354b9b60,0x3543fb3c,0x35358e7a
.long 0x0,0x0,0x0,0x0,0x0,0x0,0x0,0x0
.long 0x0,0x0,0x0,0x0,0x0,0x0,0x0,0x0
.long 0x0,0x0,0x0,0x0,0x0,0x0,0x0,0x0
.long 0x0,0x0,0x0,0x0,0x0,0x0,0x0,0x0
.long 0x0,0x0,0x0,0x0,0x0,0x0,0x0,0x0
.long 0x0,0x0,0x0,0x80000000,0x0,0x0,0x0,0x80000000
.long 0x0,0x0,0x0,0x0,0x33c092c2,0x33d08986,0x33e07b24,0x33f06739
.long 0x343f3d0b,0x344ed752,0x345e5d30,0x346dcd1c,0x348dc501,0x34990646,0x34a42590,0x34af2067
.long 0x34b9f45b,0x34c823a7,0x34d603f2,0x34e38fc3,0x34e38fc3,0x34f3ff99,0x3501ec7b,0x35098908
.long 0x350501c8,0x350df1bd,0x351663a6,0x351e5003,0x351663a6,0x351f9496,0x352804aa,0x352fa9af
.long 0x3525afca,0x352e9ee7,0x35367a67,0x353d35e5,0x3532afeb,0x353ad20d,0x35417f0c,0x3546a993
.long 0x353d35e5,0x3543fb3c,0x3548dd65,0x354bd057,0x35451c60,0x3549f44d,0x354c71de,0x354c8da6
.long 0x354a4751,0x354ca461,0x354c2b2e,0x3548dd65,0x354ca461,0x354c0047,0x35480aaa,0x3540d407
.long 0x354c2b2e,0x35480aaa,0x3540243f,0x35349e13,0x3548dd65,0x3540d407,0x35349e13,0x35247f35
.long 0x3542c6c0,0x35367a67,0x3525afca,0x3510d0c3,0x3539fcdb,0x352928e5,0x3513a17d,0x34f3ff99
.long 0x352e9ee7,0x351916f7,0x34fd94b5,0x34c11588,0x3520d539,0x35068788,0x34cf1e05,0x3489fd76
.long 0x0,0x0,0x0,0x0,0x0,0x0,0x0,0x0
.long 0x0,0x0,0x0,0x80000000,0x0,0x0,0x80000000,0x80000000
.long 0x0,0x0,0x80000000,0x80000000,0x0,0x80000000,0x80000000,0x80000000
.long 0x0,0x80000000,0x80000000,0x80000000,0x80000000,0x80000000,0x80000000,0x80000000
.long 0x80000000,0x80000000,0x80000000,0x80000000,0x80000000,0x80000000,0x80000000,0x80000000
.long 0x80000000,0x80000000,0x80000000,0x80000000,0x80000000,0x80000000,0x80000000,0x80000000
.long 0x0,0x0,0x0,0x0,0x340026af,0x34081699,0x34100327,0x3417ec27
.long 0x347d2590,0x34863284,0x348dc501,0x34954980,0x34b9f45b,0x34c49f04,0x34cf1e05,0x34d96f08
.long 0x34f0c1c0,0x34fd94b5,0x350501c8,0x350b04b5,0x3510d0c3,0x3517bf2e,0x351e5003,0x35247f35
.long 0x3525afca,0x352c7c70,0x3532afeb,0x353844b9,0x35367a67,0x353c6e97,0x35417f0c,0x3545a5a8
.long 0x3542c6c0,0x35472430,0x354a4751,0x354c2b2e,0x354a4751,0x354c510b,0x354cc2b2,0x354b9b60
.long 0x354ccccd,0x354bd057,0x3548dd65,0x3543fb3c,0x354a4751,0x3545a5a8,0x353eb67b,0x35358e7a
.long 0x3542c6c0,0x3539fcdb,0x352e9ee7,0x3520d539,0x35367a67,0x352928e5,0x351916f7,0x35068788
.long 0x3525afca,0x3513a17d,0x34fd94b5,0x34cf1e05,0x3510d0c3,0x34f3ff99,0x34c11588,0x3489fd76
.long 0x34f0c1c0,0x34b9f45b,0x347d2590,0x340026af,0x34b9f45b,0x34757c5d,0x33e07b24,0xb2c0fdd6
.long 0x347d2590,0x33e07b24,0xb300a585,0xb42f8fe3,0x340026af,0xb2c0fdd6,0xb42f8fe3,0xb4a07465
.long 0x0,0x80000000,0x80000000,0x80000000,0x80000000,0x80000000,0x80000000,0x80000000
.long 0x80000000,0x80000000,0x80000000,0x80000000,0x80000000,0x80000000,0x80000000,0x80000000
.long 0x80000000,0x80000000,0x80000000,0x80000000,0x80000000,0x80000000,0x80000000,0x80000000
.long 0x80000000,0x80000000,0x80000000,0x80000000,0x80000000,0x80000000,0x80000000,0x80000000
.long 0x80000000,0x80000000,0x80000000,0x80000000,0x80000000,0x80000000,0x80000000,0x80000000
.long 0x80000000,0x80000000,0x80000000,0x80000000,0x80000000,0x80000000,0x80000000,0x80000000
.long 0x0,0x0,0x0,0x0,0x341fd168,0x3427b2b7,0x342f8fe3,0x343768ba
.long 0x349cbf44,0x34a42590,0x34ab7ba8,0x34b2c0d3,0x34e38fc3,0x34ed7df6,0x34f7376d,0x35005d00
.long 0x3510d0c3,0x351663a6,0x351bbb2c,0x3520d539,0x352a48f4,0x352fa9af,0x35349e13,0x35392313
.long 0x353d35e5,0x35417f0c,0x35451c60,0x35480aaa,0x3548dd65,0x354b2261,0x354c71de,0x354cca46
.long 0x354ccccd,0x354c2b2e,0x354a4751,0x35472430,0x3548dd65,0x35448e3a,0x353eb67b,0x353761d3
.long 0x353d35e5,0x35349e13,0x352a48f4,0x351e5003,0x352a48f4,0x351d0787,0x350df1bd,0x34fa6928
.long 0x3510d0c3,0x34fd94b5,0x34d603f2,0x34ab7ba8,0x34e38fc3,0x34b65cd7,0x34863284,0x3427b2b7
.long 0x349cbf44,0x344ed752,0x33c092c2,0xb280abdf,0x341fd168,0x3320c8f3,0xb3a0975e,0xb4470ca3
.long 0x1ae1e84f,0xb40026af,0xb47d2590,0xb4b9f45b,0xb41fd168,0xb491890c,0xb4cf1e05,0xb50378c1
.long 0xb49cbf44,0xb4dcd4c0,0xb50b04b5,0xb5234a91,0xb4e38fc3,0xb50f6305,0xb52804aa,0xb53ad20d
.long 0x80000000,0x80000000,0x80000000,0x80000000,0x80000000,0x80000000,0x80000000,0x80000000
.long 0x80000000,0x80000000,0x80000000,0x80000000,0x80000000,0x80000000,0x80000000,0x80000000
.long 0x80000000,0x80000000,0x80000000,0x80000000,0x80000000,0x80000000,0x80000000,0x80000000
.long 0x80000000,0x80000000,0x80000000,0x80000000,0x80000000,0x80000000,0x80000000,0x80000000
.long 0x80000000,0x80000000,0x80000000,0x0,0x80000000,0x80000000,0x80000000,0x0
.long 0x80000000,0x80000000,0x0,0x0,0x80000000,0x0,0x0,0x0
.long 0x0,0x0,0x0,0x0,0x343f3d0b,0x34470ca3,0x344ed752,0x34569ce7
.long 0x34b9f45b,0x34c11588,0x34c823a7,0x34cf1e05,0x350501c8,0x35098908,0x350df1bd,0x35123aee
.long 0x3525afca,0x352a48f4,0x352e9ee7,0x3532afeb,0x353d35e5,0x3540d407,0x3543fb3c,0x3546a993
.long 0x354a4751,0x354bd057,0x354ca461,0x354cc2b2,0x354c2b2e,0x354a9556,0x35480aaa,0x35448e3a
.long 0x3542c6c0,0x353d35e5,0x35367a67,0x352e9ee7,0x352e9ee7,0x35247f35,0x351916f7,0x350c7cf5
.long 0x3510d0c3,0x3501ec7b,0x34e38fc3,0x34c11588,0x34d603f2,0x34af2067,0x34863284,0x343768ba
.long 0x347d2590,0x341fd168,0x33808c21,0xb300a585,0x33808c21,0xb320c8f3,0xb4100327,0xb4757c5d
.long 0xb40026af,0xb46dcd1c,0xb4ab7ba8,0xb4dcd4c0,0xb49cbf44,0xb4d29394,0xb501ec7b,0xb517bf2e
.long 0xb4f0c1c0,0xb510d0c3,0xb525afca,0xb5367a67,0xb51bbb2c,0xb52fa9af,0xb53eb67b,0xb5487681
.long 0xb5367a67,0xb543fb3c,0xb54b6163,0xb54c71de,0xb5472430,0xb54c8da6,0xb54ade5d,0xb542254b
.long 0x80000000,0x80000000,0x80000000,0x80000000,0x80000000,0x80000000,0x80000000,0x80000000
.long 0x80000000,0x80000000,0x80000000,0x80000000,0x80000000,0x80000000,0x80000000,0x80000000
.long 0x80000000,0x80000000,0x80000000,0x0,0x80000000,0x80000000,0x0,0x0
.long 0x80000000,0x0,0x0,0x0,0x0,0x0,0x0,0x0
.long 0x0,0x0,0x0,0x0,0x0,0x0,0x0,0x0
.long 0x0,0x0,0x0,0x0,0x0,0x0,0x0,0x0
.long 0x0,0x0,0x0,0x0,0x345e5d30,0x346617fd,0x346dcd1c,0x34757c5d
.long 0x34d603f2,0x34dcd4c0,0x34e38fc3,0x34ea3450,0x351663a6,0x351a6af9,0x351e5003,0x352211e5
.long 0x35367a67,0x3539fcdb,0x353d35e5,0x3540243f,0x3548dd65,0x354a9556,0x354bd057,0x354c8da6
.long 0x354c2b2e,0x354ade5d,0x3548dd65,0x35462a0f,0x3540243f,0x353ad20d,0x35349e13,0x352d8fd0
.long 0x3525afca,0x351bbb2c,0x3510d0c3,0x350501c8,0x34fd94b5,0x34e03506,0x34c11588,0x34a07465
.long 0x349cbf44,0x346dcd1c,0x341fd168,0x33a0975e,0x33c092c2,0x3200ad75,0xb3a0975e,0xb427b2b7
.long 0xb40026af,0xb45e5d30,0xb49cbf44,0xb4c823a7,0xb4ab7ba8,0xb4d96f08,0xb501ec7b,0xb5150468
.long 0xb50501c8,0xb51916f7,0xb52a48f4,0xb53844b9,0xb52a48f4,0xb5392313,0xb543fb3c,0xb54a9556
.long 0xb542c6c0,0xb54a4751,0xb54ccccd,0xb54a4751,0xb54ca461,0xb54b2261,0xb543fb3c,0xb53761d3
.long 0xb5472430,0xb53ba2a3,0xb52a48f4,0xb513a17d,0xb532afeb,0xb51d0787,0xb501ec7b,0xb4c49f04
.long 0x80000000,0x80000000,0x80000000,0x80000000,0x80000000,0x80000000,0x80000000,0x0
.long 0x80000000,0x80000000,0x0,0x0,0x0,0x0,0x0,0x0
.long 0x0,0x0,0x0,0x0,0x0,0x0,0x0,0x0
.long 0x0,0x0,0x0,0x0,0x0,0x0,0x0,0x0
.long 0x0,0x0,0x0,0x0,0x0,0x0,0x0,0x0
.long 0x0,0x0,0x0,0x0,0x0,0x0,0x0,0x80000000
.long 0x3f803f80,0x3f803f80,0x0,0x0,0x3f6d3f80,0x3ec43f35,0x3ec40000,0x3f6d3f35
.long 0x3f353f80,0xbf35248d,0x3f350000,0x3f353f80,0x3ec43f80,0xbf6dbf35,0x3f6d0000,0xbec43f35
.long 0x248d3f80,0xa554bf80,0x3f800000,0xbf80250d,0xbec43f80,0x3f6dbf35,0x3f6d0000,0xbec4bf35
.long 0xbf353f80,0x3f35a554,0x3f350000,0x3f35bf80,0xbf6d3f80,0xbec43f35,0x3ec40000,0x3f6dbf35
.long 0xbf803f80,0xbf803f80,0x250d0000,0x250d0000,0xbf6d3f80,0xbec43f35,0xbec40000,0xbf6d3f35
.long 0xbf353f80,0x3f35248d,0xbf350000,0xbf353f80,0xbec43f80,0x3f6dbf35,0xbf6d0000,0x3ec43f35
.long 0xa5543f80,0x248dbf80,0xbf800000,0x3f80250d,0x3ec43f80,0xbf6dbf35,0xbf6d0000,0x3ec4bf35
.long 0x3f353f80,0xbf35a554,0xbf350000,0xbf35bf80,0x3f6d3f80,0x3ec43f35,0xbec40000,0xbf6dbf35
.long 0x3f803f80,0x3f803f80,0x0,0x0,0xbec4248d,0xbf6dbf35,0x3f6d3f80,0x3ec43f35
.long 0xbf35bf80,0x3f35a554,0xbf35250d,0xbf35bf80,0x3f6da554,0xbec43f35,0xbec4bf80,0x3f6d3f35
.long 0x248d3f80,0xa554bf80,0x3f800000,0xbf80250d,0xbf6d248d,0x3ec43f35,0xbec43f80,0x3f6dbf35
.long 0x3f35bf80,0xbf35248d,0xbf35250d,0xbf353f80,0x3ec4a554,0x3f6dbf35,0x3f6dbf80,0x3ec4bf35
.long 0xbf803f80,0xbf803f80,0x250d0000,0x250d0000,0x3ec4248d,0x3f6dbf35,0xbf6d3f80,0xbec43f35
.long 0x3f35bf80,0xbf35a554,0x3f35250d,0x3f35bf80,0xbf6da554,0x3ec43f35,0x3ec4bf80,0xbf6d3f35
.long 0xa5543f80,0x248dbf80,0xbf800000,0x3f80250d,0x3f6d248d,0xbec43f35,0x3ec43f80,0xbf6dbf35
.long 0xbf35bf80,0x3f35248d,0x3f35250d,0x3f353f80,0xbec4a554,0xbf6dbf35,0xbf6dbf80,0xbec4bf35
.long 0x3f803f80,0x3f803f80,0x0,0x0,0xbf6dbf80,0xbec4bf35,0xbec4250d,0xbf6dbf35
.long 0x3f353f80,0xbf35248d,0x3f350000,0x3f353f80,0xbec4bf80,0x3f6d3f35,0xbf6d250d,0x3ec4bf35
.long 0x248d3f80,0xa554bf80,0x3f800000,0xbf80250d,0x3ec4bf80,0xbf6d3f35,0xbf6d250d,0x3ec43f35
.long 0xbf353f80,0x3f35a554,0x3f350000,0x3f35bf80,0x3f6dbf80,0x3ec4bf35,0xbec4250d,0xbf6d3f35
.long 0xbf803f80,0xbf803f80,0x250d0000,0x250d0000,0x3f6dbf80,0x3ec4bf35,0x3ec4250d,0x3f6dbf35
.long 0xbf353f80,0x3f35248d,0xbf350000,0xbf353f80,0x3ec4bf80,0xbf6d3f35,0x3f6d250d,0xbec4bf35
.long 0xa5543f80,0x248dbf80,0xbf800000,0x3f80250d,0xbec4bf80,0x3f6d3f35,0x3f6d250d,0xbec43f35
.long 0x3f353f80,0xbf35a554,0xbf350000,0xbf35bf80,0xbf6dbf80,0xbec4bf35,0x3ec4250d,0x3f6d3f35
.long 0x3f803f80,0x3f803f80,0x0,0x0,0x3ec4a554,0x3f6d3f35,0xbf6dbf80,0xbec4bf35
.long 0xbf35bf80,0x3f35a554,0xbf35250d,0xbf35bf80,0xbf6d248d,0x3ec4bf35,0x3ec43f80,0xbf6dbf35
.long 0x248d3f80,0xa554bf80,0x3f800000,0xbf80250d,0x3f6da554,0xbec4bf35,0x3ec4bf80,0xbf6d3f35
.long 0x3f35bf80,0xbf35248d,0xbf35250d,0xbf353f80,0xbec4248d,0xbf6d3f35,0xbf6d3f80,0xbec43f35
.long 0xbf803f80,0xbf803f80,0x250d0000,0x250d0000,0xbec4a554,0xbf6d3f35,0x3f6dbf80,0x3ec4bf35
.long 0x3f35bf80,0xbf35a554,0x3f35250d,0x3f35bf80,0x3f6d248d,0xbec4bf35,0xbec43f80,0x3f6dbf35
.long 0xa5543f80,0x248dbf80,0xbf800000,0x3f80250d,0xbf6da554,0x3ec4bf35,0xbec4bf80,0x3f6d3f35
.long 0xbf35bf80,0x3f35248d,0x3f35250d,0x3f353f80,0x3ec4248d,0x3f6d3f35,0x3f6d3f80,0x3ec43f35
.long 0x80008000,0x80008000,0x3f803f80,0x3f803f80,0xbec48000,0xbf6dbf35,0x3f6d3f80,0x3ec43f35
.long 0xbf358000,0xbf35bf80,0x3f353f80,0xbf35248d,0xbf6d8000,0x3ec4bf35,0x3ec43f80,0xbf6dbf35
.long 0xbf808000,0x3f80a50d,0x248d3f80,0xa554bf80,0xbf6d8000,0x3ec43f35,0xbec43f80,0x3f6dbf35
.long 0xbf358000,0xbf353f80,0xbf353f80,0x3f35a554,0xbec48000,0xbf6d3f35,0xbf6d3f80,0xbec43f35
.long 0xa50d8000,0xa50d8000,0xbf803f80,0xbf803f80,0x3ec48000,0x3f6dbf35,0xbf6d3f80,0xbec43f35
.long 0x3f358000,0x3f35bf80,0xbf353f80,0x3f35248d,0x3f6d8000,0xbec4bf35,0xbec43f80,0x3f6dbf35
.long 0x3f808000,0xbf80a50d,0xa5543f80,0x248dbf80,0x3f6d8000,0xbec43f35,0x3ec43f80,0xbf6dbf35
.long 0x3f358000,0x3f353f80,0x3f353f80,0xbf35a554,0x3ec48000,0x3f6d3f35,0x3f6d3f80,0x3ec43f35
.long 0x80008000,0x80008000,0x3f803f80,0x3f803f80,0xbf6dbf80,0xbec4bf35,0xbec4248d,0xbf6dbf35
.long 0x3f35a50d,0x3f353f80,0xbf35bf80,0x3f35a554,0x3ec43f80,0xbf6dbf35,0x3f6da554,0xbec43f35
.long 0xbf808000,0x3f80a50d,0x248d3f80,0xa554bf80,0x3ec4bf80,0xbf6d3f35,0xbf6d248d,0x3ec43f35
.long 0x3f35a50d,0x3f35bf80,0x3f35bf80,0xbf35248d,0xbf6d3f80,0xbec43f35,0x3ec4a554,0x3f6dbf35
.long 0xa50d8000,0xa50d8000,0xbf803f80,0xbf803f80,0x3f6dbf80,0x3ec4bf35,0x3ec4248d,0x3f6dbf35
.long 0xbf35a50d,0xbf353f80,0x3f35bf80,0xbf35a554,0xbec43f80,0x3f6dbf35,0xbf6da554,0x3ec43f35
.long 0x3f808000,0xbf80a50d,0xa5543f80,0x248dbf80,0xbec4bf80,0x3f6d3f35,0x3f6d248d,0xbec43f35
.long 0xbf35a50d,0xbf35bf80,0xbf35bf80,0x3f35248d,0x3f6d3f80,0x3ec43f35,0xbec4a554,0xbf6dbf35
.long 0x80008000,0x80008000,0x3f803f80,0x3f803f80,0x3ec4a50d,0x3f6d3f35,0xbf6dbf80,0xbec4bf35
.long 0xbf358000,0xbf35bf80,0x3f353f80,0xbf35248d,0x3f6da50d,0xbec43f35,0xbec4bf80,0x3f6d3f35
.long 0xbf808000,0x3f80a50d,0x248d3f80,0xa554bf80,0x3f6da50d,0xbec4bf35,0x3ec4bf80,0xbf6d3f35
.long 0xbf358000,0xbf353f80,0xbf353f80,0x3f35a554,0x3ec4a50d,0x3f6dbf35,0x3f6dbf80,0x3ec4bf35
.long 0xa50d8000,0xa50d8000,0xbf803f80,0xbf803f80,0xbec4a50d,0xbf6d3f35,0x3f6dbf80,0x3ec4bf35
.long 0x3f358000,0x3f35bf80,0xbf353f80,0x3f35248d,0xbf6da50d,0x3ec43f35,0x3ec4bf80,0xbf6d3f35
.long 0x3f808000,0xbf80a50d,0xa5543f80,0x248dbf80,0xbf6da50d,0x3ec4bf35,0xbec4bf80,0x3f6d3f35
.long 0x3f358000,0x3f353f80,0x3f353f80,0xbf35a554,0xbec4a50d,0xbf6dbf35,0xbf6dbf80,0xbec4bf35
.long 0x80008000,0x80008000,0x3f803f80,0x3f803f80,0x3f6d3f80,0x3ec43f35,0x3ec4a554,0x3f6d3f35
.long 0x3f35a50d,0x3f353f80,0xbf35bf80,0x3f35a554,0xbec4bf80,0x3f6d3f35,0xbf6d248d,0x3ec4bf35
.long 0xbf808000,0x3f80a50d,0x248d3f80,0xa554bf80,0xbec43f80,0x3f6dbf35,0x3f6da554,0xbec4bf35
.long 0x3f35a50d,0x3f35bf80,0x3f35bf80,0xbf35248d,0x3f6dbf80,0x3ec4bf35,0xbec4248d,0xbf6d3f35
.long 0xa50d8000,0xa50d8000,0xbf803f80,0xbf803f80,0xbf6d3f80,0xbec43f35,0xbec4a554,0xbf6d3f35
.long 0xbf35a50d,0xbf353f80,0x3f35bf80,0xbf35a554,0x3ec4bf80,0xbf6d3f35,0x3f6d248d,0xbec4bf35
.long 0x3f808000,0xbf80a50d,0xa5543f80,0x248dbf80,0x3ec43f80,0xbf6dbf35,0xbf6da554,0x3ec4bf35
.long 0xbf35a50d,0xbf35bf80,0xbf35bf80,0x3f35248d,0xbf6dbf80,0xbec4bf35,0x3ec4248d,0x3f6d3f35
.long 0x3f80,0x3f80,0x3f80,0x3f80,0x3f80,0x3ec43f6d,0x3f353f35,0x3f6d3ec4
.long 0x3f80,0x3f353f35,0x3f80248d,0x3f35bf35,0x3f80,0x3f6d3ec4,0x3f35bf35,0xbec4bf6d
.long 0x3f80,0x3f80248d,0x250dbf80,0xbf80a554,0x3f80,0x3f6dbec4,0xbf35bf35,0xbec43f6d
.long 0x3f80,0x3f35bf35,0xbf80a554,0x3f353f35,0x3f80,0x3ec4bf6d,0xbf353f35,0x3f6dbec4
.long 0x3f80,0x250dbf80,0x3f80,0x250dbf80,0x3f80,0xbec4bf6d,0x3f353f35,0xbf6dbec4
.long 0x3f80,0xbf35bf35,0x3f80248d,0xbf353f35,0x3f80,0xbf6dbec4,0x3f35bf35,0x3ec43f6d
.long 0x3f80,0xbf80a554,0x250dbf80,0x3f80248d,0x3f80,0xbf6d3ec4,0xbf35bf35,0x3ec4bf6d
.long 0x3f80,0xbf353f35,0xbf80a554,0xbf35bf35,0x3f80,0xbec43f6d,0xbf353f35,0xbf6d3ec4
.long 0x3f80,0x3f80,0x3f80,0x3f80,0x3f80248d,0x3f6dbec4,0x3f35bf35,0x3ec4bf6d
.long 0x250dbf80,0xbf35bf35,0xbf80a554,0xbf353f35,0xbf80a554,0xbec43f6d,0x3f353f35,0x3f6dbec4
.long 0x3f80,0x3f80248d,0x250dbf80,0xbf80a554,0x3f80248d,0xbec4bf6d,0xbf353f35,0x3f6d3ec4
.long 0x250dbf80,0xbf353f35,0x3f80248d,0xbf35bf35,0xbf80a554,0x3f6d3ec4,0xbf35bf35,0x3ec43f6d
.long 0x3f80,0x250dbf80,0x3f80,0x250dbf80,0x3f80248d,0xbf6d3ec4,0x3f35bf35,0xbec43f6d
.long 0x250dbf80,0x3f353f35,0xbf80a554,0x3f35bf35,0xbf80a554,0x3ec4bf6d,0x3f353f35,0xbf6d3ec4
.long 0x3f80,0xbf80a554,0x250dbf80,0x3f80248d,0x3f80248d,0x3ec43f6d,0xbf353f35,0xbf6dbec4
.long 0x250dbf80,0x3f35bf35,0x3f80248d,0x3f353f35,0xbf80a554,0xbf6dbec4,0xbf35bf35,0xbec4bf6d
.long 0x3f80,0x3f80,0x3f80,0x3f80,0x250dbf80,0xbec4bf6d,0xbf35bf35,0xbf6dbec4
.long 0x3f80,0x3f353f35,0x3f80248d,0x3f35bf35,0x250dbf80,0xbf6dbec4,0xbf353f35,0x3ec43f6d
.long 0x3f80,0x3f80248d,0x250dbf80,0xbf80a554,0x250dbf80,0xbf6d3ec4,0x3f353f35,0x3ec4bf6d
.long 0x3f80,0x3f35bf35,0xbf80a554,0x3f353f35,0x250dbf80,0xbec43f6d,0x3f35bf35,0xbf6d3ec4
.long 0x3f80,0x250dbf80,0x3f80,0x250dbf80,0x250dbf80,0x3ec43f6d,0xbf35bf35,0x3f6d3ec4
.long 0x3f80,0xbf35bf35,0x3f80248d,0xbf353f35,0x250dbf80,0x3f6d3ec4,0xbf353f35,0xbec4bf6d
.long 0x3f80,0xbf80a554,0x250dbf80,0x3f80248d,0x250dbf80,0x3f6dbec4,0x3f353f35,0xbec43f6d
.long 0x3f80,0xbf353f35,0xbf80a554,0xbf35bf35,0x250dbf80,0x3ec4bf6d,0x3f35bf35,0x3f6dbec4
.long 0x3f80,0x3f80,0x3f80,0x3f80,0xbf80a554,0xbf6d3ec4,0xbf353f35,0xbec43f6d
.long 0x250dbf80,0xbf35bf35,0xbf80a554,0xbf353f35,0x3f80248d,0x3ec4bf6d,0xbf35bf35,0xbf6d3ec4
.long 0x3f80,0x3f80248d,0x250dbf80,0xbf80a554,0xbf80a554,0x3ec43f6d,0x3f35bf35,0xbf6dbec4
.long 0x250dbf80,0xbf353f35,0x3f80248d,0xbf35bf35,0x3f80248d,0xbf6dbec4,0x3f353f35,0xbec4bf6d
.long 0x3f80,0x250dbf80,0x3f80,0x250dbf80,0xbf80a554,0x3f6dbec4,0xbf353f35,0x3ec4bf6d
.long 0x250dbf80,0x3f353f35,0xbf80a554,0x3f35bf35,0x3f80248d,0xbec43f6d,0xbf35bf35,0x3f6dbec4
.long 0x3f80,0xbf80a554,0x250dbf80,0x3f80248d,0xbf80a554,0xbec4bf6d,0x3f35bf35,0x3f6d3ec4
.long 0x250dbf80,0x3f35bf35,0x3f80248d,0x3f353f35,0x3f80248d,0x3f6d3ec4,0x3f353f35,0x3ec43f6d
.long 0x3f808000,0x3f808000,0x3f808000,0x3f808000,0x3f808000,0x3f6dbec4,0x3f35bf35,0x3ec4bf6d
.long 0x3f808000,0x3f35bf35,0x248dbf80,0xbf35bf35,0x3f808000,0x3ec4bf6d,0xbf35bf35,0xbf6d3ec4
.long 0x3f808000,0x248dbf80,0xbf80a50d,0xa5543f80,0x3f808000,0xbec4bf6d,0xbf353f35,0x3f6d3ec4
.long 0x3f808000,0xbf35bf35,0xa5543f80,0x3f35bf35,0x3f808000,0xbf6dbec4,0x3f353f35,0xbec4bf6d
.long 0x3f808000,0xbf80a50d,0x3f808000,0xbf80a50d,0x3f808000,0xbf6d3ec4,0x3f35bf35,0xbec43f6d
.long 0x3f808000,0xbf353f35,0x248dbf80,0x3f353f35,0x3f808000,0xbec43f6d,0xbf35bf35,0x3f6dbec4
.long 0x3f808000,0xa5543f80,0xbf80a50d,0x248dbf80,0x3f808000,0x3ec43f6d,0xbf353f35,0xbf6dbec4
.long 0x3f808000,0x3f353f35,0xa5543f80,0xbf353f35,0x3f808000,0x3f6d3ec4,0x3f353f35,0x3ec43f6d
.long 0x3f808000,0x3f808000,0x3f808000,0x3f808000,0x248dbf80,0xbec4bf6d,0xbf35bf35,0xbf6dbec4
.long 0xbf80a50d,0xbf353f35,0xa5543f80,0x3f353f35,0xa5543f80,0x3f6d3ec4,0x3f35bf35,0xbec4bf6d
.long 0x3f808000,0x248dbf80,0xbf80a50d,0xa5543f80,0x248dbf80,0xbf6d3ec4,0x3f353f35,0x3ec4bf6d
.long 0xbf80a50d,0x3f353f35,0x248dbf80,0xbf353f35,0xa5543f80,0x3ec4bf6d,0xbf353f35,0x3f6dbec4
.long 0x3f808000,0xbf80a50d,0x3f808000,0xbf80a50d,0x248dbf80,0x3ec43f6d,0xbf35bf35,0x3f6d3ec4
.long 0xbf80a50d,0x3f35bf35,0xa5543f80,0xbf35bf35,0xa5543f80,0xbf6dbec4,0x3f35bf35,0x3ec43f6d
.long 0x3f808000,0xa5543f80,0xbf80a50d,0x248dbf80,0x248dbf80,0x3f6dbec4,0x3f353f35,0xbec43f6d
.long 0xbf80a50d,0xbf35bf35,0x248dbf80,0x3f35bf35,0xa5543f80,0xbec43f6d,0xbf353f35,0xbf6d3ec4
.long 0x3f808000,0x3f808000,0x3f808000,0x3f808000,0xbf80a50d,0xbf6d3ec4,0xbf353f35,0xbec43f6d
.long 0x3f808000,0x3f35bf35,0x248dbf80,0xbf35bf35,0xbf80a50d,0xbec43f6d,0x3f353f35,0x3f6dbec4
.long 0x3f808000,0x248dbf80,0xbf80a50d,0xa5543f80,0xbf80a50d,0x3ec43f6d,0x3f35bf35,0xbf6dbec4
.long 0x3f808000,0xbf35bf35,0xa5543f80,0x3f35bf35,0xbf80a50d,0x3f6d3ec4,0xbf35bf35,0x3ec43f6d
.long 0x3f808000,0xbf80a50d,0x3f808000,0xbf80a50d,0xbf80a50d,0x3f6dbec4,0xbf353f35,0x3ec4bf6d
.long 0x3f808000,0xbf353f35,0x248dbf80,0x3f353f35,0xbf80a50d,0x3ec4bf6d,0x3f353f35,0xbf6d3ec4
.long 0x3f808000,0xa5543f80,0xbf80a50d,0x248dbf80,0xbf80a50d,0xbec4bf6d,0x3f35bf35,0x3f6d3ec4
.long 0x3f808000,0x3f353f35,0xa5543f80,0xbf353f35,0xbf80a50d,0xbf6dbec4,0xbf35bf35,0xbec4bf6d
.long 0x3f808000,0x3f808000,0x3f808000,0x3f808000,0xa5543f80,0x3ec43f6d,0x3f353f35,0x3f6d3ec4
.long 0xbf80a50d,0xbf353f35,0xa5543f80,0x3f353f35,0x248dbf80,0xbf6dbec4,0xbf353f35,0x3ec43f6d
.long 0x3f808000,0x248dbf80,0xbf80a50d,0xa5543f80,0xa5543f80,0x3f6dbec4,0xbf35bf35,0xbec43f6d
.long 0xbf80a50d,0x3f353f35,0x248dbf80,0xbf353f35,0x248dbf80,0xbec43f6d,0x3f35bf35,0xbf6d3ec4
.long 0x3f808000,0xbf80a50d,0x3f808000,0xbf80a50d,0xa5543f80,0xbec4bf6d,0x3f353f35,0xbf6dbec4
.long 0xbf80a50d,0x3f35bf35,0xa5543f80,0xbf35bf35,0x248dbf80,0x3f6d3ec4,0xbf353f35,0xbec4bf6d
.long 0x3f808000,0xa5543f80,0xbf80a50d,0x248dbf80,0xa5543f80,0xbf6d3ec4,0xbf35bf35,0x3ec4bf6d
.long 0xbf80a50d,0xbf35bf35,0x248dbf80,0x3f35bf35,0x248dbf80,0x3ec4bf6d,0x3f35bf35,0x3f6dbec4
.long 0x3f800000,0x3f800000,0x3f800000,0x3f800000,0x3f800000,0x3f7fec43,0x3f7fb10f,0x3f7f4e6d
.long 0x3f800000,0x3f7fb10f,0x3f7ec46d,0x3f7d3aac,0x3f800000,0x3f7f4e6d,0x3f7d3aac,0x3f79c79d
.long 0x3f800000,0x3f7ec46d,0x3f7b14be,0x3f74fa0b,0x3f800000,0x3f7e1324,0x3f7853f8,0x3f6ed89e
.long 0x3f800000,0x3f7d3aac,0x3f74fa0b,0x3f676bd8,0x3f800000,0x3f7c3b28,0x3f710908,0x3f5ebe05
.long 0x3f800000,0x3f7b14be,0x3f6c835e,0x3f54db31,0x3f800000,0x3f79c79d,0x3f676bd8,0x3f49d112
.long 0x3f800000,0x3f7853f8,0x3f61c598,0x3f3daef9,0x3f800000,0x3f76ba07,0x3f5b941a,0x3f3085bb
.long 0x3f800000,0x3f74fa0b,0x3f54db31,0x3f226799,0x3f800000,0x3f731447,0x3f4d9f02,0x3f13682a
.long 0x3f800000,0x3f710908,0x3f45e403,0x3f039c3d,0x3f800000,0x3f6ed89e,0x3f3daef9,0x3ee63375
.long 0x3f800000,0x3f800000,0x3f800000,0x3f800000,0x3f7ec46d,0x3f7e1324,0x3f7d3aac,0x3f7c3b28
.long 0x3f7b14be,0x3f7853f8,0x3f74fa0b,0x3f710908,0x3f74fa0b,0x3f6ed89e,0x3f676bd8,0x3f5ebe05
.long 0x3f6c835e,0x3f61c598,0x3f54db31,0x3f45e403,0x3f61c598,0x3f514d3d,0x3f3daef9,0x3f273656
.long 0x3f54db31,0x3f3daef9,0x3f226799,0x3f039c3d,0x3f45e403,0x3f273656,0x3f039c3d,0x3eb8442a
.long 0x3f3504f3,0x3f0e39da,0x3ec3ef15,0x3e47c5c2,0x3f226799,0x3ee63375,0x3e78cfcc,0x3cc90ab0
.long 0x3f0e39da,0x3eac7cd4,0x3dc8bd36,0xbe164083,0x3ef15aea,0x3e605c13,0xbd48fb30,0xbea09ae5
.long 0x3ec3ef15,0x3dc8bd36,0xbe47c5c2,0xbef15aea,0x3e94a031,0xbcc90ab0,0xbeac7cd4,0xbf1d7fd1
.long 0x3e47c5c2,0xbe164083,0xbef15aea,0xbf3daef9,0x3dc8bd36,0xbe888e93,0xbf187fc0,0xbf584853
.long 0x3f800000,0x3f800000,0x3f800000,0x3f800000,0x3f7b14be,0x3f79c79d,0x3f7853f8,0x3f76ba07
.long 0x3f6c835e,0x3f676bd8,0x3f61c598,0x3f5b941a,0x3f54db31,0x3f49d112,0x3f3daef9,0x3f3085bb
.long 0x3f3504f3,0x3f226799,0x3f0e39da,0x3ef15aea,0x3f0e39da,0x3ee63375,0x3eac7cd4,0x3e605c13
.long 0x3ec3ef15,0x3e78cfcc,0x3dc8bd36,0xbd48fb30,0x3e47c5c2,0x3cc90ab0,0xbe164083,0xbea09ae5
.long 0x248d3132,0xbe47c5c2,0xbec3ef15,0xbf0e39da,0xbe47c5c2,0xbecf7bca,0xbf187fc0,0xbf41d870
.long 0xbec3ef15,0xbf187fc0,0xbf45e403,0xbf676bd8,0xbf0e39da,0xbf41d870,0xbf676bd8,0xbf7c3b28
.long 0xbf3504f3,0xbf61c598,0xbf7b14be,0xbf7ec46d,0xbf54db31,0xbf76ba07,0xbf7fb10f,0xbf6ed89e
.long 0xbf6c835e,0xbf7fb10f,0xbf74fa0b,0xbf4d9f02,0xbf7b14be,0xbf7c3b28,0xbf5b941a,0xbf1d7fd1
.long 0x3f800000,0x3f800000,0x3f800000,0x3f800000,0x3f74fa0b,0x3f731447,0x3f710908,0x3f6ed89e
.long 0x3f54db31,0x3f4d9f02,0x3f45e403,0x3f3daef9,0x3f226799,0x3f13682a,0x3f039c3d,0x3ee63375
.long 0x3ec3ef15,0x3e94a031,0x3e47c5c2,0x3dc8bd36,0x3dc8bd36,0xbcc90ab0,0xbe164083,0xbe888e93
.long 0xbe47c5c2,0xbeac7cd4,0xbef15aea,0xbf187fc0,0xbef15aea,0xbf1d7fd1,0xbf3daef9,0xbf584853
.long 0xbf3504f3,0xbf54db31,0xbf6c835e,0xbf7b14be,0xbf61c598,0xbf76ba07,0xbf7fb10f,0xbf7c3b28
.long 0xbf7b14be,0xbf7fb10f,0xbf74fa0b,0xbf5b941a,0xbf7ec46d,0xbf6ed89e,0xbf4d9f02,0xbf1d7fd1
.long 0xbf6c835e,0xbf45e403,0xbf0e39da,0xbe94a031,0xbf45e403,0xbf08f59b,0xbe78cfcc,0x3d96a905
.long 0xbf0e39da,0xbe78cfcc,0x3dc8bd36,0x3edae880,0xbe94a031,0x3d96a905,0x3edae880,0x3f396842
.long 0x0,0x0,0x0,0x0,0x0,0x3cc90ab0,0x3d48fb30,0x3d96a905
.long 0x0,0x3d48fb30,0x3dc8bd36,0x3e164083,0x0,0x3d96a905,0x3e164083,0x3e605c13
.long 0x0,0x3dc8bd36,0x3e47c5c2,0x3e94a031,0x0,0x3dfab273,0x3e78cfcc,0x3eb8442a
.long 0x0,0x3e164083,0x3e94a031,0x3edae880,0x0,0x3e2f10a2,0x3eac7cd4,0x3efc5d27
.long 0x0,0x3e47c5c2,0x3ec3ef15,0x3f0e39da,0x0,0x3e605c13,0x3edae880,0x3f1d7fd1
.long 0x0,0x3e78cfcc,0x3ef15aea,0x3f2beb4a,0x0,0x3e888e93,0x3f039c3d,0x3f396842
.long 0x0,0x3e94a031,0x3f0e39da,0x3f45e403,0x0,0x3ea09ae5,0x3f187fc0,0x3f514d3d
.long 0x0,0x3eac7cd4,0x3f226799,0x3f5b941a,0x0,0x3eb8442a,0x3f2beb4a,0x3f64aa59
.long 0x0,0x0,0x0,0x0,0x3dc8bd36,0x3dfab273,0x3e164083,0x3e2f10a2
.long 0x3e47c5c2,0x3e78cfcc,0x3e94a031,0x3eac7cd4,0x3e94a031,0x3eb8442a,0x3edae880,0x3efc5d27
.long 0x3ec3ef15,0x3ef15aea,0x3f0e39da,0x3f226799,0x3ef15aea,0x3f13682a,0x3f2beb4a,0x3f41d870
.long 0x3f0e39da,0x3f2beb4a,0x3f45e403,0x3f5b941a,0x3f226799,0x3f41d870,0x3f5b941a,0x3f6ed89e
.long 0x3f3504f3,0x3f54db31,0x3f6c835e,0x3f7b14be,0x3f45e403,0x3f64aa59,0x3f7853f8,0x3f7fec43
.long 0x3f54db31,0x3f710908,0x3f7ec46d,0x3f7d3aac,0x3f61c598,0x3f79c79d,0x3f7fb10f,0x3f731447
.long 0x3f6c835e,0x3f7ec46d,0x3f7b14be,0x3f61c598,0x3f74fa0b,0x3f7fec43,0x3f710908,0x3f49d112
.long 0x3f7b14be,0x3f7d3aac,0x3f61c598,0x3f2beb4a,0x3f7ec46d,0x3f76ba07,0x3f4d9f02,0x3f08f59b
.long 0x0,0x0,0x0,0x0,0x3e47c5c2,0x3e605c13,0x3e78cfcc,0x3e888e93
.long 0x3ec3ef15,0x3edae880,0x3ef15aea,0x3f039c3d,0x3f0e39da,0x3f1d7fd1,0x3f2beb4a,0x3f396842
.long 0x3f3504f3,0x3f45e403,0x3f54db31,0x3f61c598,0x3f54db31,0x3f64aa59,0x3f710908,0x3f79c79d
.long 0x3f6c835e,0x3f7853f8,0x3f7ec46d,0x3f7fb10f,0x3f7b14be,0x3f7fec43,0x3f7d3aac,0x3f731447
.long 0x3f800000,0x3f7b14be,0x3f6c835e,0x3f54db31,0x3f7b14be,0x3f6a09a7,0x3f4d9f02,0x3f273656
.long 0x3f6c835e,0x3f4d9f02,0x3f226799,0x3edae880,0x3f54db31,0x3f273656,0x3edae880,0x3e2f10a2
.long 0x3f3504f3,0x3ef15aea,0x3e47c5c2,0xbdc8bd36,0x3f0e39da,0x3e888e93,0xbd48fb30,0xbeb8442a
.long 0x3ec3ef15,0x3d48fb30,0xbe94a031,0xbf187fc0,0x3e47c5c2,0xbe2f10a2,0xbf039c3d,0xbf49d112
.long 0x0,0x0,0x0,0x0,0x3e94a031,0x3ea09ae5,0x3eac7cd4,0x3eb8442a
.long 0x3f0e39da,0x3f187fc0,0x3f226799,0x3f2beb4a,0x3f45e403,0x3f514d3d,0x3f5b941a,0x3f64aa59
.long 0x3f6c835e,0x3f74fa0b,0x3f7b14be,0x3f7ec46d,0x3f7ec46d,0x3f7fec43,0x3f7d3aac,0x3f76ba07
.long 0x3f7b14be,0x3f710908,0x3f61c598,0x3f4d9f02,0x3f61c598,0x3f49d112,0x3f2beb4a,0x3f08f59b
.long 0x3f3504f3,0x3f0e39da,0x3ec3ef15,0x3e47c5c2,0x3ef15aea,0x3e888e93,0x3d48fb30,0xbe2f10a2
.long 0x3e47c5c2,0xbd48fb30,0xbe94a031,0xbf039c3d,0xbdc8bd36,0xbeb8442a,0xbf187fc0,0xbf49d112
.long 0xbec3ef15,0xbf226799,0xbf54db31,0xbf74fa0b,0xbf226799,0xbf584853,0xbf7853f8,0xbf7f4e6d
.long 0xbf54db31,0xbf7853f8,0xbf7ec46d,0xbf676bd8,0xbf74fa0b,0xbf7f4e6d,0xbf676bd8,0xbf3085bb
.long 0x3f800000,0x3f800000,0x3f800000,0x3f800000,0x3f800000,0x3f7fec43,0x3f7fb10f,0x3f7f4e6d
.long 0x3f800000,0x3f7fb10f,0x3f7ec46d,0x3f7d3aac,0x3f800000,0x3f7f4e6d,0x3f7d3aac,0x3f79c79d
.long 0x3f800000,0x3f7ec46d,0x3f7b14be,0x3f74fa0b,0x3f800000,0x3f7e1324,0x3f7853f8,0x3f6ed89e
.long 0x3f800000,0x3f7d3aac,0x3f74fa0b,0x3f676bd8,0x3f800000,0x3f7c3b28,0x3f710908,0x3f5ebe05
.long 0x3f800000,0x3f7b14be,0x3f6c835e,0x3f54db31,0x3f800000,0x3f79c79d,0x3f676bd8,0x3f49d112
.long 0x3f800000,0x3f7853f8,0x3f61c598,0x3f3daef9,0x3f800000,0x3f76ba07,0x3f5b941a,0x3f3085bb
.long 0x3f800000,0x3f74fa0b,0x3f54db31,0x3f226799,0x3f800000,0x3f731447,0x3f4d9f02,0x3f13682a
.long 0x3f800000,0x3f710908,0x3f45e403,0x3f039c3d,0x3f800000,0x3f6ed89e,0x3f3daef9,0x3ee63375
.long 0x3f800000,0x3f800000,0x3f800000,0x3f800000,0x3f7ec46d,0x3f7e1324,0x3f7d3aac,0x3f7c3b28
.long 0x3f7b14be,0x3f7853f8,0x3f74fa0b,0x3f710908,0x3f74fa0b,0x3f6ed89e,0x3f676bd8,0x3f5ebe05
.long 0x3f6c835e,0x3f61c598,0x3f54db31,0x3f45e403,0x3f61c598,0x3f514d3d,0x3f3daef9,0x3f273656
.long 0x3f54db31,0x3f3daef9,0x3f226799,0x3f039c3d,0x3f45e403,0x3f273656,0x3f039c3d,0x3eb8442a
.long 0x3f3504f3,0x3f0e39da,0x3ec3ef15,0x3e47c5c2,0x3f226799,0x3ee63375,0x3e78cfcc,0x3cc90ab0
.long 0x3f0e39da,0x3eac7cd4,0x3dc8bd36,0xbe164083,0x3ef15aea,0x3e605c13,0xbd48fb30,0xbea09ae5
.long 0x3ec3ef15,0x3dc8bd36,0xbe47c5c2,0xbef15aea,0x3e94a031,0xbcc90ab0,0xbeac7cd4,0xbf1d7fd1
.long 0x3e47c5c2,0xbe164083,0xbef15aea,0xbf3daef9,0x3dc8bd36,0xbe888e93,0xbf187fc0,0xbf584853
.long 0x3f800000,0x3f800000,0x3f800000,0x3f800000,0x3f7b14be,0x3f79c79d,0x3f7853f8,0x3f76ba07
.long 0x3f6c835e,0x3f676bd8,0x3f61c598,0x3f5b941a,0x3f54db31,0x3f49d112,0x3f3daef9,0x3f3085bb
.long 0x3f3504f3,0x3f226799,0x3f0e39da,0x3ef15aea,0x3f0e39da,0x3ee63375,0x3eac7cd4,0x3e605c13
.long 0x3ec3ef15,0x3e78cfcc,0x3dc8bd36,0xbd48fb30,0x3e47c5c2,0x3cc90ab0,0xbe164083,0xbea09ae5
.long 0x248d3132,0xbe47c5c2,0xbec3ef15,0xbf0e39da,0xbe47c5c2,0xbecf7bca,0xbf187fc0,0xbf41d870
.long 0xbec3ef15,0xbf187fc0,0xbf45e403,0xbf676bd8,0xbf0e39da,0xbf41d870,0xbf676bd8,0xbf7c3b28
.long 0xbf3504f3,0xbf61c598,0xbf7b14be,0xbf7ec46d,0xbf54db31,0xbf76ba07,0xbf7fb10f,0xbf6ed89e
.long 0xbf6c835e,0xbf7fb10f,0xbf74fa0b,0xbf4d9f02,0xbf7b14be,0xbf7c3b28,0xbf5b941a,0xbf1d7fd1
.long 0x3f800000,0x3f800000,0x3f800000,0x3f800000,0x3f74fa0b,0x3f731447,0x3f710908,0x3f6ed89e
.long 0x3f54db31,0x3f4d9f02,0x3f45e403,0x3f3daef9,0x3f226799,0x3f13682a,0x3f039c3d,0x3ee63375
.long 0x3ec3ef15,0x3e94a031,0x3e47c5c2,0x3dc8bd36,0x3dc8bd36,0xbcc90ab0,0xbe164083,0xbe888e93
.long 0xbe47c5c2,0xbeac7cd4,0xbef15aea,0xbf187fc0,0xbef15aea,0xbf1d7fd1,0xbf3daef9,0xbf584853
.long 0xbf3504f3,0xbf54db31,0xbf6c835e,0xbf7b14be,0xbf61c598,0xbf76ba07,0xbf7fb10f,0xbf7c3b28
.long 0xbf7b14be,0xbf7fb10f,0xbf74fa0b,0xbf5b941a,0xbf7ec46d,0xbf6ed89e,0xbf4d9f02,0xbf1d7fd1
.long 0xbf6c835e,0xbf45e403,0xbf0e39da,0xbe94a031,0xbf45e403,0xbf08f59b,0xbe78cfcc,0x3d96a905
.long 0xbf0e39da,0xbe78cfcc,0x3dc8bd36,0x3edae880,0xbe94a031,0x3d96a905,0x3edae880,0x3f396842
.long 0x0,0x0,0x0,0x0,0x0,0x3cc90ab0,0x3d48fb30,0x3d96a905
.long 0x0,0x3d48fb30,0x3dc8bd36,0x3e164083,0x0,0x3d96a905,0x3e164083,0x3e605c13
.long 0x0,0x3dc8bd36,0x3e47c5c2,0x3e94a031,0x0,0x3dfab273,0x3e78cfcc,0x3eb8442a
.long 0x0,0x3e164083,0x3e94a031,0x3edae880,0x0,0x3e2f10a2,0x3eac7cd4,0x3efc5d27
.long 0x0,0x3e47c5c2,0x3ec3ef15,0x3f0e39da,0x0,0x3e605c13,0x3edae880,0x3f1d7fd1
.long 0x0,0x3e78cfcc,0x3ef15aea,0x3f2beb4a,0x0,0x3e888e93,0x3f039c3d,0x3f396842
.long 0x0,0x3e94a031,0x3f0e39da,0x3f45e403,0x0,0x3ea09ae5,0x3f187fc0,0x3f514d3d
.long 0x0,0x3eac7cd4,0x3f226799,0x3f5b941a,0x0,0x3eb8442a,0x3f2beb4a,0x3f64aa59
.long 0x0,0x0,0x0,0x0,0x3dc8bd36,0x3dfab273,0x3e164083,0x3e2f10a2
.long 0x3e47c5c2,0x3e78cfcc,0x3e94a031,0x3eac7cd4,0x3e94a031,0x3eb8442a,0x3edae880,0x3efc5d27
.long 0x3ec3ef15,0x3ef15aea,0x3f0e39da,0x3f226799,0x3ef15aea,0x3f13682a,0x3f2beb4a,0x3f41d870
.long 0x3f0e39da,0x3f2beb4a,0x3f45e403,0x3f5b941a,0x3f226799,0x3f41d870,0x3f5b941a,0x3f6ed89e
.long 0x3f3504f3,0x3f54db31,0x3f6c835e,0x3f7b14be,0x3f45e403,0x3f64aa59,0x3f7853f8,0x3f7fec43
.long 0x3f54db31,0x3f710908,0x3f7ec46d,0x3f7d3aac,0x3f61c598,0x3f79c79d,0x3f7fb10f,0x3f731447
.long 0x3f6c835e,0x3f7ec46d,0x3f7b14be,0x3f61c598,0x3f74fa0b,0x3f7fec43,0x3f710908,0x3f49d112
.long 0x3f7b14be,0x3f7d3aac,0x3f61c598,0x3f2beb4a,0x3f7ec46d,0x3f76ba07,0x3f4d9f02,0x3f08f59b
.long 0x0,0x0,0x0,0x0,0x3e47c5c2,0x3e605c13,0x3e78cfcc,0x3e888e93
.long 0x3ec3ef15,0x3edae880,0x3ef15aea,0x3f039c3d,0x3f0e39da,0x3f1d7fd1,0x3f2beb4a,0x3f396842
.long 0x3f3504f3,0x3f45e403,0x3f54db31,0x3f61c598,0x3f54db31,0x3f64aa59,0x3f710908,0x3f79c79d
.long 0x3f6c835e,0x3f7853f8,0x3f7ec46d,0x3f7fb10f,0x3f7b14be,0x3f7fec43,0x3f7d3aac,0x3f731447
.long 0x3f800000,0x3f7b14be,0x3f6c835e,0x3f54db31,0x3f7b14be,0x3f6a09a7,0x3f4d9f02,0x3f273656
.long 0x3f6c835e,0x3f4d9f02,0x3f226799,0x3edae880,0x3f54db31,0x3f273656,0x3edae880,0x3e2f10a2
.long 0x3f3504f3,0x3ef15aea,0x3e47c5c2,0xbdc8bd36,0x3f0e39da,0x3e888e93,0xbd48fb30,0xbeb8442a
.long 0x3ec3ef15,0x3d48fb30,0xbe94a031,0xbf187fc0,0x3e47c5c2,0xbe2f10a2,0xbf039c3d,0xbf49d112
.long 0x0,0x0,0x0,0x0,0x3e94a031,0x3ea09ae5,0x3eac7cd4,0x3eb8442a
.long 0x3f0e39da,0x3f187fc0,0x3f226799,0x3f2beb4a,0x3f45e403,0x3f514d3d,0x3f5b941a,0x3f64aa59
.long 0x3f6c835e,0x3f74fa0b,0x3f7b14be,0x3f7ec46d,0x3f7ec46d,0x3f7fec43,0x3f7d3aac,0x3f76ba07
.long 0x3f7b14be,0x3f710908,0x3f61c598,0x3f4d9f02,0x3f61c598,0x3f49d112,0x3f2beb4a,0x3f08f59b
.long 0x3f3504f3,0x3f0e39da,0x3ec3ef15,0x3e47c5c2,0x3ef15aea,0x3e888e93,0x3d48fb30,0xbe2f10a2
.long 0x3e47c5c2,0xbd48fb30,0xbe94a031,0xbf039c3d,0xbdc8bd36,0xbeb8442a,0xbf187fc0,0xbf49d112
.long 0xbec3ef15,0xbf226799,0xbf54db31,0xbf74fa0b,0xbf226799,0xbf584853,0xbf7853f8,0xbf7f4e6d
.long 0xbf54db31,0xbf7853f8,0xbf7ec46d,0xbf676bd8,0xbf74fa0b,0xbf7f4e6d,0xbf676bd8,0xbf3085bb
.long 0x3f803f80,0x3f803f80,0x80008000,0x80008000,0x3f6d3f80,0x3ec43f35,0xbec48000,0xbf6dbf35
.long 0x3f353f80,0xbf35248d,0xbf358000,0xbf35bf80,0x3ec43f80,0xbf6dbf35,0xbf6d8000,0x3ec4bf35
.long 0x248d3f80,0xa554bf80,0xbf808000,0x3f80a50d,0xbec43f80,0x3f6dbf35,0xbf6d8000,0x3ec43f35
.long 0xbf353f80,0x3f35a554,0xbf358000,0xbf353f80,0xbf6d3f80,0xbec43f35,0xbec48000,0xbf6d3f35
.long 0xbf803f80,0xbf803f80,0xa50d8000,0xa50d8000,0xbf6d3f80,0xbec43f35,0x3ec48000,0x3f6dbf35
.long 0xbf353f80,0x3f35248d,0x3f358000,0x3f35bf80,0xbec43f80,0x3f6dbf35,0x3f6d8000,0xbec4bf35
.long 0xa5543f80,0x248dbf80,0x3f808000,0xbf80a50d,0x3ec43f80,0xbf6dbf35,0x3f6d8000,0xbec43f35
.long 0x3f353f80,0xbf35a554,0x3f358000,0x3f353f80,0x3f6d3f80,0x3ec43f35,0x3ec48000,0x3f6d3f35
.long 0x3f803f80,0x3f803f80,0x80008000,0x80008000,0xbec4248d,0xbf6dbf35,0xbf6dbf80,0xbec4bf35
.long 0xbf35bf80,0x3f35a554,0x3f35a50d,0x3f353f80,0x3f6da554,0xbec43f35,0x3ec43f80,0xbf6dbf35
.long 0x248d3f80,0xa554bf80,0xbf808000,0x3f80a50d,0xbf6d248d,0x3ec43f35,0x3ec4bf80,0xbf6d3f35
.long 0x3f35bf80,0xbf35248d,0x3f35a50d,0x3f35bf80,0x3ec4a554,0x3f6dbf35,0xbf6d3f80,0xbec43f35
.long 0xbf803f80,0xbf803f80,0xa50d8000,0xa50d8000,0x3ec4248d,0x3f6dbf35,0x3f6dbf80,0x3ec4bf35
.long 0x3f35bf80,0xbf35a554,0xbf35a50d,0xbf353f80,0xbf6da554,0x3ec43f35,0xbec43f80,0x3f6dbf35
.long 0xa5543f80,0x248dbf80,0x3f808000,0xbf80a50d,0x3f6d248d,0xbec43f35,0xbec4bf80,0x3f6d3f35
.long 0xbf35bf80,0x3f35248d,0xbf35a50d,0xbf35bf80,0xbec4a554,0xbf6dbf35,0x3f6d3f80,0x3ec43f35
.long 0x3f803f80,0x3f803f80,0x80008000,0x80008000,0xbf6dbf80,0xbec4bf35,0x3ec4a50d,0x3f6d3f35
.long 0x3f353f80,0xbf35248d,0xbf358000,0xbf35bf80,0xbec4bf80,0x3f6d3f35,0x3f6da50d,0xbec43f35
.long 0x248d3f80,0xa554bf80,0xbf808000,0x3f80a50d,0x3ec4bf80,0xbf6d3f35,0x3f6da50d,0xbec4bf35
.long 0xbf353f80,0x3f35a554,0xbf358000,0xbf353f80,0x3f6dbf80,0x3ec4bf35,0x3ec4a50d,0x3f6dbf35
.long 0xbf803f80,0xbf803f80,0xa50d8000,0xa50d8000,0x3f6dbf80,0x3ec4bf35,0xbec4a50d,0xbf6d3f35
.long 0xbf353f80,0x3f35248d,0x3f358000,0x3f35bf80,0x3ec4bf80,0xbf6d3f35,0xbf6da50d,0x3ec43f35
.long 0xa5543f80,0x248dbf80,0x3f808000,0xbf80a50d,0xbec4bf80,0x3f6d3f35,0xbf6da50d,0x3ec4bf35
.long 0x3f353f80,0xbf35a554,0x3f358000,0x3f353f80,0xbf6dbf80,0xbec4bf35,0xbec4a50d,0xbf6dbf35
.long 0x3f803f80,0x3f803f80,0x80008000,0x80008000,0x3ec4a554,0x3f6d3f35,0x3f6d3f80,0x3ec43f35
.long 0xbf35bf80,0x3f35a554,0x3f35a50d,0x3f353f80,0xbf6d248d,0x3ec4bf35,0xbec4bf80,0x3f6d3f35
.long 0x248d3f80,0xa554bf80,0xbf808000,0x3f80a50d,0x3f6da554,0xbec4bf35,0xbec43f80,0x3f6dbf35
.long 0x3f35bf80,0xbf35248d,0x3f35a50d,0x3f35bf80,0xbec4248d,0xbf6d3f35,0x3f6dbf80,0x3ec4bf35
.long 0xbf803f80,0xbf803f80,0xa50d8000,0xa50d8000,0xbec4a554,0xbf6d3f35,0xbf6d3f80,0xbec43f35
.long 0x3f35bf80,0xbf35a554,0xbf35a50d,0xbf353f80,0x3f6d248d,0xbec4bf35,0x3ec4bf80,0xbf6d3f35
.long 0xa5543f80,0x248dbf80,0x3f808000,0xbf80a50d,0xbf6da554,0x3ec4bf35,0x3ec43f80,0xbf6dbf35
.long 0xbf35bf80,0x3f35248d,0xbf35a50d,0xbf35bf80,0x3ec4248d,0x3f6d3f35,0xbf6dbf80,0xbec4bf35
.long 0x0,0x0,0x3f803f80,0x3f803f80,0x3ec40000,0x3f6d3f35,0x3f6d3f80,0x3ec43f35
.long 0x3f350000,0x3f353f80,0x3f353f80,0xbf35248d,0x3f6d0000,0xbec43f35,0x3ec43f80,0xbf6dbf35
.long 0x3f800000,0xbf80250d,0x248d3f80,0xa554bf80,0x3f6d0000,0xbec4bf35,0xbec43f80,0x3f6dbf35
.long 0x3f350000,0x3f35bf80,0xbf353f80,0x3f35a554,0x3ec40000,0x3f6dbf35,0xbf6d3f80,0xbec43f35
.long 0x250d0000,0x250d0000,0xbf803f80,0xbf803f80,0xbec40000,0xbf6d3f35,0xbf6d3f80,0xbec43f35
.long 0xbf350000,0xbf353f80,0xbf353f80,0x3f35248d,0xbf6d0000,0x3ec43f35,0xbec43f80,0x3f6dbf35
.long 0xbf800000,0x3f80250d,0xa5543f80,0x248dbf80,0xbf6d0000,0x3ec4bf35,0x3ec43f80,0xbf6dbf35
.long 0xbf350000,0xbf35bf80,0x3f353f80,0xbf35a554,0xbec40000,0xbf6dbf35,0x3f6d3f80,0x3ec43f35
.long 0x0,0x0,0x3f803f80,0x3f803f80,0x3f6d3f80,0x3ec43f35,0xbec4248d,0xbf6dbf35
.long 0xbf35250d,0xbf35bf80,0xbf35bf80,0x3f35a554,0xbec4bf80,0x3f6d3f35,0x3f6da554,0xbec43f35
.long 0x3f800000,0xbf80250d,0x248d3f80,0xa554bf80,0xbec43f80,0x3f6dbf35,0xbf6d248d,0x3ec43f35
.long 0xbf35250d,0xbf353f80,0x3f35bf80,0xbf35248d,0x3f6dbf80,0x3ec4bf35,0x3ec4a554,0x3f6dbf35
.long 0x250d0000,0x250d0000,0xbf803f80,0xbf803f80,0xbf6d3f80,0xbec43f35,0x3ec4248d,0x3f6dbf35
.long 0x3f35250d,0x3f35bf80,0x3f35bf80,0xbf35a554,0x3ec4bf80,0xbf6d3f35,0xbf6da554,0x3ec43f35
.long 0xbf800000,0x3f80250d,0xa5543f80,0x248dbf80,0x3ec43f80,0xbf6dbf35,0x3f6d248d,0xbec43f35
.long 0x3f35250d,0x3f353f80,0xbf35bf80,0x3f35248d,0xbf6dbf80,0xbec4bf35,0xbec4a554,0xbf6dbf35
.long 0x0,0x0,0x3f803f80,0x3f803f80,0xbec4250d,0xbf6dbf35,0xbf6dbf80,0xbec4bf35
.long 0x3f350000,0x3f353f80,0x3f353f80,0xbf35248d,0xbf6d250d,0x3ec4bf35,0xbec4bf80,0x3f6d3f35
.long 0x3f800000,0xbf80250d,0x248d3f80,0xa554bf80,0xbf6d250d,0x3ec43f35,0x3ec4bf80,0xbf6d3f35
.long 0x3f350000,0x3f35bf80,0xbf353f80,0x3f35a554,0xbec4250d,0xbf6d3f35,0x3f6dbf80,0x3ec4bf35
.long 0x250d0000,0x250d0000,0xbf803f80,0xbf803f80,0x3ec4250d,0x3f6dbf35,0x3f6dbf80,0x3ec4bf35
.long 0xbf350000,0xbf353f80,0xbf353f80,0x3f35248d,0x3f6d250d,0xbec4bf35,0x3ec4bf80,0xbf6d3f35
.long 0xbf800000,0x3f80250d,0xa5543f80,0x248dbf80,0x3f6d250d,0xbec43f35,0xbec4bf80,0x3f6d3f35
.long 0xbf350000,0xbf35bf80,0x3f353f80,0xbf35a554,0x3ec4250d,0x3f6d3f35,0xbf6dbf80,0xbec4bf35
.long 0x0,0x0,0x3f803f80,0x3f803f80,0xbf6dbf80,0xbec4bf35,0x3ec4a554,0x3f6d3f35
.long 0xbf35250d,0xbf35bf80,0xbf35bf80,0x3f35a554,0x3ec43f80,0xbf6dbf35,0xbf6d248d,0x3ec4bf35
.long 0x3f800000,0xbf80250d,0x248d3f80,0xa554bf80,0x3ec4bf80,0xbf6d3f35,0x3f6da554,0xbec4bf35
.long 0xbf35250d,0xbf353f80,0x3f35bf80,0xbf35248d,0xbf6d3f80,0xbec43f35,0xbec4248d,0xbf6d3f35
.long 0x250d0000,0x250d0000,0xbf803f80,0xbf803f80,0x3f6dbf80,0x3ec4bf35,0xbec4a554,0xbf6d3f35
.long 0x3f35250d,0x3f35bf80,0x3f35bf80,0xbf35a554,0xbec43f80,0x3f6dbf35,0x3f6d248d,0xbec4bf35
.long 0xbf800000,0x3f80250d,0xa5543f80,0x248dbf80,0xbec4bf80,0x3f6d3f35,0xbf6da554,0x3ec4bf35
.long 0x3f35250d,0x3f353f80,0xbf35bf80,0x3f35248d,0x3f6d3f80,0x3ec43f35,0x3ec4248d,0x3f6d3f35
.long 0x3f80,0x3d493f80,0x3dc93f7f,0x3e163f7d,0x3f80,0x3edb3f67,0x3f463f22,0x3f783e79
.long 0x3f80,0x3f3e3f2c,0x3f7fbdc9,0x3f18bf4e,0x3f80,0x3f713eac,0x3f22bf46,0xbf04bf5c
.long 0x3f80,0x3f80bd49,0xbdc9bf7f,0xbf7d3e16,0x3f80,0x3f67bedb,0xbf46bf22,0xbe793f78
.long 0x3f80,0x3f2cbf3e,0xbf7f3dc9,0x3f4e3f18,0x3f80,0x3eacbf71,0xbf223f46,0x3f5cbf04
.long 0x3f80,0xbd49bf80,0x3dc93f7f,0xbe16bf7d,0x3f80,0xbedbbf67,0x3f463f22,0xbf78be79
.long 0x3f80,0xbf3ebf2c,0x3f7fbdc9,0xbf183f4e,0x3f80,0xbf71beac,0x3f22bf46,0x3f043f5c
.long 0x3f80,0xbf803d49,0xbdc9bf7f,0x3f7dbe16,0x3f80,0xbf673edb,0xbf46bf22,0x3e79bf78
.long 0x3f80,0xbf2c3f3e,0xbf7f3dc9,0xbf4ebf18,0x3f80,0xbeac3f71,0xbf223f46,0xbf5c3f04
.long 0x3e483f7b,0x3e793f78,0x3e953f75,0x3eac3f71,0x3f7bbe48,0x3f4ebf18,0x3ef1bf62,0x3d49bf80
.long 0xbe48bf7b,0xbf5cbf04,0xbf753e95,0xbedb3f67,0xbf7b3e48,0xbe163f7d,0x3f623ef1,0x3f3ebf2c
.long 0x3e483f7b,0x3f78be79,0xbe95bf75,0xbf713eac,0x3f7bbe48,0xbf18bf4e,0xbef13f62,0x3f803d49
.long 0xbe48bf7b,0xbf043f5c,0x3f75be95,0xbf67bedb,0xbf7b3e48,0x3f7d3e16,0xbf62bef1,0x3f2c3f3e
.long 0x3e483f7b,0xbe79bf78,0x3e953f75,0xbeacbf71,0x3f7bbe48,0xbf4e3f18,0x3ef1bf62,0xbd493f80
.long 0xbe48bf7b,0x3f5c3f04,0xbf753e95,0x3edbbf67,0xbf7b3e48,0x3e16bf7d,0x3f623ef1,0xbf3e3f2c
.long 0x3e483f7b,0xbf783e79,0xbe95bf75,0x3f71beac,0x3f7bbe48,0x3f183f4e,0xbef13f62,0xbf80bd49
.long 0xbe48bf7b,0x3f04bf5c,0x3f75be95,0x3f673edb,0xbf7b3e48,0xbf7dbe16,0xbf62bef1,0xbf2cbf3e
.long 0x3ec43f6d,0x3edb3f67,0x3ef13f62,0x3f043f5c,0xbec4bf6d,0xbf3ebf2c,0xbf75be95,0xbf7d3e16
.long 0x3ec43f6d,0x3f713eac,0x3f62bef1,0x3e79bf78,0xbec4bf6d,0xbf803d49,0xbe953f75,0x3f4e3f18
.long 0x3ec43f6d,0x3f67bedb,0xbef1bf62,0xbf5c3f04,0xbec4bf6d,0xbf2c3f3e,0x3f753e95,0xbe16bf7d
.long 0x3ec43f6d,0x3eacbf71,0xbf623ef1,0x3f783e79,0xbec4bf6d,0x3d493f80,0x3e95bf75,0xbf183f4e
.long 0x3ec43f6d,0xbedbbf67,0x3ef13f62,0xbf04bf5c,0xbec4bf6d,0x3f3e3f2c,0xbf75be95,0x3f7dbe16
.long 0x3ec43f6d,0xbf71beac,0x3f62bef1,0xbe793f78,0xbec4bf6d,0x3f80bd49,0xbe953f75,0xbf4ebf18
.long 0x3ec43f6d,0xbf673edb,0xbef1bf62,0x3f5cbf04,0xbec4bf6d,0x3f2cbf3e,0x3f753e95,0x3e163f7d
.long 0x3ec43f6d,0xbeac3f71,0xbf623ef1,0xbf78be79,0xbec4bf6d,0xbd49bf80,0x3e95bf75,0x3f18bf4e
.long 0x3f0e3f55,0x3f183f4e,0x3f223f46,0x3f2c3f3e,0xbf553f0e,0xbf043f5c,0xbdc93f7f,0x3eac3f71
.long 0xbf0ebf55,0xbf7dbe16,0xbf463f22,0xbd493f80,0x3f55bf0e,0xbe79bf78,0xbf7fbdc9,0xbedb3f67
.long 0x3f0e3f55,0x3f4ebf18,0xbf22bf46,0xbf3e3f2c,0xbf553f0e,0x3f5c3f04,0x3dc9bf7f,0xbf713eac
.long 0xbf0ebf55,0xbe163f7d,0x3f46bf22,0xbf80bd49,0x3f55bf0e,0xbf783e79,0x3f7f3dc9,0xbf67bedb
.long 0x3f0e3f55,0xbf18bf4e,0x3f223f46,0xbf2cbf3e,0xbf553f0e,0x3f04bf5c,0xbdc93f7f,0xbeacbf71
.long 0xbf0ebf55,0x3f7d3e16,0xbf463f22,0x3d49bf80,0x3f55bf0e,0x3e793f78,0xbf7fbdc9,0x3edbbf67
.long 0x3f0e3f55,0xbf4e3f18,0xbf22bf46,0x3f3ebf2c,0xbf553f0e,0xbf5cbf04,0x3dc9bf7f,0x3f71beac
.long 0xbf0ebf55,0x3e16bf7d,0x3f46bf22,0x3f803d49,0x3f55bf0e,0x3f78be79,0x3f7f3dc9,0x3f673edb
.long 0x3f808000,0x3f80bd49,0x3f7fbdc9,0x3f7dbe16,0x3f808000,0x3f67bedb,0x3f22bf46,0x3e79bf78
.long 0x3f808000,0x3f2cbf3e,0xbdc9bf7f,0xbf4ebf18,0x3f808000,0x3eacbf71,0xbf46bf22,0xbf5c3f04
.long 0x3f808000,0xbd49bf80,0xbf7f3dc9,0x3e163f7d,0x3f808000,0xbedbbf67,0xbf223f46,0x3f783e79
.long 0x3f808000,0xbf3ebf2c,0x3dc93f7f,0x3f18bf4e,0x3f808000,0xbf71beac,0x3f463f22,0xbf04bf5c
.long 0x3f808000,0xbf803d49,0x3f7fbdc9,0xbf7d3e16,0x3f808000,0xbf673edb,0x3f22bf46,0xbe793f78
.long 0x3f808000,0xbf2c3f3e,0xbdc9bf7f,0x3f4e3f18,0x3f808000,0xbeac3f71,0xbf46bf22,0x3f5cbf04
.long 0x3f808000,0x3d493f80,0xbf7f3dc9,0xbe16bf7d,0x3f808000,0x3edb3f67,0xbf223f46,0xbf78be79
.long 0x3f808000,0x3f3e3f2c,0x3dc93f7f,0xbf183f4e,0x3f808000,0x3f713eac,0x3f463f22,0x3f043f5c
.long 0x3f7bbe48,0x3f78be79,0x3f75be95,0x3f71beac,0xbe48bf7b,0xbf18bf4e,0xbf62bef1,0xbf80bd49
.long 0xbf7b3e48,0xbf043f5c,0x3e953f75,0x3f673edb,0x3e483f7b,0x3f7d3e16,0x3ef1bf62,0xbf2cbf3e
.long 0x3f7bbe48,0xbe79bf78,0xbf753e95,0x3eac3f71,0xbe48bf7b,0xbf4e3f18,0x3f623ef1,0x3d49bf80
.long 0xbf7b3e48,0x3f5c3f04,0xbe95bf75,0xbedb3f67,0x3e483f7b,0x3e16bf7d,0xbef13f62,0x3f3ebf2c
.long 0x3f7bbe48,0xbf783e79,0x3f75be95,0xbf713eac,0xbe48bf7b,0x3f183f4e,0xbf62bef1,0x3f803d49
.long 0xbf7b3e48,0x3f04bf5c,0x3e953f75,0xbf67bedb,0x3e483f7b,0xbf7dbe16,0x3ef1bf62,0x3f2c3f3e
.long 0x3f7bbe48,0x3e793f78,0xbf753e95,0xbeacbf71,0xbe48bf7b,0x3f4ebf18,0x3f623ef1,0xbd493f80
.long 0xbf7b3e48,0xbf5cbf04,0xbe95bf75,0x3edbbf67,0x3e483f7b,0xbe163f7d,0xbef13f62,0xbf3e3f2c
.long 0x3f6dbec4,0x3f67bedb,0x3f62bef1,0x3f5cbf04,0xbf6d3ec4,0xbf2c3f3e,0xbe953f75,0x3e163f7d
.long 0x3f6dbec4,0x3eacbf71,0xbef1bf62,0xbf78be79,0xbf6d3ec4,0x3d493f80,0x3f753e95,0x3f18bf4e
.long 0x3f6dbec4,0xbedbbf67,0xbf623ef1,0x3f043f5c,0xbf6d3ec4,0x3f3e3f2c,0x3e95bf75,0xbf7d3e16
.long 0x3f6dbec4,0xbf71beac,0x3ef13f62,0x3e79bf78,0xbf6d3ec4,0x3f80bd49,0xbf75be95,0x3f4e3f18
.long 0x3f6dbec4,0xbf673edb,0x3f62bef1,0xbf5c3f04,0xbf6d3ec4,0x3f2cbf3e,0xbe953f75,0xbe16bf7d
.long 0x3f6dbec4,0xbeac3f71,0xbef1bf62,0x3f783e79,0xbf6d3ec4,0xbd49bf80,0x3f753e95,0xbf183f4e
.long 0x3f6dbec4,0x3edb3f67,0xbf623ef1,0xbf04bf5c,0xbf6d3ec4,0xbf3ebf2c,0x3e95bf75,0x3f7dbe16
.long 0x3f6dbec4,0x3f713eac,0x3ef13f62,0xbe793f78,0xbf6d3ec4,0xbf803d49,0xbf75be95,0xbf4ebf18
.long 0x3f55bf0e,0x3f4ebf18,0x3f46bf22,0x3f3ebf2c,0x3f0e3f55,0x3f5c3f04,0x3f7f3dc9,0x3f71beac
.long 0xbf553f0e,0xbe163f7d,0x3f223f46,0x3f803d49,0xbf0ebf55,0xbf783e79,0xbdc93f7f,0x3f673edb
.long 0x3f55bf0e,0xbf18bf4e,0xbf463f22,0x3f2c3f3e,0x3f0e3f55,0x3f04bf5c,0xbf7fbdc9,0x3eac3f71
.long 0xbf553f0e,0x3f7d3e16,0xbf22bf46,0xbd493f80,0xbf0ebf55,0x3e793f78,0x3dc9bf7f,0xbedb3f67
.long 0x3f55bf0e,0xbf4e3f18,0x3f46bf22,0xbf3e3f2c,0x3f0e3f55,0xbf5cbf04,0x3f7f3dc9,0xbf713eac
.long 0xbf553f0e,0x3e16bf7d,0x3f223f46,0xbf80bd49,0xbf0ebf55,0x3f78be79,0xbdc93f7f,0xbf67bedb
.long 0x3f55bf0e,0x3f183f4e,0xbf463f22,0xbf2cbf3e,0x3f0e3f55,0xbf043f5c,0xbf7fbdc9,0xbeacbf71
.long 0xbf553f0e,0xbf7dbe16,0xbf22bf46,0x3d49bf80,0xbf0ebf55,0xbe79bf78,0x3dc9bf7f,0x3edbbf67
.long 0x3f800000,0x3f7fffb1,0x3f7ffec4,0x3f7ffd39,0x3f800000,0x3f7fe705,0x3f7f9c18,0x3f7f1f49
.long 0x3f800000,0x3f7fa6e3,0x3f7e9bc9,0x3f7cdf6c,0x3f800000,0x3f7f3f54,0x3f7cfe73,0x3f7940c0
.long 0x3f800000,0x3f7eb069,0x3f7ac516,0x3f74484b,0x3f800000,0x3f7dfa38,0x3f77f110,0x3f6dfcf2
.long 0x3f800000,0x3f7d1cdd,0x3f748422,0x3f666771,0x3f800000,0x3f7c187a,0x3f708066,0x3f5d924d
.long 0x3f800000,0x3f7aed37,0x3f6be858,0x3f5389c7,0x3f800000,0x3f799b43,0x3f66becc,0x3f485bca
.long 0x3f800000,0x3f7822d1,0x3f6106f2,0x3f3c17d9,0x3f800000,0x3f76841b,0x3f5ac450,0x3f2ecef7
.long 0x3f800000,0x3f74bf62,0x3f53fac3,0x3f209393,0x3f800000,0x3f72d4eb,0x3f4cae79,0x3f11796b
.long 0x3f800000,0x3f70c501,0x3f44e3f5,0x3f019573,0x3f800000,0x3f6e8ff8,0x3f3ca003,0x3ee1fb6a
.long 0x3f7ffb11,0x3f7ff84a,0x3f7ff4e6,0x3f7ff0e3,0x3f7e70b0,0x3f7d906e,0x3f7c7eb0,0x3f7b3bab
.long 0x3f7a7302,0x3f77583a,0x3f73913f,0x3f6f20b0,0x3f740bdd,0x3f6d67a1,0x3f655e0b,0x3f5bfb34
.long 0x3f6b4b0c,0x3f5fe4e9,0x3f5233c6,0x3f425b89,0x3f604621,0x3f4f0417,0x3f3a7ca4,0x3f2302d3
.long 0x3f531849,0x3f3b0629,0x3f1ebc12,0x3efdbabb,0x3f43e200,0x3f24381a,0x3eff17b2,0x3eadf73c
.long 0x3f32c8c9,0x3f0af1b7,0x3ebb31a0,0x3e3228d4,0x3f1ff6cb,0x3edf28a9,0x3e667c66,0x3b490fc6
.long 0x3f0b9a6b,0x3ea5129f,0x3da3308c,0xbe2bf804,0x3eebcbbb,0x3e5101f1,0xbd8a200a,0xbeab0201
.long 0x3ebe1d4a,0x3da973ba,0xbe5a3997,0xbefafef7,0x3e8e9a22,0xbd2351cb,0xbeb554ec,0xbf21cbfb
.long 0x3e3b6ecf,0xbe25c58c,0xbef9a02d,0xbf4154e1,0x3dafb680,0xbe901c2c,0xbf1c420c,0xbf5b2c79
.long 0x3f7fec43,0x3f7fe705,0x3f7fe129,0x3f7fdaaf,0x3f79c79d,0x3f7822d1,0x3f764d97,0x3f74484b
.long 0x3f6a09a7,0x3f644fac,0x3f5df6be,0x3f570348,0x3f514d3d,0x3f456439,0x3f385216,0x3f2a2a80
.long 0x3f3085bb,0x3f1ce11f,0x3f07a136,0x3ee1fb6a,0x3f08f59b,0x3ed97cb9,0x3e9d9e78,0x3e3e853e
.long 0x3eb8442a,0x3e5d4b1a,0x3d8a200a,0xbda973ba,0x3e2f10a2,0xbb490fc6,0xbe354098,0xbeb0eacb
.long 0xbcc90ab0,0xbe636c83,0xbed25a09,0xbf1553b7,0xbe605c13,0xbedc53c1,0xbf1ebc12,0xbf476085
.long 0xbecf7bca,0xbf1e1e22,0xbf4ac77f,0xbf6afb8c,0xbf13682a,0xbf466354,0xbf6aab7b,0xbf7d906e
.long 0xbf396842,0xbf650479,0xbf7c7eb0,0xbf7dc68c,0xbf584853,0xbf788486,0xbf7f2f9d,0xbf6b99fb
.long 0xbf6ed89e,0xbf7ff0e3,0xbf7294f8,0xbf485bca,0xbf7c3b28,0xbf7aed37,0xbf577026,0xbf16999f
.long 0x3f7fd397,0x3f7fcbe2,0x3f7fc38f,0x3f7fba9e,0x3f721352,0x3f6faf1b,0x3f6d1c1d,0x3f6a5ad9
.long 0x3f4f7a1f,0x3f476085,0x3f3ebc1b,0x3f3592e7,0x3f1b02c6,0x3f0af1b7,0x3ef41f07,0x3ed0eb2a
.long 0x3eb263ef,0x3e80f8c0,0x3e1c76de,0x3d55880e,0x3d7b2b74,0xbd83db0a,0xbe419b37,0xbe9f1cdf
.long 0xbe6c9a7f,0xbebf926f,0xbf0242b1,0xbf21cbfb,0xbf00e7e4,0xbf256bcb,0xbf44e3f5,0xbf5e5aa6
.long 0xbf3b8f3b,0xbf5a5ba0,0xbf708066,0xbf7d1cdd,0xbf660f88,0xbf7940c0,0xbf7ffec4,0xbf79f35e
.long 0xbf7cbfc9,0xbf7efcc9,0xbf718f57,0xbf554aa4,0xbf7dabcc,0xbf6afb8c,0xbf46e22a,0xbf140c5f
.long 0xbf68bf3c,0xbf3f41fc,0xbf04f484,0xbe7bdba4,0xbf3fc767,0xbf003a06,0xbe4dee60,0x3df475c0
.long 0xbf064b82,0xbe5101f1,0x3e1008b7,0x3eeff7fb,0xbe827dc0,0x3de7fa9a,0x3eee9479,0x3f4154e1
.long 0x0,0x3b490fc6,0x3bc90f88,0x3c16cb58,0x0,0x3ce22a7a,0x3d621469,0x3da973ba
.long 0x0,0x3d55880e,0x3dd53db9,0x3e1f917b,0x0,0x3d9cecf9,0x3e1c76de,0x3e698bba
.long 0x0,0x3dcefdb7,0x3e4dee60,0x3e9920fe,0x0,0x3e007745,0x3e7ee6e1,0x3ebca7af
.long 0x0,0x3e195be0,0x3e97a117,0x3edf28a9,0x0,0x3e3228d4,0x3eaf713a,0x3f003a06
.long 0x0,0x3e4ada4f,0x3ec6d529,0x3f102dd5,0x0,0x3e636c83,0x3eddbe79,0x3f1f599f
.long 0x0,0x3e7bdba4,0x3ef41f07,0x3f2da859,0x0,0x3e8a11f7,0x3f04f484,0x3f3b0629
.long 0x0,0x3e9620d2,0x3f0f8784,0x3f476085,0x0,0x3ea21887,0x3f19c200,0x3f52a649
.long 0x0,0x3eadf73c,0x3f239da9,0x3f5cc7d1,0x0,0x3eb9bb1e,0x3f2d1469,0x3f65b710
.long 0x3c490e90,0x3c7b514b,0x3c96c9b6,0x3cafea69,0x3de1bc2e,0x3e0cec4a,0x3e28defc,0x3e44b0b9
.long 0x3e541501,0x3e840270,0x3e9d9e78,0x3eb6ccc3,0x3e9aa086,0x3ebf926f,0x3ee363fa,0x3f02ef9f
.long 0x3ec9b953,0x3ef840c8,0x3f121eb0,0x3f269de3,0x3ef6e0cb,0x3f16999f,0x3f2f61a5,0x3f456439
.long 0x3f10d3cd,0x3f2ecef7,0x3f48d8b3,0x3f5e5aa6,0x3f24d225,0x3f446337,0x3f5df6be,0x3f70c501
.long 0x3f373a23,0x3f570348,0x3f6e46be,0x3f7c187a,0x3f47de65,0x3f666771,0x3f796e4e,0x3f7fffb1
.long 0x3f5695e5,0x3f725470,0x3f7f2f9d,0x3f7c5d3a,0x3f633c5a,0x3f7a9c59,0x3f7f6ac7,0x3f714c7a
.long 0x3f6db293,0x3f7f1f49,0x3f7a1e84,0x3f5f20db,0x3f75dec6,0x3f7fcbe2,0x3f6f6830,0x3f466354
.long 0x3f7baccd,0x3f7c9f8a,0x3f5f8327,0x3f27ce61,0x3f7f0e58,0x3f75a67b,0x3f4ac77f,0x3f044889
.long 0x3cc90ab0,0x3ce22a7a,0x3cfb49ba,0x3d0a342f,0x3e605c13,0x3e7bdba4,0x3e8b9507,0x3e9920fe
.long 0x3ecf7bca,0x3ee79a5d,0x3eff17b2,0x3f0af1b7,0x3f13682a,0x3f2302d3,0x3f31a81d,0x3f3f41fc
.long 0x3f396842,0x3f4a4c87,0x3f591e6a,0x3f65b710,0x3f584853,0x3f67c187,0x3f73913f,0x3f7b87b2
.long 0x3f6ed89e,0x3f79f35e,0x3f7f6ac7,0x3f7f1f49,0x3f7c3b28,0x3f7fffb1,0x3f7bf531,0x3f703b37
.long 0x3f7fec43,0x3f799b43,0x3f696591,0x3f4fefa8,0x3f79c79d,0x3f671599,0x3f48d8b3,0x3f209393
.long 0x3f6a09a7,0x3f495521,0x3f1c420c,0x3ecb2aae,0x3f514d3d,0x3f21cbfb,0x3ecc9b8b,0x3e0cec4a
.long 0x3f3085bb,0x3ee4cbfe,0x3e28defc,0xbe06b26e,0x3f08f59b,0x3e75c35a,0xbda3308c,0xbec8477c
.long 0x3eb8442a,0x3cafea69,0xbea395c5,0xbf1f599f,0x3e2f10a2,0xbe4ada4f,0xbf0a48ad,0xbf4f0417
.long 0x3d16c32c,0x3d2351cb,0x3d2fe007,0x3d3c6dd5,0x3ea68f12,0x3eb3dca5,0x3ec1071e,0x3ece0bea
.long 0x3f15f6d9,0x3f209393,0x3f2ac082,0x3f34768f,0x3f4bbbf8,0x3f570348,0x3f6106f2,0x3f69b7e4
.long 0x3f6ff573,0x3f77beb7,0x3f7cfe73,0x3f7fa6e3,0x3f7f84ab,0x3f7f7808,0x3f7b61fc,0x3f73530e
.long 0x3f791298,0x3f6d67a1,0x3f5c61c7,0x3f466354,0x3f5d2d53,0x3f436051,0x3f239da9,0x3efdbabb
.long 0x3f2e3bde,0x3f05a02c,0x3eaf713a,0x3e195be0,0x3ee0924f,0x3e698bba,0x3bc90f88,0xbe5d4b1a
.long 0x3e22abb6,0xbdb5f8da,0xbea986c4,0xbf0d9281,0xbe09cf86,0xbecb2aae,0xbf212ff9,0xbf50d937
.long 0xbed53641,0xbf2a2a80,0xbf5ac450,0xbf7822d1,0xbf299415,0xbf5d924d,0xbf7ac516,0xbf7e2b72
.long 0xbf59f26a,0xbf7a9c59,0xbf7d7474,0xbf62241a,0xbf778bc5,0xbf7e5a38,0xbf628210,0xbf27ce61
.long 0x3f800000,0x3f800000,0x3f800000,0x3f800000,0x3f7fffb1,0x3f7fe705,0x3f7fa6e3,0x3f7f3f54
.long 0x3f7ffec4,0x3f7f9c18,0x3f7e9bc9,0x3f7cfe73,0x3f7ffd39,0x3f7f1f49,0x3f7cdf6c,0x3f7940c0
.long 0x3f7ffb11,0x3f7e70b0,0x3f7a7302,0x3f740bdd,0x3f7ff84a,0x3f7d906e,0x3f77583a,0x3f6d67a1
.long 0x3f7ff4e6,0x3f7c7eb0,0x3f73913f,0x3f655e0b,0x3f7ff0e3,0x3f7b3bab,0x3f6f20b0,0x3f5bfb34
.long 0x3f7fec43,0x3f79c79d,0x3f6a09a7,0x3f514d3d,0x3f7fe705,0x3f7822d1,0x3f644fac,0x3f456439
.long 0x3f7fe129,0x3f764d97,0x3f5df6be,0x3f385216,0x3f7fdaaf,0x3f74484b,0x3f570348,0x3f2a2a80
.long 0x3f7fd397,0x3f721352,0x3f4f7a1f,0x3f1b02c6,0x3f7fcbe2,0x3f6faf1b,0x3f476085,0x3f0af1b7
.long 0x3f7fc38f,0x3f6d1c1d,0x3f3ebc1b,0x3ef41f07,0x3f7fba9e,0x3f6a5ad9,0x3f3592e7,0x3ed0eb2a
.long 0x3f800000,0x3f800000,0x3f800000,0x3f800000,0x3f7eb069,0x3f7dfa38,0x3f7d1cdd,0x3f7c187a
.long 0x3f7ac516,0x3f77f110,0x3f748422,0x3f708066,0x3f74484b,0x3f6dfcf2,0x3f666771,0x3f5d924d
.long 0x3f6b4b0c,0x3f604621,0x3f531849,0x3f43e200,0x3f5fe4e9,0x3f4f0417,0x3f3b0629,0x3f24381a
.long 0x3f5233c6,0x3f3a7ca4,0x3f1ebc12,0x3eff17b2,0x3f425b89,0x3f2302d3,0x3efdbabb,0x3eadf73c
.long 0x3f3085bb,0x3f08f59b,0x3eb8442a,0x3e2f10a2,0x3f1ce11f,0x3ed97cb9,0x3e5d4b1a,0xbb490fc6
.long 0x3f07a136,0x3e9d9e78,0x3d8a200a,0xbe354098,0x3ee1fb6a,0x3e3e853e,0xbda973ba,0xbeb0eacb
.long 0x3eb263ef,0x3d7b2b74,0xbe6c9a7f,0xbf00e7e4,0x3e80f8c0,0xbd83db0a,0xbebf926f,0xbf256bcb
.long 0x3e1c76de,0xbe419b37,0xbf0242b1,0xbf44e3f5,0x3d55880e,0xbe9f1cdf,0xbf21cbfb,0xbf5e5aa6
.long 0x3f800000,0x3f800000,0x3f800000,0x3f800000,0x3f7aed37,0x3f799b43,0x3f7822d1,0x3f76841b
.long 0x3f6be858,0x3f66becc,0x3f6106f2,0x3f5ac450,0x3f5389c7,0x3f485bca,0x3f3c17d9,0x3f2ecef7
.long 0x3f32c8c9,0x3f1ff6cb,0x3f0b9a6b,0x3eebcbbb,0x3f0af1b7,0x3edf28a9,0x3ea5129f,0x3e5101f1
.long 0x3ebb31a0,0x3e667c66,0x3da3308c,0xbd8a200a,0x3e3228d4,0x3b490fc6,0xbe2bf804,0xbeab0201
.long 0xbcc90ab0,0xbe605c13,0xbecf7bca,0xbf13682a,0xbe636c83,0xbedc53c1,0xbf1e1e22,0xbf466354
.long 0xbed25a09,0xbf1ebc12,0xbf4ac77f,0xbf6aab7b,0xbf1553b7,0xbf476085,0xbf6afb8c,0xbf7d906e
.long 0xbf3b8f3b,0xbf660f88,0xbf7cbfc9,0xbf7dabcc,0xbf5a5ba0,0xbf7940c0,0xbf7efcc9,0xbf6afb8c
.long 0xbf708066,0xbf7ffec4,0xbf718f57,0xbf46e22a,0xbf7d1cdd,0xbf79f35e,0xbf554aa4,0xbf140c5f
.long 0x3f800000,0x3f800000,0x3f800000,0x3f800000,0x3f74bf62,0x3f72d4eb,0x3f70c501,0x3f6e8ff8
.long 0x3f53fac3,0x3f4cae79,0x3f44e3f5,0x3f3ca003,0x3f209393,0x3f11796b,0x3f019573,0x3ee1fb6a
.long 0x3ebe1d4a,0x3e8e9a22,0x3e3b6ecf,0x3dafb680,0x3da973ba,0xbd2351cb,0xbe25c58c,0xbe901c2c
.long 0xbe5a3997,0xbeb554ec,0xbef9a02d,0xbf1c420c,0xbefafef7,0xbf21cbfb,0xbf4154e1,0xbf5b2c79
.long 0xbf396842,0xbf584853,0xbf6ed89e,0xbf7c3b28,0xbf650479,0xbf788486,0xbf7ff0e3,0xbf7aed37
.long 0xbf7c7eb0,0xbf7f2f9d,0xbf7294f8,0xbf577026,0xbf7dc68c,0xbf6b99fb,0xbf485bca,0xbf16999f
.long 0xbf68bf3c,0xbf3fc767,0xbf064b82,0xbe827dc0,0xbf3f41fc,0xbf003a06,0xbe5101f1,0x3de7fa9a
.long 0xbf04f484,0xbe4dee60,0x3e1008b7,0x3eee9479,0xbe7bdba4,0x3df475c0,0x3eeff7fb,0x3f4154e1
.long 0x0,0x0,0x0,0x0,0x3b490fc6,0x3ce22a7a,0x3d55880e,0x3d9cecf9
.long 0x3bc90f88,0x3d621469,0x3dd53db9,0x3e1c76de,0x3c16cb58,0x3da973ba,0x3e1f917b,0x3e698bba
.long 0x3c490e90,0x3de1bc2e,0x3e541501,0x3e9aa086,0x3c7b514b,0x3e0cec4a,0x3e840270,0x3ebf926f
.long 0x3c96c9b6,0x3e28defc,0x3e9d9e78,0x3ee363fa,0x3cafea69,0x3e44b0b9,0x3eb6ccc3,0x3f02ef9f
.long 0x3cc90ab0,0x3e605c13,0x3ecf7bca,0x3f13682a,0x3ce22a7a,0x3e7bdba4,0x3ee79a5d,0x3f2302d3
.long 0x3cfb49ba,0x3e8b9507,0x3eff17b2,0x3f31a81d,0x3d0a342f,0x3e9920fe,0x3f0af1b7,0x3f3f41fc
.long 0x3d16c32c,0x3ea68f12,0x3f15f6d9,0x3f4bbbf8,0x3d2351cb,0x3eb3dca5,0x3f209393,0x3f570348
.long 0x3d2fe007,0x3ec1071e,0x3f2ac082,0x3f6106f2,0x3d3c6dd5,0x3ece0bea,0x3f34768f,0x3f69b7e4
.long 0x0,0x0,0x0,0x0,0x3dcefdb7,0x3e007745,0x3e195be0,0x3e3228d4
.long 0x3e4dee60,0x3e7ee6e1,0x3e97a117,0x3eaf713a,0x3e9920fe,0x3ebca7af,0x3edf28a9,0x3f003a06
.long 0x3ec9b953,0x3ef6e0cb,0x3f10d3cd,0x3f24d225,0x3ef840c8,0x3f16999f,0x3f2ecef7,0x3f446337
.long 0x3f121eb0,0x3f2f61a5,0x3f48d8b3,0x3f5df6be,0x3f269de3,0x3f456439,0x3f5e5aa6,0x3f70c501
.long 0x3f396842,0x3f584853,0x3f6ed89e,0x3f7c3b28,0x3f4a4c87,0x3f67c187,0x3f79f35e,0x3f7fffb1
.long 0x3f591e6a,0x3f73913f,0x3f7f6ac7,0x3f7bf531,0x3f65b710,0x3f7b87b2,0x3f7f1f49,0x3f703b37
.long 0x3f6ff573,0x3f7f84ab,0x3f791298,0x3f5d2d53,0x3f77beb7,0x3f7f7808,0x3f6d67a1,0x3f436051
.long 0x3f7cfe73,0x3f7b61fc,0x3f5c61c7,0x3f239da9,0x3f7fa6e3,0x3f73530e,0x3f466354,0x3efdbabb
.long 0x0,0x0,0x0,0x0,0x3e4ada4f,0x3e636c83,0x3e7bdba4,0x3e8a11f7
.long 0x3ec6d529,0x3eddbe79,0x3ef41f07,0x3f04f484,0x3f102dd5,0x3f1f599f,0x3f2da859,0x3f3b0629
.long 0x3f373a23,0x3f47de65,0x3f5695e5,0x3f633c5a,0x3f570348,0x3f666771,0x3f725470,0x3f7a9c59
.long 0x3f6e46be,0x3f796e4e,0x3f7f2f9d,0x3f7f6ac7,0x3f7c187a,0x3f7fffb1,0x3f7c5d3a,0x3f714c7a
.long 0x3f7fec43,0x3f79c79d,0x3f6a09a7,0x3f514d3d,0x3f799b43,0x3f671599,0x3f495521,0x3f21cbfb
.long 0x3f696591,0x3f48d8b3,0x3f1c420c,0x3ecc9b8b,0x3f4fefa8,0x3f209393,0x3ecb2aae,0x3e0cec4a
.long 0x3f2e3bde,0x3ee0924f,0x3e22abb6,0xbe09cf86,0x3f05a02c,0x3e698bba,0xbdb5f8da,0xbecb2aae
.long 0x3eaf713a,0x3bc90f88,0xbea986c4,0xbf212ff9,0x3e195be0,0xbe5d4b1a,0xbf0d9281,0xbf50d937
.long 0x0,0x0,0x0,0x0,0x3e9620d2,0x3ea21887,0x3eadf73c,0x3eb9bb1e
.long 0x3f0f8784,0x3f19c200,0x3f239da9,0x3f2d1469,0x3f476085,0x3f52a649,0x3f5cc7d1,0x3f65b710
.long 0x3f6db293,0x3f75dec6,0x3f7baccd,0x3f7f0e58,0x3f7f1f49,0x3f7fcbe2,0x3f7c9f8a,0x3f75a67b
.long 0x3f7a1e84,0x3f6f6830,0x3f5f8327,0x3f4ac77f,0x3f5f20db,0x3f466354,0x3f27ce61,0x3f044889
.long 0x3f3085bb,0x3f08f59b,0x3eb8442a,0x3e2f10a2,0x3ee4cbfe,0x3e75c35a,0x3cafea69,0xbe4ada4f
.long 0x3e28defc,0xbda3308c,0xbea395c5,0xbf0a48ad,0xbe06b26e,0xbec8477c,0xbf1f599f,0xbf4f0417
.long 0xbed53641,0xbf299415,0xbf59f26a,0xbf778bc5,0xbf2a2a80,0xbf5d924d,0xbf7a9c59,0xbf7e5a38
.long 0xbf5ac450,0xbf7ac516,0xbf7d7474,0xbf628210,0xbf7822d1,0xbf7e2b72,0xbf62241a,0xbf27ce61
.long 0x3f803f80,0x3f803f80,0x80008000,0x80008000,0x3f673f80,0x3eac3f2c,0xbedbbd49,0xbf71bf3e
.long 0x3f223f7f,0xbf46bdc9,0xbf46bdc9,0xbf22bf7f,0x3e793f7d,0xbf5cbf4e,0xbf78be16,0x3f04bf18
.long 0xbe483f7b,0x3e48bf7b,0xbf7bbe48,0x3f7b3e48,0xbf183f78,0x3f7dbf04,0xbf4ebe79,0x3e163f5c
.long 0xbf623f75,0x3ef13e95,0xbef1be95,0xbf623f75,0xbf803f71,0xbf2c3f67,0xbd49beac,0xbf3e3edb
.long 0xbf6d3f6d,0xbf6d3f6d,0x3ec4bec4,0x3ec4bec4,0xbf2c3f67,0x3d493eac,0x3f3ebedb,0x3f80bf71
.long 0xbe953f62,0x3f75bef1,0x3f75bef1,0x3e95bf62,0x3e163f5c,0x3f18bf78,0x3f7dbf04,0xbf4ebe79
.long 0x3f0e3f55,0xbf0ebf55,0x3f55bf0e,0xbf553f0e,0x3f5c3f4e,0xbf78be16,0x3f04bf18,0x3e793f7d
.long 0x3f7f3f46,0xbdc93f22,0x3dc9bf22,0x3f7f3f46,0x3f713f3e,0x3f673f80,0xbeacbf2c,0x3edb3d49
.long 0x3f803f80,0x3f803f80,0x80008000,0x80008000,0xbedbbd49,0xbf71bf3e,0xbf67bf80,0xbeacbf2c
.long 0xbf22bf7f,0x3f463dc9,0x3f463dc9,0x3f223f7f,0x3f783e16,0xbf043f18,0x3e793f7d,0xbf5cbf4e
.long 0xbe483f7b,0x3e48bf7b,0xbf7bbe48,0x3f7b3e48,0xbf4ebe79,0x3e163f5c,0x3f18bf78,0xbf7d3f04
.long 0x3f62bf75,0xbef1be95,0x3ef13e95,0x3f62bf75,0x3d493eac,0x3f3ebedb,0xbf803f71,0xbf2c3f67
.long 0xbf6d3f6d,0xbf6d3f6d,0x3ec4bec4,0x3ec4bec4,0x3f3ebedb,0x3f80bf71,0x3f2cbf67,0xbd49beac
.long 0x3e95bf62,0xbf753ef1,0xbf753ef1,0xbe953f62,0xbf7d3f04,0x3f4e3e79,0x3e163f5c,0x3f18bf78
.long 0x3f0e3f55,0xbf0ebf55,0x3f55bf0e,0xbf553f0e,0x3f04bf18,0x3e793f7d,0xbf5cbf4e,0x3f783e16
.long 0xbf7fbf46,0x3dc9bf22,0xbdc93f22,0xbf7fbf46,0x3eac3f2c,0xbedbbd49,0x3f713f3e,0x3f673f80
.long 0x3f803f80,0x3f803f80,0x80008000,0x80008000,0xbf67bf80,0xbeacbf2c,0x3edb3d49,0x3f713f3e
.long 0x3f223f7f,0xbf46bdc9,0xbf46bdc9,0xbf22bf7f,0xbe79bf7d,0x3f5c3f4e,0x3f783e16,0xbf043f18
.long 0xbe483f7b,0x3e48bf7b,0xbf7bbe48,0x3f7b3e48,0x3f18bf78,0xbf7d3f04,0x3f4e3e79,0xbe16bf5c
.long 0xbf623f75,0x3ef13e95,0xbef1be95,0xbf623f75,0x3f80bf71,0x3f2cbf67,0x3d493eac,0x3f3ebedb
.long 0xbf6d3f6d,0xbf6d3f6d,0x3ec4bec4,0x3ec4bec4,0x3f2cbf67,0xbd49beac,0xbf3e3edb,0xbf803f71
.long 0xbe953f62,0x3f75bef1,0x3f75bef1,0x3e95bf62,0xbe16bf5c,0xbf183f78,0xbf7d3f04,0x3f4e3e79
.long 0x3f0e3f55,0xbf0ebf55,0x3f55bf0e,0xbf553f0e,0xbf5cbf4e,0x3f783e16,0xbf043f18,0xbe79bf7d
.long 0x3f7f3f46,0xbdc93f22,0x3dc9bf22,0x3f7f3f46,0xbf71bf3e,0xbf67bf80,0x3eac3f2c,0xbedbbd49
.long 0x3f803f80,0x3f803f80,0x80008000,0x80008000,0x3edb3d49,0x3f713f3e,0x3f673f80,0x3eac3f2c
.long 0xbf22bf7f,0x3f463dc9,0x3f463dc9,0x3f223f7f,0xbf78be16,0x3f04bf18,0xbe79bf7d,0x3f5c3f4e
.long 0xbe483f7b,0x3e48bf7b,0xbf7bbe48,0x3f7b3e48,0x3f4e3e79,0xbe16bf5c,0xbf183f78,0x3f7dbf04
.long 0x3f62bf75,0xbef1be95,0x3ef13e95,0x3f62bf75,0xbd49beac,0xbf3e3edb,0x3f80bf71,0x3f2cbf67
.long 0xbf6d3f6d,0xbf6d3f6d,0x3ec4bec4,0x3ec4bec4,0xbf3e3edb,0xbf803f71,0xbf2c3f67,0x3d493eac
.long 0x3e95bf62,0xbf753ef1,0xbf753ef1,0xbe953f62,0x3f7dbf04,0xbf4ebe79,0xbe16bf5c,0xbf183f78
.long 0x3f0e3f55,0xbf0ebf55,0x3f55bf0e,0xbf553f0e,0xbf043f18,0xbe79bf7d,0x3f5c3f4e,0xbf78be16
.long 0xbf7fbf46,0x3dc9bf22,0xbdc93f22,0xbf7fbf46,0xbeacbf2c,0x3edb3d49,0xbf71bf3e,0xbf67bf80
.long 0x0,0x0,0x3f803f80,0x3f803f80,0x3edb3d49,0x3f713f3e,0x3f673f80,0x3eac3f2c
.long 0x3f463dc9,0x3f223f7f,0x3f223f7f,0xbf46bdc9,0x3f783e16,0xbf043f18,0x3e793f7d,0xbf5cbf4e
.long 0x3f7b3e48,0xbf7bbe48,0xbe483f7b,0x3e48bf7b,0x3f4e3e79,0xbe16bf5c,0xbf183f78,0x3f7dbf04
.long 0x3ef13e95,0x3f62bf75,0xbf623f75,0x3ef13e95,0x3d493eac,0x3f3ebedb,0xbf803f71,0xbf2c3f67
.long 0xbec43ec4,0xbec43ec4,0xbf6d3f6d,0xbf6d3f6d,0xbf3e3edb,0xbf803f71,0xbf2c3f67,0x3d493eac
.long 0xbf753ef1,0xbe953f62,0xbe953f62,0x3f75bef1,0xbf7d3f04,0x3f4e3e79,0x3e163f5c,0x3f18bf78
.long 0xbf553f0e,0x3f55bf0e,0x3f0e3f55,0xbf0ebf55,0xbf043f18,0xbe79bf7d,0x3f5c3f4e,0xbf78be16
.long 0xbdc93f22,0xbf7fbf46,0x3f7f3f46,0xbdc93f22,0x3eac3f2c,0xbedbbd49,0x3f713f3e,0x3f673f80
.long 0x0,0x0,0x3f803f80,0x3f803f80,0x3f673f80,0x3eac3f2c,0xbedbbd49,0xbf71bf3e
.long 0xbf46bdc9,0xbf22bf7f,0xbf22bf7f,0x3f463dc9,0xbe79bf7d,0x3f5c3f4e,0x3f783e16,0xbf043f18
.long 0x3f7b3e48,0xbf7bbe48,0xbe483f7b,0x3e48bf7b,0xbf183f78,0x3f7dbf04,0xbf4ebe79,0x3e163f5c
.long 0xbef1be95,0xbf623f75,0x3f62bf75,0xbef1be95,0x3f80bf71,0x3f2cbf67,0x3d493eac,0x3f3ebedb
.long 0xbec43ec4,0xbec43ec4,0xbf6d3f6d,0xbf6d3f6d,0xbf2c3f67,0x3d493eac,0x3f3ebedb,0x3f80bf71
.long 0x3f75bef1,0x3e95bf62,0x3e95bf62,0xbf753ef1,0xbe16bf5c,0xbf183f78,0xbf7d3f04,0x3f4e3e79
.long 0xbf553f0e,0x3f55bf0e,0x3f0e3f55,0xbf0ebf55,0x3f5c3f4e,0xbf78be16,0x3f04bf18,0x3e793f7d
.long 0x3dc9bf22,0x3f7f3f46,0xbf7fbf46,0x3dc9bf22,0xbf71bf3e,0xbf67bf80,0x3eac3f2c,0xbedbbd49
.long 0x0,0x0,0x3f803f80,0x3f803f80,0xbedbbd49,0xbf71bf3e,0xbf67bf80,0xbeacbf2c
.long 0x3f463dc9,0x3f223f7f,0x3f223f7f,0xbf46bdc9,0xbf78be16,0x3f04bf18,0xbe79bf7d,0x3f5c3f4e
.long 0x3f7b3e48,0xbf7bbe48,0xbe483f7b,0x3e48bf7b,0xbf4ebe79,0x3e163f5c,0x3f18bf78,0xbf7d3f04
.long 0x3ef13e95,0x3f62bf75,0xbf623f75,0x3ef13e95,0xbd49beac,0xbf3e3edb,0x3f80bf71,0x3f2cbf67
.long 0xbec43ec4,0xbec43ec4,0xbf6d3f6d,0xbf6d3f6d,0x3f3ebedb,0x3f80bf71,0x3f2cbf67,0xbd49beac
.long 0xbf753ef1,0xbe953f62,0xbe953f62,0x3f75bef1,0x3f7dbf04,0xbf4ebe79,0xbe16bf5c,0xbf183f78
.long 0xbf553f0e,0x3f55bf0e,0x3f0e3f55,0xbf0ebf55,0x3f04bf18,0x3e793f7d,0xbf5cbf4e,0x3f783e16
.long 0xbdc93f22,0xbf7fbf46,0x3f7f3f46,0xbdc93f22,0xbeacbf2c,0x3edb3d49,0xbf71bf3e,0xbf67bf80
.long 0x0,0x0,0x3f803f80,0x3f803f80,0xbf67bf80,0xbeacbf2c,0x3edb3d49,0x3f713f3e
.long 0xbf46bdc9,0xbf22bf7f,0xbf22bf7f,0x3f463dc9,0x3e793f7d,0xbf5cbf4e,0xbf78be16,0x3f04bf18
.long 0x3f7b3e48,0xbf7bbe48,0xbe483f7b,0x3e48bf7b,0x3f18bf78,0xbf7d3f04,0x3f4e3e79,0xbe16bf5c
.long 0xbef1be95,0xbf623f75,0x3f62bf75,0xbef1be95,0xbf803f71,0xbf2c3f67,0xbd49beac,0xbf3e3edb
.long 0xbec43ec4,0xbec43ec4,0xbf6d3f6d,0xbf6d3f6d,0x3f2cbf67,0xbd49beac,0xbf3e3edb,0xbf803f71
.long 0x3f75bef1,0x3e95bf62,0x3e95bf62,0xbf753ef1,0x3e163f5c,0x3f18bf78,0x3f7dbf04,0xbf4ebe79
.long 0xbf553f0e,0x3f55bf0e,0x3f0e3f55,0xbf0ebf55,0xbf5cbf4e,0x3f783e16,0xbf043f18,0xbe79bf7d
.long 0x3dc9bf22,0x3f7f3f46,0xbf7fbf46,0x3dc9bf22,0x3f713f3e,0x3f673f80,0xbeacbf2c,0x3edb3d49
.long 0x3f80,0x3dc93f7f,0x3e483f7b,0x3e953f75,0x3f80,0x3ef13f62,0x3f553f0e,0x3f7f3dc9
.long 0x3f80,0x3f463f22,0x3f7bbe48,0x3ef1bf62,0x3f80,0x3f753e95,0x3f0ebf55,0xbf22bf46
.long 0x3f80,0x3f7fbdc9,0xbe48bf7b,0xbf753e95,0x3f80,0x3f62bef1,0xbf55bf0e,0xbdc93f7f
.long 0x3f80,0x3f22bf46,0xbf7b3e48,0x3f623ef1,0x3f80,0x3e95bf75,0xbf0e3f55,0x3f46bf22
.long 0x3f80,0xbdc9bf7f,0x3e483f7b,0xbe95bf75,0x3f80,0xbef1bf62,0x3f553f0e,0xbf7fbdc9
.long 0x3f80,0xbf46bf22,0x3f7bbe48,0xbef13f62,0x3f80,0xbf75be95,0x3f0ebf55,0x3f223f46
.long 0x3f80,0xbf7f3dc9,0xbe48bf7b,0x3f75be95,0x3f80,0xbf623ef1,0xbf55bf0e,0x3dc9bf7f
.long 0x3f80,0xbf223f46,0xbf7b3e48,0xbf62bef1,0x3f80,0xbe953f75,0xbf0e3f55,0xbf463f22
.long 0x3ec43f6d,0x3ef13f62,0x3f0e3f55,0x3f223f46,0x3f6dbec4,0x3f22bf46,0x3e48bf7b,0xbe95bf75
.long 0xbec4bf6d,0xbf75be95,0xbf553f0e,0xbdc93f7f,0xbf6d3ec4,0x3dc93f7f,0x3f7b3e48,0x3ef1bf62
.long 0x3ec43f6d,0x3f62bef1,0xbf0ebf55,0xbf463f22,0x3f6dbec4,0xbf46bf22,0xbe483f7b,0x3f75be95
.long 0xbec4bf6d,0xbe953f75,0x3f55bf0e,0xbf7fbdc9,0xbf6d3ec4,0x3f7fbdc9,0xbf7bbe48,0x3f623ef1
.long 0x3ec43f6d,0xbef1bf62,0x3f0e3f55,0xbf22bf46,0x3f6dbec4,0xbf223f46,0x3e48bf7b,0x3e953f75
.long 0xbec4bf6d,0x3f753e95,0xbf553f0e,0x3dc9bf7f,0xbf6d3ec4,0xbdc9bf7f,0x3f7b3e48,0xbef13f62
.long 0x3ec43f6d,0xbf623ef1,0xbf0ebf55,0x3f46bf22,0x3f6dbec4,0x3f463f22,0xbe483f7b,0xbf753e95
.long 0xbec4bf6d,0x3e95bf75,0x3f55bf0e,0x3f7f3dc9,0xbf6d3ec4,0xbf7f3dc9,0xbf7bbe48,0xbf62bef1
.long 0x3f353f35,0x3f463f22,0x3f553f0e,0x3f623ef1,0xbf35bf35,0xbf75be95,0xbf7b3e48,0xbf463f22
.long 0x3f353f35,0x3f7fbdc9,0x3f0ebf55,0xbe95bf75,0xbf35bf35,0xbf623ef1,0x3e483f7b,0x3f7f3dc9
.long 0x3f353f35,0x3f22bf46,0xbf55bf0e,0xbef13f62,0xbf35bf35,0xbe953f75,0x3f7bbe48,0xbf22bf46
.long 0x3f353f35,0xbdc9bf7f,0xbf0e3f55,0x3f75be95,0xbf35bf35,0x3ef13f62,0xbe48bf7b,0xbdc93f7f
.long 0x3f353f35,0xbf46bf22,0x3f553f0e,0xbf62bef1,0xbf35bf35,0x3f753e95,0xbf7b3e48,0x3f46bf22
.long 0x3f353f35,0xbf7f3dc9,0x3f0ebf55,0x3e953f75,0xbf35bf35,0x3f62bef1,0x3e483f7b,0xbf7fbdc9
.long 0x3f353f35,0xbf223f46,0xbf55bf0e,0x3ef1bf62,0xbf35bf35,0x3e95bf75,0x3f7bbe48,0x3f223f46
.long 0x3f353f35,0x3dc93f7f,0xbf0e3f55,0xbf753e95,0xbf35bf35,0xbef1bf62,0xbe48bf7b,0x3dc9bf7f
.long 0x3f6d3ec4,0x3f753e95,0x3f7b3e48,0x3f7f3dc9,0xbec43f6d,0x3dc93f7f,0x3f0e3f55,0x3f623ef1
.long 0xbf6dbec4,0xbf623ef1,0xbe483f7b,0x3f223f46,0x3ec4bf6d,0xbf46bf22,0xbf553f0e,0x3e953f75
.long 0x3f6d3ec4,0x3e95bf75,0xbf7bbe48,0xbdc93f7f,0xbec43f6d,0x3f7fbdc9,0xbf0ebf55,0xbef13f62
.long 0xbf6dbec4,0x3ef13f62,0x3e48bf7b,0xbf463f22,0x3ec4bf6d,0xbf223f46,0x3f55bf0e,0xbf753e95
.long 0x3f6d3ec4,0xbf75be95,0x3f7b3e48,0xbf7fbdc9,0xbec43f6d,0xbdc9bf7f,0x3f0e3f55,0xbf62bef1
.long 0xbf6dbec4,0x3f62bef1,0xbe483f7b,0xbf22bf46,0x3ec4bf6d,0x3f463f22,0xbf553f0e,0xbe95bf75
.long 0x3f6d3ec4,0xbe953f75,0xbf7bbe48,0x3dc9bf7f,0xbec43f6d,0xbf7f3dc9,0xbf0ebf55,0x3ef1bf62
.long 0xbf6dbec4,0xbef1bf62,0x3e48bf7b,0x3f46bf22,0x3ec4bf6d,0x3f22bf46,0x3f55bf0e,0x3f75be95
.long 0x3f808000,0x3f7fbdc9,0x3f7bbe48,0x3f75be95,0x3f808000,0x3f62bef1,0x3f0ebf55,0x3dc9bf7f
.long 0x3f808000,0x3f22bf46,0xbe48bf7b,0xbf62bef1,0x3f808000,0x3e95bf75,0xbf55bf0e,0xbf463f22
.long 0x3f808000,0xbdc9bf7f,0xbf7b3e48,0x3e953f75,0x3f808000,0xbef1bf62,0xbf0e3f55,0x3f7f3dc9
.long 0x3f808000,0xbf46bf22,0x3e483f7b,0x3ef1bf62,0x3f808000,0xbf75be95,0x3f553f0e,0xbf22bf46
.long 0x3f808000,0xbf7f3dc9,0x3f7bbe48,0xbf753e95,0x3f808000,0xbf623ef1,0x3f0ebf55,0xbdc93f7f
.long 0x3f808000,0xbf223f46,0xbe48bf7b,0x3f623ef1,0x3f808000,0xbe953f75,0xbf55bf0e,0x3f46bf22
.long 0x3f808000,0x3dc93f7f,0xbf7b3e48,0xbe95bf75,0x3f808000,0x3ef13f62,0xbf0e3f55,0xbf7fbdc9
.long 0x3f808000,0x3f463f22,0x3e483f7b,0xbef13f62,0x3f808000,0x3f753e95,0x3f553f0e,0x3f223f46
.long 0x3f6dbec4,0x3f62bef1,0x3f55bf0e,0x3f46bf22,0xbec4bf6d,0xbf46bf22,0xbf7bbe48,0xbf753e95
.long 0xbf6d3ec4,0xbe953f75,0x3f0e3f55,0x3f7f3dc9,0x3ec43f6d,0x3f7fbdc9,0x3e48bf7b,0xbf62bef1
.long 0x3f6dbec4,0xbef1bf62,0xbf553f0e,0x3f223f46,0xbec4bf6d,0xbf223f46,0x3f7b3e48,0xbe95bf75
.long 0xbf6d3ec4,0x3f753e95,0xbf0ebf55,0xbdc93f7f,0x3ec43f6d,0xbdc9bf7f,0xbe483f7b,0x3ef1bf62
.long 0x3f6dbec4,0xbf623ef1,0x3f55bf0e,0xbf463f22,0xbec4bf6d,0x3f463f22,0xbf7bbe48,0x3f75be95
.long 0xbf6d3ec4,0x3e95bf75,0x3f0e3f55,0xbf7fbdc9,0x3ec43f6d,0xbf7f3dc9,0x3e48bf7b,0x3f623ef1
.long 0x3f6dbec4,0x3ef13f62,0xbf553f0e,0xbf22bf46,0xbec4bf6d,0x3f22bf46,0x3f7b3e48,0x3e953f75
.long 0xbf6d3ec4,0xbf75be95,0xbf0ebf55,0x3dc9bf7f,0x3ec43f6d,0x3dc93f7f,0xbe483f7b,0xbef13f62
.long 0x3f35bf35,0x3f22bf46,0x3f0ebf55,0x3ef1bf62,0xbf353f35,0xbe953f75,0x3e483f7b,0x3f223f46
.long 0x3f35bf35,0xbdc9bf7f,0xbf55bf0e,0xbf753e95,0xbf353f35,0x3ef13f62,0x3f7bbe48,0x3dc9bf7f
.long 0x3f35bf35,0xbf46bf22,0xbf0e3f55,0x3f623ef1,0xbf353f35,0x3f753e95,0xbe48bf7b,0xbf463f22
.long 0x3f35bf35,0xbf7f3dc9,0x3f553f0e,0xbe95bf75,0xbf353f35,0x3f62bef1,0xbf7b3e48,0x3f7f3dc9
.long 0x3f35bf35,0xbf223f46,0x3f0ebf55,0xbef13f62,0xbf353f35,0x3e95bf75,0x3e483f7b,0xbf22bf46
.long 0x3f35bf35,0x3dc93f7f,0xbf55bf0e,0x3f75be95,0xbf353f35,0xbef1bf62,0x3f7bbe48,0xbdc93f7f
.long 0x3f35bf35,0x3f463f22,0xbf0e3f55,0xbf62bef1,0xbf353f35,0xbf75be95,0xbe48bf7b,0x3f46bf22
.long 0x3f35bf35,0x3f7fbdc9,0x3f553f0e,0x3e953f75,0xbf353f35,0xbf623ef1,0xbf7b3e48,0xbf7fbdc9
.long 0x3ec4bf6d,0x3e95bf75,0x3e48bf7b,0x3dc9bf7f,0x3f6d3ec4,0x3f7fbdc9,0x3f55bf0e,0x3ef1bf62
.long 0xbec43f6d,0x3ef13f62,0x3f7b3e48,0x3f46bf22,0xbf6dbec4,0xbf223f46,0x3f0e3f55,0x3f75be95
.long 0x3ec4bf6d,0xbf75be95,0xbe483f7b,0x3f7f3dc9,0x3f6d3ec4,0xbdc9bf7f,0xbf553f0e,0x3f623ef1
.long 0xbec43f6d,0x3f62bef1,0xbf7bbe48,0x3f223f46,0xbf6dbec4,0x3f463f22,0xbf0ebf55,0x3e953f75
.long 0x3ec4bf6d,0xbe953f75,0x3e48bf7b,0xbdc93f7f,0x3f6d3ec4,0xbf7f3dc9,0x3f55bf0e,0xbef13f62
.long 0xbec43f6d,0xbef1bf62,0x3f7b3e48,0xbf463f22,0xbf6dbec4,0x3f22bf46,0x3f0e3f55,0xbf753e95
.long 0x3ec4bf6d,0x3f753e95,0xbe483f7b,0xbf7fbdc9,0x3f6d3ec4,0x3dc93f7f,0xbf553f0e,0xbf62bef1
.long 0xbec43f6d,0xbf623ef1,0xbf7bbe48,0xbf22bf46,0xbf6dbec4,0xbf46bf22,0xbf0ebf55,0xbe95bf75
.long 0x3f800000,0x3f7ffec4,0x3f7ffb11,0x3f7ff4e6,0x3f800000,0x3f7fe129,0x3f7f84ab,0x3f7eea9d
.long 0x3f800000,0x3f7f9c18,0x3f7e70b0,0x3f7c7eb0,0x3f800000,0x3f7f2f9d,0x3f7cbfc9,0x3f78b47b
.long 0x3f800000,0x3f7e9bc9,0x3f7a7302,0x3f73913f,0x3f800000,0x3f7de0b1,0x3f778bc5,0x3f6d1c1d
.long 0x3f800000,0x3f7cfe73,0x3f740bdd,0x3f655e0b,0x3f800000,0x3f7bf531,0x3f6ff573,0x3f5c61c7
.long 0x3f800000,0x3f7ac516,0x3f6b4b0c,0x3f5233c6,0x3f800000,0x3f796e4e,0x3f660f88,0x3f46e22a
.long 0x3f800000,0x3f77f110,0x3f604621,0x3f3a7ca4,0x3f800000,0x3f764d97,0x3f59f26a,0x3f2d1469
.long 0x3f800000,0x3f748422,0x3f531849,0x3f1ebc12,0x3f800000,0x3f7294f8,0x3f4bbbf8,0x3f0f8784
.long 0x3f800000,0x3f708066,0x3f43e200,0x3eff17b2,0x3f800000,0x3f6e46be,0x3f3b8f3b,0x3eddbe79
.long 0x3f7fec43,0x3f7fe129,0x3f7fd397,0x3f7fc38f,0x3f7e1324,0x3f7cfe73,0x3f7baccd,0x3f7a1e84
.long 0x3f79c79d,0x3f764d97,0x3f721352,0x3f6d1c1d,0x3f731447,0x3f6be858,0x3f633c5a,0x3f591e6a
.long 0x3f6a09a7,0x3f5df6be,0x3f4f7a1f,0x3f3ebc1b,0x3f5ebe05,0x3f4cae79,0x3f373a23,0x3f1ebc12
.long 0x3f514d3d,0x3f385216,0x3f1b02c6,0x3ef41f07,0x3f41d870,0x3f212ff9,0x3ef6e0cb,0x3ea395c5
.long 0x3f3085bb,0x3f07a136,0x3eb263ef,0x3e1c76de,0x3f1d7fd1,0x3ed8106b,0x3e541501,0xbc96c9b6
.long 0x3f08f59b,0x3e9d9e78,0x3d7b2b74,0xbe419b37,0x3ee63375,0x3e419b37,0xbdafb680,0xbeb554ec
.long 0x3eb8442a,0x3d8a200a,0xbe6c9a7f,0xbf0242b1,0x3e888e93,0xbd621469,0xbebe1d4a,0xbf26050a
.long 0x3e2f10a2,0xbe354098,0xbf00e7e4,0xbf44e3f5,0x3d96a905,0xbe97a117,0xbf1ff6cb,0xbf5df6be
.long 0x3f7fb10f,0x3f7f9c18,0x3f7f84ab,0x3f7f6ac7,0x3f7853f8,0x3f764d97,0x3f740bdd,0x3f718f57
.long 0x3f676bd8,0x3f6106f2,0x3f59f26a,0x3f5233c6,0x3f4d9f02,0x3f40d0da,0x3f32c8c9,0x3f239da9
.long 0x3f2beb4a,0x3f173c07,0x3f00e7e4,0x3ed25a09,0x3f039c3d,0x3ecc9b8b,0x3e8e9a22,0x3e1c76de
.long 0x3eac7cd4,0x3e419b37,0x3d16c32c,0xbdee3876,0x3e164083,0xbcfb49ba,0xbe541501,0xbec1071e
.long 0xbd48fb30,0xbe7ee6e1,0xbee0924f,0xbf1c420c,0xbe78cfcc,0xbee900b7,0xbf24d225,0xbf4cae79
.long 0xbedae880,0xbf239da9,0xbf4f7a1f,0xbf6e46be,0xbf187fc0,0xbf4ac77f,0xbf6db293,0xbf7e9bc9
.long 0xbf3daef9,0xbf6816a8,0xbf7dabcc,0xbf7c7eb0,0xbf5b941a,0xbf7a1e84,0xbf7e70b0,0xbf6816a8
.long 0xbf710908,0xbf7ffec4,0xbf6ff573,0xbf42de29,0xbf7d3aac,0xbf796e4e,0xbf531849,0xbf0f8784
.long 0x3f7f4e6d,0x3f7f2f9d,0x3f7f0e58,0x3f7eea9d,0x3f6ed89e,0x3f6be858,0x3f68bf3c,0x3f655e0b
.long 0x3f49d112,0x3f40d0da,0x3f373a23,0x3f2d1469,0x3f13682a,0x3f0242b1,0x3ee0924f,0x3ebb31a0
.long 0x3ea09ae5,0x3e5a3997,0x3de1bc2e,0x3bc90f88,0x3cc90ab0,0xbdd53db9,0xbe6c9a7f,0xbeb554ec
.long 0xbe888e93,0xbed25a09,0xbf0b9a6b,0xbf2ac082,0xbf08f59b,0xbf2d1469,0xbf4bbbf8,0xbf63f473
.long 0xbf41d870,0xbf5f8327,0xbf740bdd,0xbf7e9bc9,0xbf6a09a7,0xbf7b61fc,0xbf7fd397,0xbf772417
.long 0xbf7e1324,0xbf7de0b1,0xbf6db293,0xbf4e8d90,0xbf7c3b28,0xbf66becc,0xbf3fc767,0xbf0a48ad
.long 0xbf64aa59,0xbf385216,0xbef6e0cb,0xbe4dee60,0xbf396842,0xbeee9479,0xbe22abb6,0x3e28defc
.long 0xbefc5d27,0xbe28defc,0x3e3b6ecf,0x3f0242b1,0xbe605c13,0x3e1c76de,0x3f00e7e4,0x3f48d8b3
.long 0x0,0x3bc90f88,0x3c490e90,0x3c96c9b6,0x0,0x3cfb49ba,0x3d7b2b74,0x3dbc3ac3
.long 0x0,0x3d621469,0x3de1bc2e,0x3e28defc,0x0,0x3da3308c,0x3e22abb6,0x3e72b651
.long 0x0,0x3dd53db9,0x3e541501,0x3e9d9e78,0x0,0x3e039502,0x3e827dc0,0x3ec1071e
.long 0x0,0x3e1c76de,0x3e9aa086,0x3ee363fa,0x0,0x3e354098,0x3eb263ef,0x3f0242b1
.long 0x0,0x3e4dee60,0x3ec9b953,0x3f121eb0,0x0,0x3e667c66,0x3ee0924f,0x3f212ff9
.long 0x0,0x3e7ee6e1,0x3ef6e0cb,0x3f2f61a5,0x0,0x3e8b9507,0x3f064b82,0x3f3ca003
.long 0x0,0x3e97a117,0x3f10d3cd,0x3f48d8b3,0x0,0x3ea395c5,0x3f1b02c6,0x3f53fac3
.long 0x0,0x3eaf713a,0x3f24d225,0x3f5df6be,0x0,0x3ebb31a0,0x3f2e3bde,0x3f66becc
.long 0x3cc90ab0,0x3cfb49ba,0x3d16c32c,0x3d2fe007,0x3dfab273,0x3e1c76de,0x3e3b6ecf,0x3e5a3997
.long 0x3e605c13,0x3e8b9507,0x3ea68f12,0x3ec1071e,0x3ea09ae5,0x3ec6d529,0x3eebcbbb,0x3f07a136
.long 0x3ecf7bca,0x3eff17b2,0x3f15f6d9,0x3f2ac082,0x3efc5d27,0x3f19c200,0x3f32c8c9,0x3f48d8b3
.long 0x3f13682a,0x3f31a81d,0x3f4bbbf8,0x3f6106f2,0x3f273656,0x3f46e22a,0x3f604621,0x3f7294f8
.long 0x3f396842,0x3f591e6a,0x3f6ff573,0x3f7cfe73,0x3f49d112,0x3f6816a8,0x3f7a7302,0x3f7ff4e6
.long 0x3f584853,0x3f73913f,0x3f7f84ab,0x3f7b61fc,0x3f64aa59,0x3f7b61fc,0x3f7f0e58,0x3f6f6830
.long 0x3f6ed89e,0x3f7f6ac7,0x3f791298,0x3f5c61c7,0x3f76ba07,0x3f7f9c18,0x3f6db293,0x3f42de29
.long 0x3f7c3b28,0x3f7bf531,0x3f5d2d53,0x3f239da9,0x3f7f4e6d,0x3f748422,0x3f47de65,0x3eff17b2
.long 0x3d48fb30,0x3d621469,0x3d7b2b74,0x3d8a200a,0x3e78cfcc,0x3e8b9507,0x3e9aa086,0x3ea986c4
.long 0x3edae880,0x3ef41f07,0x3f064b82,0x3f121eb0,0x3f187fc0,0x3f286605,0x3f373a23,0x3f44e3f5
.long 0x3f3daef9,0x3f4e8d90,0x3f5d2d53,0x3f696591,0x3f5b941a,0x3f6aab7b,0x3f75dec6,0x3f7cfe73
.long 0x3f710908,0x3f7b61fc,0x3f7fd397,0x3f7e4323,0x3f7d3aac,0x3f7fe129,0x3f7a7302,0x3f6d1c1d
.long 0x3f7fb10f,0x3f77f110,0x3f660f88,0x3f4ac77f,0x3f7853f8,0x3f63f473,0x3f43e200,0x3f19c200
.long 0x3f676bd8,0x3f44e3f5,0x3f15f6d9,0x3ebb31a0,0x3f4d9f02,0x3f1c420c,0x3ebe1d4a,0x3dd53db9
.long 0x3f2beb4a,0x3ed8106b,0x3e09cf86,0xbe28defc,0x3f039c3d,0x3e5a3997,0xbde1bc2e,0xbed8106b
.long 0x3eac7cd4,0xbbc90f88,0xbeb263ef,0xbf26050a,0x3e164083,0xbe667c66,0xbf10d3cd,0xbf53fac3
.long 0x3d96a905,0x3da3308c,0x3dafb680,0x3dbc3ac3,0x3eb8442a,0x3ec6d529,0x3ed53641,0x3ee363fa
.long 0x3f1d7fd1,0x3f286605,0x3f32c8c9,0x3f3ca003,0x3f514d3d,0x3f5c61c7,0x3f660f88,0x3f6e46be
.long 0x3f731447,0x3f7a1e84,0x3f7e70b0,0x3f7ffec4,0x3f7fec43,0x3f7e9bc9,0x3f791298,0x3f6f6830
.long 0x3f76ba07,0x3f696591,0x3f5695e5,0x3f3ebc1b,0x3f584853,0x3f3ca003,0x3f1b02c6,0x3ee900b7
.long 0x3f273656,0x3ef9a02d,0x3e9aa086,0x3dd53db9,0x3ecf7bca,0x3e419b37,0xbd16c32c,0xbe8586ce
.long 0x3dfab273,0xbe039502,0xbebe1d4a,0xbf173c07,0xbe2f10a2,0xbeddbe79,0xbf299415,0xbf577026
.long 0xbee63375,0xbf31a81d,0xbf604621,0xbf7ac516,0xbf3085bb,0xbf628210,0xbf7cbfc9,0xbf7c7eb0
.long 0xbf5ebe05,0xbf7c7eb0,0xbf7baccd,0xbf5c61c7,0xbf79c79d,0xbf7cfe73,0xbf5d2d53,0xbf1ebc12
.long 0x3f800000,0x3f800000,0x3f800000,0x3f800000,0x3f7ffec4,0x3f7fe129,0x3f7f9c18,0x3f7f2f9d
.long 0x3f7ffb11,0x3f7f84ab,0x3f7e70b0,0x3f7cbfc9,0x3f7ff4e6,0x3f7eea9d,0x3f7c7eb0,0x3f78b47b
.long 0x3f7fec43,0x3f7e1324,0x3f79c79d,0x3f731447,0x3f7fe129,0x3f7cfe73,0x3f764d97,0x3f6be858
.long 0x3f7fd397,0x3f7baccd,0x3f721352,0x3f633c5a,0x3f7fc38f,0x3f7a1e84,0x3f6d1c1d,0x3f591e6a
.long 0x3f7fb10f,0x3f7853f8,0x3f676bd8,0x3f4d9f02,0x3f7f9c18,0x3f764d97,0x3f6106f2,0x3f40d0da
.long 0x3f7f84ab,0x3f740bdd,0x3f59f26a,0x3f32c8c9,0x3f7f6ac7,0x3f718f57,0x3f5233c6,0x3f239da9
.long 0x3f7f4e6d,0x3f6ed89e,0x3f49d112,0x3f13682a,0x3f7f2f9d,0x3f6be858,0x3f40d0da,0x3f0242b1
.long 0x3f7f0e58,0x3f68bf3c,0x3f373a23,0x3ee0924f,0x3f7eea9d,0x3f655e0b,0x3f2d1469,0x3ebb31a0
.long 0x3f800000,0x3f800000,0x3f800000,0x3f800000,0x3f7e9bc9,0x3f7de0b1,0x3f7cfe73,0x3f7bf531
.long 0x3f7a7302,0x3f778bc5,0x3f740bdd,0x3f6ff573,0x3f73913f,0x3f6d1c1d,0x3f655e0b,0x3f5c61c7
.long 0x3f6a09a7,0x3f5ebe05,0x3f514d3d,0x3f41d870,0x3f5df6be,0x3f4cae79,0x3f385216,0x3f212ff9
.long 0x3f4f7a1f,0x3f373a23,0x3f1b02c6,0x3ef6e0cb,0x3f3ebc1b,0x3f1ebc12,0x3ef41f07,0x3ea395c5
.long 0x3f2beb4a,0x3f039c3d,0x3eac7cd4,0x3e164083,0x3f173c07,0x3ecc9b8b,0x3e419b37,0xbcfb49ba
.long 0x3f00e7e4,0x3e8e9a22,0x3d16c32c,0xbe541501,0x3ed25a09,0x3e1c76de,0xbdee3876,0xbec1071e
.long 0x3ea09ae5,0x3cc90ab0,0xbe888e93,0xbf08f59b,0x3e5a3997,0xbdd53db9,0xbed25a09,0xbf2d1469
.long 0x3de1bc2e,0xbe6c9a7f,0xbf0b9a6b,0xbf4bbbf8,0x3bc90f88,0xbeb554ec,0xbf2ac082,0xbf63f473
.long 0x3f800000,0x3f800000,0x3f800000,0x3f800000,0x3f7ac516,0x3f796e4e,0x3f77f110,0x3f764d97
.long 0x3f6b4b0c,0x3f660f88,0x3f604621,0x3f59f26a,0x3f5233c6,0x3f46e22a,0x3f3a7ca4,0x3f2d1469
.long 0x3f3085bb,0x3f1d7fd1,0x3f08f59b,0x3ee63375,0x3f07a136,0x3ed8106b,0x3e9d9e78,0x3e419b37
.long 0x3eb263ef,0x3e541501,0x3d7b2b74,0xbdafb680,0x3e1c76de,0xbc96c9b6,0xbe419b37,0xbeb554ec
.long 0xbd48fb30,0xbe78cfcc,0xbedae880,0xbf187fc0,0xbe7ee6e1,0xbee900b7,0xbf239da9,0xbf4ac77f
.long 0xbee0924f,0xbf24d225,0xbf4f7a1f,0xbf6db293,0xbf1c420c,0xbf4cae79,0xbf6e46be,0xbf7e9bc9
.long 0xbf41d870,0xbf6a09a7,0xbf7e1324,0xbf7c3b28,0xbf5f8327,0xbf7b61fc,0xbf7de0b1,0xbf66becc
.long 0xbf740bdd,0xbf7fd397,0xbf6db293,0xbf3fc767,0xbf7e9bc9,0xbf772417,0xbf4e8d90,0xbf0a48ad
.long 0x3f800000,0x3f800000,0x3f800000,0x3f800000,0x3f748422,0x3f7294f8,0x3f708066,0x3f6e46be
.long 0x3f531849,0x3f4bbbf8,0x3f43e200,0x3f3b8f3b,0x3f1ebc12,0x3f0f8784,0x3eff17b2,0x3eddbe79
.long 0x3eb8442a,0x3e888e93,0x3e2f10a2,0x3d96a905,0x3d8a200a,0xbd621469,0xbe354098,0xbe97a117
.long 0xbe6c9a7f,0xbebe1d4a,0xbf00e7e4,0xbf1ff6cb,0xbf0242b1,0xbf26050a,0xbf44e3f5,0xbf5df6be
.long 0xbf3daef9,0xbf5b941a,0xbf710908,0xbf7d3aac,0xbf6816a8,0xbf7a1e84,0xbf7ffec4,0xbf796e4e
.long 0xbf7dabcc,0xbf7e70b0,0xbf6ff573,0xbf531849,0xbf7c7eb0,0xbf6816a8,0xbf42de29,0xbf0f8784
.long 0xbf64aa59,0xbf396842,0xbefc5d27,0xbe605c13,0xbf385216,0xbeee9479,0xbe28defc,0x3e1c76de
.long 0xbef6e0cb,0xbe22abb6,0x3e3b6ecf,0x3f00e7e4,0xbe4dee60,0x3e28defc,0x3f0242b1,0x3f48d8b3
.long 0x0,0x0,0x0,0x0,0x3bc90f88,0x3cfb49ba,0x3d621469,0x3da3308c
.long 0x3c490e90,0x3d7b2b74,0x3de1bc2e,0x3e22abb6,0x3c96c9b6,0x3dbc3ac3,0x3e28defc,0x3e72b651
.long 0x3cc90ab0,0x3dfab273,0x3e605c13,0x3ea09ae5,0x3cfb49ba,0x3e1c76de,0x3e8b9507,0x3ec6d529
.long 0x3d16c32c,0x3e3b6ecf,0x3ea68f12,0x3eebcbbb,0x3d2fe007,0x3e5a3997,0x3ec1071e,0x3f07a136
.long 0x3d48fb30,0x3e78cfcc,0x3edae880,0x3f187fc0,0x3d621469,0x3e8b9507,0x3ef41f07,0x3f286605
.long 0x3d7b2b74,0x3e9aa086,0x3f064b82,0x3f373a23,0x3d8a200a,0x3ea986c4,0x3f121eb0,0x3f44e3f5
.long 0x3d96a905,0x3eb8442a,0x3f1d7fd1,0x3f514d3d,0x3da3308c,0x3ec6d529,0x3f286605,0x3f5c61c7
.long 0x3dafb680,0x3ed53641,0x3f32c8c9,0x3f660f88,0x3dbc3ac3,0x3ee363fa,0x3f3ca003,0x3f6e46be
.long 0x0,0x0,0x0,0x0,0x3dd53db9,0x3e039502,0x3e1c76de,0x3e354098
.long 0x3e541501,0x3e827dc0,0x3e9aa086,0x3eb263ef,0x3e9d9e78,0x3ec1071e,0x3ee363fa,0x3f0242b1
.long 0x3ecf7bca,0x3efc5d27,0x3f13682a,0x3f273656,0x3eff17b2,0x3f19c200,0x3f31a81d,0x3f46e22a
.long 0x3f15f6d9,0x3f32c8c9,0x3f4bbbf8,0x3f604621,0x3f2ac082,0x3f48d8b3,0x3f6106f2,0x3f7294f8
.long 0x3f3daef9,0x3f5b941a,0x3f710908,0x3f7d3aac,0x3f4e8d90,0x3f6aab7b,0x3f7b61fc,0x3f7fe129
.long 0x3f5d2d53,0x3f75dec6,0x3f7fd397,0x3f7a7302,0x3f696591,0x3f7cfe73,0x3f7e4323,0x3f6d1c1d
.long 0x3f731447,0x3f7fec43,0x3f76ba07,0x3f584853,0x3f7a1e84,0x3f7e9bc9,0x3f696591,0x3f3ca003
.long 0x3f7e70b0,0x3f791298,0x3f5695e5,0x3f1b02c6,0x3f7ffec4,0x3f6f6830,0x3f3ebc1b,0x3ee900b7
.long 0x0,0x0,0x0,0x0,0x3e4dee60,0x3e667c66,0x3e7ee6e1,0x3e8b9507
.long 0x3ec9b953,0x3ee0924f,0x3ef6e0cb,0x3f064b82,0x3f121eb0,0x3f212ff9,0x3f2f61a5,0x3f3ca003
.long 0x3f396842,0x3f49d112,0x3f584853,0x3f64aa59,0x3f591e6a,0x3f6816a8,0x3f73913f,0x3f7b61fc
.long 0x3f6ff573,0x3f7a7302,0x3f7f84ab,0x3f7f0e58,0x3f7cfe73,0x3f7ff4e6,0x3f7b61fc,0x3f6f6830
.long 0x3f7fb10f,0x3f7853f8,0x3f676bd8,0x3f4d9f02,0x3f77f110,0x3f63f473,0x3f44e3f5,0x3f1c420c
.long 0x3f660f88,0x3f43e200,0x3f15f6d9,0x3ebe1d4a,0x3f4ac77f,0x3f19c200,0x3ebb31a0,0x3dd53db9
.long 0x3f273656,0x3ecf7bca,0x3dfab273,0xbe2f10a2,0x3ef9a02d,0x3e419b37,0xbe039502,0xbeddbe79
.long 0x3e9aa086,0xbd16c32c,0xbebe1d4a,0xbf299415,0x3dd53db9,0xbe8586ce,0xbf173c07,0xbf577026
.long 0x0,0x0,0x0,0x0,0x3e97a117,0x3ea395c5,0x3eaf713a,0x3ebb31a0
.long 0x3f10d3cd,0x3f1b02c6,0x3f24d225,0x3f2e3bde,0x3f48d8b3,0x3f53fac3,0x3f5df6be,0x3f66becc
.long 0x3f6ed89e,0x3f76ba07,0x3f7c3b28,0x3f7f4e6d,0x3f7f6ac7,0x3f7f9c18,0x3f7bf531,0x3f748422
.long 0x3f791298,0x3f6db293,0x3f5d2d53,0x3f47de65,0x3f5c61c7,0x3f42de29,0x3f239da9,0x3eff17b2
.long 0x3f2beb4a,0x3f039c3d,0x3eac7cd4,0x3e164083,0x3ed8106b,0x3e5a3997,0xbbc90f88,0xbe667c66
.long 0x3e09cf86,0xbde1bc2e,0xbeb263ef,0xbf10d3cd,0xbe28defc,0xbed8106b,0xbf26050a,0xbf53fac3
.long 0xbee63375,0xbf3085bb,0xbf5ebe05,0xbf79c79d,0xbf31a81d,0xbf628210,0xbf7c7eb0,0xbf7cfe73
.long 0xbf604621,0xbf7cbfc9,0xbf7baccd,0xbf5d2d53,0xbf7ac516,0xbf7c7eb0,0xbf5c61c7,0xbf1ebc12
.long 0x3f803f80,0x3f803f80,0x80008000,0x80008000,0x3f623f7f,0x3e953f22,0xbef1bdc9,0xbf75bf46
.long 0x3f0e3f7b,0xbf55be48,0xbf55be48,0xbf0ebf7b,0x3dc93f75,0xbf46bf62,0xbf7fbe95,0x3f22bef1
.long 0xbec43f6d,0x3ec4bf6d,0xbf6dbec4,0x3f6d3ec4,0xbf463f62,0x3f7fbe95,0xbf22bef1,0xbdc93f75
.long 0xbf7b3f55,0x3e483f0e,0xbe48bf0e,0xbf7b3f55,0xbf753f46,0xbf623f7f,0x3e95bf22,0xbef13dc9
.long 0xbf353f35,0xbf353f35,0x3f35bf35,0x3f35bf35,0xbe953f22,0x3ef1bdc9,0x3f75bf46,0x3f62bf7f
.long 0x3e483f0e,0x3f7bbf55,0x3f7bbf55,0xbe48bf0e,0x3f223ef1,0x3dc9bf75,0x3f46bf62,0xbf7f3e95
.long 0x3f6d3ec4,0xbf6dbec4,0x3ec4bf6d,0xbec43f6d,0x3f7f3e95,0xbf223ef1,0xbdc9bf75,0x3f463f62
.long 0x3f553e48,0x3f0e3f7b,0xbf0ebf7b,0x3f553e48,0x3ef13dc9,0x3f753f46,0xbf62bf7f,0xbe95bf22
.long 0x3f803f80,0x3f803f80,0x80008000,0x80008000,0xbef1bdc9,0xbf75bf46,0xbf62bf7f,0xbe95bf22
.long 0xbf0ebf7b,0x3f553e48,0x3f553e48,0x3f0e3f7b,0x3f7f3e95,0xbf223ef1,0x3dc93f75,0xbf46bf62
.long 0xbec43f6d,0x3ec4bf6d,0xbf6dbec4,0x3f6d3ec4,0xbf22bef1,0xbdc93f75,0x3f46bf62,0xbf7f3e95
.long 0x3f7bbf55,0xbe48bf0e,0x3e483f0e,0x3f7bbf55,0xbe953f22,0x3ef1bdc9,0xbf753f46,0xbf623f7f
.long 0xbf353f35,0xbf353f35,0x3f35bf35,0x3f35bf35,0x3f75bf46,0x3f62bf7f,0x3e95bf22,0xbef13dc9
.long 0xbe48bf0e,0xbf7b3f55,0xbf7b3f55,0x3e483f0e,0xbf463f62,0x3f7fbe95,0x3f223ef1,0x3dc9bf75
.long 0x3f6d3ec4,0xbf6dbec4,0x3ec4bf6d,0xbec43f6d,0xbdc9bf75,0x3f463f62,0xbf7fbe95,0x3f22bef1
.long 0xbf55be48,0xbf0ebf7b,0x3f0e3f7b,0xbf55be48,0x3f623f7f,0x3e953f22,0x3ef13dc9,0x3f753f46
.long 0x3f803f80,0x3f803f80,0x80008000,0x80008000,0xbf62bf7f,0xbe95bf22,0x3ef13dc9,0x3f753f46
.long 0x3f0e3f7b,0xbf55be48,0xbf55be48,0xbf0ebf7b,0xbdc9bf75,0x3f463f62,0x3f7f3e95,0xbf223ef1
.long 0xbec43f6d,0x3ec4bf6d,0xbf6dbec4,0x3f6d3ec4,0x3f46bf62,0xbf7f3e95,0x3f223ef1,0x3dc9bf75
.long 0xbf7b3f55,0x3e483f0e,0xbe48bf0e,0xbf7b3f55,0x3f75bf46,0x3f62bf7f,0xbe953f22,0x3ef1bdc9
.long 0xbf353f35,0xbf353f35,0x3f35bf35,0x3f35bf35,0x3e95bf22,0xbef13dc9,0xbf753f46,0xbf623f7f
.long 0x3e483f0e,0x3f7bbf55,0x3f7bbf55,0xbe48bf0e,0xbf22bef1,0xbdc93f75,0xbf463f62,0x3f7fbe95
.long 0x3f6d3ec4,0xbf6dbec4,0x3ec4bf6d,0xbec43f6d,0xbf7fbe95,0x3f22bef1,0x3dc93f75,0xbf46bf62
.long 0x3f553e48,0x3f0e3f7b,0xbf0ebf7b,0x3f553e48,0xbef1bdc9,0xbf75bf46,0x3f623f7f,0x3e953f22
.long 0x3f803f80,0x3f803f80,0x80008000,0x80008000,0x3ef13dc9,0x3f753f46,0x3f623f7f,0x3e953f22
.long 0xbf0ebf7b,0x3f553e48,0x3f553e48,0x3f0e3f7b,0xbf7fbe95,0x3f22bef1,0xbdc9bf75,0x3f463f62
.long 0xbec43f6d,0x3ec4bf6d,0xbf6dbec4,0x3f6d3ec4,0x3f223ef1,0x3dc9bf75,0xbf463f62,0x3f7fbe95
.long 0x3f7bbf55,0xbe48bf0e,0x3e483f0e,0x3f7bbf55,0x3e95bf22,0xbef13dc9,0x3f75bf46,0x3f62bf7f
.long 0xbf353f35,0xbf353f35,0x3f35bf35,0x3f35bf35,0xbf753f46,0xbf623f7f,0xbe953f22,0x3ef1bdc9
.long 0xbe48bf0e,0xbf7b3f55,0xbf7b3f55,0x3e483f0e,0x3f46bf62,0xbf7f3e95,0xbf22bef1,0xbdc93f75
.long 0x3f6d3ec4,0xbf6dbec4,0x3ec4bf6d,0xbec43f6d,0x3dc93f75,0xbf46bf62,0x3f7f3e95,0xbf223ef1
.long 0xbf55be48,0xbf0ebf7b,0x3f0e3f7b,0xbf55be48,0xbf62bf7f,0xbe95bf22,0xbef1bdc9,0xbf75bf46
.long 0x0,0x0,0x3f803f80,0x3f803f80,0x3ef13dc9,0x3f753f46,0x3f623f7f,0x3e953f22
.long 0x3f553e48,0x3f0e3f7b,0x3f0e3f7b,0xbf55be48,0x3f7f3e95,0xbf223ef1,0x3dc93f75,0xbf46bf62
.long 0x3f6d3ec4,0xbf6dbec4,0xbec43f6d,0x3ec4bf6d,0x3f223ef1,0x3dc9bf75,0xbf463f62,0x3f7fbe95
.long 0x3e483f0e,0x3f7bbf55,0xbf7b3f55,0x3e483f0e,0xbe953f22,0x3ef1bdc9,0xbf753f46,0xbf623f7f
.long 0xbf353f35,0xbf353f35,0xbf353f35,0xbf353f35,0xbf753f46,0xbf623f7f,0xbe953f22,0x3ef1bdc9
.long 0xbf7b3f55,0x3e483f0e,0x3e483f0e,0x3f7bbf55,0xbf463f62,0x3f7fbe95,0x3f223ef1,0x3dc9bf75
.long 0xbec43f6d,0x3ec4bf6d,0x3f6d3ec4,0xbf6dbec4,0x3dc93f75,0xbf46bf62,0x3f7f3e95,0xbf223ef1
.long 0x3f0e3f7b,0xbf55be48,0x3f553e48,0x3f0e3f7b,0x3f623f7f,0x3e953f22,0x3ef13dc9,0x3f753f46
.long 0x0,0x0,0x3f803f80,0x3f803f80,0x3f623f7f,0x3e953f22,0xbef1bdc9,0xbf75bf46
.long 0xbf55be48,0xbf0ebf7b,0xbf0ebf7b,0x3f553e48,0xbdc9bf75,0x3f463f62,0x3f7f3e95,0xbf223ef1
.long 0x3f6d3ec4,0xbf6dbec4,0xbec43f6d,0x3ec4bf6d,0xbf463f62,0x3f7fbe95,0xbf22bef1,0xbdc93f75
.long 0xbe48bf0e,0xbf7b3f55,0x3f7bbf55,0xbe48bf0e,0x3f75bf46,0x3f62bf7f,0xbe953f22,0x3ef1bdc9
.long 0xbf353f35,0xbf353f35,0xbf353f35,0xbf353f35,0xbe953f22,0x3ef1bdc9,0x3f75bf46,0x3f62bf7f
.long 0x3f7bbf55,0xbe48bf0e,0xbe48bf0e,0xbf7b3f55,0xbf22bef1,0xbdc93f75,0xbf463f62,0x3f7fbe95
.long 0xbec43f6d,0x3ec4bf6d,0x3f6d3ec4,0xbf6dbec4,0x3f7f3e95,0xbf223ef1,0xbdc9bf75,0x3f463f62
.long 0xbf0ebf7b,0x3f553e48,0xbf55be48,0xbf0ebf7b,0xbef1bdc9,0xbf75bf46,0x3f623f7f,0x3e953f22
.long 0x0,0x0,0x3f803f80,0x3f803f80,0xbef1bdc9,0xbf75bf46,0xbf62bf7f,0xbe95bf22
.long 0x3f553e48,0x3f0e3f7b,0x3f0e3f7b,0xbf55be48,0xbf7fbe95,0x3f22bef1,0xbdc9bf75,0x3f463f62
.long 0x3f6d3ec4,0xbf6dbec4,0xbec43f6d,0x3ec4bf6d,0xbf22bef1,0xbdc93f75,0x3f46bf62,0xbf7f3e95
.long 0x3e483f0e,0x3f7bbf55,0xbf7b3f55,0x3e483f0e,0x3e95bf22,0xbef13dc9,0x3f75bf46,0x3f62bf7f
.long 0xbf353f35,0xbf353f35,0xbf353f35,0xbf353f35,0x3f75bf46,0x3f62bf7f,0x3e95bf22,0xbef13dc9
.long 0xbf7b3f55,0x3e483f0e,0x3e483f0e,0x3f7bbf55,0x3f46bf62,0xbf7f3e95,0xbf22bef1,0xbdc93f75
.long 0xbec43f6d,0x3ec4bf6d,0x3f6d3ec4,0xbf6dbec4,0xbdc9bf75,0x3f463f62,0xbf7fbe95,0x3f22bef1
.long 0x3f0e3f7b,0xbf55be48,0x3f553e48,0x3f0e3f7b,0xbf62bf7f,0xbe95bf22,0xbef1bdc9,0xbf75bf46
.long 0x0,0x0,0x3f803f80,0x3f803f80,0xbf62bf7f,0xbe95bf22,0x3ef13dc9,0x3f753f46
.long 0xbf55be48,0xbf0ebf7b,0xbf0ebf7b,0x3f553e48,0x3dc93f75,0xbf46bf62,0xbf7fbe95,0x3f22bef1
.long 0x3f6d3ec4,0xbf6dbec4,0xbec43f6d,0x3ec4bf6d,0x3f46bf62,0xbf7f3e95,0x3f223ef1,0x3dc9bf75
.long 0xbe48bf0e,0xbf7b3f55,0x3f7bbf55,0xbe48bf0e,0xbf753f46,0xbf623f7f,0x3e95bf22,0xbef13dc9
.long 0xbf353f35,0xbf353f35,0xbf353f35,0xbf353f35,0x3e95bf22,0xbef13dc9,0xbf753f46,0xbf623f7f
.long 0x3f7bbf55,0xbe48bf0e,0xbe48bf0e,0xbf7b3f55,0x3f223ef1,0x3dc9bf75,0x3f46bf62,0xbf7f3e95
.long 0xbec43f6d,0x3ec4bf6d,0x3f6d3ec4,0xbf6dbec4,0xbf7fbe95,0x3f22bef1,0x3dc93f75,0xbf46bf62
.long 0xbf0ebf7b,0x3f553e48,0xbf55be48,0xbf0ebf7b,0x3ef13dc9,0x3f753f46,0xbf62bf7f,0xbe95bf22
.long 0x3f80,0x3e163f7d,0x3e953f75,0x3edb3f67,0x3f80,0x3f043f5c,0x3f623ef1,0x3f80bd49
.long 0x3f80,0x3f4e3f18,0x3f75be95,0x3eacbf71,0x3f80,0x3f783e79,0x3ef1bf62,0xbf3ebf2c
.long 0x3f80,0x3f7dbe16,0xbe95bf75,0xbf673edb,0x3f80,0x3f5cbf04,0xbf62bef1,0x3d493f80
.long 0x3f80,0x3f18bf4e,0xbf753e95,0x3f713eac,0x3f80,0x3e79bf78,0xbef13f62,0x3f2cbf3e
.long 0x3f80,0xbe16bf7d,0x3e953f75,0xbedbbf67,0x3f80,0xbf04bf5c,0x3f623ef1,0xbf803d49
.long 0x3f80,0xbf4ebf18,0x3f75be95,0xbeac3f71,0x3f80,0xbf78be79,0x3ef1bf62,0x3f3e3f2c
.long 0x3f80,0xbf7d3e16,0xbe95bf75,0x3f67bedb,0x3f80,0xbf5c3f04,0xbf62bef1,0xbd49bf80
.long 0x3f80,0xbf183f4e,0xbf753e95,0xbf71beac,0x3f80,0xbe793f78,0xbef13f62,0xbf2c3f3e
.long 0x3f0e3f55,0x3f2c3f3e,0x3f463f22,0x3f5c3f04,0x3f55bf0e,0x3edbbf67,0xbdc9bf7f,0xbf18bf4e
.long 0xbf0ebf55,0xbf80bd49,0xbf223f46,0x3e793f78,0xbf553f0e,0x3eac3f71,0x3f7fbdc9,0x3e16bf7d
.long 0x3f0e3f55,0x3f3ebf2c,0xbf46bf22,0xbf043f5c,0x3f55bf0e,0xbf67bedb,0x3dc93f7f,0x3f4ebf18
.long 0xbf0ebf55,0xbd493f80,0x3f22bf46,0xbf783e79,0xbf553f0e,0x3f71beac,0xbf7f3dc9,0x3f7d3e16
.long 0x3f0e3f55,0xbf2cbf3e,0x3f463f22,0xbf5cbf04,0x3f55bf0e,0xbedb3f67,0xbdc9bf7f,0x3f183f4e
.long 0xbf0ebf55,0x3f803d49,0xbf223f46,0xbe79bf78,0xbf553f0e,0xbeacbf71,0x3f7fbdc9,0xbe163f7d
.long 0x3f0e3f55,0xbf3e3f2c,0xbf46bf22,0x3f04bf5c,0x3f55bf0e,0x3f673edb,0x3dc93f7f,0xbf4e3f18
.long 0xbf0ebf55,0x3d49bf80,0x3f22bf46,0x3f78be79,0xbf553f0e,0xbf713eac,0xbf7f3dc9,0xbf7dbe16
.long 0x3f6d3ec4,0x3f783e79,0x3f7f3dc9,0x3f80bd49,0xbf6dbec4,0xbf7d3e16,0xbf463f22,0xbeac3f71
.long 0x3f6d3ec4,0x3f5cbf04,0x3dc9bf7f,0xbf3ebf2c,0xbf6dbec4,0xbf183f4e,0x3f223f46,0x3f67bedb
.long 0x3f6d3ec4,0x3e79bf78,0xbf7fbdc9,0x3d493f80,0xbf6dbec4,0x3e163f7d,0x3f46bf22,0xbf71beac
.long 0x3f6d3ec4,0xbf04bf5c,0xbdc93f7f,0x3f2cbf3e,0xbf6dbec4,0x3f4e3f18,0xbf22bf46,0x3edb3f67
.long 0x3f6d3ec4,0xbf78be79,0x3f7f3dc9,0xbf803d49,0xbf6dbec4,0x3f7dbe16,0xbf463f22,0x3eacbf71
.long 0x3f6d3ec4,0xbf5c3f04,0x3dc9bf7f,0x3f3e3f2c,0xbf6dbec4,0x3f18bf4e,0x3f223f46,0xbf673edb
.long 0x3f6d3ec4,0xbe793f78,0xbf7fbdc9,0xbd49bf80,0xbf6dbec4,0xbe16bf7d,0x3f46bf22,0x3f713eac
.long 0x3f6d3ec4,0x3f043f5c,0xbdc93f7f,0xbf2c3f3e,0xbf6dbec4,0xbf4ebf18,0xbf22bf46,0xbedbbf67
.long 0x3f7bbe48,0x3f71beac,0x3f62bef1,0x3f4ebf18,0x3e483f7b,0x3f2c3f3e,0x3f753e95,0x3f78be79
.long 0xbf7b3e48,0xbedb3f67,0x3ef13f62,0x3f7d3e16,0xbe48bf7b,0xbf80bd49,0xbe953f75,0x3f5c3f04
.long 0x3f7bbe48,0xbeacbf71,0xbf623ef1,0x3f183f4e,0x3e483f7b,0x3f3ebf2c,0xbf75be95,0x3e793f78
.long 0xbf7b3e48,0x3f673edb,0xbef1bf62,0xbe163f7d,0xbe48bf7b,0xbd493f80,0x3e95bf75,0xbf043f5c
.long 0x3f7bbe48,0xbf713eac,0x3f62bef1,0xbf4e3f18,0x3e483f7b,0xbf2cbf3e,0x3f753e95,0xbf783e79
.long 0xbf7b3e48,0x3edbbf67,0x3ef13f62,0xbf7dbe16,0xbe48bf7b,0x3f803d49,0xbe953f75,0xbf5cbf04
.long 0x3f7bbe48,0x3eac3f71,0xbf623ef1,0xbf18bf4e,0x3e483f7b,0xbf3e3f2c,0xbf75be95,0xbe79bf78
.long 0xbf7b3e48,0xbf67bedb,0xbef1bf62,0x3e16bf7d,0xbe48bf7b,0x3d49bf80,0x3e95bf75,0x3f04bf5c
.long 0x3f808000,0x3f7dbe16,0x3f75be95,0x3f67bedb,0x3f808000,0x3f5cbf04,0x3ef1bf62,0xbd49bf80
.long 0x3f808000,0x3f18bf4e,0xbe95bf75,0xbf71beac,0x3f808000,0x3e79bf78,0xbf62bef1,0xbf2c3f3e
.long 0x3f808000,0xbe16bf7d,0xbf753e95,0x3edb3f67,0x3f808000,0xbf04bf5c,0xbef13f62,0x3f80bd49
.long 0x3f808000,0xbf4ebf18,0x3e953f75,0x3eacbf71,0x3f808000,0xbf78be79,0x3f623ef1,0xbf3ebf2c
.long 0x3f808000,0xbf7d3e16,0x3f75be95,0xbf673edb,0x3f808000,0xbf5c3f04,0x3ef1bf62,0x3d493f80
.long 0x3f808000,0xbf183f4e,0xbe95bf75,0x3f713eac,0x3f808000,0xbe793f78,0xbf62bef1,0x3f2cbf3e
.long 0x3f808000,0x3e163f7d,0xbf753e95,0xbedbbf67,0x3f808000,0x3f043f5c,0xbef13f62,0xbf803d49
.long 0x3f808000,0x3f4e3f18,0x3e953f75,0xbeac3f71,0x3f808000,0x3f783e79,0x3f623ef1,0x3f3e3f2c
.long 0x3f55bf0e,0x3f3ebf2c,0x3f22bf46,0x3f04bf5c,0xbf0ebf55,0xbf67bedb,0xbf7f3dc9,0xbf4e3f18
.long 0xbf553f0e,0xbd493f80,0x3f463f22,0x3f78be79,0x3f0e3f55,0x3f71beac,0xbdc9bf7f,0xbf7dbe16
.long 0x3f55bf0e,0xbf2cbf3e,0xbf223f46,0x3f5c3f04,0xbf0ebf55,0xbedb3f67,0x3f7fbdc9,0xbf18bf4e
.long 0xbf553f0e,0x3f803d49,0xbf46bf22,0x3e793f78,0x3f0e3f55,0xbeacbf71,0x3dc93f7f,0x3e16bf7d
.long 0x3f55bf0e,0xbf3e3f2c,0x3f22bf46,0xbf043f5c,0xbf0ebf55,0x3f673edb,0xbf7f3dc9,0x3f4ebf18
.long 0xbf553f0e,0x3d49bf80,0x3f463f22,0xbf783e79,0x3f0e3f55,0xbf713eac,0xbdc9bf7f,0x3f7d3e16
.long 0x3f55bf0e,0x3f2c3f3e,0xbf223f46,0xbf5cbf04,0xbf0ebf55,0x3edbbf67,0x3f7fbdc9,0x3f183f4e
.long 0xbf553f0e,0xbf80bd49,0xbf46bf22,0xbe79bf78,0x3f0e3f55,0x3eac3f71,0x3dc93f7f,0xbe163f7d
.long 0x3ec4bf6d,0x3e79bf78,0x3dc9bf7f,0xbd49bf80,0xbec43f6d,0x3e163f7d,0x3f223f46,0x3f713eac
.long 0x3ec4bf6d,0xbf04bf5c,0xbf7fbdc9,0xbf2c3f3e,0xbec43f6d,0x3f4e3f18,0x3f46bf22,0xbedbbf67
.long 0x3ec4bf6d,0xbf78be79,0xbdc93f7f,0x3f80bd49,0xbec43f6d,0x3f7dbe16,0xbf22bf46,0xbeac3f71
.long 0x3ec4bf6d,0xbf5c3f04,0x3f7f3dc9,0xbf3ebf2c,0xbec43f6d,0x3f18bf4e,0xbf463f22,0x3f67bedb
.long 0x3ec4bf6d,0xbe793f78,0x3dc9bf7f,0x3d493f80,0xbec43f6d,0xbe16bf7d,0x3f223f46,0xbf71beac
.long 0x3ec4bf6d,0x3f043f5c,0xbf7fbdc9,0x3f2cbf3e,0xbec43f6d,0xbf4ebf18,0x3f46bf22,0x3edb3f67
.long 0x3ec4bf6d,0x3f783e79,0xbdc93f7f,0xbf803d49,0xbec43f6d,0xbf7d3e16,0xbf22bf46,0x3eacbf71
.long 0x3ec4bf6d,0x3f5cbf04,0x3f7f3dc9,0x3f3e3f2c,0xbec43f6d,0xbf183f4e,0xbf463f22,0xbf673edb
.long 0xbe48bf7b,0xbeacbf71,0xbef1bf62,0xbf18bf4e,0x3f7bbe48,0x3f3ebf2c,0x3e95bf75,0xbe79bf78
.long 0x3e483f7b,0x3f673edb,0x3f62bef1,0x3e16bf7d,0xbf7b3e48,0xbd493f80,0x3f753e95,0x3f04bf5c
.long 0xbe48bf7b,0xbf713eac,0x3ef13f62,0x3f4ebf18,0x3f7bbe48,0xbf2cbf3e,0xbe953f75,0x3f78be79
.long 0x3e483f7b,0x3edbbf67,0xbf623ef1,0x3f7d3e16,0xbf7b3e48,0x3f803d49,0xbf75be95,0x3f5c3f04
.long 0xbe48bf7b,0x3eac3f71,0xbef1bf62,0x3f183f4e,0x3f7bbe48,0xbf3e3f2c,0x3e95bf75,0x3e793f78
.long 0x3e483f7b,0xbf67bedb,0x3f62bef1,0xbe163f7d,0xbf7b3e48,0x3d49bf80,0x3f753e95,0xbf043f5c
.long 0xbe48bf7b,0x3f71beac,0x3ef13f62,0xbf4e3f18,0x3f7bbe48,0x3f2c3f3e,0xbe953f75,0xbf783e79
.long 0x3e483f7b,0xbedb3f67,0xbf623ef1,0xbf7dbe16,0xbf7b3e48,0xbf80bd49,0xbf75be95,0xbf5cbf04
.long 0x3f800000,0x3f7ffd39,0x3f7ff4e6,0x3f7fe705,0x3f800000,0x3f7fdaaf,0x3f7f6ac7,0x3f7eb069
.long 0x3f800000,0x3f7f90b1,0x3f7e4323,0x3f7c187a,0x3f800000,0x3f7f1f49,0x3f7c7eb0,0x3f7822d1
.long 0x3f800000,0x3f7e868b,0x3f7a1e84,0x3f72d4eb,0x3f800000,0x3f7dc68c,0x3f772417,0x3f6c3624
.long 0x3f800000,0x3f7cdf6c,0x3f73913f,0x3f644fac,0x3f800000,0x3f7bd14d,0x3f6f6830,0x3f5b2c79
.long 0x3f800000,0x3f7a9c59,0x3f6aab7b,0x3f50d937,0x3f800000,0x3f7940c0,0x3f655e0b,0x3f456439
.long 0x3f800000,0x3f77beb7,0x3f5f8327,0x3f38dd65,0x3f800000,0x3f76167a,0x3f591e6a,0x3f2b561b
.long 0x3f800000,0x3f74484b,0x3f5233c6,0x3f1ce11f,0x3f800000,0x3f725470,0x3f4ac77f,0x3f0d9281
.long 0x3f800000,0x3f703b37,0x3f42de29,0x3efafef7,0x3f800000,0x3f6dfcf2,0x3f3a7ca4,0x3ed97cb9
.long 0x3f7fd397,0x3f7fba9e,0x3f7f9c18,0x3f7f7808,0x3f7dabcc,0x3f7c5d3a,0x3f7ac516,0x3f78e3d6
.long 0x3f791298,0x3f75341d,0x3f708066,0x3f6afb8c,0x3f721352,0x3f6a5ad9,0x3f6106f2,0x3f5627fe
.long 0x3f68bf3c,0x3f5bfb34,0x3f4cae79,0x3f3b0629,0x3f5d2d53,0x3f4a4c87,0x3f33e7bc,0x3f1a6293
.long 0x3f4f7a1f,0x3f3592e7,0x3f173c07,0x3eea6681,0x3f3fc767,0x3f1e1e22,0x3eee9479,0x3e9920fe
.long 0x3f2e3bde,0x3f044889,0x3ea986c4,0x3e06b26e,0x3f1b02c6,0x3ed0eb2a,0x3e419b37,0xbd2351cb
.long 0x3f064b82,0x3e9620d2,0x3d2fe007,0xbe57278f,0x3ee0924f,0x3e3228d4,0xbdd53db9,0xbebf926f
.long 0x3eb263ef,0x3d55880e,0xbe7ee6e1,0xbf06f686,0x3e827dc0,0xbd9064b4,0xbec6d529,0xbf2a2a80
.long 0x3e22abb6,0xbe44b0b9,0xbf04f484,0xbf485bca,0x3d7b2b74,0xbe9f1cdf,0xbf239da9,0xbf60a6cf
.long 0x3f7f4e6d,0x3f7f1f49,0x3f7eea9d,0x3f7eb069,0x3f76ba07,0x3f74484b,0x3f718f57,0x3f6e8ff8
.long 0x3f64aa59,0x3f5d924d,0x3f55b993,0x3f4d26fd,0x3f49d112,0x3f3c17d9,0x3f2d1469,0x3f1ce11f
.long 0x3f273656,0x3f11796b,0x3ef41f07,0x3ec27b55,0x3efc5d27,0x3ebf926f,0x3e7ee6e1,0x3df475c0
.long 0x3ea09ae5,0x3e25c58c,0x3bc90f88,0xbe195be0,0x3dfab273,0xbd6ea038,0xbe72b651,0xbed0eb2a
.long 0xbd96a905,0xbe8d17c0,0xbeee9479,0xbf2302d3,0xbe888e93,0xbef58035,0xbf2ac082,0xbf51c0c2
.long 0xbee63375,0xbf28fd41,0xbf53fac3,0xbf714c7a,0xbf1d7fd1,0xbf4f0417,0xbf708066,0xbf7f5ce9
.long 0xbf41d870,0xbf6afb8c,0xbf7e9bc9,0xbf7aed37,0xbf5ebe05,0xbf7b87b2,0xbf7d7474,0xbf644fac
.long 0xbf731447,0xbf7fdaaf,0xbf6d1c1d,0xbf3d27b8,0xbf7e1324,0xbf77beb7,0xbf4e8d90,0xbf084b92
.long 0x3f7e70b0,0x3f7e2b72,0x3f7de0b1,0x3f7d906e,0x3f6b4b0c,0x3f67c187,0x3f63f473,0x3f5fe4e9
.long 0x3f43e200,0x3f39f2ac,0x3f2f61a5,0x3f24381a,0x3f0b9a6b,0x3ef2bd43,0x3ecc9b8b,0x3ea5129f
.long 0x3e8e9a22,0x3e3228d4,0x3d8a200a,0xbd2351cb,0xbc490e90,0xbe1324ca,0xbe8b9507,0xbecb2aae
.long 0xbe9aa086,0xbee4cbfe,0xbf14b039,0xbf33587a,0xbf10d3cd,0xbf34768f,0xbf5233c6,0xbf6912ae
.long 0xbf47de65,0xbf644fac,0xbf772417,0xbf7f90b1,0xbf6db293,0xbf7d1cdd,0xbf7f2f9d,0xbf73ced9
.long 0xbf7f0e58,0xbf7c5d3a,0xbf696591,0xbf476085,0xbf7a7302,0xbf62241a,0xbf385216,0xbf003a06
.long 0xbf604621,0xbf311722,0xbee363fa,0xbe1f917b,0xbf32c8c9,0xbedc53c1,0xbdee3876,0x3e57278f
.long 0xbeebcbbb,0xbe007745,0x3e667c66,0x3f0c42c9,0xbe3b6ecf,0x3e44b0b9,0x3f0a48ad,0x3f4fefa8
.long 0x0,0x3c16cb58,0x3c96c9b6,0x3ce22a7a,0x0,0x3d0a342f,0x3d8a200a,0x3dcefdb7
.long 0x0,0x3d6ea038,0x3dee3876,0x3e3228d4,0x0,0x3da973ba,0x3e28defc,0x3e7bdba4
.long 0x0,0x3ddb7d37,0x3e5a3997,0x3ea21887,0x0,0x3e06b26e,0x3e8586ce,0x3ec5625c
.long 0x0,0x3e1f917b,0x3e9d9e78,0x3ee79a5d,0x0,0x3e3857ec,0x3eb554ec,0x3f044889
.long 0x0,0x3e5101f1,0x3ecc9b8b,0x3f140c5f,0x0,0x3e698bba,0x3ee363fa,0x3f2302d3
.long 0x0,0x3e80f8c0,0x3ef9a02d,0x3f311722,0x0,0x3e8d17c0,0x3f07a136,0x3f3e35c5
.long 0x0,0x3e9920fe,0x3f121eb0,0x3f4a4c87,0x0,0x3ea5129f,0x3f1c420c,0x3f554aa4
.long 0x0,0x3eb0eacb,0x3f26050a,0x3f5f20db,0x0,0x3ebca7af,0x3f2f61a5,0x3f67c187
.long 0x3d16c32c,0x3d3c6dd5,0x3d621469,0x3d83db0a,0x3e09cf86,0x3e2bf804,0x3e4dee60,0x3e6fa8b2
.long 0x3e6c9a7f,0x3e931f35,0x3eaf713a,0x3ecb2aae,0x3ea68f12,0x3ece0bea,0x3ef41f07,0x3f0c42c9
.long 0x3ed53641,0x3f02ef9f,0x3f19c200,0x3f2ecef7,0x3f00e7e4,0x3f1ce11f,0x3f36206c,0x3f4c3578
.long 0x3f15f6d9,0x3f34768f,0x3f4e8d90,0x3f6398ac,0x3f299415,0x3f495521,0x3f628210,0x3f74484b
.long 0x3f3b8f3b,0x3f5b2c79,0x3f718f57,0x3f7dc68c,0x3f4bbbf8,0x3f69b7e4,0x3f7b61fc,0x3f7fcbe2
.long 0x3f59f26a,0x3f74bf62,0x3f7fc38f,0x3f7a4910,0x3f660f88,0x3f7c187a,0x3f7e9bc9,0x3f6d67a1
.long 0x3f6ff573,0x3f7fa6e3,0x3f77f110,0x3f5988ad,0x3f778bc5,0x3f7f5ce9,0x3f6be858,0x3f3f41fc
.long 0x3f7cbfc9,0x3f7b3bab,0x3f5ac450,0x3f1f599f,0x3f7f84ab,0x3f73530e,0x3f44e3f5,0x3ef58035
.long 0x3d96a905,0x3da973ba,0x3dbc3ac3,0x3dcefdb7,0x3e888e93,0x3e9920fe,0x3ea986c4,0x3eb9bb1e
.long 0x3ee63375,0x3f003a06,0x3f0cead0,0x3f19210f,0x3f1d7fd1,0x3f2da859,0x3f3ca003,0x3f4a4c87
.long 0x3f41d870,0x3f52a649,0x3f6106f2,0x3f6cd007,0x3f5ebe05,0x3f6d67a1,0x3f77f110,0x3f7e2b72
.long 0x3f731447,0x3f7c9f8a,0x3f7ffec4,0x3f7d1cdd,0x3f7e1324,0x3f7f90b1,0x3f78b47b,0x3f69b7e4
.long 0x3f7f4e6d,0x3f76167a,0x3f628210,0x3f456439,0x3f76ba07,0x3f60a6cf,0x3f3ebc1b,0x3f12c39a
.long 0x3f64aa59,0x3f404c5c,0x3f0f8784,0x3eab0201,0x3f49d112,0x3f16999f,0x3eaf713a,0x3d9064b4
.long 0x3f273656,0x3ecb2aae,0x3dd53db9,0xbe4ada4f,0x3efc5d27,0x3e3e853e,0xbe1008b7,0xbee79a5d
.long 0x3ea09ae5,0xbd0a342f,0xbec1071e,0xbf2c800f,0x3dfab273,0xbe80f8c0,0xbf173c07,0xbf58b3a1
.long 0x3de1bc2e,0x3df475c0,0x3e039502,0x3e0cec4a,0x3ec9b953,0x3ed97cb9,0x3ee900b7,0x3ef840c8
.long 0x3f24d225,0x3f2ff3e6,0x3f3a7ca4,0x3f446337,0x3f5695e5,0x3f61668a,0x3f6aab7b,0x3f725470
.long 0x3f75dec6,0x3f7c187a,0x3f7f6ac7,0x3f7fcbe2,0x3f7ffb11,0x3f7d57de,0x3f764d97,0x3f6afb8c
.long 0x3f740bdd,0x3f650479,0x3f5064af,0x3f36ad7f,0x3f531849,0x3f3592e7,0x3f121eb0,0x3ed3c867
.long 0x3f1ff6cb,0x3ee79a5d,0x3e8586ce,0x3d6ea038,0x3ebe1d4a,0x3e195be0,0xbda3308c,0xbe9c1faf
.long 0x3dafb680,0xbe2bf804,0xbed25a09,0xbf209393,0xbe541501,0xbeeff7fb,0xbf31a81d,0xbf5d924d
.long 0xbef6e0cb,0xbf38dd65,0xbf655e0b,0xbf7cdf6c,0xbf373a23,0xbf671599,0xbf7e4323,0xbf7a4910
.long 0xbf633c5a,0xbf7dfa38,0xbf796e4e,0xbf5627fe,0xbf7baccd,0xbf7b3bab,0xbf577026,0xbf1553b7
.long 0x3f800000,0x3f800000,0x3f800000,0x3f800000,0x3f7ffd39,0x3f7fdaaf,0x3f7f90b1,0x3f7f1f49
.long 0x3f7ff4e6,0x3f7f6ac7,0x3f7e4323,0x3f7c7eb0,0x3f7fe705,0x3f7eb069,0x3f7c187a,0x3f7822d1
.long 0x3f7fd397,0x3f7dabcc,0x3f791298,0x3f721352,0x3f7fba9e,0x3f7c5d3a,0x3f75341d,0x3f6a5ad9
.long 0x3f7f9c18,0x3f7ac516,0x3f708066,0x3f6106f2,0x3f7f7808,0x3f78e3d6,0x3f6afb8c,0x3f5627fe
.long 0x3f7f4e6d,0x3f76ba07,0x3f64aa59,0x3f49d112,0x3f7f1f49,0x3f74484b,0x3f5d924d,0x3f3c17d9
.long 0x3f7eea9d,0x3f718f57,0x3f55b993,0x3f2d1469,0x3f7eb069,0x3f6e8ff8,0x3f4d26fd,0x3f1ce11f
.long 0x3f7e70b0,0x3f6b4b0c,0x3f43e200,0x3f0b9a6b,0x3f7e2b72,0x3f67c187,0x3f39f2ac,0x3ef2bd43
.long 0x3f7de0b1,0x3f63f473,0x3f2f61a5,0x3ecc9b8b,0x3f7d906e,0x3f5fe4e9,0x3f24381a,0x3ea5129f
.long 0x3f800000,0x3f800000,0x3f800000,0x3f800000,0x3f7e868b,0x3f7dc68c,0x3f7cdf6c,0x3f7bd14d
.long 0x3f7a1e84,0x3f772417,0x3f73913f,0x3f6f6830,0x3f72d4eb,0x3f6c3624,0x3f644fac,0x3f5b2c79
.long 0x3f68bf3c,0x3f5d2d53,0x3f4f7a1f,0x3f3fc767,0x3f5bfb34,0x3f4a4c87,0x3f3592e7,0x3f1e1e22
.long 0x3f4cae79,0x3f33e7bc,0x3f173c07,0x3eee9479,0x3f3b0629,0x3f1a6293,0x3eea6681,0x3e9920fe
.long 0x3f273656,0x3efc5d27,0x3ea09ae5,0x3dfab273,0x3f11796b,0x3ebf926f,0x3e25c58c,0xbd6ea038
.long 0x3ef41f07,0x3e7ee6e1,0x3bc90f88,0xbe72b651,0x3ec27b55,0x3df475c0,0xbe195be0,0xbed0eb2a
.long 0x3e8e9a22,0xbc490e90,0xbe9aa086,0xbf10d3cd,0x3e3228d4,0xbe1324ca,0xbee4cbfe,0xbf34768f
.long 0x3d8a200a,0xbe8b9507,0xbf14b039,0xbf5233c6,0xbd2351cb,0xbecb2aae,0xbf33587a,0xbf6912ae
.long 0x3f800000,0x3f800000,0x3f800000,0x3f800000,0x3f7a9c59,0x3f7940c0,0x3f77beb7,0x3f76167a
.long 0x3f6aab7b,0x3f655e0b,0x3f5f8327,0x3f591e6a,0x3f50d937,0x3f456439,0x3f38dd65,0x3f2b561b
.long 0x3f2e3bde,0x3f1b02c6,0x3f064b82,0x3ee0924f,0x3f044889,0x3ed0eb2a,0x3e9620d2,0x3e3228d4
.long 0x3ea986c4,0x3e419b37,0x3d2fe007,0xbdd53db9,0x3e06b26e,0xbd2351cb,0xbe57278f,0xbebf926f
.long 0xbd96a905,0xbe888e93,0xbee63375,0xbf1d7fd1,0xbe8d17c0,0xbef58035,0xbf28fd41,0xbf4f0417
.long 0xbeee9479,0xbf2ac082,0xbf53fac3,0xbf708066,0xbf2302d3,0xbf51c0c2,0xbf714c7a,0xbf7f5ce9
.long 0xbf47de65,0xbf6db293,0xbf7f0e58,0xbf7a7302,0xbf644fac,0xbf7d1cdd,0xbf7c5d3a,0xbf62241a
.long 0xbf772417,0xbf7f2f9d,0xbf696591,0xbf385216,0xbf7f90b1,0xbf73ced9,0xbf476085,0xbf003a06
.long 0x3f800000,0x3f800000,0x3f800000,0x3f800000,0x3f74484b,0x3f725470,0x3f703b37,0x3f6dfcf2
.long 0x3f5233c6,0x3f4ac77f,0x3f42de29,0x3f3a7ca4,0x3f1ce11f,0x3f0d9281,0x3efafef7,0x3ed97cb9
.long 0x3eb263ef,0x3e827dc0,0x3e22abb6,0x3d7b2b74,0x3d55880e,0xbd9064b4,0xbe44b0b9,0xbe9f1cdf
.long 0xbe7ee6e1,0xbec6d529,0xbf04f484,0xbf239da9,0xbf06f686,0xbf2a2a80,0xbf485bca,0xbf60a6cf
.long 0xbf41d870,0xbf5ebe05,0xbf731447,0xbf7e1324,0xbf6afb8c,0xbf7b87b2,0xbf7fdaaf,0xbf77beb7
.long 0xbf7e9bc9,0xbf7d7474,0xbf6d1c1d,0xbf4e8d90,0xbf7aed37,0xbf644fac,0xbf3d27b8,0xbf084b92
.long 0xbf604621,0xbf32c8c9,0xbeebcbbb,0xbe3b6ecf,0xbf311722,0xbedc53c1,0xbe007745,0x3e44b0b9
.long 0xbee363fa,0xbdee3876,0x3e667c66,0x3f0a48ad,0xbe1f917b,0x3e57278f,0x3f0c42c9,0x3f4fefa8
.long 0x0,0x0,0x0,0x0,0x3c16cb58,0x3d0a342f,0x3d6ea038,0x3da973ba
.long 0x3c96c9b6,0x3d8a200a,0x3dee3876,0x3e28defc,0x3ce22a7a,0x3dcefdb7,0x3e3228d4,0x3e7bdba4
.long 0x3d16c32c,0x3e09cf86,0x3e6c9a7f,0x3ea68f12,0x3d3c6dd5,0x3e2bf804,0x3e931f35,0x3ece0bea
.long 0x3d621469,0x3e4dee60,0x3eaf713a,0x3ef41f07,0x3d83db0a,0x3e6fa8b2,0x3ecb2aae,0x3f0c42c9
.long 0x3d96a905,0x3e888e93,0x3ee63375,0x3f1d7fd1,0x3da973ba,0x3e9920fe,0x3f003a06,0x3f2da859
.long 0x3dbc3ac3,0x3ea986c4,0x3f0cead0,0x3f3ca003,0x3dcefdb7,0x3eb9bb1e,0x3f19210f,0x3f4a4c87
.long 0x3de1bc2e,0x3ec9b953,0x3f24d225,0x3f5695e5,0x3df475c0,0x3ed97cb9,0x3f2ff3e6,0x3f61668a
.long 0x3e039502,0x3ee900b7,0x3f3a7ca4,0x3f6aab7b,0x3e0cec4a,0x3ef840c8,0x3f446337,0x3f725470
.long 0x0,0x0,0x0,0x0,0x3ddb7d37,0x3e06b26e,0x3e1f917b,0x3e3857ec
.long 0x3e5a3997,0x3e8586ce,0x3e9d9e78,0x3eb554ec,0x3ea21887,0x3ec5625c,0x3ee79a5d,0x3f044889
.long 0x3ed53641,0x3f00e7e4,0x3f15f6d9,0x3f299415,0x3f02ef9f,0x3f1ce11f,0x3f34768f,0x3f495521
.long 0x3f19c200,0x3f36206c,0x3f4e8d90,0x3f628210,0x3f2ecef7,0x3f4c3578,0x3f6398ac,0x3f74484b
.long 0x3f41d870,0x3f5ebe05,0x3f731447,0x3f7e1324,0x3f52a649,0x3f6d67a1,0x3f7c9f8a,0x3f7f90b1
.long 0x3f6106f2,0x3f77f110,0x3f7ffec4,0x3f78b47b,0x3f6cd007,0x3f7e2b72,0x3f7d1cdd,0x3f69b7e4
.long 0x3f75dec6,0x3f7ffb11,0x3f740bdd,0x3f531849,0x3f7c187a,0x3f7d57de,0x3f650479,0x3f3592e7
.long 0x3f7f6ac7,0x3f764d97,0x3f5064af,0x3f121eb0,0x3f7fcbe2,0x3f6afb8c,0x3f36ad7f,0x3ed3c867
.long 0x0,0x0,0x0,0x0,0x3e5101f1,0x3e698bba,0x3e80f8c0,0x3e8d17c0
.long 0x3ecc9b8b,0x3ee363fa,0x3ef9a02d,0x3f07a136,0x3f140c5f,0x3f2302d3,0x3f311722,0x3f3e35c5
.long 0x3f3b8f3b,0x3f4bbbf8,0x3f59f26a,0x3f660f88,0x3f5b2c79,0x3f69b7e4,0x3f74bf62,0x3f7c187a
.long 0x3f718f57,0x3f7b61fc,0x3f7fc38f,0x3f7e9bc9,0x3f7dc68c,0x3f7fcbe2,0x3f7a4910,0x3f6d67a1
.long 0x3f7f4e6d,0x3f76ba07,0x3f64aa59,0x3f49d112,0x3f76167a,0x3f60a6cf,0x3f404c5c,0x3f16999f
.long 0x3f628210,0x3f3ebc1b,0x3f0f8784,0x3eaf713a,0x3f456439,0x3f12c39a,0x3eab0201,0x3d9064b4
.long 0x3f1ff6cb,0x3ebe1d4a,0x3dafb680,0xbe541501,0x3ee79a5d,0x3e195be0,0xbe2bf804,0xbeeff7fb
.long 0x3e8586ce,0xbda3308c,0xbed25a09,0xbf31a81d,0x3d6ea038,0xbe9c1faf,0xbf209393,0xbf5d924d
.long 0x0,0x0,0x0,0x0,0x3e9920fe,0x3ea5129f,0x3eb0eacb,0x3ebca7af
.long 0x3f121eb0,0x3f1c420c,0x3f26050a,0x3f2f61a5,0x3f4a4c87,0x3f554aa4,0x3f5f20db,0x3f67c187
.long 0x3f6ff573,0x3f778bc5,0x3f7cbfc9,0x3f7f84ab,0x3f7fa6e3,0x3f7f5ce9,0x3f7b3bab,0x3f73530e
.long 0x3f77f110,0x3f6be858,0x3f5ac450,0x3f44e3f5,0x3f5988ad,0x3f3f41fc,0x3f1f599f,0x3ef58035
.long 0x3f273656,0x3efc5d27,0x3ea09ae5,0x3dfab273,0x3ecb2aae,0x3e3e853e,0xbd0a342f,0xbe80f8c0
.long 0x3dd53db9,0xbe1008b7,0xbec1071e,0xbf173c07,0xbe4ada4f,0xbee79a5d,0xbf2c800f,0xbf58b3a1
.long 0xbef6e0cb,0xbf373a23,0xbf633c5a,0xbf7baccd,0xbf38dd65,0xbf671599,0xbf7dfa38,0xbf7b3bab
.long 0xbf655e0b,0xbf7e4323,0xbf796e4e,0xbf577026,0xbf7cdf6c,0xbf7a4910,0xbf5627fe,0xbf1553b7
.long 0x3f803f80,0x3f803f80,0x80008000,0x80008000,0x3f5c3f7d,0x3e793f18,0xbf04be16,0xbf78bf4e
.long 0x3ef13f75,0xbf62be95,0xbf62be95,0xbef1bf75,0xbd493f67,0xbf2cbf71,0xbf80bedb,0x3f3ebeac
.long 0xbf0e3f55,0x3f0ebf55,0xbf55bf0e,0x3f553f0e,0xbf673f3e,0x3f71bd49,0xbedbbf2c,0xbeac3f80
.long 0xbf7f3f22,0xbdc93f46,0x3dc9bf46,0xbf7f3f22,0xbf4e3f04,0xbf7d3f78,0x3f18bf5c,0xbe16be79
.long 0xbec43ec4,0xbec43ec4,0x3f6dbf6d,0x3f6dbf6d,0x3e163e79,0x3f4ebf04,0x3f7dbf78,0x3f18bf5c
.long 0x3f223dc9,0x3f46bf7f,0x3f46bf7f,0xbf22bdc9,0x3f71bd49,0xbedbbf2c,0x3eacbf80,0xbf673f3e
.long 0x3f7bbe48,0xbf7b3e48,0xbe48bf7b,0x3e483f7b,0x3f3ebeac,0xbd493f67,0xbf2cbf71,0x3f803edb
.long 0x3e95bef1,0x3f753f62,0xbf75bf62,0x3e95bef1,0xbe79bf18,0x3f043e16,0xbf78bf4e,0xbf5cbf7d
.long 0x3f803f80,0x3f803f80,0x80008000,0x80008000,0xbf04be16,0xbf78bf4e,0xbf5cbf7d,0xbe79bf18
.long 0xbef1bf75,0x3f623e95,0x3f623e95,0x3ef13f75,0x3f803edb,0xbf3e3eac,0xbd493f67,0xbf2cbf71
.long 0xbf0e3f55,0x3f0ebf55,0xbf55bf0e,0x3f553f0e,0xbedbbf2c,0xbeac3f80,0x3f67bf3e,0xbf713d49
.long 0x3f7fbf22,0x3dc9bf46,0xbdc93f46,0x3f7fbf22,0xbf183f5c,0x3e163e79,0xbf4e3f04,0xbf7d3f78
.long 0xbec43ec4,0xbec43ec4,0x3f6dbf6d,0x3f6dbf6d,0x3f7dbf78,0x3f18bf5c,0xbe16be79,0xbf4e3f04
.long 0xbf22bdc9,0xbf463f7f,0xbf463f7f,0x3f223dc9,0xbeac3f80,0x3f67bf3e,0x3f71bd49,0xbedbbf2c
.long 0x3f7bbe48,0xbf7b3e48,0xbe48bf7b,0x3e483f7b,0xbf2cbf71,0x3f803edb,0xbf3e3eac,0x3d49bf67
.long 0xbe953ef1,0xbf75bf62,0x3f753f62,0xbe953ef1,0x3f783f4e,0x3f5c3f7d,0xbe79bf18,0x3f043e16
.long 0x3f803f80,0x3f803f80,0x80008000,0x80008000,0xbf5cbf7d,0xbe79bf18,0x3f043e16,0x3f783f4e
.long 0x3ef13f75,0xbf62be95,0xbf62be95,0xbef1bf75,0x3d49bf67,0x3f2c3f71,0x3f803edb,0xbf3e3eac
.long 0xbf0e3f55,0x3f0ebf55,0xbf55bf0e,0x3f553f0e,0x3f67bf3e,0xbf713d49,0x3edb3f2c,0x3eacbf80
.long 0xbf7f3f22,0xbdc93f46,0x3dc9bf46,0xbf7f3f22,0x3f4ebf04,0x3f7dbf78,0xbf183f5c,0x3e163e79
.long 0xbec43ec4,0xbec43ec4,0x3f6dbf6d,0x3f6dbf6d,0xbe16be79,0xbf4e3f04,0xbf7d3f78,0xbf183f5c
.long 0x3f223dc9,0x3f46bf7f,0x3f46bf7f,0xbf22bdc9,0xbf713d49,0x3edb3f2c,0xbeac3f80,0x3f67bf3e
.long 0x3f7bbe48,0xbf7b3e48,0xbe48bf7b,0x3e483f7b,0xbf3e3eac,0x3d49bf67,0x3f2c3f71,0xbf80bedb
.long 0x3e95bef1,0x3f753f62,0xbf75bf62,0x3e95bef1,0x3e793f18,0xbf04be16,0x3f783f4e,0x3f5c3f7d
.long 0x3f803f80,0x3f803f80,0x80008000,0x80008000,0x3f043e16,0x3f783f4e,0x3f5c3f7d,0x3e793f18
.long 0xbef1bf75,0x3f623e95,0x3f623e95,0x3ef13f75,0xbf80bedb,0x3f3ebeac,0x3d49bf67,0x3f2c3f71
.long 0xbf0e3f55,0x3f0ebf55,0xbf55bf0e,0x3f553f0e,0x3edb3f2c,0x3eacbf80,0xbf673f3e,0x3f71bd49
.long 0x3f7fbf22,0x3dc9bf46,0xbdc93f46,0x3f7fbf22,0x3f18bf5c,0xbe16be79,0x3f4ebf04,0x3f7dbf78
.long 0xbec43ec4,0xbec43ec4,0x3f6dbf6d,0x3f6dbf6d,0xbf7d3f78,0xbf183f5c,0x3e163e79,0x3f4ebf04
.long 0xbf22bdc9,0xbf463f7f,0xbf463f7f,0x3f223dc9,0x3eacbf80,0xbf673f3e,0xbf713d49,0x3edb3f2c
.long 0x3f7bbe48,0xbf7b3e48,0xbe48bf7b,0x3e483f7b,0x3f2c3f71,0xbf80bedb,0x3f3ebeac,0xbd493f67
.long 0xbe953ef1,0xbf75bf62,0x3f753f62,0xbe953ef1,0xbf78bf4e,0xbf5cbf7d,0x3e793f18,0xbf04be16
.long 0x0,0x0,0x3f803f80,0x3f803f80,0x3f043e16,0x3f783f4e,0x3f5c3f7d,0x3e793f18
.long 0x3f623e95,0x3ef13f75,0x3ef13f75,0xbf62be95,0x3f803edb,0xbf3e3eac,0xbd493f67,0xbf2cbf71
.long 0x3f553f0e,0xbf55bf0e,0xbf0e3f55,0x3f0ebf55,0x3edb3f2c,0x3eacbf80,0xbf673f3e,0x3f71bd49
.long 0xbdc93f46,0x3f7fbf22,0xbf7f3f22,0xbdc93f46,0xbf183f5c,0x3e163e79,0xbf4e3f04,0xbf7d3f78
.long 0xbf6d3f6d,0xbf6d3f6d,0xbec43ec4,0xbec43ec4,0xbf7d3f78,0xbf183f5c,0x3e163e79,0x3f4ebf04
.long 0xbf463f7f,0x3f223dc9,0x3f223dc9,0x3f46bf7f,0xbeac3f80,0x3f67bf3e,0x3f71bd49,0xbedbbf2c
.long 0x3e483f7b,0xbe48bf7b,0x3f7bbe48,0xbf7b3e48,0x3f2c3f71,0xbf80bedb,0x3f3ebeac,0xbd493f67
.long 0x3f753f62,0xbe953ef1,0x3e95bef1,0x3f753f62,0x3f783f4e,0x3f5c3f7d,0xbe79bf18,0x3f043e16
.long 0x0,0x0,0x3f803f80,0x3f803f80,0x3f5c3f7d,0x3e793f18,0xbf04be16,0xbf78bf4e
.long 0xbf62be95,0xbef1bf75,0xbef1bf75,0x3f623e95,0x3d49bf67,0x3f2c3f71,0x3f803edb,0xbf3e3eac
.long 0x3f553f0e,0xbf55bf0e,0xbf0e3f55,0x3f0ebf55,0xbf673f3e,0x3f71bd49,0xbedbbf2c,0xbeac3f80
.long 0x3dc9bf46,0xbf7f3f22,0x3f7fbf22,0x3dc9bf46,0x3f4ebf04,0x3f7dbf78,0xbf183f5c,0x3e163e79
.long 0xbf6d3f6d,0xbf6d3f6d,0xbec43ec4,0xbec43ec4,0x3e163e79,0x3f4ebf04,0x3f7dbf78,0x3f18bf5c
.long 0x3f46bf7f,0xbf22bdc9,0xbf22bdc9,0xbf463f7f,0xbf713d49,0x3edb3f2c,0xbeac3f80,0x3f67bf3e
.long 0x3e483f7b,0xbe48bf7b,0x3f7bbe48,0xbf7b3e48,0x3f3ebeac,0xbd493f67,0xbf2cbf71,0x3f803edb
.long 0xbf75bf62,0x3e95bef1,0xbe953ef1,0xbf75bf62,0x3e793f18,0xbf04be16,0x3f783f4e,0x3f5c3f7d
.long 0x0,0x0,0x3f803f80,0x3f803f80,0xbf04be16,0xbf78bf4e,0xbf5cbf7d,0xbe79bf18
.long 0x3f623e95,0x3ef13f75,0x3ef13f75,0xbf62be95,0xbf80bedb,0x3f3ebeac,0x3d49bf67,0x3f2c3f71
.long 0x3f553f0e,0xbf55bf0e,0xbf0e3f55,0x3f0ebf55,0xbedbbf2c,0xbeac3f80,0x3f67bf3e,0xbf713d49
.long 0xbdc93f46,0x3f7fbf22,0xbf7f3f22,0xbdc93f46,0x3f18bf5c,0xbe16be79,0x3f4ebf04,0x3f7dbf78
.long 0xbf6d3f6d,0xbf6d3f6d,0xbec43ec4,0xbec43ec4,0x3f7dbf78,0x3f18bf5c,0xbe16be79,0xbf4e3f04
.long 0xbf463f7f,0x3f223dc9,0x3f223dc9,0x3f46bf7f,0x3eacbf80,0xbf673f3e,0xbf713d49,0x3edb3f2c
.long 0x3e483f7b,0xbe48bf7b,0x3f7bbe48,0xbf7b3e48,0xbf2cbf71,0x3f803edb,0xbf3e3eac,0x3d49bf67
.long 0x3f753f62,0xbe953ef1,0x3e95bef1,0x3f753f62,0xbf78bf4e,0xbf5cbf7d,0x3e793f18,0xbf04be16
.long 0x0,0x0,0x3f803f80,0x3f803f80,0xbf5cbf7d,0xbe79bf18,0x3f043e16,0x3f783f4e
.long 0xbf62be95,0xbef1bf75,0xbef1bf75,0x3f623e95,0xbd493f67,0xbf2cbf71,0xbf80bedb,0x3f3ebeac
.long 0x3f553f0e,0xbf55bf0e,0xbf0e3f55,0x3f0ebf55,0x3f67bf3e,0xbf713d49,0x3edb3f2c,0x3eacbf80
.long 0x3dc9bf46,0xbf7f3f22,0x3f7fbf22,0x3dc9bf46,0xbf4e3f04,0xbf7d3f78,0x3f18bf5c,0xbe16be79
.long 0xbf6d3f6d,0xbf6d3f6d,0xbec43ec4,0xbec43ec4,0xbe16be79,0xbf4e3f04,0xbf7d3f78,0xbf183f5c
.long 0x3f46bf7f,0xbf22bdc9,0xbf22bdc9,0xbf463f7f,0x3f71bd49,0xbedbbf2c,0x3eacbf80,0xbf673f3e
.long 0x3e483f7b,0xbe48bf7b,0x3f7bbe48,0xbf7b3e48,0xbf3e3eac,0x3d49bf67,0x3f2c3f71,0xbf80bedb
.long 0xbf75bf62,0x3e95bef1,0xbe953ef1,0xbf75bf62,0xbe79bf18,0x3f043e16,0xbf78bf4e,0xbf5cbf7d
.long 0x3f80,0x3e483f7b,0x3ec43f6d,0x3f0e3f55,0x3f80,0x3f0e3f55,0x3f6d3ec4,0x3f7bbe48
.long 0x3f80,0x3f553f0e,0x3f6dbec4,0x3e48bf7b,0x3f80,0x3f7b3e48,0x3ec4bf6d,0xbf55bf0e
.long 0x3f80,0x3f7bbe48,0xbec4bf6d,0xbf553f0e,0x3f80,0x3f55bf0e,0xbf6dbec4,0x3e483f7b
.long 0x3f80,0x3f0ebf55,0xbf6d3ec4,0x3f7b3e48,0x3f80,0x3e48bf7b,0xbec43f6d,0x3f0ebf55
.long 0x3f80,0xbe48bf7b,0x3ec43f6d,0xbf0ebf55,0x3f80,0xbf0ebf55,0x3f6d3ec4,0xbf7b3e48
.long 0x3f80,0xbf55bf0e,0x3f6dbec4,0xbe483f7b,0x3f80,0xbf7bbe48,0x3ec4bf6d,0x3f553f0e
.long 0x3f80,0xbf7b3e48,0xbec4bf6d,0x3f55bf0e,0x3f80,0xbf553f0e,0xbf6dbec4,0xbe48bf7b
.long 0x3f80,0xbf0e3f55,0xbf6d3ec4,0xbf7bbe48,0x3f80,0xbe483f7b,0xbec43f6d,0xbf0e3f55
.long 0x3f353f35,0x3f553f0e,0x3f6d3ec4,0x3f7b3e48,0x3f35bf35,0x3e48bf7b,0xbec4bf6d,0xbf55bf0e
.long 0xbf35bf35,0xbf7b3e48,0xbec43f6d,0x3f0e3f55,0xbf353f35,0x3f0e3f55,0x3f6dbec4,0xbe48bf7b
.long 0x3f353f35,0x3f0ebf55,0xbf6dbec4,0xbe483f7b,0x3f35bf35,0xbf7bbe48,0x3ec43f6d,0x3f0ebf55
.long 0xbf35bf35,0x3e483f7b,0x3ec4bf6d,0xbf553f0e,0xbf353f35,0x3f55bf0e,0xbf6d3ec4,0x3f7bbe48
.long 0x3f353f35,0xbf55bf0e,0x3f6d3ec4,0xbf7bbe48,0x3f35bf35,0xbe483f7b,0xbec4bf6d,0x3f553f0e
.long 0xbf35bf35,0x3f7bbe48,0xbec43f6d,0xbf0ebf55,0xbf353f35,0xbf0ebf55,0x3f6dbec4,0x3e483f7b
.long 0x3f353f35,0xbf0e3f55,0xbf6dbec4,0x3e48bf7b,0x3f35bf35,0x3f7b3e48,0x3ec43f6d,0xbf0e3f55
.long 0xbf35bf35,0xbe48bf7b,0x3ec4bf6d,0x3f55bf0e,0xbf353f35,0xbf553f0e,0xbf6d3ec4,0xbf7b3e48
.long 0x3f80248d,0x3f7bbe48,0x3f6dbec4,0x3f55bf0e,0xbf80a554,0xbf553f0e,0xbec43f6d,0x3e483f7b
.long 0x3f80248d,0x3f0ebf55,0xbec4bf6d,0xbf7bbe48,0xbf80a554,0xbe483f7b,0x3f6d3ec4,0x3f0ebf55
.long 0x3f80248d,0xbe48bf7b,0xbf6d3ec4,0x3f0e3f55,0xbf80a554,0x3f0e3f55,0x3ec4bf6d,0xbf7b3e48
.long 0x3f80248d,0xbf55bf0e,0x3ec43f6d,0x3e48bf7b,0xbf80a554,0x3f7b3e48,0xbf6dbec4,0x3f553f0e
.long 0x3f80248d,0xbf7b3e48,0x3f6dbec4,0xbf553f0e,0xbf80a554,0x3f55bf0e,0xbec43f6d,0xbe48bf7b
.long 0x3f80248d,0xbf0e3f55,0xbec4bf6d,0x3f7b3e48,0xbf80a554,0x3e48bf7b,0x3f6d3ec4,0xbf0e3f55
.long 0x3f80248d,0x3e483f7b,0xbf6d3ec4,0xbf0ebf55,0xbf80a554,0xbf0ebf55,0x3ec4bf6d,0x3f7bbe48
.long 0x3f80248d,0x3f553f0e,0x3ec43f6d,0xbe483f7b,0xbf80a554,0xbf7bbe48,0xbf6dbec4,0xbf55bf0e
.long 0x3f35bf35,0x3f0ebf55,0x3ec4bf6d,0x3e48bf7b,0x3f353f35,0x3f7b3e48,0x3f6dbec4,0x3f0ebf55
.long 0xbf353f35,0x3e483f7b,0x3f6d3ec4,0x3f55bf0e,0xbf35bf35,0xbf553f0e,0x3ec43f6d,0x3f7bbe48
.long 0x3f35bf35,0xbf55bf0e,0xbec43f6d,0x3f7b3e48,0x3f353f35,0x3e48bf7b,0xbf6d3ec4,0x3f553f0e
.long 0xbf353f35,0x3f7bbe48,0xbf6dbec4,0x3f0e3f55,0xbf35bf35,0x3f0e3f55,0xbec4bf6d,0x3e483f7b
.long 0x3f35bf35,0xbf0e3f55,0x3ec4bf6d,0xbe483f7b,0x3f353f35,0xbf7bbe48,0x3f6dbec4,0xbf0e3f55
.long 0xbf353f35,0xbe48bf7b,0x3f6d3ec4,0xbf553f0e,0xbf35bf35,0x3f55bf0e,0x3ec43f6d,0xbf7b3e48
.long 0x3f35bf35,0x3f553f0e,0xbec43f6d,0xbf7bbe48,0x3f353f35,0xbe483f7b,0xbf6d3ec4,0xbf55bf0e
.long 0xbf353f35,0xbf7b3e48,0xbf6dbec4,0xbf0ebf55,0xbf35bf35,0xbf0ebf55,0xbec4bf6d,0xbe48bf7b
.long 0x3f808000,0x3f7bbe48,0x3f6dbec4,0x3f55bf0e,0x3f808000,0x3f55bf0e,0x3ec4bf6d,0xbe48bf7b
.long 0x3f808000,0x3f0ebf55,0xbec4bf6d,0xbf7bbe48,0x3f808000,0x3e48bf7b,0xbf6dbec4,0xbf0e3f55
.long 0x3f808000,0xbe48bf7b,0xbf6d3ec4,0x3f0e3f55,0x3f808000,0xbf0ebf55,0xbec43f6d,0x3f7bbe48
.long 0x3f808000,0xbf55bf0e,0x3ec43f6d,0x3e48bf7b,0x3f808000,0xbf7bbe48,0x3f6d3ec4,0xbf55bf0e
.long 0x3f808000,0xbf7b3e48,0x3f6dbec4,0xbf553f0e,0x3f808000,0xbf553f0e,0x3ec4bf6d,0x3e483f7b
.long 0x3f808000,0xbf0e3f55,0xbec4bf6d,0x3f7b3e48,0x3f808000,0xbe483f7b,0xbf6dbec4,0x3f0ebf55
.long 0x3f808000,0x3e483f7b,0xbf6d3ec4,0xbf0ebf55,0x3f808000,0x3f0e3f55,0xbec43f6d,0xbf7b3e48
.long 0x3f808000,0x3f553f0e,0x3ec43f6d,0xbe483f7b,0x3f808000,0x3f7b3e48,0x3f6d3ec4,0x3f553f0e
.long 0x3f35bf35,0x3f0ebf55,0x3ec4bf6d,0x3e48bf7b,0xbf35bf35,0xbf7bbe48,0xbf6d3ec4,0xbf0e3f55
.long 0xbf353f35,0x3e483f7b,0x3f6d3ec4,0x3f55bf0e,0x3f353f35,0x3f55bf0e,0xbec4bf6d,0xbf7b3e48
.long 0x3f35bf35,0xbf55bf0e,0xbec43f6d,0x3f7b3e48,0xbf35bf35,0xbe483f7b,0x3f6dbec4,0xbf55bf0e
.long 0xbf353f35,0x3f7bbe48,0xbf6dbec4,0x3f0e3f55,0x3f353f35,0xbf0ebf55,0x3ec43f6d,0xbe48bf7b
.long 0x3f35bf35,0xbf0e3f55,0x3ec4bf6d,0xbe483f7b,0xbf35bf35,0x3f7b3e48,0xbf6d3ec4,0x3f0ebf55
.long 0xbf353f35,0xbe48bf7b,0x3f6d3ec4,0xbf553f0e,0x3f353f35,0xbf553f0e,0xbec4bf6d,0x3f7bbe48
.long 0x3f35bf35,0x3f553f0e,0xbec43f6d,0xbf7bbe48,0xbf35bf35,0x3e48bf7b,0x3f6dbec4,0x3f553f0e
.long 0xbf353f35,0xbf7b3e48,0xbf6dbec4,0xbf0ebf55,0x3f353f35,0x3f0e3f55,0x3ec43f6d,0x3e483f7b
.long 0x248dbf80,0xbe48bf7b,0xbec4bf6d,0xbf0ebf55,0xa5543f80,0x3f0e3f55,0x3f6d3ec4,0x3f7bbe48
.long 0x248dbf80,0xbf55bf0e,0xbf6d3ec4,0xbe483f7b,0xa5543f80,0x3f7b3e48,0x3ec4bf6d,0xbf55bf0e
.long 0x248dbf80,0xbf7b3e48,0x3ec43f6d,0x3f55bf0e,0xa5543f80,0x3f55bf0e,0xbf6dbec4,0x3e483f7b
.long 0x248dbf80,0xbf0e3f55,0x3f6dbec4,0xbf7bbe48,0xa5543f80,0x3e48bf7b,0xbec43f6d,0x3f0ebf55
.long 0x248dbf80,0x3e483f7b,0xbec4bf6d,0x3f0e3f55,0xa5543f80,0xbf0ebf55,0x3f6d3ec4,0xbf7b3e48
.long 0x248dbf80,0x3f553f0e,0xbf6d3ec4,0x3e48bf7b,0xa5543f80,0xbf7bbe48,0x3ec4bf6d,0x3f553f0e
.long 0x248dbf80,0x3f7bbe48,0x3ec43f6d,0xbf553f0e,0xa5543f80,0xbf553f0e,0xbf6dbec4,0xbe48bf7b
.long 0x248dbf80,0x3f0ebf55,0x3f6dbec4,0x3f7b3e48,0xa5543f80,0xbe483f7b,0xbec43f6d,0xbf0e3f55
.long 0xbf35bf35,0xbf55bf0e,0xbf6dbec4,0xbf7bbe48,0x3f35bf35,0x3e48bf7b,0xbec4bf6d,0xbf55bf0e
.long 0x3f353f35,0x3f7bbe48,0x3ec4bf6d,0xbf0ebf55,0xbf353f35,0x3f0e3f55,0x3f6dbec4,0xbe48bf7b
.long 0xbf35bf35,0xbf0e3f55,0x3f6d3ec4,0x3e48bf7b,0x3f35bf35,0xbf7bbe48,0x3ec43f6d,0x3f0ebf55
.long 0x3f353f35,0xbe48bf7b,0xbec43f6d,0x3f55bf0e,0xbf353f35,0x3f55bf0e,0xbf6d3ec4,0x3f7bbe48
.long 0xbf35bf35,0x3f553f0e,0xbf6dbec4,0x3f7b3e48,0x3f35bf35,0xbe483f7b,0xbec4bf6d,0x3f553f0e
.long 0x3f353f35,0xbf7b3e48,0x3ec4bf6d,0x3f0e3f55,0xbf353f35,0xbf0ebf55,0x3f6dbec4,0x3e483f7b
.long 0xbf35bf35,0x3f0ebf55,0x3f6d3ec4,0xbe483f7b,0x3f35bf35,0x3f7b3e48,0x3ec43f6d,0xbf0e3f55
.long 0x3f353f35,0x3e483f7b,0xbec43f6d,0xbf553f0e,0xbf353f35,0xbf553f0e,0xbf6d3ec4,0xbf7b3e48
.long 0x3f800000,0x3f7ffb11,0x3f7fec43,0x3f7fd397,0x3f800000,0x3f7fd397,0x3f7f4e6d,0x3f7e70b0
.long 0x3f800000,0x3f7f84ab,0x3f7e1324,0x3f7baccd,0x3f800000,0x3f7f0e58,0x3f7c3b28,0x3f778bc5
.long 0x3f800000,0x3f7e70b0,0x3f79c79d,0x3f721352,0x3f800000,0x3f7dabcc,0x3f76ba07,0x3f6b4b0c
.long 0x3f800000,0x3f7cbfc9,0x3f731447,0x3f633c5a,0x3f800000,0x3f7baccd,0x3f6ed89e,0x3f59f26a
.long 0x3f800000,0x3f7a7302,0x3f6a09a7,0x3f4f7a1f,0x3f800000,0x3f791298,0x3f64aa59,0x3f43e200
.long 0x3f800000,0x3f778bc5,0x3f5ebe05,0x3f373a23,0x3f800000,0x3f75dec6,0x3f584853,0x3f299415
.long 0x3f800000,0x3f740bdd,0x3f514d3d,0x3f1b02c6,0x3f800000,0x3f721352,0x3f49d112,0x3f0b9a6b
.long 0x3f800000,0x3f6ff573,0x3f41d870,0x3ef6e0cb,0x3f800000,0x3f6db293,0x3f396842,0x3ed53641
.long 0x3f7fb10f,0x3f7f84ab,0x3f7f4e6d,0x3f7f0e58,0x3f7d3aac,0x3f7baccd,0x3f79c79d,0x3f778bc5
.long 0x3f7853f8,0x3f740bdd,0x3f6ed89e,0x3f68bf3c,0x3f710908,0x3f68bf3c,0x3f5ebe05,0x3f531849
.long 0x3f676bd8,0x3f59f26a,0x3f49d112,0x3f373a23,0x3f5b941a,0x3f47de65,0x3f3085bb,0x3f15f6d9
.long 0x3f4d9f02,0x3f32c8c9,0x3f13682a,0x3ee0924f,0x3f3daef9,0x3f1b02c6,0x3ee63375,0x3e8e9a22
.long 0x3f2beb4a,0x3f00e7e4,0x3ea09ae5,0x3de1bc2e,0x3f187fc0,0x3ec9b953,0x3e2f10a2,0xbd7b2b74
.long 0x3f039c3d,0x3e8e9a22,0x3cc90ab0,0xbe6c9a7f,0x3edae880,0x3e22abb6,0xbdfab273,0xbec9b953
.long 0x3eac7cd4,0x3d16c32c,0xbe888e93,0xbf0b9a6b,0x3e78cfcc,0xbdafb680,0xbecf7bca,0xbf2e3bde
.long 0x3e164083,0xbe541501,0xbf08f59b,0xbf4bbbf8,0x3d48fb30,0xbea68f12,0xbf273656,0xbf633c5a
.long 0x3f7ec46d,0x3f7e70b0,0x3f7e1324,0x3f7dabcc,0x3f74fa0b,0x3f721352,0x3f6ed89e,0x3f6b4b0c
.long 0x3f61c598,0x3f59f26a,0x3f514d3d,0x3f47de65,0x3f45e403,0x3f373a23,0x3f273656,0x3f15f6d9
.long 0x3f226799,0x3f0b9a6b,0x3ee63375,0x3eb263ef,0x3ef15aea,0x3eb263ef,0x3e605c13,0x3dafb680
.long 0x3e94a031,0x3e09cf86,0xbcc90ab0,0xbe3b6ecf,0x3dc8bd36,0xbdafb680,0xbe888e93,0xbee0924f
.long 0xbdc8bd36,0xbe9aa086,0xbefc5d27,0xbf299415,0xbe94a031,0xbf00e7e4,0xbf3085bb,0xbf5695e5
.long 0xbef15aea,0xbf2e3bde,0xbf584853,0xbf740bdd,0xbf226799,0xbf531849,0xbf731447,0xbf7fd397
.long 0xbf45e403,0xbf6db293,0xbf7f4e6d,0xbf791298,0xbf61c598,0xbf7cbfc9,0xbf7c3b28,0xbf604621
.long 0xbf74fa0b,0xbf7f84ab,0xbf6a09a7,0xbf373a23,0xbf7ec46d,0xbf75dec6,0xbf49d112,0xbf00e7e4
.long 0x3f7d3aac,0x3f7cbfc9,0x3f7c3b28,0x3f7baccd,0x3f676bd8,0x3f633c5a,0x3f5ebe05,0x3f59f26a
.long 0x3f3daef9,0x3f32c8c9,0x3f273656,0x3f1b02c6,0x3f039c3d,0x3ee0924f,0x3eb8442a,0x3e8e9a22
.long 0x3e78cfcc,0x3e09cf86,0x3cc90ab0,0xbdafb680,0xbd48fb30,0xbe3b6ecf,0xbea09ae5,0xbee0924f
.long 0xbeac7cd4,0xbef6e0cb,0xbf1d7fd1,0xbf3b8f3b,0xbf187fc0,0xbf3b8f3b,0xbf584853,0xbf6db293
.long 0xbf4d9f02,0xbf68bf3c,0xbf79c79d,0xbf7ffb11,0xbf710908,0xbf7e70b0,0xbf7e1324,0xbf6ff573
.long 0xbf7fb10f,0xbf7a7302,0xbf64aa59,0xbf3fc767,0xbf7853f8,0xbf5d2d53,0xbf3085bb,0xbeebcbbb
.long 0xbf5b941a,0xbf299415,0xbecf7bca,0xbde1bc2e,0xbf2beb4a,0xbec9b953,0xbd96a905,0x3e827dc0
.long 0xbedae880,0xbdafb680,0x3e888e93,0x3f15f6d9,0xbe164083,0x3e6c9a7f,0x3f13682a,0x3f5695e5
.long 0x0,0x3c490e90,0x3cc90ab0,0x3d16c32c,0x0,0x3d16c32c,0x3d96a905,0x3de1bc2e
.long 0x0,0x3d7b2b74,0x3dfab273,0x3e3b6ecf,0x0,0x3dafb680,0x3e2f10a2,0x3e827dc0
.long 0x0,0x3de1bc2e,0x3e605c13,0x3ea68f12,0x0,0x3e09cf86,0x3e888e93,0x3ec9b953
.long 0x0,0x3e22abb6,0x3ea09ae5,0x3eebcbbb,0x0,0x3e3b6ecf,0x3eb8442a,0x3f064b82
.long 0x0,0x3e541501,0x3ecf7bca,0x3f15f6d9,0x0,0x3e6c9a7f,0x3ee63375,0x3f24d225
.long 0x0,0x3e827dc0,0x3efc5d27,0x3f32c8c9,0x0,0x3e8e9a22,0x3f08f59b,0x3f3fc767
.long 0x0,0x3e9aa086,0x3f13682a,0x3f4bbbf8,0x0,0x3ea68f12,0x3f1d7fd1,0x3f5695e5
.long 0x0,0x3eb263ef,0x3f273656,0x3f604621,0x0,0x3ebe1d4a,0x3f3085bb,0x3f68bf3c
.long 0x3d48fb30,0x3d7b2b74,0x3d96a905,0x3dafb680,0x3e164083,0x3e3b6ecf,0x3e605c13,0x3e827dc0
.long 0x3e78cfcc,0x3e9aa086,0x3eb8442a,0x3ed53641,0x3eac7cd4,0x3ed53641,0x3efc5d27,0x3f10d3cd
.long 0x3edae880,0x3f064b82,0x3f1d7fd1,0x3f32c8c9,0x3f039c3d,0x3f1ff6cb,0x3f396842,0x3f4f7a1f
.long 0x3f187fc0,0x3f373a23,0x3f514d3d,0x3f660f88,0x3f2beb4a,0x3f4bbbf8,0x3f64aa59,0x3f75dec6
.long 0x3f3daef9,0x3f5d2d53,0x3f731447,0x3f7e70b0,0x3f4d9f02,0x3f6b4b0c,0x3f7c3b28,0x3f7f84ab
.long 0x3f5b941a,0x3f75dec6,0x3f7fec43,0x3f791298,0x3f676bd8,0x3f7cbfc9,0x3f7e1324,0x3f6b4b0c
.long 0x3f710908,0x3f7fd397,0x3f76ba07,0x3f5695e5,0x3f7853f8,0x3f7f0e58,0x3f6a09a7,0x3f3b8f3b
.long 0x3f7d3aac,0x3f7a7302,0x3f584853,0x3f1b02c6,0x3f7fb10f,0x3f721352,0x3f41d870,0x3eebcbbb
.long 0x3dc8bd36,0x3de1bc2e,0x3dfab273,0x3e09cf86,0x3e94a031,0x3ea68f12,0x3eb8442a,0x3ec9b953
.long 0x3ef15aea,0x3f064b82,0x3f13682a,0x3f1ff6cb,0x3f226799,0x3f32c8c9,0x3f41d870,0x3f4f7a1f
.long 0x3f45e403,0x3f5695e5,0x3f64aa59,0x3f6ff573,0x3f61c598,0x3f6ff573,0x3f79c79d,0x3f7f0e58
.long 0x3f74fa0b,0x3f7dabcc,0x3f7fec43,0x3f7baccd,0x3f7ec46d,0x3f7f0e58,0x3f76ba07,0x3f660f88
.long 0x3f7ec46d,0x3f740bdd,0x3f5ebe05,0x3f3fc767,0x3f74fa0b,0x3f5d2d53,0x3f396842,0x3f0b9a6b
.long 0x3f61c598,0x3f3b8f3b,0x3f08f59b,0x3e9aa086,0x3f45e403,0x3f10d3cd,0x3ea09ae5,0x3d16c32c
.long 0x3f226799,0x3ebe1d4a,0x3d96a905,0xbe6c9a7f,0x3ef15aea,0x3e22abb6,0xbe2f10a2,0xbef6e0cb
.long 0x3e94a031,0xbd7b2b74,0xbecf7bca,0xbf32c8c9,0x3dc8bd36,0xbe8e9a22,0xbf1d7fd1,0xbf5d2d53
.long 0x3e164083,0x3e22abb6,0x3e2f10a2,0x3e3b6ecf,0x3edae880,0x3eebcbbb,0x3efc5d27,0x3f064b82
.long 0x3f2beb4a,0x3f373a23,0x3f41d870,0x3f4bbbf8,0x3f5b941a,0x3f660f88,0x3f6ed89e,0x3f75dec6
.long 0x3f7853f8,0x3f7dabcc,0x3f7fec43,0x3f7f0e58,0x3f7fb10f,0x3f7baccd,0x3f731447,0x3f660f88
.long 0x3f710908,0x3f604621,0x3f49d112,0x3f2e3bde,0x3f4d9f02,0x3f2e3bde,0x3f08f59b,0x3ebe1d4a
.long 0x3f187fc0,0x3ed53641,0x3e605c13,0x3c490e90,0x3eac7cd4,0x3de1bc2e,0xbdfab273,0xbeb263ef
.long 0x3d48fb30,0xbe541501,0xbee63375,0xbf299415,0xbe78cfcc,0xbf00e7e4,0xbf396842,0xbf633c5a
.long 0xbf039c3d,0xbf3fc767,0xbf6a09a7,0xbf7e70b0,0xbf3daef9,0xbf6b4b0c,0xbf7f4e6d,0xbf778bc5
.long 0xbf676bd8,0xbf7f0e58,0xbf76ba07,0xbf4f7a1f,0xbf7d3aac,0xbf791298,0xbf514d3d,0xbf0b9a6b
.long 0x3f800000,0x3f800000,0x3f800000,0x3f800000,0x3f7ffb11,0x3f7fd397,0x3f7f84ab,0x3f7f0e58
.long 0x3f7fec43,0x3f7f4e6d,0x3f7e1324,0x3f7c3b28,0x3f7fd397,0x3f7e70b0,0x3f7baccd,0x3f778bc5
.long 0x3f7fb10f,0x3f7d3aac,0x3f7853f8,0x3f710908,0x3f7f84ab,0x3f7baccd,0x3f740bdd,0x3f68bf3c
.long 0x3f7f4e6d,0x3f79c79d,0x3f6ed89e,0x3f5ebe05,0x3f7f0e58,0x3f778bc5,0x3f68bf3c,0x3f531849
.long 0x3f7ec46d,0x3f74fa0b,0x3f61c598,0x3f45e403,0x3f7e70b0,0x3f721352,0x3f59f26a,0x3f373a23
.long 0x3f7e1324,0x3f6ed89e,0x3f514d3d,0x3f273656,0x3f7dabcc,0x3f6b4b0c,0x3f47de65,0x3f15f6d9
.long 0x3f7d3aac,0x3f676bd8,0x3f3daef9,0x3f039c3d,0x3f7cbfc9,0x3f633c5a,0x3f32c8c9,0x3ee0924f
.long 0x3f7c3b28,0x3f5ebe05,0x3f273656,0x3eb8442a,0x3f7baccd,0x3f59f26a,0x3f1b02c6,0x3e8e9a22
.long 0x3f800000,0x3f800000,0x3f800000,0x3f800000,0x3f7e70b0,0x3f7dabcc,0x3f7cbfc9,0x3f7baccd
.long 0x3f79c79d,0x3f76ba07,0x3f731447,0x3f6ed89e,0x3f721352,0x3f6b4b0c,0x3f633c5a,0x3f59f26a
.long 0x3f676bd8,0x3f5b941a,0x3f4d9f02,0x3f3daef9,0x3f59f26a,0x3f47de65,0x3f32c8c9,0x3f1b02c6
.long 0x3f49d112,0x3f3085bb,0x3f13682a,0x3ee63375,0x3f373a23,0x3f15f6d9,0x3ee0924f,0x3e8e9a22
.long 0x3f226799,0x3ef15aea,0x3e94a031,0x3dc8bd36,0x3f0b9a6b,0x3eb263ef,0x3e09cf86,0xbdafb680
.long 0x3ee63375,0x3e605c13,0xbcc90ab0,0xbe888e93,0x3eb263ef,0x3dafb680,0xbe3b6ecf,0xbee0924f
.long 0x3e78cfcc,0xbd48fb30,0xbeac7cd4,0xbf187fc0,0x3e09cf86,0xbe3b6ecf,0xbef6e0cb,0xbf3b8f3b
.long 0x3cc90ab0,0xbea09ae5,0xbf1d7fd1,0xbf584853,0xbdafb680,0xbee0924f,0xbf3b8f3b,0xbf6db293
.long 0x3f800000,0x3f800000,0x3f800000,0x3f800000,0x3f7a7302,0x3f791298,0x3f778bc5,0x3f75dec6
.long 0x3f6a09a7,0x3f64aa59,0x3f5ebe05,0x3f584853,0x3f4f7a1f,0x3f43e200,0x3f373a23,0x3f299415
.long 0x3f2beb4a,0x3f187fc0,0x3f039c3d,0x3edae880,0x3f00e7e4,0x3ec9b953,0x3e8e9a22,0x3e22abb6
.long 0x3ea09ae5,0x3e2f10a2,0x3cc90ab0,0xbdfab273,0x3de1bc2e,0xbd7b2b74,0xbe6c9a7f,0xbec9b953
.long 0xbdc8bd36,0xbe94a031,0xbef15aea,0xbf226799,0xbe9aa086,0xbf00e7e4,0xbf2e3bde,0xbf531849
.long 0xbefc5d27,0xbf3085bb,0xbf584853,0xbf731447,0xbf299415,0xbf5695e5,0xbf740bdd,0xbf7fd397
.long 0xbf4d9f02,0xbf710908,0xbf7fb10f,0xbf7853f8,0xbf68bf3c,0xbf7e70b0,0xbf7a7302,0xbf5d2d53
.long 0xbf79c79d,0xbf7e1324,0xbf64aa59,0xbf3085bb,0xbf7ffb11,0xbf6ff573,0xbf3fc767,0xbeebcbbb
.long 0x3f800000,0x3f800000,0x3f800000,0x3f800000,0x3f740bdd,0x3f721352,0x3f6ff573,0x3f6db293
.long 0x3f514d3d,0x3f49d112,0x3f41d870,0x3f396842,0x3f1b02c6,0x3f0b9a6b,0x3ef6e0cb,0x3ed53641
.long 0x3eac7cd4,0x3e78cfcc,0x3e164083,0x3d48fb30,0x3d16c32c,0xbdafb680,0xbe541501,0xbea68f12
.long 0xbe888e93,0xbecf7bca,0xbf08f59b,0xbf273656,0xbf0b9a6b,0xbf2e3bde,0xbf4bbbf8,0xbf633c5a
.long 0xbf45e403,0xbf61c598,0xbf74fa0b,0xbf7ec46d,0xbf6db293,0xbf7cbfc9,0xbf7f84ab,0xbf75dec6
.long 0xbf7f4e6d,0xbf7c3b28,0xbf6a09a7,0xbf49d112,0xbf791298,0xbf604621,0xbf373a23,0xbf00e7e4
.long 0xbf5b941a,0xbf2beb4a,0xbedae880,0xbe164083,0xbf299415,0xbec9b953,0xbdafb680,0x3e6c9a7f
.long 0xbecf7bca,0xbd96a905,0x3e888e93,0x3f13682a,0xbde1bc2e,0x3e827dc0,0x3f15f6d9,0x3f5695e5
.long 0x0,0x0,0x0,0x0,0x3c490e90,0x3d16c32c,0x3d7b2b74,0x3dafb680
.long 0x3cc90ab0,0x3d96a905,0x3dfab273,0x3e2f10a2,0x3d16c32c,0x3de1bc2e,0x3e3b6ecf,0x3e827dc0
.long 0x3d48fb30,0x3e164083,0x3e78cfcc,0x3eac7cd4,0x3d7b2b74,0x3e3b6ecf,0x3e9aa086,0x3ed53641
.long 0x3d96a905,0x3e605c13,0x3eb8442a,0x3efc5d27,0x3dafb680,0x3e827dc0,0x3ed53641,0x3f10d3cd
.long 0x3dc8bd36,0x3e94a031,0x3ef15aea,0x3f226799,0x3de1bc2e,0x3ea68f12,0x3f064b82,0x3f32c8c9
.long 0x3dfab273,0x3eb8442a,0x3f13682a,0x3f41d870,0x3e09cf86,0x3ec9b953,0x3f1ff6cb,0x3f4f7a1f
.long 0x3e164083,0x3edae880,0x3f2beb4a,0x3f5b941a,0x3e22abb6,0x3eebcbbb,0x3f373a23,0x3f660f88
.long 0x3e2f10a2,0x3efc5d27,0x3f41d870,0x3f6ed89e,0x3e3b6ecf,0x3f064b82,0x3f4bbbf8,0x3f75dec6
.long 0x0,0x0,0x0,0x0,0x3de1bc2e,0x3e09cf86,0x3e22abb6,0x3e3b6ecf
.long 0x3e605c13,0x3e888e93,0x3ea09ae5,0x3eb8442a,0x3ea68f12,0x3ec9b953,0x3eebcbbb,0x3f064b82
.long 0x3edae880,0x3f039c3d,0x3f187fc0,0x3f2beb4a,0x3f064b82,0x3f1ff6cb,0x3f373a23,0x3f4bbbf8
.long 0x3f1d7fd1,0x3f396842,0x3f514d3d,0x3f64aa59,0x3f32c8c9,0x3f4f7a1f,0x3f660f88,0x3f75dec6
.long 0x3f45e403,0x3f61c598,0x3f74fa0b,0x3f7ec46d,0x3f5695e5,0x3f6ff573,0x3f7dabcc,0x3f7f0e58
.long 0x3f64aa59,0x3f79c79d,0x3f7fec43,0x3f76ba07,0x3f6ff573,0x3f7f0e58,0x3f7baccd,0x3f660f88
.long 0x3f7853f8,0x3f7fb10f,0x3f710908,0x3f4d9f02,0x3f7dabcc,0x3f7baccd,0x3f604621,0x3f2e3bde
.long 0x3f7fec43,0x3f731447,0x3f49d112,0x3f08f59b,0x3f7f0e58,0x3f660f88,0x3f2e3bde,0x3ebe1d4a
.long 0x0,0x0,0x0,0x0,0x3e541501,0x3e6c9a7f,0x3e827dc0,0x3e8e9a22
.long 0x3ecf7bca,0x3ee63375,0x3efc5d27,0x3f08f59b,0x3f15f6d9,0x3f24d225,0x3f32c8c9,0x3f3fc767
.long 0x3f3daef9,0x3f4d9f02,0x3f5b941a,0x3f676bd8,0x3f5d2d53,0x3f6b4b0c,0x3f75dec6,0x3f7cbfc9
.long 0x3f731447,0x3f7c3b28,0x3f7fec43,0x3f7e1324,0x3f7e70b0,0x3f7f84ab,0x3f791298,0x3f6b4b0c
.long 0x3f7ec46d,0x3f74fa0b,0x3f61c598,0x3f45e403,0x3f740bdd,0x3f5d2d53,0x3f3b8f3b,0x3f10d3cd
.long 0x3f5ebe05,0x3f396842,0x3f08f59b,0x3ea09ae5,0x3f3fc767,0x3f0b9a6b,0x3e9aa086,0x3d16c32c
.long 0x3f187fc0,0x3eac7cd4,0x3d48fb30,0xbe78cfcc,0x3ed53641,0x3de1bc2e,0xbe541501,0xbf00e7e4
.long 0x3e605c13,0xbdfab273,0xbee63375,0xbf396842,0x3c490e90,0xbeb263ef,0xbf299415,0xbf633c5a
.long 0x0,0x0,0x0,0x0,0x3e9aa086,0x3ea68f12,0x3eb263ef,0x3ebe1d4a
.long 0x3f13682a,0x3f1d7fd1,0x3f273656,0x3f3085bb,0x3f4bbbf8,0x3f5695e5,0x3f604621,0x3f68bf3c
.long 0x3f710908,0x3f7853f8,0x3f7d3aac,0x3f7fb10f,0x3f7fd397,0x3f7f0e58,0x3f7a7302,0x3f721352
.long 0x3f76ba07,0x3f6a09a7,0x3f584853,0x3f41d870,0x3f5695e5,0x3f3b8f3b,0x3f1b02c6,0x3eebcbbb
.long 0x3f226799,0x3ef15aea,0x3e94a031,0x3dc8bd36,0x3ebe1d4a,0x3e22abb6,0xbd7b2b74,0xbe8e9a22
.long 0x3d96a905,0xbe2f10a2,0xbecf7bca,0xbf1d7fd1,0xbe6c9a7f,0xbef6e0cb,0xbf32c8c9,0xbf5d2d53
.long 0xbf039c3d,0xbf3daef9,0xbf676bd8,0xbf7d3aac,0xbf3fc767,0xbf6b4b0c,0xbf7f0e58,0xbf791298
.long 0xbf6a09a7,0xbf7f4e6d,0xbf76ba07,0xbf514d3d,0xbf7e70b0,0xbf778bc5,0xbf4f7a1f,0xbf0b9a6b
.long 0x3f803f80,0x3f803f80,0x80008000,0x80008000,0x3f553f7b,0x3e483f0e,0xbf0ebe48,0xbf7bbf55
.long 0x3ec43f6d,0xbf6dbec4,0xbf6dbec4,0xbec4bf6d,0xbe483f55,0xbf0ebf7b,0xbf7bbf0e,0x3f55be48
.long 0xbf353f35,0x3f35bf35,0xbf35bf35,0x3f353f35,0xbf7b3f0e,0x3f553e48,0xbe48bf55,0xbf0e3f7b
.long 0xbf6d3ec4,0xbec43f6d,0x3ec4bf6d,0xbf6d3ec4,0xbf0e3e48,0xbf7b3f55,0x3f55bf7b,0x3e48bf0e
.long 0xa554248d,0xa554248d,0x3f80bf80,0x3f80bf80,0x3f0ebe48,0x3f7bbf55,0x3f55bf7b,0x3e48bf0e
.long 0x3f6dbec4,0x3ec4bf6d,0x3ec4bf6d,0xbf6d3ec4,0x3f7bbf0e,0xbf55be48,0xbe48bf55,0xbf0e3f7b
.long 0x3f35bf35,0xbf353f35,0xbf35bf35,0x3f353f35,0x3e48bf55,0x3f0e3f7b,0xbf7bbf0e,0x3f55be48
.long 0xbec4bf6d,0x3f6d3ec4,0xbf6dbec4,0xbec4bf6d,0xbf55bf7b,0xbe48bf0e,0xbf0ebe48,0xbf7bbf55
.long 0x3f803f80,0x3f803f80,0x80008000,0x80008000,0xbf0ebe48,0xbf7bbf55,0xbf55bf7b,0xbe48bf0e
.long 0xbec4bf6d,0x3f6d3ec4,0x3f6d3ec4,0x3ec43f6d,0x3f7b3f0e,0xbf553e48,0xbe483f55,0xbf0ebf7b
.long 0xbf353f35,0x3f35bf35,0xbf35bf35,0x3f353f35,0xbe48bf55,0xbf0e3f7b,0x3f7bbf0e,0xbf55be48
.long 0x3f6dbec4,0x3ec4bf6d,0xbec43f6d,0x3f6dbec4,0xbf553f7b,0xbe483f0e,0xbf0e3e48,0xbf7b3f55
.long 0xa554248d,0xa554248d,0x3f80bf80,0x3f80bf80,0x3f55bf7b,0x3e48bf0e,0xbf0e3e48,0xbf7b3f55
.long 0xbf6d3ec4,0xbec43f6d,0xbec43f6d,0x3f6dbec4,0x3e483f55,0x3f0ebf7b,0x3f7bbf0e,0xbf55be48
.long 0x3f35bf35,0xbf353f35,0xbf35bf35,0x3f353f35,0xbf7bbf0e,0x3f55be48,0xbe483f55,0xbf0ebf7b
.long 0x3ec43f6d,0xbf6dbec4,0x3f6d3ec4,0x3ec43f6d,0x3f0e3e48,0x3f7b3f55,0xbf55bf7b,0xbe48bf0e
.long 0x3f803f80,0x3f803f80,0x80008000,0x80008000,0xbf55bf7b,0xbe48bf0e,0x3f0e3e48,0x3f7b3f55
.long 0x3ec43f6d,0xbf6dbec4,0xbf6dbec4,0xbec4bf6d,0x3e48bf55,0x3f0e3f7b,0x3f7b3f0e,0xbf553e48
.long 0xbf353f35,0x3f35bf35,0xbf35bf35,0x3f353f35,0x3f7bbf0e,0xbf55be48,0x3e483f55,0x3f0ebf7b
.long 0xbf6d3ec4,0xbec43f6d,0x3ec4bf6d,0xbf6d3ec4,0x3f0ebe48,0x3f7bbf55,0xbf553f7b,0xbe483f0e
.long 0xa554248d,0xa554248d,0x3f80bf80,0x3f80bf80,0xbf0e3e48,0xbf7b3f55,0xbf553f7b,0xbe483f0e
.long 0x3f6dbec4,0x3ec4bf6d,0x3ec4bf6d,0xbf6d3ec4,0xbf7b3f0e,0x3f553e48,0x3e483f55,0x3f0ebf7b
.long 0x3f35bf35,0xbf353f35,0xbf35bf35,0x3f353f35,0xbe483f55,0xbf0ebf7b,0x3f7b3f0e,0xbf553e48
.long 0xbec4bf6d,0x3f6d3ec4,0xbf6dbec4,0xbec4bf6d,0x3f553f7b,0x3e483f0e,0x3f0e3e48,0x3f7b3f55
.long 0x3f803f80,0x3f803f80,0x80008000,0x80008000,0x3f0e3e48,0x3f7b3f55,0x3f553f7b,0x3e483f0e
.long 0xbec4bf6d,0x3f6d3ec4,0x3f6d3ec4,0x3ec43f6d,0xbf7bbf0e,0x3f55be48,0x3e48bf55,0x3f0e3f7b
.long 0xbf353f35,0x3f35bf35,0xbf35bf35,0x3f353f35,0x3e483f55,0x3f0ebf7b,0xbf7b3f0e,0x3f553e48
.long 0x3f6dbec4,0x3ec4bf6d,0xbec43f6d,0x3f6dbec4,0x3f55bf7b,0x3e48bf0e,0x3f0ebe48,0x3f7bbf55
.long 0xa554248d,0xa554248d,0x3f80bf80,0x3f80bf80,0xbf553f7b,0xbe483f0e,0x3f0ebe48,0x3f7bbf55
.long 0xbf6d3ec4,0xbec43f6d,0xbec43f6d,0x3f6dbec4,0xbe48bf55,0xbf0e3f7b,0xbf7b3f0e,0x3f553e48
.long 0x3f35bf35,0xbf353f35,0xbf35bf35,0x3f353f35,0x3f7b3f0e,0xbf553e48,0x3e48bf55,0x3f0e3f7b
.long 0x3ec43f6d,0xbf6dbec4,0x3f6d3ec4,0x3ec43f6d,0xbf0ebe48,0xbf7bbf55,0x3f553f7b,0x3e483f0e
.long 0x0,0x0,0x3f803f80,0x3f803f80,0x3f0e3e48,0x3f7b3f55,0x3f553f7b,0x3e483f0e
.long 0x3f6d3ec4,0x3ec43f6d,0x3ec43f6d,0xbf6dbec4,0x3f7b3f0e,0xbf553e48,0xbe483f55,0xbf0ebf7b
.long 0x3f353f35,0xbf35bf35,0xbf353f35,0x3f35bf35,0x3e483f55,0x3f0ebf7b,0xbf7b3f0e,0x3f553e48
.long 0xbec43f6d,0x3f6dbec4,0xbf6d3ec4,0xbec43f6d,0xbf553f7b,0xbe483f0e,0xbf0e3e48,0xbf7b3f55
.long 0xbf803f80,0xbf803f80,0xa554248d,0xa554248d,0xbf553f7b,0xbe483f0e,0x3f0ebe48,0x3f7bbf55
.long 0xbec43f6d,0x3f6dbec4,0x3f6dbec4,0x3ec4bf6d,0x3e483f55,0x3f0ebf7b,0x3f7bbf0e,0xbf55be48
.long 0x3f353f35,0xbf35bf35,0x3f35bf35,0xbf353f35,0x3f7b3f0e,0xbf553e48,0x3e48bf55,0x3f0e3f7b
.long 0x3f6d3ec4,0x3ec43f6d,0xbec4bf6d,0x3f6d3ec4,0x3f0e3e48,0x3f7b3f55,0xbf55bf7b,0xbe48bf0e
.long 0x0,0x0,0x3f803f80,0x3f803f80,0x3f553f7b,0x3e483f0e,0xbf0ebe48,0xbf7bbf55
.long 0xbf6dbec4,0xbec4bf6d,0xbec4bf6d,0x3f6d3ec4,0x3e48bf55,0x3f0e3f7b,0x3f7b3f0e,0xbf553e48
.long 0x3f353f35,0xbf35bf35,0xbf353f35,0x3f35bf35,0xbf7b3f0e,0x3f553e48,0xbe48bf55,0xbf0e3f7b
.long 0x3ec4bf6d,0xbf6d3ec4,0x3f6dbec4,0x3ec4bf6d,0x3f0ebe48,0x3f7bbf55,0xbf553f7b,0xbe483f0e
.long 0xbf803f80,0xbf803f80,0xa554248d,0xa554248d,0x3f0ebe48,0x3f7bbf55,0x3f55bf7b,0x3e48bf0e
.long 0x3ec4bf6d,0xbf6d3ec4,0xbf6d3ec4,0xbec43f6d,0xbf7b3f0e,0x3f553e48,0x3e483f55,0x3f0ebf7b
.long 0x3f353f35,0xbf35bf35,0x3f35bf35,0xbf353f35,0x3e48bf55,0x3f0e3f7b,0xbf7bbf0e,0x3f55be48
.long 0xbf6dbec4,0xbec4bf6d,0x3ec43f6d,0xbf6dbec4,0x3f553f7b,0x3e483f0e,0x3f0e3e48,0x3f7b3f55
.long 0x0,0x0,0x3f803f80,0x3f803f80,0xbf0ebe48,0xbf7bbf55,0xbf55bf7b,0xbe48bf0e
.long 0x3f6d3ec4,0x3ec43f6d,0x3ec43f6d,0xbf6dbec4,0xbf7bbf0e,0x3f55be48,0x3e48bf55,0x3f0e3f7b
.long 0x3f353f35,0xbf35bf35,0xbf353f35,0x3f35bf35,0xbe48bf55,0xbf0e3f7b,0x3f7bbf0e,0xbf55be48
.long 0xbec43f6d,0x3f6dbec4,0xbf6d3ec4,0xbec43f6d,0x3f55bf7b,0x3e48bf0e,0x3f0ebe48,0x3f7bbf55
.long 0xbf803f80,0xbf803f80,0xa554248d,0xa554248d,0x3f55bf7b,0x3e48bf0e,0xbf0e3e48,0xbf7b3f55
.long 0xbec43f6d,0x3f6dbec4,0x3f6dbec4,0x3ec4bf6d,0xbe48bf55,0xbf0e3f7b,0xbf7b3f0e,0x3f553e48
.long 0x3f353f35,0xbf35bf35,0x3f35bf35,0xbf353f35,0xbf7bbf0e,0x3f55be48,0xbe483f55,0xbf0ebf7b
.long 0x3f6d3ec4,0x3ec43f6d,0xbec4bf6d,0x3f6d3ec4,0xbf0ebe48,0xbf7bbf55,0x3f553f7b,0x3e483f0e
.long 0x0,0x0,0x3f803f80,0x3f803f80,0xbf55bf7b,0xbe48bf0e,0x3f0e3e48,0x3f7b3f55
.long 0xbf6dbec4,0xbec4bf6d,0xbec4bf6d,0x3f6d3ec4,0xbe483f55,0xbf0ebf7b,0xbf7bbf0e,0x3f55be48
.long 0x3f353f35,0xbf35bf35,0xbf353f35,0x3f35bf35,0x3f7bbf0e,0xbf55be48,0x3e483f55,0x3f0ebf7b
.long 0x3ec4bf6d,0xbf6d3ec4,0x3f6dbec4,0x3ec4bf6d,0xbf0e3e48,0xbf7b3f55,0x3f55bf7b,0x3e48bf0e
.long 0xbf803f80,0xbf803f80,0xa554248d,0xa554248d,0xbf0e3e48,0xbf7b3f55,0xbf553f7b,0xbe483f0e
.long 0x3ec4bf6d,0xbf6d3ec4,0xbf6d3ec4,0xbec43f6d,0x3f7bbf0e,0xbf55be48,0xbe48bf55,0xbf0e3f7b
.long 0x3f353f35,0xbf35bf35,0x3f35bf35,0xbf353f35,0xbe483f55,0xbf0ebf7b,0x3f7b3f0e,0xbf553e48
.long 0xbf6dbec4,0xbec4bf6d,0x3ec43f6d,0xbf6dbec4,0xbf55bf7b,0xbe48bf0e,0xbf0ebe48,0xbf7bbf55
.long 0x3f80,0x3e793f78,0x3ef13f62,0x3f2c3f3e,0x3f80,0x3f183f4e,0x3f753e95,0x3f71beac
.long 0x3f80,0x3f5c3f04,0x3f62bef1,0x3d49bf80,0x3f80,0x3f7d3e16,0x3e95bf75,0xbf67bedb
.long 0x3f80,0x3f78be79,0xbef1bf62,0xbf3e3f2c,0x3f80,0x3f4ebf18,0xbf75be95,0x3eac3f71
.long 0x3f80,0x3f04bf5c,0xbf623ef1,0x3f803d49,0x3f80,0x3e16bf7d,0xbe953f75,0x3edbbf67
.long 0x3f80,0xbe79bf78,0x3ef13f62,0xbf2cbf3e,0x3f80,0xbf18bf4e,0x3f753e95,0xbf713eac
.long 0x3f80,0xbf5cbf04,0x3f62bef1,0xbd493f80,0x3f80,0xbf7dbe16,0x3e95bf75,0x3f673edb
.long 0x3f80,0xbf783e79,0xbef1bf62,0x3f3ebf2c,0x3f80,0xbf4e3f18,0xbf75be95,0xbeacbf71
.long 0x3f80,0xbf043f5c,0xbf623ef1,0xbf80bd49,0x3f80,0xbe163f7d,0xbe953f75,0xbedb3f67
.long 0x3f553f0e,0x3f713eac,0x3f7f3dc9,0x3f7dbe16,0x3f0ebf55,0xbd49bf80,0xbf22bf46,0xbf78be79
.long 0xbf55bf0e,0xbf673edb,0xbdc93f7f,0x3f4e3f18,0xbf0e3f55,0x3f3e3f2c,0x3f46bf22,0xbf04bf5c
.long 0x3f553f0e,0x3eacbf71,0xbf7fbdc9,0x3e163f7d,0x3f0ebf55,0xbf803d49,0x3f223f46,0x3e79bf78
.long 0xbf55bf0e,0x3edb3f67,0x3dc9bf7f,0xbf183f4e,0xbf0e3f55,0x3f2cbf3e,0xbf463f22,0x3f5cbf04
.long 0x3f553f0e,0xbf71beac,0x3f7f3dc9,0xbf7d3e16,0x3f0ebf55,0x3d493f80,0xbf22bf46,0x3f783e79
.long 0xbf55bf0e,0x3f67bedb,0xbdc93f7f,0xbf4ebf18,0xbf0e3f55,0xbf3ebf2c,0x3f46bf22,0x3f043f5c
.long 0x3f553f0e,0xbeac3f71,0xbf7fbdc9,0xbe16bf7d,0x3f0ebf55,0x3f80bd49,0x3f223f46,0xbe793f78
.long 0xbf55bf0e,0xbedbbf67,0x3dc9bf7f,0x3f18bf4e,0xbf0e3f55,0xbf2c3f3e,0xbf463f22,0xbf5c3f04
.long 0x3f6dbec4,0x3f4ebf18,0x3f22bf46,0x3edbbf67,0xbf6d3ec4,0xbf043f5c,0x3dc93f7f,0x3f2c3f3e
.long 0x3f6dbec4,0x3e16bf7d,0xbf46bf22,0xbf713eac,0xbf6d3ec4,0x3e793f78,0x3f7fbdc9,0x3d49bf80
.long 0x3f6dbec4,0xbf18bf4e,0xbf223f46,0x3f673edb,0xbf6d3ec4,0x3f5c3f04,0xbdc9bf7f,0xbf3e3f2c
.long 0x3f6dbec4,0xbf7dbe16,0x3f463f22,0xbeacbf71,0xbf6d3ec4,0x3f78be79,0xbf7f3dc9,0x3f803d49
.long 0x3f6dbec4,0xbf4e3f18,0x3f22bf46,0xbedb3f67,0xbf6d3ec4,0x3f04bf5c,0x3dc93f7f,0xbf2cbf3e
.long 0x3f6dbec4,0xbe163f7d,0xbf46bf22,0x3f71beac,0xbf6d3ec4,0xbe79bf78,0x3f7fbdc9,0xbd493f80
.long 0x3f6dbec4,0x3f183f4e,0xbf223f46,0xbf67bedb,0xbf6d3ec4,0xbf5cbf04,0xbdc9bf7f,0x3f3ebf2c
.long 0x3f6dbec4,0x3f7d3e16,0x3f463f22,0x3eac3f71,0xbf6d3ec4,0xbf783e79,0xbf7f3dc9,0xbf80bd49
.long 0x3e48bf7b,0xbd49bf80,0xbe95bf75,0xbf04bf5c,0x3f7b3e48,0x3f67bedb,0x3ef1bf62,0xbe16bf7d
.long 0xbe483f7b,0x3f3e3f2c,0x3f75be95,0x3e79bf78,0xbf7bbe48,0xbeac3f71,0x3f623ef1,0x3f18bf4e
.long 0x3e48bf7b,0xbf803d49,0x3e953f75,0x3f5cbf04,0x3f7b3e48,0xbedbbf67,0xbef13f62,0x3f7dbe16
.long 0xbe483f7b,0x3f2cbf3e,0xbf753e95,0x3f783e79,0xbf7bbe48,0x3f713eac,0xbf62bef1,0x3f4e3f18
.long 0x3e48bf7b,0x3d493f80,0xbe95bf75,0x3f043f5c,0x3f7b3e48,0xbf673edb,0x3ef1bf62,0x3e163f7d
.long 0xbe483f7b,0xbf3ebf2c,0x3f75be95,0xbe793f78,0xbf7bbe48,0x3eacbf71,0x3f623ef1,0xbf183f4e
.long 0x3e48bf7b,0x3f80bd49,0x3e953f75,0xbf5c3f04,0x3f7b3e48,0x3edb3f67,0xbef13f62,0xbf7d3e16
.long 0xbe483f7b,0xbf2c3f3e,0xbf753e95,0xbf78be79,0xbf7bbe48,0xbf71beac,0xbf62bef1,0xbf4ebf18
.long 0x3f808000,0x3f78be79,0x3f62bef1,0x3f3ebf2c,0x3f808000,0x3f4ebf18,0x3e95bf75,0xbeacbf71
.long 0x3f808000,0x3f04bf5c,0xbef1bf62,0xbf80bd49,0x3f808000,0x3e16bf7d,0xbf75be95,0xbedb3f67
.long 0x3f808000,0xbe79bf78,0xbf623ef1,0x3f2c3f3e,0x3f808000,0xbf18bf4e,0xbe953f75,0x3f71beac
.long 0x3f808000,0xbf5cbf04,0x3ef13f62,0x3d49bf80,0x3f808000,0xbf7dbe16,0x3f753e95,0xbf67bedb
.long 0x3f808000,0xbf783e79,0x3f62bef1,0xbf3e3f2c,0x3f808000,0xbf4e3f18,0x3e95bf75,0x3eac3f71
.long 0x3f808000,0xbf043f5c,0xbef1bf62,0x3f803d49,0x3f808000,0xbe163f7d,0xbf75be95,0x3edbbf67
.long 0x3f808000,0x3e793f78,0xbf623ef1,0xbf2cbf3e,0x3f808000,0x3f183f4e,0xbe953f75,0xbf713eac
.long 0x3f808000,0x3f5c3f04,0x3ef13f62,0xbd493f80,0x3f808000,0x3f7d3e16,0x3f753e95,0x3f673edb
.long 0x3f0ebf55,0x3eacbf71,0x3dc9bf7f,0xbe16bf7d,0xbf55bf0e,0xbf803d49,0xbf463f22,0xbe793f78
.long 0xbf0e3f55,0x3edb3f67,0x3f7f3dc9,0x3f18bf4e,0x3f553f0e,0x3f2cbf3e,0xbf22bf46,0xbf5c3f04
.long 0x3f0ebf55,0xbf71beac,0xbdc93f7f,0x3f7dbe16,0xbf55bf0e,0x3d493f80,0x3f46bf22,0xbf78be79
.long 0xbf0e3f55,0x3f67bedb,0xbf7fbdc9,0x3f4e3f18,0x3f553f0e,0xbf3ebf2c,0x3f223f46,0xbf04bf5c
.long 0x3f0ebf55,0xbeac3f71,0x3dc9bf7f,0x3e163f7d,0xbf55bf0e,0x3f80bd49,0xbf463f22,0x3e79bf78
.long 0xbf0e3f55,0xbedbbf67,0x3f7f3dc9,0xbf183f4e,0x3f553f0e,0xbf2c3f3e,0xbf22bf46,0x3f5cbf04
.long 0x3f0ebf55,0x3f713eac,0xbdc93f7f,0xbf7d3e16,0xbf55bf0e,0xbd49bf80,0x3f46bf22,0x3f783e79
.long 0xbf0e3f55,0xbf673edb,0xbf7fbdc9,0xbf4ebf18,0x3f553f0e,0x3f3e3f2c,0x3f223f46,0x3f043f5c
.long 0xbec4bf6d,0xbf18bf4e,0xbf46bf22,0xbf67bedb,0x3ec43f6d,0x3f5c3f04,0x3f7fbdc9,0x3f3ebf2c
.long 0xbec4bf6d,0xbf7dbe16,0xbf223f46,0x3eac3f71,0x3ec43f6d,0x3f78be79,0xbdc9bf7f,0xbf80bd49
.long 0xbec4bf6d,0xbf4e3f18,0x3f463f22,0x3edbbf67,0x3ec43f6d,0x3f04bf5c,0xbf7f3dc9,0x3f2c3f3e
.long 0xbec4bf6d,0xbe163f7d,0x3f22bf46,0xbf713eac,0x3ec43f6d,0xbe79bf78,0x3dc93f7f,0x3d49bf80
.long 0xbec4bf6d,0x3f183f4e,0xbf46bf22,0x3f673edb,0x3ec43f6d,0xbf5cbf04,0x3f7fbdc9,0xbf3e3f2c
.long 0xbec4bf6d,0x3f7d3e16,0xbf223f46,0xbeacbf71,0x3ec43f6d,0xbf783e79,0xbdc9bf7f,0x3f803d49
.long 0xbec4bf6d,0x3f4ebf18,0x3f463f22,0xbedb3f67,0x3ec43f6d,0xbf043f5c,0xbf7f3dc9,0xbf2cbf3e
.long 0xbec4bf6d,0x3e16bf7d,0x3f22bf46,0x3f71beac,0x3ec43f6d,0x3e793f78,0x3dc93f7f,0xbd493f80
.long 0xbf7bbe48,0xbf803d49,0xbf753e95,0xbf5c3f04,0x3e48bf7b,0xbedbbf67,0xbf62bef1,0xbf7d3e16
.long 0x3f7b3e48,0x3f2cbf3e,0xbe95bf75,0xbf78be79,0xbe483f7b,0x3f713eac,0x3ef1bf62,0xbf4ebf18
.long 0xbf7bbe48,0x3d493f80,0x3f75be95,0xbf04bf5c,0x3e48bf7b,0xbf673edb,0x3f623ef1,0xbe16bf7d
.long 0x3f7b3e48,0xbf3ebf2c,0x3e953f75,0x3e79bf78,0xbe483f7b,0x3eacbf71,0xbef13f62,0x3f18bf4e
.long 0xbf7bbe48,0x3f80bd49,0xbf753e95,0x3f5cbf04,0x3e48bf7b,0x3edb3f67,0xbf62bef1,0x3f7dbe16
.long 0x3f7b3e48,0xbf2c3f3e,0xbe95bf75,0x3f783e79,0xbe483f7b,0xbf71beac,0x3ef1bf62,0x3f4e3f18
.long 0xbf7bbe48,0xbd49bf80,0x3f75be95,0x3f043f5c,0x3e48bf7b,0x3f67bedb,0x3f623ef1,0x3e163f7d
.long 0x3f7b3e48,0x3f3e3f2c,0x3e953f75,0xbe793f78,0xbe483f7b,0xbeac3f71,0xbef13f62,0xbf183f4e
.long 0x3f800000,0x3f7ff84a,0x3f7fe129,0x3f7fba9e,0x3f800000,0x3f7fcbe2,0x3f7f2f9d,0x3f7e2b72
.long 0x3f800000,0x3f7f7808,0x3f7de0b1,0x3f7b3bab,0x3f800000,0x3f7efcc9,0x3f7bf531,0x3f76ef5b
.long 0x3f800000,0x3f7e5a38,0x3f796e4e,0x3f714c7a,0x3f800000,0x3f7d906e,0x3f764d97,0x3f6a5ad9
.long 0x3f800000,0x3f7c9f8a,0x3f7294f8,0x3f62241a,0x3f800000,0x3f7b87b2,0x3f6e46be,0x3f58b3a1
.long 0x3f800000,0x3f7a4910,0x3f696591,0x3f4e1689,0x3f800000,0x3f78e3d6,0x3f63f473,0x3f425b89
.long 0x3f800000,0x3f77583a,0x3f5df6be,0x3f3592e7,0x3f800000,0x3f75a67b,0x3f577026,0x3f27ce61
.long 0x3f800000,0x3f73ced9,0x3f5064af,0x3f19210f,0x3f800000,0x3f71d19f,0x3f48d8b3,0x3f099f4e
.long 0x3f800000,0x3f6faf1b,0x3f40d0da,0x3ef2bd43,0x3f800000,0x3f6d67a1,0x3f385216,0x3ed0eb2a
.long 0x3f7f84ab,0x3f7f3f54,0x3f7eea9d,0x3f7e868b,0x3f7cbfc9,0x3f7aed37,0x3f78b47b,0x3f76167a
.long 0x3f778bc5,0x3f72d4eb,0x3f6d1c1d,0x3f666771,0x3f6ff573,0x3f671599,0x3f5c61c7,0x3f4fefa8
.long 0x3f660f88,0x3f57dc7f,0x3f46e22a,0x3f33587a,0x3f59f26a,0x3f456439,0x3f2d1469,0x3f11796b
.long 0x3f4bbbf8,0x3f2ff3e6,0x3f0f8784,0x3ed6a399,0x3f3b8f3b,0x3f17de12,0x3eddbe79,0x3e840270
.long 0x3f299415,0x3efafef7,0x3e97a117,0x3db5f8da,0x3f15f6d9,0x3ec27b55,0x3e1c76de,0xbda973ba
.long 0x3f00e7e4,0x3e870ada,0x3bc90f88,0xbe80f8c0,0x3ed53641,0x3e1324ca,0xbe1008b7,0xbed3c867
.long 0x3ea68f12,0x3cafea69,0xbe919ddd,0xbf102dd5,0x3e6c9a7f,0xbdcefdb7,0xbed8106b,0xbf3238aa
.long 0x3e09cf86,0xbe636c83,0xbf0cead0,0xbf4f0417,0x3d16c32c,0xbeadf73c,0xbf2ac082,0xbf65b710
.long 0x3f7e1324,0x3f7d906e,0x3f7cfe73,0x3f7c5d3a,0x3f731447,0x3f6faf1b,0x3f6be858,0x3f67c187
.long 0x3f5ebe05,0x3f5627fe,0x3f4cae79,0x3f425b89,0x3f41d870,0x3f3238aa,0x3f212ff9,0x3f0ee0db
.long 0x3f1d7fd1,0x3f05a02c,0x3ed8106b,0x3ea21887,0x3ee63375,0x3ea5129f,0x3e419b37,0x3d55880e
.long 0x3e888e93,0x3ddb7d37,0xbd621469,0xbe5d4b1a,0x3d96a905,0xbde7fa9a,0xbe97a117,0xbeeff7fb
.long 0xbdfab273,0xbea80b1f,0xbf04f484,0xbf2ff3e6,0xbea09ae5,0xbf06f686,0xbf36206c,0xbf5b2c79
.long 0xbefc5d27,0xbf33587a,0xbf5c61c7,0xbf76841b,0xbf273656,0xbf570348,0xbf756d97,0xbf7fffb1
.long 0xbf49d112,0xbf703b37,0xbf7fc38f,0xbf76ef5b,0xbf64aa59,0xbf7dc68c,0xbf7ac516,0xbf5bfb34
.long 0xbf76ba07,0xbf7efcc9,0xbf66becc,0xbf311722,0xbf7f4e6d,0xbf73ced9,0xbf44e3f5,0xbef2bd43
.long 0x3f7baccd,0x3f7aed37,0x3f7a1e84,0x3f7940c0,0x3f633c5a,0x3f5e5aa6,0x3f591e6a,0x3f5389c7
.long 0x3f373a23,0x3f2b561b,0x3f1ebc12,0x3f11796b,0x3ef6e0cb,0x3ece0bea,0x3ea395c5,0x3e6fa8b2
.long 0x3e541501,0x3dc27c39,0xbc96c9b6,0xbe06b26e,0xbdafb680,0xbe636c83,0xbeb554ec,0xbef58035
.long 0xbebe1d4a,0xbf044889,0xbf26050a,0xbf436051,0xbf1ff6cb,0xbf425b89,0xbf5df6be,0xbf71d19f
.long 0xbf531849,0xbf6cd007,0xbf7bf531,0xbf7fdaaf,0xbf740bdd,0xbf7f5ce9,0xbf7c7eb0,0xbf6b99fb
.long 0xbf7ffb11,0xbf7822d1,0xbf5f8327,0xbf37c655,0xbf75dec6,0xbf57dc7f,0xbf286605,0xbed6a399
.long 0xbf5695e5,0xbf21cbfb,0xbebb31a0,0xbd83db0a,0xbf24d225,0xbeb6ccc3,0xbcfb49ba,0x3e9920fe
.long 0xbec9b953,0xbd3c6dd5,0x3e9d9e78,0x3f1f599f,0xbde1bc2e,0x3e8a11f7,0x3f1c420c,0x3f5cc7d1
.long 0x0,0x3c7b514b,0x3cfb49ba,0x3d3c6dd5,0x0,0x3d2351cb,0x3da3308c,0x3df475c0
.long 0x0,0x3d83db0a,0x3e039502,0x3e44b0b9,0x0,0x3db5f8da,0x3e354098,0x3e870ada
.long 0x0,0x3de7fa9a,0x3e667c66,0x3eab0201,0x0,0x3e0cec4a,0x3e8b9507,0x3ece0bea
.long 0x0,0x3e25c58c,0x3ea395c5,0x3eeff7fb,0x0,0x3e3e853e,0x3ebb31a0,0x3f084b92
.long 0x0,0x3e57278f,0x3ed25a09,0x3f17de12,0x0,0x3e6fa8b2,0x3ee900b7,0x3f269de3
.long 0x0,0x3e840270,0x3eff17b2,0x3f34768f,0x0,0x3e901c2c,0x3f0a48ad,0x3f4154e1
.long 0x0,0x3e9c1faf,0x3f14b039,0x3f4d26fd,0x0,0x3ea80b1f,0x3f1ebc12,0x3f57dc7f
.long 0x0,0x3eb3dca5,0x3f286605,0x3f61668a,0x0,0x3ebf926f,0x3f31a81d,0x3f69b7e4
.long 0x3d7b2b74,0x3d9cecf9,0x3dbc3ac3,0x3ddb7d37,0x3e22abb6,0x3e4ada4f,0x3e72b651,0x3e8d17c0
.long 0x3e827dc0,0x3ea21887,0x3ec1071e,0x3edf28a9,0x3eb263ef,0x3edc53c1,0x3f0242b1,0x3f1553b7
.long 0x3ee0924f,0x3f099f4e,0x3f212ff9,0x3f36ad7f,0x3f064b82,0x3f2302d3,0x3f3ca003,0x3f52a649
.long 0x3f1b02c6,0x3f39f2ac,0x3f53fac3,0x3f686b39,0x3f2e3bde,0x3f4e1689,0x3f66becc,0x3f77583a
.long 0x3f3fc767,0x3f5f20db,0x3f748422,0x3f7efcc9,0x3f4f7a1f,0x3f6cd007,0x3f7cfe73,0x3f7f1f49
.long 0x3f5d2d53,0x3f76ef5b,0x3f7ffec4,0x3f77beb7,0x3f68bf3c,0x3f7d57de,0x3f7d7474,0x3f6912ae
.long 0x3f721352,0x3f7ff0e3,0x3f756d97,0x3f5389c7,0x3f791298,0x3f7eb069,0x3f6816a8,0x3f37c655
.long 0x3f7dabcc,0x3f799b43,0x3f55b993,0x3f16999f,0x3f7fd397,0x3f70c501,0x3f3ebc1b,0x3ee1fb6a
.long 0x3dfab273,0x3e0cec4a,0x3e1c76de,0x3e2bf804,0x3ea09ae5,0x3eb3dca5,0x3ec6d529,0x3ed97cb9
.long 0x3efc5d27,0x3f0c42c9,0x3f19c200,0x3f269de3,0x3f273656,0x3f37c655,0x3f46e22a,0x3f546b3b
.long 0x3f49d112,0x3f5a5ba0,0x3f6816a8,0x3f72d4eb,0x3f64aa59,0x3f725470,0x3f7b61fc,0x3f7fa6e3
.long 0x3f76ba07,0x3f7e868b,0x3f7f9c18,0x3f79f35e,0x3f7f4e6d,0x3f7e5a38,0x3f748422,0x3f62241a
.long 0x3f7e1324,0x3f71d19f,0x3f5ac450,0x3f39f2ac,0x3f731447,0x3f5988ad,0x3f33e7bc,0x3f044889
.long 0x3f5ebe05,0x3f36ad7f,0x3f0242b1,0x3e8a11f7,0x3f41d870,0x3f0af1b7,0x3e919ddd,0x3b490fc6
.long 0x3f1d7fd1,0x3eb0eacb,0x3d2fe007,0xbe870ada,0x3ee63375,0x3e06b26e,0xbe4dee60,0xbf02ef9f
.long 0x3e888e93,0xbdb5f8da,0xbeddbe79,0xbf38dd65,0x3d96a905,0xbe9c1faf,0xbf239da9,0xbf61668a
.long 0x3e3b6ecf,0x3e4ada4f,0x3e5a3997,0x3e698bba,0x3eebcbbb,0x3efdbabb,0x3f07a136,0x3f102dd5
.long 0x3f32c8c9,0x3f3e35c5,0x3f48d8b3,0x3f52a649,0x3f604621,0x3f6a5ad9,0x3f7294f8,0x3f78e3d6
.long 0x3f7a7302,0x3f7ed7d4,0x3f7ff4e6,0x3f7dc68c,0x3f7f0e58,0x3f799b43,0x3f6f6830,0x3f60a6cf
.long 0x3f6db293,0x3f5b2c79,0x3f42de29,0x3f256bcb,0x3f47de65,0x3f269de3,0x3eff17b2,0x3ea80b1f
.long 0x3f10d3cd,0x3ec27b55,0x3e354098,0xbd0a342f,0x3e9aa086,0x3d9064b4,0xbe28defc,0xbec8477c
.long 0x3c490e90,0xbe7bdba4,0xbef9a02d,0xbf3238aa,0xbe8e9a22,0xbf099f4e,0xbf40d0da,0xbf686b39
.long 0xbf0b9a6b,0xbf466354,0xbf6e46be,0xbf7f7808,0xbf43e200,0xbf6f20b0,0xbf7fe129,0xbf74484b
.long 0xbf6b4b0c,0xbf7fba9e,0xbf73913f,0xbf485bca,0xbf7e70b0,0xbf76841b,0xbf4ac77f,0xbf019573
.long 0x3f800000,0x3f800000,0x3f800000,0x3f800000,0x3f7ff84a,0x3f7fcbe2,0x3f7f7808,0x3f7efcc9
.long 0x3f7fe129,0x3f7f2f9d,0x3f7de0b1,0x3f7bf531,0x3f7fba9e,0x3f7e2b72,0x3f7b3bab,0x3f76ef5b
.long 0x3f7f84ab,0x3f7cbfc9,0x3f778bc5,0x3f6ff573,0x3f7f3f54,0x3f7aed37,0x3f72d4eb,0x3f671599
.long 0x3f7eea9d,0x3f78b47b,0x3f6d1c1d,0x3f5c61c7,0x3f7e868b,0x3f76167a,0x3f666771,0x3f4fefa8
.long 0x3f7e1324,0x3f731447,0x3f5ebe05,0x3f41d870,0x3f7d906e,0x3f6faf1b,0x3f5627fe,0x3f3238aa
.long 0x3f7cfe73,0x3f6be858,0x3f4cae79,0x3f212ff9,0x3f7c5d3a,0x3f67c187,0x3f425b89,0x3f0ee0db
.long 0x3f7baccd,0x3f633c5a,0x3f373a23,0x3ef6e0cb,0x3f7aed37,0x3f5e5aa6,0x3f2b561b,0x3ece0bea
.long 0x3f7a1e84,0x3f591e6a,0x3f1ebc12,0x3ea395c5,0x3f7940c0,0x3f5389c7,0x3f11796b,0x3e6fa8b2
.long 0x3f800000,0x3f800000,0x3f800000,0x3f800000,0x3f7e5a38,0x3f7d906e,0x3f7c9f8a,0x3f7b87b2
.long 0x3f796e4e,0x3f764d97,0x3f7294f8,0x3f6e46be,0x3f714c7a,0x3f6a5ad9,0x3f62241a,0x3f58b3a1
.long 0x3f660f88,0x3f59f26a,0x3f4bbbf8,0x3f3b8f3b,0x3f57dc7f,0x3f456439,0x3f2ff3e6,0x3f17de12
.long 0x3f46e22a,0x3f2d1469,0x3f0f8784,0x3eddbe79,0x3f33587a,0x3f11796b,0x3ed6a399,0x3e840270
.long 0x3f1d7fd1,0x3ee63375,0x3e888e93,0x3d96a905,0x3f05a02c,0x3ea5129f,0x3ddb7d37,0xbde7fa9a
.long 0x3ed8106b,0x3e419b37,0xbd621469,0xbe97a117,0x3ea21887,0x3d55880e,0xbe5d4b1a,0xbeeff7fb
.long 0x3e541501,0xbdafb680,0xbebe1d4a,0xbf1ff6cb,0x3dc27c39,0xbe636c83,0xbf044889,0xbf425b89
.long 0xbc96c9b6,0xbeb554ec,0xbf26050a,0xbf5df6be,0xbe06b26e,0xbef58035,0xbf436051,0xbf71d19f
.long 0x3f800000,0x3f800000,0x3f800000,0x3f800000,0x3f7a4910,0x3f78e3d6,0x3f77583a,0x3f75a67b
.long 0x3f696591,0x3f63f473,0x3f5df6be,0x3f577026,0x3f4e1689,0x3f425b89,0x3f3592e7,0x3f27ce61
.long 0x3f299415,0x3f15f6d9,0x3f00e7e4,0x3ed53641,0x3efafef7,0x3ec27b55,0x3e870ada,0x3e1324ca
.long 0x3e97a117,0x3e1c76de,0x3bc90f88,0xbe1008b7,0x3db5f8da,0xbda973ba,0xbe80f8c0,0xbed3c867
.long 0xbdfab273,0xbea09ae5,0xbefc5d27,0xbf273656,0xbea80b1f,0xbf06f686,0xbf33587a,0xbf570348
.long 0xbf04f484,0xbf36206c,0xbf5c61c7,0xbf756d97,0xbf2ff3e6,0xbf5b2c79,0xbf76841b,0xbf7fffb1
.long 0xbf531849,0xbf740bdd,0xbf7ffb11,0xbf75dec6,0xbf6cd007,0xbf7f5ce9,0xbf7822d1,0xbf57dc7f
.long 0xbf7bf531,0xbf7c7eb0,0xbf5f8327,0xbf286605,0xbf7fdaaf,0xbf6b99fb,0xbf37c655,0xbed6a399
.long 0x3f800000,0x3f800000,0x3f800000,0x3f800000,0x3f73ced9,0x3f71d19f,0x3f6faf1b,0x3f6d67a1
.long 0x3f5064af,0x3f48d8b3,0x3f40d0da,0x3f385216,0x3f19210f,0x3f099f4e,0x3ef2bd43,0x3ed0eb2a
.long 0x3ea68f12,0x3e6c9a7f,0x3e09cf86,0x3d16c32c,0x3cafea69,0xbdcefdb7,0xbe636c83,0xbeadf73c
.long 0xbe919ddd,0xbed8106b,0xbf0cead0,0xbf2ac082,0xbf102dd5,0xbf3238aa,0xbf4f0417,0xbf65b710
.long 0xbf49d112,0xbf64aa59,0xbf76ba07,0xbf7f4e6d,0xbf703b37,0xbf7dc68c,0xbf7efcc9,0xbf73ced9
.long 0xbf7fc38f,0xbf7ac516,0xbf66becc,0xbf44e3f5,0xbf76ef5b,0xbf5bfb34,0xbf311722,0xbef2bd43
.long 0xbf5695e5,0xbf24d225,0xbec9b953,0xbde1bc2e,0xbf21cbfb,0xbeb6ccc3,0xbd3c6dd5,0x3e8a11f7
.long 0xbebb31a0,0xbcfb49ba,0x3e9d9e78,0x3f1c420c,0xbd83db0a,0x3e9920fe,0x3f1f599f,0x3f5cc7d1
.long 0x0,0x0,0x0,0x0,0x3c7b514b,0x3d2351cb,0x3d83db0a,0x3db5f8da
.long 0x3cfb49ba,0x3da3308c,0x3e039502,0x3e354098,0x3d3c6dd5,0x3df475c0,0x3e44b0b9,0x3e870ada
.long 0x3d7b2b74,0x3e22abb6,0x3e827dc0,0x3eb263ef,0x3d9cecf9,0x3e4ada4f,0x3ea21887,0x3edc53c1
.long 0x3dbc3ac3,0x3e72b651,0x3ec1071e,0x3f0242b1,0x3ddb7d37,0x3e8d17c0,0x3edf28a9,0x3f1553b7
.long 0x3dfab273,0x3ea09ae5,0x3efc5d27,0x3f273656,0x3e0cec4a,0x3eb3dca5,0x3f0c42c9,0x3f37c655
.long 0x3e1c76de,0x3ec6d529,0x3f19c200,0x3f46e22a,0x3e2bf804,0x3ed97cb9,0x3f269de3,0x3f546b3b
.long 0x3e3b6ecf,0x3eebcbbb,0x3f32c8c9,0x3f604621,0x3e4ada4f,0x3efdbabb,0x3f3e35c5,0x3f6a5ad9
.long 0x3e5a3997,0x3f07a136,0x3f48d8b3,0x3f7294f8,0x3e698bba,0x3f102dd5,0x3f52a649,0x3f78e3d6
.long 0x0,0x0,0x0,0x0,0x3de7fa9a,0x3e0cec4a,0x3e25c58c,0x3e3e853e
.long 0x3e667c66,0x3e8b9507,0x3ea395c5,0x3ebb31a0,0x3eab0201,0x3ece0bea,0x3eeff7fb,0x3f084b92
.long 0x3ee0924f,0x3f064b82,0x3f1b02c6,0x3f2e3bde,0x3f099f4e,0x3f2302d3,0x3f39f2ac,0x3f4e1689
.long 0x3f212ff9,0x3f3ca003,0x3f53fac3,0x3f66becc,0x3f36ad7f,0x3f52a649,0x3f686b39,0x3f77583a
.long 0x3f49d112,0x3f64aa59,0x3f76ba07,0x3f7f4e6d,0x3f5a5ba0,0x3f725470,0x3f7e868b,0x3f7e5a38
.long 0x3f6816a8,0x3f7b61fc,0x3f7f9c18,0x3f748422,0x3f72d4eb,0x3f7fa6e3,0x3f79f35e,0x3f62241a
.long 0x3f7a7302,0x3f7f0e58,0x3f6db293,0x3f47de65,0x3f7ed7d4,0x3f799b43,0x3f5b2c79,0x3f269de3
.long 0x3f7ff4e6,0x3f6f6830,0x3f42de29,0x3eff17b2,0x3f7dc68c,0x3f60a6cf,0x3f256bcb,0x3ea80b1f
.long 0x0,0x0,0x0,0x0,0x3e57278f,0x3e6fa8b2,0x3e840270,0x3e901c2c
.long 0x3ed25a09,0x3ee900b7,0x3eff17b2,0x3f0a48ad,0x3f17de12,0x3f269de3,0x3f34768f,0x3f4154e1
.long 0x3f3fc767,0x3f4f7a1f,0x3f5d2d53,0x3f68bf3c,0x3f5f20db,0x3f6cd007,0x3f76ef5b,0x3f7d57de
.long 0x3f748422,0x3f7cfe73,0x3f7ffec4,0x3f7d7474,0x3f7efcc9,0x3f7f1f49,0x3f77beb7,0x3f6912ae
.long 0x3f7e1324,0x3f731447,0x3f5ebe05,0x3f41d870,0x3f71d19f,0x3f5988ad,0x3f36ad7f,0x3f0af1b7
.long 0x3f5ac450,0x3f33e7bc,0x3f0242b1,0x3e919ddd,0x3f39f2ac,0x3f044889,0x3e8a11f7,0x3b490fc6
.long 0x3f10d3cd,0x3e9aa086,0x3c490e90,0xbe8e9a22,0x3ec27b55,0x3d9064b4,0xbe7bdba4,0xbf099f4e
.long 0x3e354098,0xbe28defc,0xbef9a02d,0xbf40d0da,0xbd0a342f,0xbec8477c,0xbf3238aa,0xbf686b39
.long 0x0,0x0,0x0,0x0,0x3e9c1faf,0x3ea80b1f,0x3eb3dca5,0x3ebf926f
.long 0x3f14b039,0x3f1ebc12,0x3f286605,0x3f31a81d,0x3f4d26fd,0x3f57dc7f,0x3f61668a,0x3f69b7e4
.long 0x3f721352,0x3f791298,0x3f7dabcc,0x3f7fd397,0x3f7ff0e3,0x3f7eb069,0x3f799b43,0x3f70c501
.long 0x3f756d97,0x3f6816a8,0x3f55b993,0x3f3ebc1b,0x3f5389c7,0x3f37c655,0x3f16999f,0x3ee1fb6a
.long 0x3f1d7fd1,0x3ee63375,0x3e888e93,0x3d96a905,0x3eb0eacb,0x3e06b26e,0xbdb5f8da,0xbe9c1faf
.long 0x3d2fe007,0xbe4dee60,0xbeddbe79,0xbf239da9,0xbe870ada,0xbf02ef9f,0xbf38dd65,0xbf61668a
.long 0xbf0b9a6b,0xbf43e200,0xbf6b4b0c,0xbf7e70b0,0xbf466354,0xbf6f20b0,0xbf7fba9e,0xbf76841b
.long 0xbf6e46be,0xbf7fe129,0xbf73913f,0xbf4ac77f,0xbf7f7808,0xbf74484b,0xbf485bca,0xbf019573
.long 0x3f803f80,0x3f803f80,0x80008000,0x80008000,0x3f4e3f78,0x3e163f04,0xbf18be79,0xbf7dbf5c
.long 0x3e953f62,0xbf75bef1,0xbf75bef1,0xbe95bf62,0xbeac3f3e,0xbedbbf80,0xbf71bf2c,0x3f67bd49
.long 0xbf553f0e,0x3f55bf0e,0xbf0ebf55,0x3f0e3f55,0xbf803eac,0x3f2c3edb,0x3d49bf71,0xbf3e3f67
.long 0xbf463dc9,0xbf223f7f,0x3f22bf7f,0xbf463dc9,0xbe79be16,0xbf5c3f18,0x3f78bf7d,0x3f04bf4e
.long 0x3ec4bec4,0x3ec4bec4,0x3f6dbf6d,0x3f6dbf6d,0x3f5cbf18,0x3f78bf7d,0x3f04bf4e,0xbe79be16
.long 0x3f7fbf46,0xbdc9bf22,0xbdc9bf22,0xbf7f3f46,0x3f3ebf67,0xbf803eac,0xbf2cbedb,0xbd493f71
.long 0x3e48bf7b,0xbe483f7b,0xbf7bbe48,0x3f7b3e48,0xbedbbf80,0x3f713f2c,0xbf673d49,0x3eacbf3e
.long 0xbf62bf75,0x3ef1be95,0xbef13e95,0xbf62bf75,0xbf7dbf5c,0xbf4ebf78,0x3e163f04,0xbf18be79
.long 0x3f803f80,0x3f803f80,0x80008000,0x80008000,0xbf18be79,0xbf7dbf5c,0xbf4ebf78,0xbe16bf04
.long 0xbe95bf62,0x3f753ef1,0x3f753ef1,0x3e953f62,0x3f713f2c,0xbf673d49,0xbeac3f3e,0xbedbbf80
.long 0xbf553f0e,0x3f55bf0e,0xbf0ebf55,0x3f0e3f55,0x3d49bf71,0xbf3e3f67,0x3f80beac,0xbf2cbedb
.long 0x3f46bdc9,0x3f22bf7f,0xbf223f7f,0x3f46bdc9,0xbf783f7d,0xbf043f4e,0xbe79be16,0xbf5c3f18
.long 0x3ec4bec4,0x3ec4bec4,0x3f6dbf6d,0x3f6dbf6d,0x3f04bf4e,0xbe79be16,0xbf5c3f18,0xbf783f7d
.long 0xbf7f3f46,0x3dc93f22,0x3dc93f22,0x3f7fbf46,0x3f2c3edb,0x3d49bf71,0x3f3ebf67,0xbf803eac
.long 0x3e48bf7b,0xbe483f7b,0xbf7bbe48,0x3f7b3e48,0xbf673d49,0x3eacbf3e,0x3edb3f80,0xbf71bf2c
.long 0x3f623f75,0xbef13e95,0x3ef1be95,0x3f623f75,0xbe16bf04,0x3f183e79,0xbf7dbf5c,0xbf4ebf78
.long 0x3f803f80,0x3f803f80,0x80008000,0x80008000,0xbf4ebf78,0xbe16bf04,0x3f183e79,0x3f7d3f5c
.long 0x3e953f62,0xbf75bef1,0xbf75bef1,0xbe95bf62,0x3eacbf3e,0x3edb3f80,0x3f713f2c,0xbf673d49
.long 0xbf553f0e,0x3f55bf0e,0xbf0ebf55,0x3f0e3f55,0x3f80beac,0xbf2cbedb,0xbd493f71,0x3f3ebf67
.long 0xbf463dc9,0xbf223f7f,0x3f22bf7f,0xbf463dc9,0x3e793e16,0x3f5cbf18,0xbf783f7d,0xbf043f4e
.long 0x3ec4bec4,0x3ec4bec4,0x3f6dbf6d,0x3f6dbf6d,0xbf5c3f18,0xbf783f7d,0xbf043f4e,0x3e793e16
.long 0x3f7fbf46,0xbdc9bf22,0xbdc9bf22,0xbf7f3f46,0xbf3e3f67,0x3f80beac,0x3f2c3edb,0x3d49bf71
.long 0x3e48bf7b,0xbe483f7b,0xbf7bbe48,0x3f7b3e48,0x3edb3f80,0xbf71bf2c,0x3f67bd49,0xbeac3f3e
.long 0xbf62bf75,0x3ef1be95,0xbef13e95,0xbf62bf75,0x3f7d3f5c,0x3f4e3f78,0xbe16bf04,0x3f183e79
.long 0x3f803f80,0x3f803f80,0x80008000,0x80008000,0x3f183e79,0x3f7d3f5c,0x3f4e3f78,0x3e163f04
.long 0xbe95bf62,0x3f753ef1,0x3f753ef1,0x3e953f62,0xbf71bf2c,0x3f67bd49,0x3eacbf3e,0x3edb3f80
.long 0xbf553f0e,0x3f55bf0e,0xbf0ebf55,0x3f0e3f55,0xbd493f71,0x3f3ebf67,0xbf803eac,0x3f2c3edb
.long 0x3f46bdc9,0x3f22bf7f,0xbf223f7f,0x3f46bdc9,0x3f78bf7d,0x3f04bf4e,0x3e793e16,0x3f5cbf18
.long 0x3ec4bec4,0x3ec4bec4,0x3f6dbf6d,0x3f6dbf6d,0xbf043f4e,0x3e793e16,0x3f5cbf18,0x3f78bf7d
.long 0xbf7f3f46,0x3dc93f22,0x3dc93f22,0x3f7fbf46,0xbf2cbedb,0xbd493f71,0xbf3e3f67,0x3f80beac
.long 0x3e48bf7b,0xbe483f7b,0xbf7bbe48,0x3f7b3e48,0x3f67bd49,0xbeac3f3e,0xbedbbf80,0x3f713f2c
.long 0x3f623f75,0xbef13e95,0x3ef1be95,0x3f623f75,0x3e163f04,0xbf18be79,0x3f7d3f5c,0x3f4e3f78
.long 0x0,0x0,0x3f803f80,0x3f803f80,0x3f183e79,0x3f7d3f5c,0x3f4e3f78,0x3e163f04
.long 0x3f753ef1,0x3e953f62,0x3e953f62,0xbf75bef1,0x3f713f2c,0xbf673d49,0xbeac3f3e,0xbedbbf80
.long 0x3f0e3f55,0xbf0ebf55,0xbf553f0e,0x3f55bf0e,0xbd493f71,0x3f3ebf67,0xbf803eac,0x3f2c3edb
.long 0xbf223f7f,0x3f46bdc9,0xbf463dc9,0xbf223f7f,0xbf783f7d,0xbf043f4e,0xbe79be16,0xbf5c3f18
.long 0xbf6d3f6d,0xbf6d3f6d,0x3ec4bec4,0x3ec4bec4,0xbf043f4e,0x3e793e16,0x3f5cbf18,0x3f78bf7d
.long 0x3dc93f22,0x3f7fbf46,0x3f7fbf46,0xbdc9bf22,0x3f2c3edb,0x3d49bf71,0x3f3ebf67,0xbf803eac
.long 0x3f7b3e48,0xbf7bbe48,0x3e48bf7b,0xbe483f7b,0x3f67bd49,0xbeac3f3e,0xbedbbf80,0x3f713f2c
.long 0x3ef1be95,0x3f623f75,0xbf62bf75,0x3ef1be95,0xbe16bf04,0x3f183e79,0xbf7dbf5c,0xbf4ebf78
.long 0x0,0x0,0x3f803f80,0x3f803f80,0x3f4e3f78,0x3e163f04,0xbf18be79,0xbf7dbf5c
.long 0xbf75bef1,0xbe95bf62,0xbe95bf62,0x3f753ef1,0x3eacbf3e,0x3edb3f80,0x3f713f2c,0xbf673d49
.long 0x3f0e3f55,0xbf0ebf55,0xbf553f0e,0x3f55bf0e,0xbf803eac,0x3f2c3edb,0x3d49bf71,0xbf3e3f67
.long 0x3f22bf7f,0xbf463dc9,0x3f46bdc9,0x3f22bf7f,0x3e793e16,0x3f5cbf18,0xbf783f7d,0xbf043f4e
.long 0xbf6d3f6d,0xbf6d3f6d,0x3ec4bec4,0x3ec4bec4,0x3f5cbf18,0x3f78bf7d,0x3f04bf4e,0xbe79be16
.long 0xbdc9bf22,0xbf7f3f46,0xbf7f3f46,0x3dc93f22,0xbf3e3f67,0x3f80beac,0x3f2c3edb,0x3d49bf71
.long 0x3f7b3e48,0xbf7bbe48,0x3e48bf7b,0xbe483f7b,0xbedbbf80,0x3f713f2c,0xbf673d49,0x3eacbf3e
.long 0xbef13e95,0xbf62bf75,0x3f623f75,0xbef13e95,0x3f7d3f5c,0x3f4e3f78,0xbe16bf04,0x3f183e79
.long 0x0,0x0,0x3f803f80,0x3f803f80,0xbf18be79,0xbf7dbf5c,0xbf4ebf78,0xbe16bf04
.long 0x3f753ef1,0x3e953f62,0x3e953f62,0xbf75bef1,0xbf71bf2c,0x3f67bd49,0x3eacbf3e,0x3edb3f80
.long 0x3f0e3f55,0xbf0ebf55,0xbf553f0e,0x3f55bf0e,0x3d49bf71,0xbf3e3f67,0x3f80beac,0xbf2cbedb
.long 0xbf223f7f,0x3f46bdc9,0xbf463dc9,0xbf223f7f,0x3f78bf7d,0x3f04bf4e,0x3e793e16,0x3f5cbf18
.long 0xbf6d3f6d,0xbf6d3f6d,0x3ec4bec4,0x3ec4bec4,0x3f04bf4e,0xbe79be16,0xbf5c3f18,0xbf783f7d
.long 0x3dc93f22,0x3f7fbf46,0x3f7fbf46,0xbdc9bf22,0xbf2cbedb,0xbd493f71,0xbf3e3f67,0x3f80beac
.long 0x3f7b3e48,0xbf7bbe48,0x3e48bf7b,0xbe483f7b,0xbf673d49,0x3eacbf3e,0x3edb3f80,0xbf71bf2c
.long 0x3ef1be95,0x3f623f75,0xbf62bf75,0x3ef1be95,0x3e163f04,0xbf18be79,0x3f7d3f5c,0x3f4e3f78
.long 0x0,0x0,0x3f803f80,0x3f803f80,0xbf4ebf78,0xbe16bf04,0x3f183e79,0x3f7d3f5c
.long 0xbf75bef1,0xbe95bf62,0xbe95bf62,0x3f753ef1,0xbeac3f3e,0xbedbbf80,0xbf71bf2c,0x3f67bd49
.long 0x3f0e3f55,0xbf0ebf55,0xbf553f0e,0x3f55bf0e,0x3f80beac,0xbf2cbedb,0xbd493f71,0x3f3ebf67
.long 0x3f22bf7f,0xbf463dc9,0x3f46bdc9,0x3f22bf7f,0xbe79be16,0xbf5c3f18,0x3f78bf7d,0x3f04bf4e
.long 0xbf6d3f6d,0xbf6d3f6d,0x3ec4bec4,0x3ec4bec4,0xbf5c3f18,0xbf783f7d,0xbf043f4e,0x3e793e16
.long 0xbdc9bf22,0xbf7f3f46,0xbf7f3f46,0x3dc93f22,0x3f3ebf67,0xbf803eac,0xbf2cbedb,0xbd493f71
.long 0x3f7b3e48,0xbf7bbe48,0x3e48bf7b,0xbe483f7b,0x3edb3f80,0xbf71bf2c,0x3f67bd49,0xbeac3f3e
.long 0xbef13e95,0xbf62bf75,0x3f623f75,0xbef13e95,0xbf7dbf5c,0xbf4ebf78,0x3e163f04,0xbf18be79
.long 0x3f80,0x3e953f75,0x3f0e3f55,0x3f463f22,0x3f80,0x3f223f46,0x3f7b3e48,0x3f62bef1
.long 0x3f80,0x3f623ef1,0x3f55bf0e,0xbdc9bf7f,0x3f80,0x3f7f3dc9,0x3e48bf7b,0xbf75be95
.long 0x3f80,0x3f75be95,0xbf0ebf55,0xbf223f46,0x3f80,0x3f46bf22,0xbf7bbe48,0x3ef13f62
.long 0x3f80,0x3ef1bf62,0xbf553f0e,0x3f7fbdc9,0x3f80,0x3dc9bf7f,0xbe483f7b,0x3e95bf75
.long 0x3f80,0xbe95bf75,0x3f0e3f55,0xbf46bf22,0x3f80,0xbf22bf46,0x3f7b3e48,0xbf623ef1
.long 0x3f80,0xbf62bef1,0x3f55bf0e,0x3dc93f7f,0x3f80,0xbf7fbdc9,0x3e48bf7b,0x3f753e95
.long 0x3f80,0xbf753e95,0xbf0ebf55,0x3f22bf46,0x3f80,0xbf463f22,0xbf7bbe48,0xbef1bf62
.long 0x3f80,0xbef13f62,0xbf553f0e,0xbf7f3dc9,0x3f80,0xbdc93f7f,0xbe483f7b,0xbe953f75
.long 0x3f6d3ec4,0x3f7f3dc9,0x3f7bbe48,0x3f62bef1,0x3ec4bf6d,0xbe95bf75,0xbf55bf0e,0xbf7f3dc9
.long 0xbf6dbec4,0xbf463f22,0x3e483f7b,0x3f753e95,0xbec43f6d,0x3f623ef1,0x3f0ebf55,0xbf46bf22
.long 0x3f6d3ec4,0x3dc9bf7f,0xbf7b3e48,0x3ef13f62,0x3ec4bf6d,0xbf753e95,0x3f553f0e,0xbdc9bf7f
.long 0xbf6dbec4,0x3f223f46,0xbe48bf7b,0xbe953f75,0xbec43f6d,0x3ef1bf62,0xbf0e3f55,0x3f22bf46
.long 0x3f6d3ec4,0xbf7fbdc9,0x3f7bbe48,0xbf623ef1,0x3ec4bf6d,0x3e953f75,0xbf55bf0e,0x3f7fbdc9
.long 0xbf6dbec4,0x3f46bf22,0x3e483f7b,0xbf75be95,0xbec43f6d,0xbf62bef1,0x3f0ebf55,0x3f463f22
.long 0x3f6d3ec4,0xbdc93f7f,0xbf7b3e48,0xbef1bf62,0x3ec4bf6d,0x3f75be95,0x3f553f0e,0x3dc93f7f
.long 0xbf6dbec4,0xbf22bf46,0xbe48bf7b,0x3e95bf75,0xbec43f6d,0xbef13f62,0xbf0e3f55,0xbf223f46
.long 0x3f35bf35,0x3ef1bf62,0x3e48bf7b,0xbdc9bf7f,0xbf353f35,0xbdc93f7f,0x3f0e3f55,0x3f753e95
.long 0x3f35bf35,0xbe95bf75,0xbf7bbe48,0xbf223f46,0xbf353f35,0x3f223f46,0x3f55bf0e,0xbef1bf62
.long 0x3f35bf35,0xbf62bef1,0xbe483f7b,0x3f7fbdc9,0xbf353f35,0x3f7f3dc9,0xbf0ebf55,0xbe953f75
.long 0x3f35bf35,0xbf753e95,0x3f7b3e48,0xbf46bf22,0xbf353f35,0x3f46bf22,0xbf553f0e,0x3f62bef1
.long 0x3f35bf35,0xbef13f62,0x3e48bf7b,0x3dc93f7f,0xbf353f35,0x3dc9bf7f,0x3f0e3f55,0xbf75be95
.long 0x3f35bf35,0x3e953f75,0xbf7bbe48,0x3f22bf46,0xbf353f35,0xbf22bf46,0x3f55bf0e,0x3ef13f62
.long 0x3f35bf35,0x3f623ef1,0xbe483f7b,0xbf7f3dc9,0xbf353f35,0xbf7fbdc9,0xbf0ebf55,0x3e95bf75
.long 0x3f35bf35,0x3f75be95,0x3f7b3e48,0x3f463f22,0xbf353f35,0xbf463f22,0xbf553f0e,0xbf623ef1
.long 0xbec4bf6d,0xbf22bf46,0xbf55bf0e,0xbf75be95,0x3f6dbec4,0x3ef1bf62,0xbe48bf7b,0xbf46bf22
.long 0x3ec43f6d,0x3f7f3dc9,0x3f0ebf55,0xbef1bf62,0xbf6d3ec4,0x3e953f75,0x3f7bbe48,0xbdc9bf7f
.long 0xbec4bf6d,0xbf463f22,0x3f553f0e,0x3e95bf75,0x3f6dbec4,0xbf62bef1,0x3e483f7b,0x3f22bf46
.long 0x3ec43f6d,0x3dc9bf7f,0xbf0e3f55,0x3f62bef1,0xbf6d3ec4,0x3f75be95,0xbf7b3e48,0x3f7fbdc9
.long 0xbec4bf6d,0x3f223f46,0xbf55bf0e,0x3f753e95,0x3f6dbec4,0xbef13f62,0xbe48bf7b,0x3f463f22
.long 0x3ec43f6d,0xbf7fbdc9,0x3f0ebf55,0x3ef13f62,0xbf6d3ec4,0xbe95bf75,0x3f7bbe48,0x3dc93f7f
.long 0xbec4bf6d,0x3f46bf22,0x3f553f0e,0xbe953f75,0x3f6dbec4,0x3f623ef1,0x3e483f7b,0xbf223f46
.long 0x3ec43f6d,0xbdc93f7f,0xbf0e3f55,0xbf623ef1,0xbf6d3ec4,0xbf753e95,0xbf7b3e48,0xbf7f3dc9
.long 0x3f808000,0x3f75be95,0x3f55bf0e,0x3f22bf46,0x3f808000,0x3f46bf22,0x3e48bf7b,0xbef1bf62
.long 0x3f808000,0x3ef1bf62,0xbf0ebf55,0xbf7f3dc9,0x3f808000,0x3dc9bf7f,0xbf7bbe48,0xbe953f75
.long 0x3f808000,0xbe95bf75,0xbf553f0e,0x3f463f22,0x3f808000,0xbf22bf46,0xbe483f7b,0x3f62bef1
.long 0x3f808000,0xbf62bef1,0x3f0e3f55,0xbdc9bf7f,0x3f808000,0xbf7fbdc9,0x3f7b3e48,0xbf75be95
.long 0x3f808000,0xbf753e95,0x3f55bf0e,0xbf223f46,0x3f808000,0xbf463f22,0x3e48bf7b,0x3ef13f62
.long 0x3f808000,0xbef13f62,0xbf0ebf55,0x3f7fbdc9,0x3f808000,0xbdc93f7f,0xbf7bbe48,0x3e95bf75
.long 0x3f808000,0x3e953f75,0xbf553f0e,0xbf46bf22,0x3f808000,0x3f223f46,0xbe483f7b,0xbf623ef1
.long 0x3f808000,0x3f623ef1,0x3f0e3f55,0x3dc93f7f,0x3f808000,0x3f7f3dc9,0x3f7b3e48,0x3f753e95
.long 0x3ec4bf6d,0x3dc9bf7f,0xbe48bf7b,0xbef1bf62,0xbf6dbec4,0xbf753e95,0xbf0e3f55,0x3dc93f7f
.long 0xbec43f6d,0x3f223f46,0x3f7bbe48,0x3e95bf75,0x3f6d3ec4,0x3ef1bf62,0xbf55bf0e,0xbf223f46
.long 0x3ec4bf6d,0xbf7fbdc9,0x3e483f7b,0x3f62bef1,0xbf6dbec4,0x3e953f75,0x3f0ebf55,0xbf7f3dc9
.long 0xbec43f6d,0x3f46bf22,0xbf7b3e48,0x3f753e95,0x3f6d3ec4,0xbf62bef1,0x3f553f0e,0xbf46bf22
.long 0x3ec4bf6d,0xbdc93f7f,0xbe48bf7b,0x3ef13f62,0xbf6dbec4,0x3f75be95,0xbf0e3f55,0xbdc9bf7f
.long 0xbec43f6d,0xbf22bf46,0x3f7bbe48,0xbe953f75,0x3f6d3ec4,0xbef13f62,0xbf55bf0e,0x3f22bf46
.long 0x3ec4bf6d,0x3f7f3dc9,0x3e483f7b,0xbf623ef1,0xbf6dbec4,0xbe95bf75,0x3f0ebf55,0x3f7fbdc9
.long 0xbec43f6d,0xbf463f22,0xbf7b3e48,0xbf75be95,0x3f6d3ec4,0x3f623ef1,0x3f553f0e,0x3f463f22
.long 0xbf35bf35,0xbf62bef1,0xbf7bbe48,0xbf7f3dc9,0x3f353f35,0x3f7f3dc9,0x3f55bf0e,0x3e95bf75
.long 0xbf35bf35,0xbf753e95,0xbe483f7b,0x3f463f22,0x3f353f35,0x3f46bf22,0xbf0ebf55,0xbf623ef1
.long 0xbf35bf35,0xbef13f62,0x3f7b3e48,0xbdc9bf7f,0x3f353f35,0x3dc9bf7f,0xbf553f0e,0x3f753e95
.long 0xbf35bf35,0x3e953f75,0x3e48bf7b,0xbf223f46,0x3f353f35,0xbf22bf46,0x3f0e3f55,0xbef1bf62
.long 0xbf35bf35,0x3f623ef1,0xbf7bbe48,0x3f7fbdc9,0x3f353f35,0xbf7fbdc9,0x3f55bf0e,0xbe953f75
.long 0xbf35bf35,0x3f75be95,0xbe483f7b,0xbf46bf22,0x3f353f35,0xbf463f22,0xbf0ebf55,0x3f62bef1
.long 0xbf35bf35,0x3ef1bf62,0x3f7b3e48,0x3dc93f7f,0x3f353f35,0xbdc93f7f,0xbf553f0e,0xbf75be95
.long 0xbf35bf35,0xbe95bf75,0x3e48bf7b,0x3f22bf46,0x3f353f35,0x3f223f46,0x3f0e3f55,0x3ef13f62
.long 0xbf6d3ec4,0xbf463f22,0xbf0e3f55,0xbe953f75,0xbec4bf6d,0xbf62bef1,0xbf7b3e48,0xbf223f46
.long 0x3f6dbec4,0x3dc9bf7f,0xbf55bf0e,0xbf623ef1,0x3ec43f6d,0x3f75be95,0xbe48bf7b,0xbf7f3dc9
.long 0xbf6d3ec4,0x3f223f46,0x3f0ebf55,0xbf75be95,0xbec4bf6d,0xbef13f62,0x3f7bbe48,0xbf46bf22
.long 0x3f6dbec4,0xbf7fbdc9,0x3f553f0e,0xbef1bf62,0x3ec43f6d,0xbe95bf75,0x3e483f7b,0xbdc9bf7f
.long 0xbf6d3ec4,0x3f46bf22,0xbf0e3f55,0x3e95bf75,0xbec4bf6d,0x3f623ef1,0xbf7b3e48,0x3f22bf46
.long 0x3f6dbec4,0xbdc93f7f,0xbf55bf0e,0x3f62bef1,0x3ec43f6d,0xbf753e95,0xbe48bf7b,0x3f7fbdc9
.long 0xbf6d3ec4,0xbf22bf46,0x3f0ebf55,0x3f753e95,0xbec4bf6d,0x3ef1bf62,0x3f7bbe48,0x3f463f22
.long 0x3f6dbec4,0x3f7f3dc9,0x3f553f0e,0x3ef13f62,0x3ec43f6d,0x3e953f75,0x3e483f7b,0x3dc93f7f
.long 0x3f800000,0x3f7ff4e6,0x3f7fd397,0x3f7f9c18,0x3f800000,0x3f7fc38f,0x3f7f0e58,0x3f7de0b1
.long 0x3f800000,0x3f7f6ac7,0x3f7dabcc,0x3f7ac516,0x3f800000,0x3f7eea9d,0x3f7baccd,0x3f764d97
.long 0x3f800000,0x3f7e4323,0x3f791298,0x3f708066,0x3f800000,0x3f7d7474,0x3f75dec6,0x3f696591
.long 0x3f800000,0x3f7c7eb0,0x3f721352,0x3f6106f2,0x3f800000,0x3f7b61fc,0x3f6db293,0x3f577026
.long 0x3f800000,0x3f7a1e84,0x3f68bf3c,0x3f4cae79,0x3f800000,0x3f78b47b,0x3f633c5a,0x3f40d0da
.long 0x3f800000,0x3f772417,0x3f5d2d53,0x3f33e7bc,0x3f800000,0x3f756d97,0x3f5695e5,0x3f26050a
.long 0x3f800000,0x3f73913f,0x3f4f7a1f,0x3f173c07,0x3f800000,0x3f718f57,0x3f47de65,0x3f07a136
.long 0x3f800000,0x3f6f6830,0x3f3fc767,0x3eee9479,0x3f800000,0x3f6d1c1d,0x3f373a23,0x3ecc9b8b
.long 0x3f7f4e6d,0x3f7eea9d,0x3f7e70b0,0x3f7de0b1,0x3f7c3b28,0x3f7a1e84,0x3f778bc5,0x3f748422
.long 0x3f76ba07,0x3f718f57,0x3f6b4b0c,0x3f63f473,0x3f6ed89e,0x3f655e0b,0x3f59f26a,0x3f4cae79
.long 0x3f64aa59,0x3f55b993,0x3f43e200,0x3f2f61a5,0x3f584853,0x3f42de29,0x3f299415,0x3f0cead0
.long 0x3f49d112,0x3f2d1469,0x3f0b9a6b,0x3ecc9b8b,0x3f396842,0x3f14b039,0x3ed53641,0x3e72b651
.long 0x3f273656,0x3ef41f07,0x3e8e9a22,0x3d8a200a,0x3f13682a,0x3ebb31a0,0x3e09cf86,0xbdd53db9
.long 0x3efc5d27,0x3e7ee6e1,0xbc490e90,0xbe8b9507,0x3ecf7bca,0x3e039502,0xbe22abb6,0xbeddbe79
.long 0x3ea09ae5,0x3bc90f88,0xbe9aa086,0xbf14b039,0x3e605c13,0xbdee3876,0xbee0924f,0xbf36206c
.long 0x3dfab273,0xbe72b651,0xbf10d3cd,0xbf5233c6,0x3cc90ab0,0xbeb554ec,0xbf2e3bde,0xbf6816a8
.long 0x3f7d3aac,0x3f7c7eb0,0x3f7baccd,0x3f7ac516,0x3f710908,0x3f6d1c1d,0x3f68bf3c,0x3f63f473
.long 0x3f5b941a,0x3f5233c6,0x3f47de65,0x3f3ca003,0x3f3daef9,0x3f2d1469,0x3f1b02c6,0x3f07a136
.long 0x3f187fc0,0x3eff17b2,0x3ec9b953,0x3e919ddd,0x3edae880,0x3e97a117,0x3e22abb6,0x3c96c9b6
.long 0x3e78cfcc,0x3da3308c,0xbdafb680,0xbe7ee6e1,0x3d48fb30,0xbe1008b7,0xbea68f12,0xbeff17b2
.long 0xbe164083,0xbeb554ec,0xbf0b9a6b,0xbf36206c,0xbeac7cd4,0xbf0cead0,0xbf3b8f3b,0xbf5f8327
.long 0xbf039c3d,0xbf385216,0xbf604621,0xbf78b47b,0xbf2beb4a,0xbf5ac450,0xbf778bc5,0xbf7fe129
.long 0xbf4d9f02,0xbf7294f8,0xbf7ffb11,0xbf748422,0xbf676bd8,0xbf7e9bc9,0xbf791298,0xbf577026
.long 0xbf7853f8,0xbf7e4323,0xbf633c5a,0xbf2ac082,0xbf7fb10f,0xbf718f57,0xbf3fc767,0xbee363fa
.long 0x3f79c79d,0x3f78b47b,0x3f778bc5,0x3f764d97,0x3f5ebe05,0x3f591e6a,0x3f531849,0x3f4cae79
.long 0x3f3085bb,0x3f239da9,0x3f15f6d9,0x3f07a136,0x3ee63375,0x3ebb31a0,0x3e8e9a22,0x3e419b37
.long 0x3e2f10a2,0x3d621469,0xbd7b2b74,0xbe354098,0xbdfab273,0xbe8586ce,0xbec9b953,0xbf04f484
.long 0xbecf7bca,0xbf0cead0,0xbf2e3bde,0xbf4ac77f,0xbf273656,0xbf48d8b3,0xbf633c5a,0xbf756d97
.long 0xbf584853,0xbf708066,0xbf7dabcc,0xbf7f2f9d,0xbf76ba07,0xbf7fe129,0xbf7a7302,0xbf66becc
.long 0xbf7fec43,0xbf756d97,0xbf59f26a,0xbf2f61a5,0xbf731447,0xbf5233c6,0xbf1ff6cb,0xbec1071e
.long 0xbf514d3d,0xbf19c200,0xbea68f12,0xbc96c9b6,0xbf1d7fd1,0xbea395c5,0x3c490e90,0x3eaf713a
.long 0xbeb8442a,0xbbc90f88,0x3eb263ef,0x3f286605,0xbd96a905,0x3e9d9e78,0x3f24d225,0x3f628210
.long 0x0,0x3c96c9b6,0x3d16c32c,0x3d621469,0x0,0x3d2fe007,0x3dafb680,0x3e039502
.long 0x0,0x3d8a200a,0x3e09cf86,0x3e4dee60,0x0,0x3dbc3ac3,0x3e3b6ecf,0x3e8b9507
.long 0x0,0x3dee3876,0x3e6c9a7f,0x3eaf713a,0x0,0x3e1008b7,0x3e8e9a22,0x3ed25a09
.long 0x0,0x3e28defc,0x3ea68f12,0x3ef41f07,0x0,0x3e419b37,0x3ebe1d4a,0x3f0a48ad
.long 0x0,0x3e5a3997,0x3ed53641,0x3f19c200,0x0,0x3e72b651,0x3eebcbbb,0x3f286605
.long 0x0,0x3e8586ce,0x3f00e7e4,0x3f36206c,0x0,0x3e919ddd,0x3f0b9a6b,0x3f42de29
.long 0x0,0x3e9d9e78,0x3f15f6d9,0x3f4e8d90,0x0,0x3ea986c4,0x3f1ff6cb,0x3f591e6a
.long 0x0,0x3eb554ec,0x3f299415,0x3f628210,0x0,0x3ec1071e,0x3f32c8c9,0x3f6aab7b
.long 0x3d96a905,0x3dbc3ac3,0x3de1bc2e,0x3e039502,0x3e2f10a2,0x3e5a3997,0x3e827dc0,0x3e97a117
.long 0x3e888e93,0x3ea986c4,0x3ec9b953,0x3ee900b7,0x3eb8442a,0x3ee363fa,0x3f064b82,0x3f19c200
.long 0x3ee63375,0x3f0cead0,0x3f24d225,0x3f3a7ca4,0x3f08f59b,0x3f26050a,0x3f3fc767,0x3f55b993
.long 0x3f1d7fd1,0x3f3ca003,0x3f5695e5,0x3f6aab7b,0x3f3085bb,0x3f5064af,0x3f68bf3c,0x3f78b47b
.long 0x3f41d870,0x3f6106f2,0x3f75dec6,0x3f7f6ac7,0x3f514d3d,0x3f6e46be,0x3f7dabcc,0x3f7e9bc9
.long 0x3f5ebe05,0x3f77f110,0x3f7ffb11,0x3f764d97,0x3f6a09a7,0x3f7de0b1,0x3f7cbfc9,0x3f66becc
.long 0x3f731447,0x3f7ffec4,0x3f740bdd,0x3f5064af,0x3f79c79d,0x3f7e4323,0x3f660f88,0x3f33e7bc
.long 0x3f7e1324,0x3f78b47b,0x3f531849,0x3f121eb0,0x3f7fec43,0x3f6f6830,0x3f3b8f3b,0x3ed8106b
.long 0x3e164083,0x3e28defc,0x3e3b6ecf,0x3e4dee60,0x3eac7cd4,0x3ec1071e,0x3ed53641,0x3ee900b7
.long 0x3f039c3d,0x3f121eb0,0x3f1ff6cb,0x3f2d1469,0x3f2beb4a,0x3f3ca003,0x3f4bbbf8,0x3f591e6a
.long 0x3f4d9f02,0x3f5df6be,0x3f6b4b0c,0x3f756d97,0x3f676bd8,0x3f748422,0x3f7cbfc9,0x3f7ff4e6
.long 0x3f7853f8,0x3f7f2f9d,0x3f7f0e58,0x3f77f110,0x3f7fb10f,0x3f7d7474,0x3f721352,0x3f5df6be
.long 0x3f7d3aac,0x3f6f6830,0x3f5695e5,0x3f33e7bc,0x3f710908,0x3f55b993,0x3f2e3bde,0x3ef9a02d
.long 0x3f5b941a,0x3f31a81d,0x3ef6e0cb,0x3e72b651,0x3f3daef9,0x3f04f484,0x3e827dc0,0xbcfb49ba
.long 0x3f187fc0,0x3ea395c5,0x3c490e90,0xbe97a117,0x3edae880,0x3dd53db9,0xbe6c9a7f,0xbf0a48ad
.long 0x3e78cfcc,0xbdee3876,0xbeebcbbb,0xbf3ebc1b,0x3d48fb30,0xbea986c4,0xbf299415,0xbf655e0b
.long 0x3e605c13,0x3e72b651,0x3e827dc0,0x3e8b9507,0x3efc5d27,0x3f07a136,0x3f10d3cd,0x3f19c200
.long 0x3f396842,0x3f44e3f5,0x3f4f7a1f,0x3f591e6a,0x3f64aa59,0x3f6e46be,0x3f75dec6,0x3f7b61fc
.long 0x3f7c3b28,0x3f7f9c18,0x3f7f84ab,0x3f7bf531,0x3f7e1324,0x3f772417,0x3f6b4b0c,0x3f5ac450
.long 0x3f6a09a7,0x3f55b993,0x3f3b8f3b,0x3f1c420c,0x3f41d870,0x3f1ebc12,0x3eebcbbb,0x3e919ddd
.long 0x3f08f59b,0x3eaf713a,0x3e09cf86,0xbda3308c,0x3e888e93,0x3cfb49ba,0xbe541501,0xbeddbe79
.long 0xbcc90ab0,0xbe919ddd,0xbf064b82,0xbf3a7ca4,0xbea09ae5,0xbf121eb0,0xbf47de65,0xbf6d1c1d
.long 0xbf13682a,0xbf4cae79,0xbf721352,0xbf7ff4e6,0xbf49d112,0xbf7294f8,0xbf7ffb11,0xbf708066
.long 0xbf6ed89e,0xbf7ffec4,0xbf6ff573,0xbf40d0da,0xbf7f4e6d,0xbf73913f,0xbf43e200,0xbeee9479
.long 0x3f800000,0x3f800000,0x3f800000,0x3f800000,0x3f7ff4e6,0x3f7fc38f,0x3f7f6ac7,0x3f7eea9d
.long 0x3f7fd397,0x3f7f0e58,0x3f7dabcc,0x3f7baccd,0x3f7f9c18,0x3f7de0b1,0x3f7ac516,0x3f764d97
.long 0x3f7f4e6d,0x3f7c3b28,0x3f76ba07,0x3f6ed89e,0x3f7eea9d,0x3f7a1e84,0x3f718f57,0x3f655e0b
.long 0x3f7e70b0,0x3f778bc5,0x3f6b4b0c,0x3f59f26a,0x3f7de0b1,0x3f748422,0x3f63f473,0x3f4cae79
.long 0x3f7d3aac,0x3f710908,0x3f5b941a,0x3f3daef9,0x3f7c7eb0,0x3f6d1c1d,0x3f5233c6,0x3f2d1469
.long 0x3f7baccd,0x3f68bf3c,0x3f47de65,0x3f1b02c6,0x3f7ac516,0x3f63f473,0x3f3ca003,0x3f07a136
.long 0x3f79c79d,0x3f5ebe05,0x3f3085bb,0x3ee63375,0x3f78b47b,0x3f591e6a,0x3f239da9,0x3ebb31a0
.long 0x3f778bc5,0x3f531849,0x3f15f6d9,0x3e8e9a22,0x3f764d97,0x3f4cae79,0x3f07a136,0x3e419b37
.long 0x3f800000,0x3f800000,0x3f800000,0x3f800000,0x3f7e4323,0x3f7d7474,0x3f7c7eb0,0x3f7b61fc
.long 0x3f791298,0x3f75dec6,0x3f721352,0x3f6db293,0x3f708066,0x3f696591,0x3f6106f2,0x3f577026
.long 0x3f64aa59,0x3f584853,0x3f49d112,0x3f396842,0x3f55b993,0x3f42de29,0x3f2d1469,0x3f14b039
.long 0x3f43e200,0x3f299415,0x3f0b9a6b,0x3ed53641,0x3f2f61a5,0x3f0cead0,0x3ecc9b8b,0x3e72b651
.long 0x3f187fc0,0x3edae880,0x3e78cfcc,0x3d48fb30,0x3eff17b2,0x3e97a117,0x3da3308c,0xbe1008b7
.long 0x3ec9b953,0x3e22abb6,0xbdafb680,0xbea68f12,0x3e919ddd,0x3c96c9b6,0xbe7ee6e1,0xbeff17b2
.long 0x3e2f10a2,0xbdfab273,0xbecf7bca,0xbf273656,0x3d621469,0xbe8586ce,0xbf0cead0,0xbf48d8b3
.long 0xbd7b2b74,0xbec9b953,0xbf2e3bde,0xbf633c5a,0xbe354098,0xbf04f484,0xbf4ac77f,0xbf756d97
.long 0x3f800000,0x3f800000,0x3f800000,0x3f800000,0x3f7a1e84,0x3f78b47b,0x3f772417,0x3f756d97
.long 0x3f68bf3c,0x3f633c5a,0x3f5d2d53,0x3f5695e5,0x3f4cae79,0x3f40d0da,0x3f33e7bc,0x3f26050a
.long 0x3f273656,0x3f13682a,0x3efc5d27,0x3ecf7bca,0x3ef41f07,0x3ebb31a0,0x3e7ee6e1,0x3e039502
.long 0x3e8e9a22,0x3e09cf86,0xbc490e90,0xbe22abb6,0x3d8a200a,0xbdd53db9,0xbe8b9507,0xbeddbe79
.long 0xbe164083,0xbeac7cd4,0xbf039c3d,0xbf2beb4a,0xbeb554ec,0xbf0cead0,0xbf385216,0xbf5ac450
.long 0xbf0b9a6b,0xbf3b8f3b,0xbf604621,0xbf778bc5,0xbf36206c,0xbf5f8327,0xbf78b47b,0xbf7fe129
.long 0xbf584853,0xbf76ba07,0xbf7fec43,0xbf731447,0xbf708066,0xbf7fe129,0xbf756d97,0xbf5233c6
.long 0xbf7dabcc,0xbf7a7302,0xbf59f26a,0xbf1ff6cb,0xbf7f2f9d,0xbf66becc,0xbf2f61a5,0xbec1071e
.long 0x3f800000,0x3f800000,0x3f800000,0x3f800000,0x3f73913f,0x3f718f57,0x3f6f6830,0x3f6d1c1d
.long 0x3f4f7a1f,0x3f47de65,0x3f3fc767,0x3f373a23,0x3f173c07,0x3f07a136,0x3eee9479,0x3ecc9b8b
.long 0x3ea09ae5,0x3e605c13,0x3dfab273,0x3cc90ab0,0x3bc90f88,0xbdee3876,0xbe72b651,0xbeb554ec
.long 0xbe9aa086,0xbee0924f,0xbf10d3cd,0xbf2e3bde,0xbf14b039,0xbf36206c,0xbf5233c6,0xbf6816a8
.long 0xbf4d9f02,0xbf676bd8,0xbf7853f8,0xbf7fb10f,0xbf7294f8,0xbf7e9bc9,0xbf7e4323,0xbf718f57
.long 0xbf7ffb11,0xbf791298,0xbf633c5a,0xbf3fc767,0xbf748422,0xbf577026,0xbf2ac082,0xbee363fa
.long 0xbf514d3d,0xbf1d7fd1,0xbeb8442a,0xbd96a905,0xbf19c200,0xbea395c5,0xbbc90f88,0x3e9d9e78
.long 0xbea68f12,0x3c490e90,0x3eb263ef,0x3f24d225,0xbc96c9b6,0x3eaf713a,0x3f286605,0x3f628210
.long 0x0,0x0,0x0,0x0,0x3c96c9b6,0x3d2fe007,0x3d8a200a,0x3dbc3ac3
.long 0x3d16c32c,0x3dafb680,0x3e09cf86,0x3e3b6ecf,0x3d621469,0x3e039502,0x3e4dee60,0x3e8b9507
.long 0x3d96a905,0x3e2f10a2,0x3e888e93,0x3eb8442a,0x3dbc3ac3,0x3e5a3997,0x3ea986c4,0x3ee363fa
.long 0x3de1bc2e,0x3e827dc0,0x3ec9b953,0x3f064b82,0x3e039502,0x3e97a117,0x3ee900b7,0x3f19c200
.long 0x3e164083,0x3eac7cd4,0x3f039c3d,0x3f2beb4a,0x3e28defc,0x3ec1071e,0x3f121eb0,0x3f3ca003
.long 0x3e3b6ecf,0x3ed53641,0x3f1ff6cb,0x3f4bbbf8,0x3e4dee60,0x3ee900b7,0x3f2d1469,0x3f591e6a
.long 0x3e605c13,0x3efc5d27,0x3f396842,0x3f64aa59,0x3e72b651,0x3f07a136,0x3f44e3f5,0x3f6e46be
.long 0x3e827dc0,0x3f10d3cd,0x3f4f7a1f,0x3f75dec6,0x3e8b9507,0x3f19c200,0x3f591e6a,0x3f7b61fc
.long 0x0,0x0,0x0,0x0,0x3dee3876,0x3e1008b7,0x3e28defc,0x3e419b37
.long 0x3e6c9a7f,0x3e8e9a22,0x3ea68f12,0x3ebe1d4a,0x3eaf713a,0x3ed25a09,0x3ef41f07,0x3f0a48ad
.long 0x3ee63375,0x3f08f59b,0x3f1d7fd1,0x3f3085bb,0x3f0cead0,0x3f26050a,0x3f3ca003,0x3f5064af
.long 0x3f24d225,0x3f3fc767,0x3f5695e5,0x3f68bf3c,0x3f3a7ca4,0x3f55b993,0x3f6aab7b,0x3f78b47b
.long 0x3f4d9f02,0x3f676bd8,0x3f7853f8,0x3f7fb10f,0x3f5df6be,0x3f748422,0x3f7f2f9d,0x3f7d7474
.long 0x3f6b4b0c,0x3f7cbfc9,0x3f7f0e58,0x3f721352,0x3f756d97,0x3f7ff4e6,0x3f77f110,0x3f5df6be
.long 0x3f7c3b28,0x3f7e1324,0x3f6a09a7,0x3f41d870,0x3f7f9c18,0x3f772417,0x3f55b993,0x3f1ebc12
.long 0x3f7f84ab,0x3f6b4b0c,0x3f3b8f3b,0x3eebcbbb,0x3f7bf531,0x3f5ac450,0x3f1c420c,0x3e919ddd
.long 0x0,0x0,0x0,0x0,0x3e5a3997,0x3e72b651,0x3e8586ce,0x3e919ddd
.long 0x3ed53641,0x3eebcbbb,0x3f00e7e4,0x3f0b9a6b,0x3f19c200,0x3f286605,0x3f36206c,0x3f42de29
.long 0x3f41d870,0x3f514d3d,0x3f5ebe05,0x3f6a09a7,0x3f6106f2,0x3f6e46be,0x3f77f110,0x3f7de0b1
.long 0x3f75dec6,0x3f7dabcc,0x3f7ffb11,0x3f7cbfc9,0x3f7f6ac7,0x3f7e9bc9,0x3f764d97,0x3f66becc
.long 0x3f7d3aac,0x3f710908,0x3f5b941a,0x3f3daef9,0x3f6f6830,0x3f55b993,0x3f31a81d,0x3f04f484
.long 0x3f5695e5,0x3f2e3bde,0x3ef6e0cb,0x3e827dc0,0x3f33e7bc,0x3ef9a02d,0x3e72b651,0xbcfb49ba
.long 0x3f08f59b,0x3e888e93,0xbcc90ab0,0xbea09ae5,0x3eaf713a,0x3cfb49ba,0xbe919ddd,0xbf121eb0
.long 0x3e09cf86,0xbe541501,0xbf064b82,0xbf47de65,0xbda3308c,0xbeddbe79,0xbf3a7ca4,0xbf6d1c1d
.long 0x0,0x0,0x0,0x0,0x3e9d9e78,0x3ea986c4,0x3eb554ec,0x3ec1071e
.long 0x3f15f6d9,0x3f1ff6cb,0x3f299415,0x3f32c8c9,0x3f4e8d90,0x3f591e6a,0x3f628210,0x3f6aab7b
.long 0x3f731447,0x3f79c79d,0x3f7e1324,0x3f7fec43,0x3f7ffec4,0x3f7e4323,0x3f78b47b,0x3f6f6830
.long 0x3f740bdd,0x3f660f88,0x3f531849,0x3f3b8f3b,0x3f5064af,0x3f33e7bc,0x3f121eb0,0x3ed8106b
.long 0x3f187fc0,0x3edae880,0x3e78cfcc,0x3d48fb30,0x3ea395c5,0x3dd53db9,0xbdee3876,0xbea986c4
.long 0x3c490e90,0xbe6c9a7f,0xbeebcbbb,0xbf299415,0xbe97a117,0xbf0a48ad,0xbf3ebc1b,0xbf655e0b
.long 0xbf13682a,0xbf49d112,0xbf6ed89e,0xbf7f4e6d,0xbf4cae79,0xbf7294f8,0xbf7ffec4,0xbf73913f
.long 0xbf721352,0xbf7ffb11,0xbf6ff573,0xbf43e200,0xbf7ff4e6,0xbf708066,0xbf40d0da,0xbeee9479
.long 0x3f803f80,0x3f803f80,0x80008000,0x80008000,0x3f463f75,0x3dc93ef1,0xbf22be95,0xbf7fbf62
.long 0x3e483f55,0xbf7bbf0e,0xbf7bbf0e,0xbe48bf55,0xbef13f22,0xbe95bf7f,0xbf62bf46,0x3f753dc9
.long 0xbf6d3ec4,0x3f6dbec4,0xbec4bf6d,0x3ec43f6d,0xbf753dc9,0x3ef13f22,0x3e95bf7f,0xbf623f46
.long 0xbf0ebe48,0xbf553f7b,0x3f55bf7b,0xbf0ebe48,0x3dc9bef1,0xbf223e95,0x3f7fbf62,0x3f46bf75
.long 0x3f35bf35,0x3f35bf35,0x3f35bf35,0x3f35bf35,0x3f7fbf62,0x3f46bf75,0x3dc9bef1,0xbf223e95
.long 0x3f55bf7b,0xbf0ebe48,0xbf0ebe48,0xbf553f7b,0x3e95bf7f,0xbf623f46,0xbf753dc9,0x3ef13f22
.long 0xbec4bf6d,0x3ec43f6d,0xbf6d3ec4,0x3f6dbec4,0xbf62bf46,0x3f753dc9,0xbef13f22,0xbe95bf7f
.long 0xbf7bbf0e,0xbe48bf55,0x3e483f55,0xbf7bbf0e,0xbf22be95,0xbf7fbf62,0x3f463f75,0x3dc93ef1
.long 0x3f803f80,0x3f803f80,0x80008000,0x80008000,0xbf22be95,0xbf7fbf62,0xbf46bf75,0xbdc9bef1
.long 0xbe48bf55,0x3f7b3f0e,0x3f7b3f0e,0x3e483f55,0x3f623f46,0xbf75bdc9,0xbef13f22,0xbe95bf7f
.long 0xbf6d3ec4,0x3f6dbec4,0xbec4bf6d,0x3ec43f6d,0x3e95bf7f,0xbf623f46,0x3f75bdc9,0xbef1bf22
.long 0x3f0e3e48,0x3f55bf7b,0xbf553f7b,0x3f0e3e48,0xbf7f3f62,0xbf463f75,0x3dc9bef1,0xbf223e95
.long 0x3f35bf35,0x3f35bf35,0x3f35bf35,0x3f35bf35,0x3dc9bef1,0xbf223e95,0xbf7f3f62,0xbf463f75
.long 0xbf553f7b,0x3f0e3e48,0x3f0e3e48,0x3f55bf7b,0x3f75bdc9,0xbef1bf22,0x3e95bf7f,0xbf623f46
.long 0xbec4bf6d,0x3ec43f6d,0xbf6d3ec4,0x3f6dbec4,0xbef13f22,0xbe95bf7f,0x3f623f46,0xbf75bdc9
.long 0x3f7b3f0e,0x3e483f55,0xbe48bf55,0x3f7b3f0e,0xbf46bf75,0xbdc9bef1,0xbf22be95,0xbf7fbf62
.long 0x3f803f80,0x3f803f80,0x80008000,0x80008000,0xbf46bf75,0xbdc9bef1,0x3f223e95,0x3f7f3f62
.long 0x3e483f55,0xbf7bbf0e,0xbf7bbf0e,0xbe48bf55,0x3ef1bf22,0x3e953f7f,0x3f623f46,0xbf75bdc9
.long 0xbf6d3ec4,0x3f6dbec4,0xbec4bf6d,0x3ec43f6d,0x3f75bdc9,0xbef1bf22,0xbe953f7f,0x3f62bf46
.long 0xbf0ebe48,0xbf553f7b,0x3f55bf7b,0xbf0ebe48,0xbdc93ef1,0x3f22be95,0xbf7f3f62,0xbf463f75
.long 0x3f35bf35,0x3f35bf35,0x3f35bf35,0x3f35bf35,0xbf7f3f62,0xbf463f75,0xbdc93ef1,0x3f22be95
.long 0x3f55bf7b,0xbf0ebe48,0xbf0ebe48,0xbf553f7b,0xbe953f7f,0x3f62bf46,0x3f75bdc9,0xbef1bf22
.long 0xbec4bf6d,0x3ec43f6d,0xbf6d3ec4,0x3f6dbec4,0x3f623f46,0xbf75bdc9,0x3ef1bf22,0x3e953f7f
.long 0xbf7bbf0e,0xbe48bf55,0x3e483f55,0xbf7bbf0e,0x3f223e95,0x3f7f3f62,0xbf46bf75,0xbdc9bef1
.long 0x3f803f80,0x3f803f80,0x80008000,0x80008000,0x3f223e95,0x3f7f3f62,0x3f463f75,0x3dc93ef1
.long 0xbe48bf55,0x3f7b3f0e,0x3f7b3f0e,0x3e483f55,0xbf62bf46,0x3f753dc9,0x3ef1bf22,0x3e953f7f
.long 0xbf6d3ec4,0x3f6dbec4,0xbec4bf6d,0x3ec43f6d,0xbe953f7f,0x3f62bf46,0xbf753dc9,0x3ef13f22
.long 0x3f0e3e48,0x3f55bf7b,0xbf553f7b,0x3f0e3e48,0x3f7fbf62,0x3f46bf75,0xbdc93ef1,0x3f22be95
.long 0x3f35bf35,0x3f35bf35,0x3f35bf35,0x3f35bf35,0xbdc93ef1,0x3f22be95,0x3f7fbf62,0x3f46bf75
.long 0xbf553f7b,0x3f0e3e48,0x3f0e3e48,0x3f55bf7b,0xbf753dc9,0x3ef13f22,0xbe953f7f,0x3f62bf46
.long 0xbec4bf6d,0x3ec43f6d,0xbf6d3ec4,0x3f6dbec4,0x3ef1bf22,0x3e953f7f,0xbf62bf46,0x3f753dc9
.long 0x3f7b3f0e,0x3e483f55,0xbe48bf55,0x3f7b3f0e,0x3f463f75,0x3dc93ef1,0x3f223e95,0x3f7f3f62
.long 0x0,0x0,0x3f803f80,0x3f803f80,0x3f223e95,0x3f7f3f62,0x3f463f75,0x3dc93ef1
.long 0x3f7b3f0e,0x3e483f55,0x3e483f55,0xbf7bbf0e,0x3f623f46,0xbf75bdc9,0xbef13f22,0xbe95bf7f
.long 0x3ec43f6d,0xbec4bf6d,0xbf6d3ec4,0x3f6dbec4,0xbe953f7f,0x3f62bf46,0xbf753dc9,0x3ef13f22
.long 0xbf553f7b,0x3f0e3e48,0xbf0ebe48,0xbf553f7b,0xbf7f3f62,0xbf463f75,0x3dc9bef1,0xbf223e95
.long 0xbf353f35,0xbf353f35,0x3f35bf35,0x3f35bf35,0xbdc93ef1,0x3f22be95,0x3f7fbf62,0x3f46bf75
.long 0x3f0e3e48,0x3f55bf7b,0x3f55bf7b,0xbf0ebe48,0x3f75bdc9,0xbef1bf22,0x3e95bf7f,0xbf623f46
.long 0x3f6dbec4,0xbf6d3ec4,0xbec4bf6d,0x3ec43f6d,0x3ef1bf22,0x3e953f7f,0xbf62bf46,0x3f753dc9
.long 0xbe48bf55,0x3f7b3f0e,0xbf7bbf0e,0xbe48bf55,0xbf46bf75,0xbdc9bef1,0xbf22be95,0xbf7fbf62
.long 0x0,0x0,0x3f803f80,0x3f803f80,0x3f463f75,0x3dc93ef1,0xbf22be95,0xbf7fbf62
.long 0xbf7bbf0e,0xbe48bf55,0xbe48bf55,0x3f7b3f0e,0x3ef1bf22,0x3e953f7f,0x3f623f46,0xbf75bdc9
.long 0x3ec43f6d,0xbec4bf6d,0xbf6d3ec4,0x3f6dbec4,0xbf753dc9,0x3ef13f22,0x3e95bf7f,0xbf623f46
.long 0x3f55bf7b,0xbf0ebe48,0x3f0e3e48,0x3f55bf7b,0xbdc93ef1,0x3f22be95,0xbf7f3f62,0xbf463f75
.long 0xbf353f35,0xbf353f35,0x3f35bf35,0x3f35bf35,0x3f7fbf62,0x3f46bf75,0x3dc9bef1,0xbf223e95
.long 0xbf0ebe48,0xbf553f7b,0xbf553f7b,0x3f0e3e48,0xbe953f7f,0x3f62bf46,0x3f75bdc9,0xbef1bf22
.long 0x3f6dbec4,0xbf6d3ec4,0xbec4bf6d,0x3ec43f6d,0xbf62bf46,0x3f753dc9,0xbef13f22,0xbe95bf7f
.long 0x3e483f55,0xbf7bbf0e,0x3f7b3f0e,0x3e483f55,0x3f223e95,0x3f7f3f62,0xbf46bf75,0xbdc9bef1
.long 0x0,0x0,0x3f803f80,0x3f803f80,0xbf22be95,0xbf7fbf62,0xbf46bf75,0xbdc9bef1
.long 0x3f7b3f0e,0x3e483f55,0x3e483f55,0xbf7bbf0e,0xbf62bf46,0x3f753dc9,0x3ef1bf22,0x3e953f7f
.long 0x3ec43f6d,0xbec4bf6d,0xbf6d3ec4,0x3f6dbec4,0x3e95bf7f,0xbf623f46,0x3f75bdc9,0xbef1bf22
.long 0xbf553f7b,0x3f0e3e48,0xbf0ebe48,0xbf553f7b,0x3f7fbf62,0x3f46bf75,0xbdc93ef1,0x3f22be95
.long 0xbf353f35,0xbf353f35,0x3f35bf35,0x3f35bf35,0x3dc9bef1,0xbf223e95,0xbf7f3f62,0xbf463f75
.long 0x3f0e3e48,0x3f55bf7b,0x3f55bf7b,0xbf0ebe48,0xbf753dc9,0x3ef13f22,0xbe953f7f,0x3f62bf46
.long 0x3f6dbec4,0xbf6d3ec4,0xbec4bf6d,0x3ec43f6d,0xbef13f22,0xbe95bf7f,0x3f623f46,0xbf75bdc9
.long 0xbe48bf55,0x3f7b3f0e,0xbf7bbf0e,0xbe48bf55,0x3f463f75,0x3dc93ef1,0x3f223e95,0x3f7f3f62
.long 0x0,0x0,0x3f803f80,0x3f803f80,0xbf46bf75,0xbdc9bef1,0x3f223e95,0x3f7f3f62
.long 0xbf7bbf0e,0xbe48bf55,0xbe48bf55,0x3f7b3f0e,0xbef13f22,0xbe95bf7f,0xbf62bf46,0x3f753dc9
.long 0x3ec43f6d,0xbec4bf6d,0xbf6d3ec4,0x3f6dbec4,0x3f75bdc9,0xbef1bf22,0xbe953f7f,0x3f62bf46
.long 0x3f55bf7b,0xbf0ebe48,0x3f0e3e48,0x3f55bf7b,0x3dc9bef1,0xbf223e95,0x3f7fbf62,0x3f46bf75
.long 0xbf353f35,0xbf353f35,0x3f35bf35,0x3f35bf35,0xbf7f3f62,0xbf463f75,0xbdc93ef1,0x3f22be95
.long 0xbf0ebe48,0xbf553f7b,0xbf553f7b,0x3f0e3e48,0x3e95bf7f,0xbf623f46,0xbf753dc9,0x3ef13f22
.long 0x3f6dbec4,0xbf6d3ec4,0xbec4bf6d,0x3ec43f6d,0x3f623f46,0xbf75bdc9,0x3ef1bf22,0x3e953f7f
.long 0x3e483f55,0xbf7bbf0e,0x3f7b3f0e,0x3e483f55,0xbf22be95,0xbf7fbf62,0x3f463f75,0x3dc93ef1
.long 0x3f80,0x3eac3f71,0x3f223f46,0x3f5c3f04,0x3f80,0x3f2c3f3e,0x3f7f3dc9,0x3f4ebf18
.long 0x3f80,0x3f673edb,0x3f46bf22,0xbe79bf78,0x3f80,0x3f803d49,0x3dc9bf7f,0xbf7dbe16
.long 0x3f80,0x3f71beac,0xbf22bf46,0xbf043f5c,0x3f80,0x3f3ebf2c,0xbf7fbdc9,0x3f183f4e
.long 0x3f80,0x3edbbf67,0xbf463f22,0x3f78be79,0x3f80,0x3d49bf80,0xbdc93f7f,0x3e16bf7d
.long 0x3f80,0xbeacbf71,0x3f223f46,0xbf5cbf04,0x3f80,0xbf2cbf3e,0x3f7f3dc9,0xbf4e3f18
.long 0x3f80,0xbf67bedb,0x3f46bf22,0x3e793f78,0x3f80,0xbf80bd49,0x3dc9bf7f,0x3f7d3e16
.long 0x3f80,0xbf713eac,0xbf22bf46,0x3f04bf5c,0x3f80,0xbf3e3f2c,0xbf7fbdc9,0xbf18bf4e
.long 0x3f80,0xbedb3f67,0xbf463f22,0xbf783e79,0x3f80,0xbd493f80,0xbdc93f7f,0xbe163f7d
.long 0x3f7b3e48,0x3f7dbe16,0x3f62bef1,0x3f2cbf3e,0x3e48bf7b,0xbf04bf5c,0xbf75be95,0xbf673edb
.long 0xbf7bbe48,0xbf183f4e,0x3ef13f62,0x3f80bd49,0xbe483f7b,0x3f783e79,0x3e95bf75,0xbf71beac
.long 0x3f7b3e48,0xbe16bf7d,0xbf623ef1,0x3f3e3f2c,0x3e48bf7b,0xbf5c3f04,0x3f753e95,0xbedbbf67
.long 0xbf7bbe48,0x3f4e3f18,0xbef1bf62,0x3d493f80,0xbe483f7b,0x3e79bf78,0xbe953f75,0x3eacbf71
.long 0x3f7b3e48,0xbf7d3e16,0x3f62bef1,0xbf2c3f3e,0x3e48bf7b,0x3f043f5c,0xbf75be95,0x3f67bedb
.long 0xbf7bbe48,0x3f18bf4e,0x3ef13f62,0xbf803d49,0xbe483f7b,0xbf78be79,0x3e95bf75,0x3f713eac
.long 0x3f7b3e48,0x3e163f7d,0xbf623ef1,0xbf3ebf2c,0x3e48bf7b,0x3f5cbf04,0x3f753e95,0x3edb3f67
.long 0xbf7bbe48,0xbf4ebf18,0xbef1bf62,0xbd49bf80,0xbe483f7b,0xbe793f78,0xbe953f75,0xbeac3f71
.long 0x3ec4bf6d,0x3d49bf80,0xbe95bf75,0xbf18bf4e,0xbec43f6d,0x3eac3f71,0x3f623ef1,0x3f78be79
.long 0x3ec4bf6d,0xbf2cbf3e,0xbf753e95,0xbe163f7d,0xbec43f6d,0x3f673edb,0x3ef1bf62,0xbf5cbf04
.long 0x3ec4bf6d,0xbf80bd49,0x3e953f75,0x3f4ebf18,0xbec43f6d,0x3f71beac,0xbf62bef1,0x3e793f78
.long 0x3ec4bf6d,0xbf3e3f2c,0x3f75be95,0xbf7dbe16,0xbec43f6d,0x3edbbf67,0xbef13f62,0x3f04bf5c
.long 0x3ec4bf6d,0xbd493f80,0xbe95bf75,0x3f183f4e,0xbec43f6d,0xbeacbf71,0x3f623ef1,0xbf783e79
.long 0x3ec4bf6d,0x3f2c3f3e,0xbf753e95,0x3e16bf7d,0xbec43f6d,0xbf67bedb,0x3ef1bf62,0x3f5c3f04
.long 0x3ec4bf6d,0x3f803d49,0x3e953f75,0xbf4e3f18,0xbec43f6d,0xbf713eac,0xbf62bef1,0xbe79bf78
.long 0x3ec4bf6d,0x3f3ebf2c,0x3f75be95,0x3f7d3e16,0xbec43f6d,0xbedb3f67,0xbef13f62,0xbf043f5c
.long 0xbf55bf0e,0xbf78be79,0xbf7f3dc9,0xbf673edb,0x3f0ebf55,0xbe16bf7d,0xbf46bf22,0xbf803d49
.long 0x3f553f0e,0x3f5cbf04,0xbdc9bf7f,0xbf71beac,0xbf0e3f55,0x3f4e3f18,0x3f22bf46,0xbf3ebf2c
.long 0xbf55bf0e,0xbe793f78,0x3f7fbdc9,0xbedbbf67,0x3f0ebf55,0xbf7d3e16,0x3f463f22,0xbd49bf80
.long 0x3f553f0e,0xbf04bf5c,0x3dc93f7f,0x3eacbf71,0xbf0e3f55,0x3f18bf4e,0xbf223f46,0x3f2cbf3e
.long 0xbf55bf0e,0x3f783e79,0xbf7f3dc9,0x3f67bedb,0x3f0ebf55,0x3e163f7d,0xbf46bf22,0x3f80bd49
.long 0x3f553f0e,0xbf5c3f04,0xbdc9bf7f,0x3f713eac,0xbf0e3f55,0xbf4ebf18,0x3f22bf46,0x3f3e3f2c
.long 0xbf55bf0e,0x3e79bf78,0x3f7fbdc9,0x3edb3f67,0x3f0ebf55,0x3f7dbe16,0x3f463f22,0x3d493f80
.long 0x3f553f0e,0x3f043f5c,0x3dc93f7f,0xbeac3f71,0xbf0e3f55,0xbf183f4e,0xbf223f46,0xbf2c3f3e
.long 0x3f808000,0x3f71beac,0x3f46bf22,0x3f04bf5c,0x3f808000,0x3f3ebf2c,0x3dc9bf7f,0xbf18bf4e
.long 0x3f808000,0x3edbbf67,0xbf22bf46,0xbf783e79,0x3f808000,0x3d49bf80,0xbf7fbdc9,0xbe163f7d
.long 0x3f808000,0xbeacbf71,0xbf463f22,0x3f5c3f04,0x3f808000,0xbf2cbf3e,0xbdc93f7f,0x3f4ebf18
.long 0x3f808000,0xbf67bedb,0x3f223f46,0xbe79bf78,0x3f808000,0xbf80bd49,0x3f7f3dc9,0xbf7dbe16
.long 0x3f808000,0xbf713eac,0x3f46bf22,0xbf043f5c,0x3f808000,0xbf3e3f2c,0x3dc9bf7f,0x3f183f4e
.long 0x3f808000,0xbedb3f67,0xbf22bf46,0x3f78be79,0x3f808000,0xbd493f80,0xbf7fbdc9,0x3e16bf7d
.long 0x3f808000,0x3eac3f71,0xbf463f22,0xbf5cbf04,0x3f808000,0x3f2c3f3e,0xbdc93f7f,0xbf4e3f18
.long 0x3f808000,0x3f673edb,0x3f223f46,0x3e793f78,0x3f808000,0x3f803d49,0x3f7f3dc9,0x3f7d3e16
.long 0x3e48bf7b,0xbe16bf7d,0xbef1bf62,0xbf3ebf2c,0xbf7bbe48,0xbf5c3f04,0xbe953f75,0x3edb3f67
.long 0xbe483f7b,0x3f4e3f18,0x3f62bef1,0xbd49bf80,0x3f7b3e48,0x3e79bf78,0xbf75be95,0xbeac3f71
.long 0x3e48bf7b,0xbf7d3e16,0x3ef13f62,0x3f2cbf3e,0xbf7bbe48,0x3f043f5c,0x3e95bf75,0xbf673edb
.long 0xbe483f7b,0x3f18bf4e,0xbf623ef1,0x3f80bd49,0x3f7b3e48,0xbf78be79,0x3f753e95,0xbf71beac
.long 0x3e48bf7b,0x3e163f7d,0xbef1bf62,0x3f3e3f2c,0xbf7bbe48,0x3f5cbf04,0xbe953f75,0xbedbbf67
.long 0xbe483f7b,0xbf4ebf18,0x3f62bef1,0x3d493f80,0x3f7b3e48,0xbe793f78,0xbf75be95,0x3eacbf71
.long 0x3e48bf7b,0x3f7dbe16,0x3ef13f62,0xbf2c3f3e,0xbf7bbe48,0xbf04bf5c,0x3e95bf75,0x3f67bedb
.long 0xbe483f7b,0xbf183f4e,0xbf623ef1,0xbf803d49,0x3f7b3e48,0x3f783e79,0x3f753e95,0x3f713eac
.long 0xbf6dbec4,0xbf80bd49,0xbf753e95,0xbf4e3f18,0x3f6d3ec4,0x3f71beac,0x3ef1bf62,0xbe79bf78
.long 0xbf6dbec4,0xbf3e3f2c,0x3e953f75,0x3f7d3e16,0x3f6d3ec4,0x3edbbf67,0xbf62bef1,0xbf043f5c
.long 0xbf6dbec4,0xbd493f80,0x3f75be95,0xbf18bf4e,0x3f6d3ec4,0xbeacbf71,0xbef13f62,0x3f78be79
.long 0xbf6dbec4,0x3f2c3f3e,0xbe95bf75,0xbe163f7d,0x3f6d3ec4,0xbf67bedb,0x3f623ef1,0xbf5cbf04
.long 0xbf6dbec4,0x3f803d49,0xbf753e95,0x3f4ebf18,0x3f6d3ec4,0xbf713eac,0x3ef1bf62,0x3e793f78
.long 0xbf6dbec4,0x3f3ebf2c,0x3e953f75,0xbf7dbe16,0x3f6d3ec4,0xbedb3f67,0xbf62bef1,0x3f04bf5c
.long 0xbf6dbec4,0x3d49bf80,0x3f75be95,0x3f183f4e,0x3f6d3ec4,0x3eac3f71,0xbef13f62,0xbf783e79
.long 0xbf6dbec4,0xbf2cbf3e,0xbe95bf75,0x3e16bf7d,0x3f6d3ec4,0x3f673edb,0x3f623ef1,0x3f5c3f04
.long 0xbf0e3f55,0xbe793f78,0x3dc93f7f,0x3edb3f67,0xbf55bf0e,0xbf7d3e16,0xbf223f46,0x3d493f80
.long 0x3f0ebf55,0xbf04bf5c,0xbf7f3dc9,0xbeac3f71,0x3f553f0e,0x3f18bf4e,0xbf46bf22,0xbf2c3f3e
.long 0xbf0e3f55,0x3f783e79,0xbdc9bf7f,0xbf673edb,0xbf55bf0e,0x3e163f7d,0x3f22bf46,0xbf803d49
.long 0x3f0ebf55,0xbf5c3f04,0x3f7fbdc9,0xbf71beac,0x3f553f0e,0xbf4ebf18,0x3f463f22,0xbf3ebf2c
.long 0xbf0e3f55,0x3e79bf78,0x3dc93f7f,0xbedbbf67,0xbf55bf0e,0x3f7dbe16,0xbf223f46,0xbd49bf80
.long 0x3f0ebf55,0x3f043f5c,0xbf7f3dc9,0x3eacbf71,0x3f553f0e,0xbf183f4e,0xbf46bf22,0x3f2cbf3e
.long 0xbf0e3f55,0xbf78be79,0xbdc9bf7f,0x3f67bedb,0xbf55bf0e,0xbe16bf7d,0x3f22bf46,0x3f80bd49
.long 0x3f0ebf55,0x3f5cbf04,0x3f7fbdc9,0x3f713eac,0x3f553f0e,0x3f4e3f18,0x3f463f22,0x3f3e3f2c
.long 0x3f800000,0x3f7ff0e3,0x3f7fc38f,0x3f7f7808,0x3f800000,0x3f7fba9e,0x3f7eea9d,0x3f7d906e
.long 0x3f800000,0x3f7f5ce9,0x3f7d7474,0x3f7a4910,0x3f800000,0x3f7ed7d4,0x3f7b61fc,0x3f75a67b
.long 0x3f800000,0x3f7e2b72,0x3f78b47b,0x3f6faf1b,0x3f800000,0x3f7d57de,0x3f756d97,0x3f686b39
.long 0x3f800000,0x3f7c5d3a,0x3f718f57,0x3f5fe4e9,0x3f800000,0x3f7b3bab,0x3f6d1c1d,0x3f5627fe
.long 0x3f800000,0x3f79f35e,0x3f6816a8,0x3f4b41fa,0x3f800000,0x3f788486,0x3f628210,0x3f3f41fc
.long 0x3f800000,0x3f76ef5b,0x3f5c61c7,0x3f3238aa,0x3f800000,0x3f75341d,0x3f55b993,0x3f24381a
.long 0x3f800000,0x3f73530e,0x3f4e8d90,0x3f1553b7,0x3f800000,0x3f714c7a,0x3f46e22a,0x3f05a02c
.long 0x3f800000,0x3f6f20b0,0x3f3ebc1b,0x3eea6681,0x3f800000,0x3f6cd007,0x3f36206c,0x3ec8477c
.long 0x3f7f0e58,0x3f7e868b,0x3f7de0b1,0x3f7d1cdd,0x3f7baccd,0x3f7940c0,0x3f764d97,0x3f72d4eb
.long 0x3f75dec6,0x3f703b37,0x3f696591,0x3f61668a,0x3f6db293,0x3f6398ac,0x3f577026,0x3f495521
.long 0x3f633c5a,0x3f5389c7,0x3f40d0da,0x3f2b561b,0x3f5695e5,0x3f404c5c,0x3f26050a,0x3f084b92
.long 0x3f47de65,0x3f2a2a80,0x3f07a136,0x3ec27b55,0x3f373a23,0x3f11796b,0x3ecc9b8b,0x3e5d4b1a
.long 0x3f24d225,0x3eed3063,0x3e8586ce,0x3d3c6dd5,0x3f10d3cd,0x3eb3dca5,0x3dee3876,0xbe007745
.long 0x3ef6e0cb,0x3e6fa8b2,0xbcfb49ba,0xbe9620d2,0x3ec9b953,0x3de7fa9a,0xbe354098,0xbee79a5d
.long 0x3e9aa086,0xbc16cb58,0xbea395c5,0xbf19210f,0x3e541501,0xbe06b26e,0xbee900b7,0xbf39f2ac
.long 0x3de1bc2e,0xbe80f8c0,0xbf14b039,0xbf554aa4,0x3c490e90,0xbebca7af,0xbf31a81d,0xbf6a5ad9
.long 0x3f7c3b28,0x3f7b3bab,0x3f7a1e84,0x3f78e3d6,0x3f6ed89e,0x3f6a5ad9,0x3f655e0b,0x3f5fe4e9
.long 0x3f584853,0x3f4e1689,0x3f42de29,0x3f36ad7f,0x3f396842,0x3f27ce61,0x3f14b039,0x3f003a06
.long 0x3f13682a,0x3ef2bd43,0x3ebb31a0,0x3e80f8c0,0x3ecf7bca,0x3e8a11f7,0x3e039502,0xbc7b514b
.long 0x3e605c13,0x3d55880e,0xbdee3876,0xbe901c2c,0x3cc90ab0,0xbe2bf804,0xbeb554ec,0xbf06f686
.long 0xbe2f10a2,0xbec27b55,0xbf121eb0,0xbf3c17d9,0xbeb8442a,0xbf12c39a,0xbf40d0da,0xbf6398ac
.long 0xbf08f59b,0xbf3d27b8,0xbf63f473,0xbf7a9c59,0xbf3085bb,0xbf5e5aa6,0xbf796e4e,0xbf7f7808
.long 0xbf514d3d,0xbf74bf62,0xbf7ff4e6,0xbf71d19f,0xbf6a09a7,0xbf7f3f54,0xbf772417,0xbf52a649
.long 0xbf79c79d,0xbf7d57de,0xbf5f8327,0xbf24381a,0xbf7fec43,0xbf6f20b0,0xbf3a7ca4,0xbed3c867
.long 0x3f778bc5,0x3f76167a,0x3f748422,0x3f72d4eb,0x3f59f26a,0x3f5389c7,0x3f4cae79,0x3f456439
.long 0x3f299415,0x3f1ba299,0x3f0cead0,0x3efafef7,0x3ed53641,0x3ea80b1f,0x3e72b651,0x3e1324ca
.long 0x3e09cf86,0x3c7b514b,0xbdd53db9,0xbe636c83,0xbe22abb6,0xbe9920fe,0xbeddbe79,0xbf0ee0db
.long 0xbee0924f,0xbf1553b7,0xbf36206c,0xbf51c0c2,0xbf2e3bde,0xbf4f0417,0xbf6816a8,0xbf788486
.long 0xbf5d2d53,0xbf73ced9,0xbf7eea9d,0xbf7dfa38,0xbf791298,0xbf7ffd39,0xbf77f110,0xbf61668a
.long 0xbf7f84ab,0xbf725470,0xbf53fac3,0xbf269de3,0xbf6ff573,0xbf4c3578,0xbf173c07,0xbeab0201
.long 0xbf4bbbf8,0xbf11796b,0xbe919ddd,0x3ce22a7a,0xbf15f6d9,0xbe901c2c,0x3d621469,0x3ec5625c
.long 0xbea68f12,0x3d0a342f,0x3ec6d529,0x3f311722,0xbd16c32c,0x3eb0eacb,0x3f2d1469,0x3f67c187
.long 0x0,0x3cafea69,0x3d2fe007,0x3d83db0a,0x0,0x3d3c6dd5,0x3dbc3ac3,0x3e0cec4a
.long 0x0,0x3d9064b4,0x3e1008b7,0x3e57278f,0x0,0x3dc27c39,0x3e419b37,0x3e901c2c
.long 0x0,0x3df475c0,0x3e72b651,0x3eb3dca5,0x0,0x3e1324ca,0x3e919ddd,0x3ed6a399
.long 0x0,0x3e2bf804,0x3ea986c4,0x3ef840c8,0x0,0x3e44b0b9,0x3ec1071e,0x3f0c42c9
.long 0x0,0x3e5d4b1a,0x3ed8106b,0x3f1ba299,0x0,0x3e75c35a,0x3eee9479,0x3f2a2a80
.long 0x0,0x3e870ada,0x3f0242b1,0x3f37c655,0x0,0x3e931f35,0x3f0cead0,0x3f446337
.long 0x0,0x3e9f1cdf,0x3f173c07,0x3f4fefa8,0x0,0x3eab0201,0x3f212ff9,0x3f5a5ba0
.long 0x0,0x3eb6ccc3,0x3f2ac082,0x3f6398ac,0x0,0x3ec27b55,0x3f33e7bc,0x3f6b99fb
.long 0x3dafb680,0x3ddb7d37,0x3e039502,0x3e195be0,0x3e3b6ecf,0x3e698bba,0x3e8b9507,0x3ea21887
.long 0x3e8e9a22,0x3eb0eacb,0x3ed25a09,0x3ef2bd43,0x3ebe1d4a,0x3eea6681,0x3f0a48ad,0x3f1e1e22
.long 0x3eebcbbb,0x3f102dd5,0x3f286605,0x3f3e35c5,0x3f0b9a6b,0x3f28fd41,0x3f42de29,0x3f58b3a1
.long 0x3f1ff6cb,0x3f3f41fc,0x3f591e6a,0x3f6cd007,0x3f32c8c9,0x3f52a649,0x3f6aab7b,0x3f79f35e
.long 0x3f43e200,0x3f62df7b,0x3f772417,0x3f7fba9e,0x3f531849,0x3f6faf1b,0x3f7e4323,0x3f7dfa38
.long 0x3f604621,0x3f78e3d6,0x3f7fe129,0x3f74bf62,0x3f6b4b0c,0x3f7e5a38,0x3f7bf531,0x3f644fac
.long 0x3f740bdd,0x3f7ffd39,0x3f7294f8,0x3f4d26fd,0x3f7a7302,0x3f7dc68c,0x3f63f473,0x3f2ff3e6
.long 0x3f7e70b0,0x3f77beb7,0x3f5064af,0x3f0d9281,0x3f7ffb11,0x3f6dfcf2,0x3f385216,0x3ece0bea
.long 0x3e2f10a2,0x3e44b0b9,0x3e5a3997,0x3e6fa8b2,0x3eb8442a,0x3ece0bea,0x3ee363fa,0x3ef840c8
.long 0x3f08f59b,0x3f17de12,0x3f26050a,0x3f33587a,0x3f3085bb,0x3f4154e1,0x3f5064af,0x3f5d924d
.long 0x3f514d3d,0x3f61668a,0x3f6e46be,0x3f77beb7,0x3f6a09a7,0x3f76841b,0x3f7de0b1,0x3f7ff84a
.long 0x3f79c79d,0x3f7fa6e3,0x3f7e4323,0x3f75a67b,0x3f7fec43,0x3f7c5d3a,0x3f6f6830,0x3f5988ad
.long 0x3f7c3b28,0x3f6cd007,0x3f5233c6,0x3f2da859,0x3f6ed89e,0x3f51c0c2,0x3f286605,0x3eea6681
.long 0x3f584853,0x3f2c800f,0x3ee900b7,0x3e5101f1,0x3f396842,0x3efdbabb,0x3e667c66,0xbd83db0a
.long 0x3f13682a,0x3e9620d2,0xbc96c9b6,0xbea80b1f,0x3ecf7bca,0x3d9cecf9,0xbe8586ce,0xbf11796b
.long 0x3e605c13,0xbe1324ca,0xbef9a02d,0xbf446337,0x3cc90ab0,0xbeb6ccc3,0xbf2f61a5,0xbf6912ae
.long 0x3e827dc0,0x3e8d17c0,0x3e97a117,0x3ea21887,0x3f064b82,0x3f102dd5,0x3f19c200,0x3f2302d3
.long 0x3f3fc767,0x3f4b41fa,0x3f55b993,0x3f5f20db,0x3f68bf3c,0x3f71d19f,0x3f78b47b,0x3f7d57de
.long 0x3f7dabcc,0x3f7ff84a,0x3f7e9bc9,0x3f799b43,0x3f7cbfc9,0x3f74484b,0x3f66becc,0x3f546b3b
.long 0x3f660f88,0x3f4fefa8,0x3f33e7bc,0x3f12c39a,0x3f3b8f3b,0x3f16999f,0x3ed8106b,0x3e75c35a
.long 0x3f00e7e4,0x3e9c1faf,0x3dbc3ac3,0xbe007745,0x3e6c9a7f,0xbc16cb58,0xbe7ee6e1,0xbef2bd43
.long 0xbd7b2b74,0xbea5129f,0xbf0f8784,0xbf425b89,0xbeb263ef,0xbf1a6293,0xbf4e8d90,0xbf714c7a
.long 0xbf1b02c6,0xbf52a649,0xbf756d97,0xbf7fe705,0xbf4f7a1f,0xbf75a67b,0xbf7f9c18,0xbf6c3624
.long 0xbf721352,0xbf7fdaaf,0xbf6be858,0xbf38dd65,0xbf7fd397,0xbf703b37,0xbf3ca003,0xbed97cb9
.long 0x3f800000,0x3f800000,0x3f800000,0x3f800000,0x3f7ff0e3,0x3f7fba9e,0x3f7f5ce9,0x3f7ed7d4
.long 0x3f7fc38f,0x3f7eea9d,0x3f7d7474,0x3f7b61fc,0x3f7f7808,0x3f7d906e,0x3f7a4910,0x3f75a67b
.long 0x3f7f0e58,0x3f7baccd,0x3f75dec6,0x3f6db293,0x3f7e868b,0x3f7940c0,0x3f703b37,0x3f6398ac
.long 0x3f7de0b1,0x3f764d97,0x3f696591,0x3f577026,0x3f7d1cdd,0x3f72d4eb,0x3f61668a,0x3f495521
.long 0x3f7c3b28,0x3f6ed89e,0x3f584853,0x3f396842,0x3f7b3bab,0x3f6a5ad9,0x3f4e1689,0x3f27ce61
.long 0x3f7a1e84,0x3f655e0b,0x3f42de29,0x3f14b039,0x3f78e3d6,0x3f5fe4e9,0x3f36ad7f,0x3f003a06
.long 0x3f778bc5,0x3f59f26a,0x3f299415,0x3ed53641,0x3f76167a,0x3f5389c7,0x3f1ba299,0x3ea80b1f
.long 0x3f748422,0x3f4cae79,0x3f0cead0,0x3e72b651,0x3f72d4eb,0x3f456439,0x3efafef7,0x3e1324ca
.long 0x3f800000,0x3f800000,0x3f800000,0x3f800000,0x3f7e2b72,0x3f7d57de,0x3f7c5d3a,0x3f7b3bab
.long 0x3f78b47b,0x3f756d97,0x3f718f57,0x3f6d1c1d,0x3f6faf1b,0x3f686b39,0x3f5fe4e9,0x3f5627fe
.long 0x3f633c5a,0x3f5695e5,0x3f47de65,0x3f373a23,0x3f5389c7,0x3f404c5c,0x3f2a2a80,0x3f11796b
.long 0x3f40d0da,0x3f26050a,0x3f07a136,0x3ecc9b8b,0x3f2b561b,0x3f084b92,0x3ec27b55,0x3e5d4b1a
.long 0x3f13682a,0x3ecf7bca,0x3e605c13,0x3cc90ab0,0x3ef2bd43,0x3e8a11f7,0x3d55880e,0xbe2bf804
.long 0x3ebb31a0,0x3e039502,0xbdee3876,0xbeb554ec,0x3e80f8c0,0xbc7b514b,0xbe901c2c,0xbf06f686
.long 0x3e09cf86,0xbe22abb6,0xbee0924f,0xbf2e3bde,0x3c7b514b,0xbe9920fe,0xbf1553b7,0xbf4f0417
.long 0xbdd53db9,0xbeddbe79,0xbf36206c,0xbf6816a8,0xbe636c83,0xbf0ee0db,0xbf51c0c2,0xbf788486
.long 0x3f800000,0x3f800000,0x3f800000,0x3f800000,0x3f79f35e,0x3f788486,0x3f76ef5b,0x3f75341d
.long 0x3f6816a8,0x3f628210,0x3f5c61c7,0x3f55b993,0x3f4b41fa,0x3f3f41fc,0x3f3238aa,0x3f24381a
.long 0x3f24d225,0x3f10d3cd,0x3ef6e0cb,0x3ec9b953,0x3eed3063,0x3eb3dca5,0x3e6fa8b2,0x3de7fa9a
.long 0x3e8586ce,0x3dee3876,0xbcfb49ba,0xbe354098,0x3d3c6dd5,0xbe007745,0xbe9620d2,0xbee79a5d
.long 0xbe2f10a2,0xbeb8442a,0xbf08f59b,0xbf3085bb,0xbec27b55,0xbf12c39a,0xbf3d27b8,0xbf5e5aa6
.long 0xbf121eb0,0xbf40d0da,0xbf63f473,0xbf796e4e,0xbf3c17d9,0xbf6398ac,0xbf7a9c59,0xbf7f7808
.long 0xbf5d2d53,0xbf791298,0xbf7f84ab,0xbf6ff573,0xbf73ced9,0xbf7ffd39,0xbf725470,0xbf4c3578
.long 0xbf7eea9d,0xbf77f110,0xbf53fac3,0xbf173c07,0xbf7dfa38,0xbf61668a,0xbf269de3,0xbeab0201
.long 0x3f800000,0x3f800000,0x3f800000,0x3f800000,0x3f73530e,0x3f714c7a,0x3f6f20b0,0x3f6cd007
.long 0x3f4e8d90,0x3f46e22a,0x3f3ebc1b,0x3f36206c,0x3f1553b7,0x3f05a02c,0x3eea6681,0x3ec8477c
.long 0x3e9aa086,0x3e541501,0x3de1bc2e,0x3c490e90,0xbc16cb58,0xbe06b26e,0xbe80f8c0,0xbebca7af
.long 0xbea395c5,0xbee900b7,0xbf14b039,0xbf31a81d,0xbf19210f,0xbf39f2ac,0xbf554aa4,0xbf6a5ad9
.long 0xbf514d3d,0xbf6a09a7,0xbf79c79d,0xbf7fec43,0xbf74bf62,0xbf7f3f54,0xbf7d57de,0xbf6f20b0
.long 0xbf7ff4e6,0xbf772417,0xbf5f8327,0xbf3a7ca4,0xbf71d19f,0xbf52a649,0xbf24381a,0xbed3c867
.long 0xbf4bbbf8,0xbf15f6d9,0xbea68f12,0xbd16c32c,0xbf11796b,0xbe901c2c,0x3d0a342f,0x3eb0eacb
.long 0xbe919ddd,0x3d621469,0x3ec6d529,0x3f2d1469,0x3ce22a7a,0x3ec5625c,0x3f311722,0x3f67c187
.long 0x0,0x0,0x0,0x0,0x3cafea69,0x3d3c6dd5,0x3d9064b4,0x3dc27c39
.long 0x3d2fe007,0x3dbc3ac3,0x3e1008b7,0x3e419b37,0x3d83db0a,0x3e0cec4a,0x3e57278f,0x3e901c2c
.long 0x3dafb680,0x3e3b6ecf,0x3e8e9a22,0x3ebe1d4a,0x3ddb7d37,0x3e698bba,0x3eb0eacb,0x3eea6681
.long 0x3e039502,0x3e8b9507,0x3ed25a09,0x3f0a48ad,0x3e195be0,0x3ea21887,0x3ef2bd43,0x3f1e1e22
.long 0x3e2f10a2,0x3eb8442a,0x3f08f59b,0x3f3085bb,0x3e44b0b9,0x3ece0bea,0x3f17de12,0x3f4154e1
.long 0x3e5a3997,0x3ee363fa,0x3f26050a,0x3f5064af,0x3e6fa8b2,0x3ef840c8,0x3f33587a,0x3f5d924d
.long 0x3e827dc0,0x3f064b82,0x3f3fc767,0x3f68bf3c,0x3e8d17c0,0x3f102dd5,0x3f4b41fa,0x3f71d19f
.long 0x3e97a117,0x3f19c200,0x3f55b993,0x3f78b47b,0x3ea21887,0x3f2302d3,0x3f5f20db,0x3f7d57de
.long 0x0,0x0,0x0,0x0,0x3df475c0,0x3e1324ca,0x3e2bf804,0x3e44b0b9
.long 0x3e72b651,0x3e919ddd,0x3ea986c4,0x3ec1071e,0x3eb3dca5,0x3ed6a399,0x3ef840c8,0x3f0c42c9
.long 0x3eebcbbb,0x3f0b9a6b,0x3f1ff6cb,0x3f32c8c9,0x3f102dd5,0x3f28fd41,0x3f3f41fc,0x3f52a649
.long 0x3f286605,0x3f42de29,0x3f591e6a,0x3f6aab7b,0x3f3e35c5,0x3f58b3a1,0x3f6cd007,0x3f79f35e
.long 0x3f514d3d,0x3f6a09a7,0x3f79c79d,0x3f7fec43,0x3f61668a,0x3f76841b,0x3f7fa6e3,0x3f7c5d3a
.long 0x3f6e46be,0x3f7de0b1,0x3f7e4323,0x3f6f6830,0x3f77beb7,0x3f7ff84a,0x3f75a67b,0x3f5988ad
.long 0x3f7dabcc,0x3f7cbfc9,0x3f660f88,0x3f3b8f3b,0x3f7ff84a,0x3f74484b,0x3f4fefa8,0x3f16999f
.long 0x3f7e9bc9,0x3f66becc,0x3f33e7bc,0x3ed8106b,0x3f799b43,0x3f546b3b,0x3f12c39a,0x3e75c35a
.long 0x0,0x0,0x0,0x0,0x3e5d4b1a,0x3e75c35a,0x3e870ada,0x3e931f35
.long 0x3ed8106b,0x3eee9479,0x3f0242b1,0x3f0cead0,0x3f1ba299,0x3f2a2a80,0x3f37c655,0x3f446337
.long 0x3f43e200,0x3f531849,0x3f604621,0x3f6b4b0c,0x3f62df7b,0x3f6faf1b,0x3f78e3d6,0x3f7e5a38
.long 0x3f772417,0x3f7e4323,0x3f7fe129,0x3f7bf531,0x3f7fba9e,0x3f7dfa38,0x3f74bf62,0x3f644fac
.long 0x3f7c3b28,0x3f6ed89e,0x3f584853,0x3f396842,0x3f6cd007,0x3f51c0c2,0x3f2c800f,0x3efdbabb
.long 0x3f5233c6,0x3f286605,0x3ee900b7,0x3e667c66,0x3f2da859,0x3eea6681,0x3e5101f1,0xbd83db0a
.long 0x3f00e7e4,0x3e6c9a7f,0xbd7b2b74,0xbeb263ef,0x3e9c1faf,0xbc16cb58,0xbea5129f,0xbf1a6293
.long 0x3dbc3ac3,0xbe7ee6e1,0xbf0f8784,0xbf4e8d90,0xbe007745,0xbef2bd43,0xbf425b89,0xbf714c7a
.long 0x0,0x0,0x0,0x0,0x3e9f1cdf,0x3eab0201,0x3eb6ccc3,0x3ec27b55
.long 0x3f173c07,0x3f212ff9,0x3f2ac082,0x3f33e7bc,0x3f4fefa8,0x3f5a5ba0,0x3f6398ac,0x3f6b99fb
.long 0x3f740bdd,0x3f7a7302,0x3f7e70b0,0x3f7ffb11,0x3f7ffd39,0x3f7dc68c,0x3f77beb7,0x3f6dfcf2
.long 0x3f7294f8,0x3f63f473,0x3f5064af,0x3f385216,0x3f4d26fd,0x3f2ff3e6,0x3f0d9281,0x3ece0bea
.long 0x3f13682a,0x3ecf7bca,0x3e605c13,0x3cc90ab0,0x3e9620d2,0x3d9cecf9,0xbe1324ca,0xbeb6ccc3
.long 0xbc96c9b6,0xbe8586ce,0xbef9a02d,0xbf2f61a5,0xbea80b1f,0xbf11796b,0xbf446337,0xbf6912ae
.long 0xbf1b02c6,0xbf4f7a1f,0xbf721352,0xbf7fd397,0xbf52a649,0xbf75a67b,0xbf7fdaaf,0xbf703b37
.long 0xbf756d97,0xbf7f9c18,0xbf6be858,0xbf3ca003,0xbf7fe705,0xbf6c3624,0xbf38dd65,0xbed97cb9
.long 0x3f803f80,0x3f803f80,0x80008000,0x80008000,0x3f3e3f71,0x3d493edb,0xbf2cbeac,0xbf80bf67
.long 0x3dc93f46,0xbf7fbf22,0xbf7fbf22,0xbdc9bf46,0xbf183f04,0xbe16bf78,0xbf4ebf5c,0x3f7d3e79
.long 0xbf7b3e48,0x3f7bbe48,0xbe48bf7b,0x3e483f7b,0xbf5cbe16,0x3e793f4e,0x3f04bf7d,0xbf783f18
.long 0xbe95bef1,0xbf753f62,0x3f75bf62,0xbe95bef1,0x3edbbf3e,0xbeacbd49,0x3f67bf2c,0x3f71bf80
.long 0x3f6dbf6d,0x3f6dbf6d,0x3ec4bec4,0x3ec4bec4,0x3f71bf80,0x3edbbf3e,0xbeacbd49,0xbf673f2c
.long 0x3ef1bf75,0xbf623e95,0xbf623e95,0xbef13f75,0xbe79bf4e,0xbf043f7d,0xbf783f18,0x3f5c3e16
.long 0xbf55bf0e,0x3f553f0e,0xbf0e3f55,0x3f0ebf55,0xbf7dbe79,0x3f18bf04,0x3e163f78,0xbf4ebf5c
.long 0xbf223dc9,0xbf46bf7f,0x3f463f7f,0xbf223dc9,0x3d493edb,0xbf2cbeac,0x3f803f67,0x3f3e3f71
.long 0x3f803f80,0x3f803f80,0x80008000,0x80008000,0xbf2cbeac,0xbf80bf67,0xbf3ebf71,0xbd49bedb
.long 0xbdc9bf46,0x3f7f3f22,0x3f7f3f22,0x3dc93f46,0x3f4e3f5c,0xbf7dbe79,0xbf183f04,0xbe16bf78
.long 0xbf7b3e48,0x3f7bbe48,0xbe48bf7b,0x3e483f7b,0x3f04bf7d,0xbf783f18,0x3f5c3e16,0xbe79bf4e
.long 0x3e953ef1,0x3f75bf62,0xbf753f62,0x3e953ef1,0xbf673f2c,0xbf713f80,0x3edbbf3e,0xbeacbd49
.long 0x3f6dbf6d,0x3f6dbf6d,0x3ec4bec4,0x3ec4bec4,0xbeacbd49,0xbf673f2c,0xbf713f80,0xbedb3f3e
.long 0xbef13f75,0x3f62be95,0x3f62be95,0x3ef1bf75,0x3f78bf18,0xbf5cbe16,0xbe79bf4e,0xbf043f7d
.long 0xbf55bf0e,0x3f553f0e,0xbf0e3f55,0x3f0ebf55,0x3e163f78,0xbf4ebf5c,0x3f7d3e79,0xbf183f04
.long 0x3f22bdc9,0x3f463f7f,0xbf46bf7f,0x3f22bdc9,0xbf80bf67,0xbf3ebf71,0x3d493edb,0xbf2cbeac
.long 0x3f803f80,0x3f803f80,0x80008000,0x80008000,0xbf3ebf71,0xbd49bedb,0x3f2c3eac,0x3f803f67
.long 0x3dc93f46,0xbf7fbf22,0xbf7fbf22,0xbdc9bf46,0x3f18bf04,0x3e163f78,0x3f4e3f5c,0xbf7dbe79
.long 0xbf7b3e48,0x3f7bbe48,0xbe48bf7b,0x3e483f7b,0x3f5c3e16,0xbe79bf4e,0xbf043f7d,0x3f78bf18
.long 0xbe95bef1,0xbf753f62,0x3f75bf62,0xbe95bef1,0xbedb3f3e,0x3eac3d49,0xbf673f2c,0xbf713f80
.long 0x3f6dbf6d,0x3f6dbf6d,0x3ec4bec4,0x3ec4bec4,0xbf713f80,0xbedb3f3e,0x3eac3d49,0x3f67bf2c
.long 0x3ef1bf75,0xbf623e95,0xbf623e95,0xbef13f75,0x3e793f4e,0x3f04bf7d,0x3f78bf18,0xbf5cbe16
.long 0xbf55bf0e,0x3f553f0e,0xbf0e3f55,0x3f0ebf55,0x3f7d3e79,0xbf183f04,0xbe16bf78,0x3f4e3f5c
.long 0xbf223dc9,0xbf46bf7f,0x3f463f7f,0xbf223dc9,0xbd49bedb,0x3f2c3eac,0xbf80bf67,0xbf3ebf71
.long 0x3f803f80,0x3f803f80,0x80008000,0x80008000,0x3f2c3eac,0x3f803f67,0x3f3e3f71,0x3d493edb
.long 0xbdc9bf46,0x3f7f3f22,0x3f7f3f22,0x3dc93f46,0xbf4ebf5c,0x3f7d3e79,0x3f18bf04,0x3e163f78
.long 0xbf7b3e48,0x3f7bbe48,0xbe48bf7b,0x3e483f7b,0xbf043f7d,0x3f78bf18,0xbf5cbe16,0x3e793f4e
.long 0x3e953ef1,0x3f75bf62,0xbf753f62,0x3e953ef1,0x3f67bf2c,0x3f71bf80,0xbedb3f3e,0x3eac3d49
.long 0x3f6dbf6d,0x3f6dbf6d,0x3ec4bec4,0x3ec4bec4,0x3eac3d49,0x3f67bf2c,0x3f71bf80,0x3edbbf3e
.long 0xbef13f75,0x3f62be95,0x3f62be95,0x3ef1bf75,0xbf783f18,0x3f5c3e16,0x3e793f4e,0x3f04bf7d
.long 0xbf55bf0e,0x3f553f0e,0xbf0e3f55,0x3f0ebf55,0xbe16bf78,0x3f4e3f5c,0xbf7dbe79,0x3f18bf04
.long 0x3f22bdc9,0x3f463f7f,0xbf46bf7f,0x3f22bdc9,0x3f803f67,0x3f3e3f71,0xbd49bedb,0x3f2c3eac
.long 0x0,0x0,0x3f803f80,0x3f803f80,0x3f2c3eac,0x3f803f67,0x3f3e3f71,0x3d493edb
.long 0x3f7f3f22,0x3dc93f46,0x3dc93f46,0xbf7fbf22,0x3f4e3f5c,0xbf7dbe79,0xbf183f04,0xbe16bf78
.long 0x3e483f7b,0xbe48bf7b,0xbf7b3e48,0x3f7bbe48,0xbf043f7d,0x3f78bf18,0xbf5cbe16,0x3e793f4e
.long 0xbf753f62,0x3e953ef1,0xbe95bef1,0xbf753f62,0xbf673f2c,0xbf713f80,0x3edbbf3e,0xbeacbd49
.long 0xbec43ec4,0xbec43ec4,0x3f6dbf6d,0x3f6dbf6d,0x3eac3d49,0x3f67bf2c,0x3f71bf80,0x3edbbf3e
.long 0x3f62be95,0x3ef1bf75,0x3ef1bf75,0xbf623e95,0x3f78bf18,0xbf5cbe16,0xbe79bf4e,0xbf043f7d
.long 0x3f0ebf55,0xbf0e3f55,0xbf55bf0e,0x3f553f0e,0xbe16bf78,0x3f4e3f5c,0xbf7dbe79,0x3f18bf04
.long 0xbf46bf7f,0x3f22bdc9,0xbf223dc9,0xbf46bf7f,0xbf80bf67,0xbf3ebf71,0x3d493edb,0xbf2cbeac
.long 0x0,0x0,0x3f803f80,0x3f803f80,0x3f3e3f71,0x3d493edb,0xbf2cbeac,0xbf80bf67
.long 0xbf7fbf22,0xbdc9bf46,0xbdc9bf46,0x3f7f3f22,0x3f18bf04,0x3e163f78,0x3f4e3f5c,0xbf7dbe79
.long 0x3e483f7b,0xbe48bf7b,0xbf7b3e48,0x3f7bbe48,0xbf5cbe16,0x3e793f4e,0x3f04bf7d,0xbf783f18
.long 0x3f75bf62,0xbe95bef1,0x3e953ef1,0x3f75bf62,0xbedb3f3e,0x3eac3d49,0xbf673f2c,0xbf713f80
.long 0xbec43ec4,0xbec43ec4,0x3f6dbf6d,0x3f6dbf6d,0x3f71bf80,0x3edbbf3e,0xbeacbd49,0xbf673f2c
.long 0xbf623e95,0xbef13f75,0xbef13f75,0x3f62be95,0x3e793f4e,0x3f04bf7d,0x3f78bf18,0xbf5cbe16
.long 0x3f0ebf55,0xbf0e3f55,0xbf55bf0e,0x3f553f0e,0xbf7dbe79,0x3f18bf04,0x3e163f78,0xbf4ebf5c
.long 0x3f463f7f,0xbf223dc9,0x3f22bdc9,0x3f463f7f,0xbd49bedb,0x3f2c3eac,0xbf80bf67,0xbf3ebf71
.long 0x0,0x0,0x3f803f80,0x3f803f80,0xbf2cbeac,0xbf80bf67,0xbf3ebf71,0xbd49bedb
.long 0x3f7f3f22,0x3dc93f46,0x3dc93f46,0xbf7fbf22,0xbf4ebf5c,0x3f7d3e79,0x3f18bf04,0x3e163f78
.long 0x3e483f7b,0xbe48bf7b,0xbf7b3e48,0x3f7bbe48,0x3f04bf7d,0xbf783f18,0x3f5c3e16,0xbe79bf4e
.long 0xbf753f62,0x3e953ef1,0xbe95bef1,0xbf753f62,0x3f67bf2c,0x3f71bf80,0xbedb3f3e,0x3eac3d49
.long 0xbec43ec4,0xbec43ec4,0x3f6dbf6d,0x3f6dbf6d,0xbeacbd49,0xbf673f2c,0xbf713f80,0xbedb3f3e
.long 0x3f62be95,0x3ef1bf75,0x3ef1bf75,0xbf623e95,0xbf783f18,0x3f5c3e16,0x3e793f4e,0x3f04bf7d
.long 0x3f0ebf55,0xbf0e3f55,0xbf55bf0e,0x3f553f0e,0x3e163f78,0xbf4ebf5c,0x3f7d3e79,0xbf183f04
.long 0xbf46bf7f,0x3f22bdc9,0xbf223dc9,0xbf46bf7f,0x3f803f67,0x3f3e3f71,0xbd49bedb,0x3f2c3eac
.long 0x0,0x0,0x3f803f80,0x3f803f80,0xbf3ebf71,0xbd49bedb,0x3f2c3eac,0x3f803f67
.long 0xbf7fbf22,0xbdc9bf46,0xbdc9bf46,0x3f7f3f22,0xbf183f04,0xbe16bf78,0xbf4ebf5c,0x3f7d3e79
.long 0x3e483f7b,0xbe48bf7b,0xbf7b3e48,0x3f7bbe48,0x3f5c3e16,0xbe79bf4e,0xbf043f7d,0x3f78bf18
.long 0x3f75bf62,0xbe95bef1,0x3e953ef1,0x3f75bf62,0x3edbbf3e,0xbeacbd49,0x3f67bf2c,0x3f71bf80
.long 0xbec43ec4,0xbec43ec4,0x3f6dbf6d,0x3f6dbf6d,0xbf713f80,0xbedb3f3e,0x3eac3d49,0x3f67bf2c
.long 0xbf623e95,0xbef13f75,0xbef13f75,0x3f62be95,0xbe79bf4e,0xbf043f7d,0xbf783f18,0x3f5c3e16
.long 0x3f0ebf55,0xbf0e3f55,0xbf55bf0e,0x3f553f0e,0x3f7d3e79,0xbf183f04,0xbe16bf78,0x3f4e3f5c
.long 0x3f463f7f,0xbf223dc9,0x3f22bdc9,0x3f463f7f,0x3d493edb,0xbf2cbeac,0x3f803f67,0x3f3e3f71
.size L_tables, 100352
.section .rodata,"a"
.p2align 6
.amdhsa_kernel concat_heads__grouped_kv_mqa__spectral_gfnet__prompt_kernel
  .amdhsa_next_free_vgpr 168
  .amdhsa_next_free_sgpr 96
  .amdhsa_accum_offset 168
  .amdhsa_group_segment_fixed_size 0
  .amdhsa_kernarg_size 88
  .amdhsa_user_sgpr_count 2
  .amdhsa_user_sgpr_kernarg_segment_ptr 1
  .amdhsa_system_sgpr_workgroup_id_x 1
.end_amdhsa_kernel
```
